```python
import torch

def _softmax(x, axis=-1):
    return torch.softmax(x, dim=axis)
def _gelu(x):
    return torch.nn.functional.gelu(x, approximate="tanh")
def _silu(x):
    return torch.nn.functional.silu(x)
def _sigmoid(x):
    return torch.sigmoid(x)
def _layernorm(x, axis=-1, eps=1e-5):
    m = x.mean(dim=axis, keepdim=True)
    v = x.var(dim=axis, keepdim=True, unbiased=False)
    return (x - m) / torch.sqrt(v + eps)
def _scatter_add(tgt, idx, src, axis=0):
    return tgt.clone().index_add_(axis, idx, src)
def _segment_sum(src, seg, n):
    out = torch.zeros((n,) + src.shape[1:], dtype=src.dtype)
    return out.index_add_(0, seg, src)
def _pad(x, pw):
    flat = tuple(v for pair in reversed(pw) for v in pair)
    return torch.nn.functional.pad(x, flat)

kernel_name = 'standalone__mha_block_cached__near_ridge'

def setup_inputs():

    _w = (lambda a: (lambda t: t.to(torch.bfloat16) if t.is_floating_point() else t)(torch.as_tensor(a)))
    B, Sq, D = 8, 192, 512
    H, Sk, Dh = 32, 2048, 128
    return {
        "x": _w((lambda *s: torch.randn(*s, dtype=torch.bfloat16) * 0.8)(B, Sq, D)),
        "k_cache": _w((lambda *s: torch.randn(*s, dtype=torch.bfloat16) * 0.8)(B, H, Sk, Dh)),
        "v_cache": _w((lambda *s: torch.randn(*s, dtype=torch.bfloat16) * 0.05)(B, H, Sk, Dh)),
        "wq": _w((lambda *s: torch.randn(*s, dtype=torch.bfloat16) * 0.8)(D, H * Dh) * (D ** -0.5)),
        "wo": _w((lambda *s: torch.randn(*s, dtype=torch.bfloat16) * 0.05)(H * Dh, D) * ((H * Dh) ** -0.5)),
    }

def reference(x, k_cache, v_cache, wq, wo):
    B, Sq, D = x.shape
    H, Dh = 32, 128
    q = (lambda x, *d: x.permute(*d))((x @ wq).reshape(B, Sq, H, Dh), 0, 2, 1, 3)
    scores = torch.einsum("bhqd,bhkd->bhqk", q, k_cache) * (Dh ** -0.5)
    p = _softmax(scores, axis=-1)
    o = torch.einsum("bhqk,bhkd->bhqd", p, v_cache)
    return (lambda x, *d: x.permute(*d))(o, 0, 2, 1, 3).reshape(B, Sq, H * Dh) @ wo
```

```asm
; @launch grid=(256,1,1) block=(256,1,1) lds=163840
.amdgcn_target "amdgcn-amd-amdhsa--gfx950"
.text
.globl standalone__mha_block_cached__near_ridge_kernel
.p2align 8
.type standalone__mha_block_cached__near_ridge_kernel,@function
standalone__mha_block_cached__near_ridge_kernel:
s_cmp_ge_u32 s2, 256
s_cbranch_scc1 L_end
s_load_dwordx8 s[40:47], s[0:1], 0
s_load_dwordx8 s[48:55], s[0:1], 32
v_lshrrev_b32 v1, 6, v0
v_and_b32 v27, 63, v0
v_readfirstlane_b32 s56, v1
s_and_b32 s3, s2, 7
s_lshr_b32 s4, s2, 3
s_and_b32 s57, s4, 7
s_lshr_b32 s5, s4, 3
s_lshl_b32 s58, s3, 2
s_add_u32 s58, s58, s5
s_lshr_b32 s5, s4, 2
s_lshr_b32 s58, s3, 1
s_lshl_b32 s58, s58, 3
s_add_u32 s58, s58, s5
s_and_b32 s57, s3, 1
s_lshl_b32 s57, s57, 2
s_and_b32 s6, s4, 3
s_add_u32 s57, s57, s6
s_add_u32 s62, s5, s57
s_and_b32 s62, s62, 3
s_lshl_b32 s62, s62, 1
s_lshl_b32 s65, s56, 12
s_mul_i32 s66, s56, 49152
s_lshl_b32 s67, s56, 17
s_mul_i32 s77, s56, 18432
v_lshrrev_b32 v1, 3, v27
v_and_b32 v2, 7, v27
v_lshrrev_b32 v3, 1, v1
v_xor_b32 v3, v3, v2
v_lshlrev_b32 v3, 4, v3
v_lshl_add_u32 v3, v1, 10, v3
v_xor_b32 v4, 64, v3
v_add_u32 v246, 0, v3
v_add_u32 v247, 7168, v4
v_add_u32 v248, 14336, v3
v_add_u32 v249, 21504, v4
v_add_u32 v250, 32768, v3
v_add_u32 v251, 39936, v4
v_lshrrev_b32 v1, 4, v27
v_and_b32 v2, 15, v27
v_and_b32 v3, 1, v1
v_and_b32 v4, 2, v1
v_lshl_or_b32 v3, v4, 1, v3
v_xor_b32 v3, v3, v2
v_lshlrev_b32 v3, 4, v3
v_lshl_add_u32 v3, v1, 13, v3
v_xor_b32 v4, 128, v3
v_add_u32 v252, 0, v3
v_add_u32 v253, 31744, v3
v_add_u32 v254, 63488, v4
v_add_u32 v255, 95232, v4
s_waitcnt lgkmcnt(0)
s_mul_i32 s6, s57, 196608
s_add_u32 s16, s40, s6
s_addc_u32 s17, s41, 0
s_mov_b32 s18, 196608
s_mov_b32 s19, 0x20000
s_lshl_b32 s6, s58, 8
s_add_u32 s20, s46, s6
s_addc_u32 s21, s47, 0
s_sub_u32 s22, 4194304, s6
s_mov_b32 s23, 0x20000
s_lshl_b32 s63, s62, 7
s_add_u32 s63, s63, s66
s_lshl_b32 s64, s62, 19
s_add_u32 s64, s64, s67
s_add_u32 m0, s65, 32768
s_add_u32 s62, s62, 1
buffer_load_dwordx4 v252, s[20:23], s64 offen lds
buffer_load_dwordx4 v253, s[20:23], s64 offen offset:1024 lds
buffer_load_dwordx4 v254, s[20:23], s64 offen offset:2048 lds
buffer_load_dwordx4 v255, s[20:23], s64 offen offset:3072 lds
s_add_u32 m0, s77, 81920
s_and_b32 s62, s62, 7
buffer_load_dwordx4 v246, s[16:19], s63 offen lds
buffer_load_dwordx4 v247, s[16:19], s63 offen offset:1024 lds
buffer_load_dwordx4 v248, s[16:19], s63 offen offset:2048 lds
buffer_load_dwordx4 v249, s[16:19], s63 offen offset:3072 lds
s_add_u32 m0, s77, 86016
s_nop 0
buffer_load_dwordx4 v250, s[16:19], s63 offen lds
buffer_load_dwordx4 v251, s[16:19], s63 offen offset:1024 lds
s_getpc_b64 s[6:7]
L_pc:
s_sub_u32 s6, s6, L_pc-standalone__mha_block_cached__near_ridge_kernel
s_subb_u32 s7, s7, 0
s_lshl_b32 s100, s4, 2
s_add_u32 s100, s100, s56
s_lshl_b32 s100, s100, 10
v_lshlrev_b32 v3, 7, v27
v_add_u32 v3, s100, v3
v_cmp_gt_u32 vcc, L_codeend-standalone__mha_block_cached__near_ridge_kernel, v3
s_mov_b64 exec, 0xff
s_and_b64 exec, exec, vcc
s_cbranch_execz L_nopfc
global_load_dword v0, v3, s[6:7]
L_nopfc:
s_mov_b64 exec, -1
s_and_b32 s6, s4, 3
s_and_b32 s7, s3, 1
s_lshl_b32 s7, s7, 2
s_add_u32 s61, s7, s6
s_lshr_b32 s7, s4, 2
s_mov_b32 s6, 0
s_mul_i32 s78, s7, 4
s_add_u32 s78, s6, s78
s_and_b32 s78, s78, 7
s_and_b32 s5, s7, 3
s_lshr_b32 s7, s7, 2
s_and_b32 s3, s3, 6
s_add_u32 s3, s3, s7
s_lshl_b32 s6, s57, 5
s_add_u32 s6, s6, s58
s_lshl_b32 s7, s6, 19
s_lshr_b32 s6, s6, 13
s_add_u32 s8, s42, s7
s_addc_u32 s9, s43, s6
s_mov_b32 s10, 524288
s_mov_b32 s11, 0x20000
s_add_u32 s12, s44, s7
s_addc_u32 s13, s45, s6
s_mov_b32 s14, 524288
s_mov_b32 s15, 0x20000
s_lshl_b32 s6, s61, 7
s_add_u32 s24, s48, s6
s_addc_u32 s25, s49, 0
s_sub_u32 s26, 4194304, s6
s_mov_b32 s27, 0x20000
s_lshl_b32 s6, s57, 2
s_add_u32 s6, s6, s56
s_lshl_b32 s7, s6, 5
s_add_u32 s7, s7, s58
s_mul_i32 s7, s7, 12288
s_add_u32 s28, s54, s7
s_addc_u32 s29, s55, 0
s_mov_b32 s30, 12288
s_mov_b32 s31, 0x20000
s_lshl_b32 s6, s6, 2
s_lshr_b32 s7, s58, 3
s_add_u32 s6, s6, s7
s_lshl_b32 s6, s6, 7
s_and_b32 s7, s58, 7
s_lshl_b32 s7, s7, 3
s_add_u32 s6, s6, s7
s_add_u32 s6, s6, 25165824
s_add_u32 s70, s54, s6
s_addc_u32 s71, s55, 0
s_lshl_b32 s6, s3, 2
s_add_u32 s6, s6, s5
s_lshl_b32 s6, s6, 2
s_add_u32 s6, s6, s56
s_mul_i32 s7, s6, 98304
s_add_u32 s32, s54, s7
s_addc_u32 s33, s55, 0
s_mov_b32 s34, 98304
s_mov_b32 s35, 0x20000
s_lshl_b32 s6, s6, 7
s_add_u32 s6, s6, 25165824
s_add_u32 s72, s54, s6
s_addc_u32 s73, s55, 0
s_mul_i32 s6, s3, 196608
s_mul_i32 s7, s5, 49152
s_add_u32 s6, s6, s7
s_lshl_b32 s7, s61, 7
s_add_u32 s6, s6, s7
s_add_u32 s36, s50, s6
s_addc_u32 s37, s51, 0
s_mov_b32 s38, 48256
s_mov_b32 s39, 0x20000
s_mov_b32 s74, 0
s_lshl_b32 s98, s56, 10
s_lshr_b32 s98, s2, 3
s_mul_i32 s98, s98, 11
s_lshr_b32 s98, s98, 0
s_and_b32 s98, s98, 31
s_lshl_b32 s98, s98, 14
s_add_u32 s98, s98, s65
s_mov_b32 s59, s98
s_mov_b32 s60, s98
s_or_b32 s6, s2, s56
s_cmp_lg_u32 s6, 0
s_cbranch_scc1 L_nononce
s_memrealtime s[6:7]
s_waitcnt lgkmcnt(0)
s_or_b32 s6, s6, 1
s_xor_b32 s7, s7, 0x5ca1ab1e
v_mov_b32 v4, s6
v_mov_b32 v5, s7
v_mov_b32 v3, 0
global_store_dwordx2 v3, v[4:5], s[52:53] sc1
L_nononce:
v_xor_b32 v3, v1, v2
v_lshlrev_b32 v3, 4, v3
v_lshl_add_u32 v3, v2, 8, v3
v_xor_b32 v8, 0, v3
v_xor_b32 v9, 64, v3
v_xor_b32 v10, 128, v3
v_xor_b32 v11, 192, v3
v_xor_b32 v3, v1, v2
v_lshlrev_b32 v3, 4, v3
v_lshl_add_u32 v3, v1, 8, v3
v_xor_b32 v20, 0, v3
v_xor_b32 v21, 64, v3
v_xor_b32 v22, 128, v3
v_xor_b32 v23, 192, v3
v_lshlrev_b32 v3, 1, v1
v_xor_b32 v3, v3, v2
v_lshlrev_b32 v3, 4, v3
v_lshl_add_u32 v24, v1, 8, v3
v_xor_b32 v25, 128, v24
v_lshrrev_b32 v4, 2, v2
v_and_b32 v5, 3, v27
v_lshl_add_u32 v6, v1, 2, v4
v_and_b32 v3, 7, v6
v_lshlrev_b32 v3, 1, v3
v_lshrrev_b32 v7, 1, v5
v_xor_b32 v3, v3, v7
v_lshlrev_b32 v3, 4, v3
v_lshl_add_u32 v3, v6, 8, v3
v_and_b32 v7, 1, v5
v_lshl_add_u32 v3, v7, 3, v3
v_add_u32 v3, 65536, v3
v_xor_b32 v12, 0, v3
v_xor_b32 v13, 32, v3
v_xor_b32 v14, 64, v3
v_xor_b32 v15, 96, v3
v_xor_b32 v16, 128, v3
v_xor_b32 v17, 160, v3
v_xor_b32 v18, 192, v3
v_xor_b32 v19, 224, v3
v_lshrrev_b32 v3, 1, v2
v_xor_b32 v3, v3, v1
v_lshlrev_b32 v3, 4, v3
v_lshl_add_u32 v3, v2, 7, v3
v_xor_b32 v7, 64, v3
s_add_u32 s6, s77, 81920
v_add_u32 v236, s6, v3
v_add_u32 v237, s6, v7
v_and_b32 v3, 1, v4
v_and_b32 v7, 2, v4
v_lshl_or_b32 v3, v7, 1, v3
v_and_b32 v7, 1, v1
v_lshl_or_b32 v3, v7, 3, v3
v_xor_b32 v3, v3, v5
v_lshlrev_b32 v3, 4, v3
v_lshl_add_u32 v7, v1, 3, v4
v_lshl_add_u32 v3, v7, 8, v3
v_and_b32 v7, 1, v5
v_lshl_add_u32 v3, v7, 3, v3
v_add_u32 v3, 32768, v3
v_xor_b32 v238, 0, v3
v_xor_b32 v239, 8, v3
v_xor_b32 v240, 64, v3
v_xor_b32 v241, 72, v3
v_xor_b32 v242, 128, v3
v_xor_b32 v243, 136, v3
v_xor_b32 v244, 192, v3
v_xor_b32 v245, 200, v3
v_lshrrev_b32 v3, 3, v27
v_and_b32 v7, 6, v3
v_and_b32 v6, 7, v27
v_xor_b32 v7, v7, v6
v_lshlrev_b32 v7, 4, v7
v_lshl_add_u32 v3, v3, 10, v7
v_add_u32 v28, 0, v3
v_add_u32 v29, 7168, v3
v_add_u32 v30, 14336, v3
v_add_u32 v31, 21504, v3
v_lshlrev_b32 v26, 4, v27
s_lshl_b32 s79, s56, 20
s_lshl_b32 s75, s78, 17
s_or_b32 s75, s75, s79
v_mov_b32 v3, 0x3f803f80
v_accvgpr_write_b32 a60, v3
v_accvgpr_write_b32 a61, v3
v_accvgpr_write_b32 a62, v3
v_accvgpr_write_b32 a63, v3
v_mov_b32 v3, 0
v_mov_b32 v4, 163776
ds_write_b32 v4, v3
s_lshl_b32 s63, s62, 7
s_add_u32 s63, s63, s66
s_lshl_b32 s64, s62, 19
s_add_u32 s64, s64, s67
s_add_u32 m0, s65, 49152
s_add_u32 s62, s62, 1
buffer_load_dwordx4 v252, s[20:23], s64 offen lds
buffer_load_dwordx4 v253, s[20:23], s64 offen offset:1024 lds
buffer_load_dwordx4 v254, s[20:23], s64 offen offset:2048 lds
buffer_load_dwordx4 v255, s[20:23], s64 offen offset:3072 lds
s_add_u32 m0, s77, 88064
s_and_b32 s62, s62, 7
buffer_load_dwordx4 v246, s[16:19], s63 offen lds
buffer_load_dwordx4 v247, s[16:19], s63 offen offset:1024 lds
buffer_load_dwordx4 v248, s[16:19], s63 offen offset:2048 lds
buffer_load_dwordx4 v249, s[16:19], s63 offen offset:3072 lds
s_add_u32 m0, s77, 92160
s_nop 0
buffer_load_dwordx4 v250, s[16:19], s63 offen lds
buffer_load_dwordx4 v251, s[16:19], s63 offen offset:1024 lds
s_waitcnt vmcnt(10)
s_waitcnt lgkmcnt(0)
s_barrier
ds_read_b128 a[96:99], v236 offset:0
ds_read_b128 a[100:103], v236 offset:2048
ds_read_b128 a[104:107], v236 offset:4096
ds_read_b64_tr_b16 a[64:65], v238 offset:0
ds_read_b64_tr_b16 a[66:67], v238 offset:1024
ds_read_b64_tr_b16 a[68:69], v239 offset:0
ds_read_b64_tr_b16 a[70:71], v239 offset:1024
ds_read_b64_tr_b16 a[72:73], v240 offset:0
ds_read_b64_tr_b16 a[74:75], v240 offset:1024
ds_read_b64_tr_b16 a[76:77], v241 offset:0
ds_read_b64_tr_b16 a[78:79], v241 offset:1024
s_waitcnt lgkmcnt(4)
v_mfma_f32_16x16x32_bf16 v[140:143], a[64:67], a[96:99], 0
ds_read_b64_tr_b16 a[80:81], v242 offset:0
ds_read_b64_tr_b16 a[82:83], v242 offset:1024
v_mfma_f32_16x16x32_bf16 v[172:175], a[64:67], a[100:103], 0
s_lshl_b32 s63, s62, 7
s_add_u32 s63, s63, s66
s_lshl_b32 s64, s62, 19
s_add_u32 s64, s64, s67
v_mfma_f32_16x16x32_bf16 v[204:207], a[64:67], a[104:107], 0
s_add_u32 m0, s65, 65536
s_add_u32 s62, s62, 1
v_mfma_f32_16x16x32_bf16 v[144:147], a[68:71], a[96:99], 0
ds_read_b64_tr_b16 a[84:85], v243 offset:0
ds_read_b64_tr_b16 a[86:87], v243 offset:1024
v_mfma_f32_16x16x32_bf16 v[176:179], a[68:71], a[100:103], 0
ds_read_b128 a[108:111], v237 offset:0
buffer_load_dwordx4 v252, s[20:23], s64 offen lds
v_mfma_f32_16x16x32_bf16 v[208:211], a[68:71], a[104:107], 0
ds_read_b64_tr_b16 a[88:89], v244 offset:0
s_waitcnt lgkmcnt(6)
v_mfma_f32_16x16x32_bf16 v[148:151], a[72:75], a[96:99], 0
ds_read_b64_tr_b16 a[90:91], v244 offset:1024
ds_read_b128 a[112:115], v237 offset:2048
v_mfma_f32_16x16x32_bf16 v[180:183], a[72:75], a[100:103], 0
buffer_load_dwordx4 v253, s[20:23], s64 offen offset:1024 lds
v_mfma_f32_16x16x32_bf16 v[212:215], a[72:75], a[104:107], 0
ds_read_b64_tr_b16 a[92:93], v245 offset:0
v_mfma_f32_16x16x32_bf16 v[152:155], a[76:79], a[96:99], 0
ds_read_b64_tr_b16 a[94:95], v245 offset:1024
ds_read_b128 a[116:119], v237 offset:4096
v_mfma_f32_16x16x32_bf16 v[184:187], a[76:79], a[100:103], 0
buffer_load_dwordx4 v254, s[20:23], s64 offen offset:2048 lds
v_mfma_f32_16x16x32_bf16 v[216:219], a[76:79], a[104:107], 0
ds_read_b64_tr_b16 a[64:65], v238 offset:8192
s_waitcnt lgkmcnt(8)
v_mfma_f32_16x16x32_bf16 v[156:159], a[80:83], a[96:99], 0
ds_read_b64_tr_b16 a[66:67], v238 offset:9216
buffer_load_dwordx4 v255, s[20:23], s64 offen offset:3072 lds
v_mfma_f32_16x16x32_bf16 v[188:191], a[80:83], a[100:103], 0
v_mfma_f32_16x16x32_bf16 v[220:223], a[80:83], a[104:107], 0
ds_read_b64_tr_b16 a[68:69], v239 offset:8192
v_mfma_f32_16x16x32_bf16 v[160:163], a[84:87], a[96:99], 0
ds_read_b64_tr_b16 a[70:71], v239 offset:9216
v_mfma_f32_16x16x32_bf16 v[192:195], a[84:87], a[100:103], 0
s_add_u32 m0, s77, 94208
s_and_b32 s62, s62, 7
v_mfma_f32_16x16x32_bf16 v[224:227], a[84:87], a[104:107], 0
ds_read_b64_tr_b16 a[72:73], v240 offset:8192
s_waitcnt lgkmcnt(7)
v_mfma_f32_16x16x32_bf16 v[164:167], a[88:91], a[96:99], 0
buffer_load_dwordx4 v246, s[16:19], s63 offen lds
ds_read_b64_tr_b16 a[74:75], v240 offset:9216
v_mfma_f32_16x16x32_bf16 v[196:199], a[88:91], a[100:103], 0
v_mfma_f32_16x16x32_bf16 v[228:231], a[88:91], a[104:107], 0
ds_read_b64_tr_b16 a[76:77], v241 offset:8192
buffer_load_dwordx4 v247, s[16:19], s63 offen offset:1024 lds
s_waitcnt lgkmcnt(8)
v_mfma_f32_16x16x32_bf16 v[168:171], a[92:95], a[96:99], 0
ds_read_b64_tr_b16 a[78:79], v241 offset:9216
v_mfma_f32_16x16x32_bf16 v[200:203], a[92:95], a[100:103], 0
v_mfma_f32_16x16x32_bf16 v[232:235], a[92:95], a[104:107], 0
ds_read_b64_tr_b16 a[80:81], v242 offset:8192
s_waitcnt lgkmcnt(5)
v_mfma_f32_16x16x32_bf16 v[140:143], a[64:67], a[108:111], v[140:143]
buffer_load_dwordx4 v248, s[16:19], s63 offen offset:2048 lds
ds_read_b64_tr_b16 a[82:83], v242 offset:9216
v_mfma_f32_16x16x32_bf16 v[172:175], a[64:67], a[112:115], v[172:175]
buffer_load_dwordx4 v249, s[16:19], s63 offen offset:3072 lds
v_mfma_f32_16x16x32_bf16 v[204:207], a[64:67], a[116:119], v[204:207]
ds_read_b64_tr_b16 a[84:85], v243 offset:8192
v_mfma_f32_16x16x32_bf16 v[144:147], a[68:71], a[108:111], v[144:147]
ds_read_b64_tr_b16 a[86:87], v243 offset:9216
v_mfma_f32_16x16x32_bf16 v[176:179], a[68:71], a[112:115], v[176:179]
s_add_u32 m0, s77, 98304
s_nop 0
v_mfma_f32_16x16x32_bf16 v[208:211], a[68:71], a[116:119], v[208:211]
ds_read_b64_tr_b16 a[88:89], v244 offset:8192
s_waitcnt lgkmcnt(5)
v_mfma_f32_16x16x32_bf16 v[148:151], a[72:75], a[108:111], v[148:151]
ds_read_b64_tr_b16 a[90:91], v244 offset:9216
v_mfma_f32_16x16x32_bf16 v[180:183], a[72:75], a[112:115], v[180:183]
buffer_load_dwordx4 v250, s[16:19], s63 offen lds
v_mfma_f32_16x16x32_bf16 v[212:215], a[72:75], a[116:119], v[212:215]
ds_read_b64_tr_b16 a[92:93], v245 offset:8192
v_mfma_f32_16x16x32_bf16 v[152:155], a[76:79], a[108:111], v[152:155]
ds_read_b64_tr_b16 a[94:95], v245 offset:9216
v_mfma_f32_16x16x32_bf16 v[184:187], a[76:79], a[112:115], v[184:187]
buffer_load_dwordx4 v251, s[16:19], s63 offen offset:1024 lds
v_mfma_f32_16x16x32_bf16 v[216:219], a[76:79], a[116:119], v[216:219]
s_waitcnt lgkmcnt(4)
v_mfma_f32_16x16x32_bf16 v[156:159], a[80:83], a[108:111], v[156:159]
s_waitcnt vmcnt(10)
s_waitcnt lgkmcnt(0)
s_barrier
v_mfma_f32_16x16x32_bf16 v[188:191], a[80:83], a[112:115], v[188:191]
ds_read_b128 a[96:99], v236 offset:6144
ds_read_b128 a[100:103], v236 offset:8192
v_mfma_f32_16x16x32_bf16 v[220:223], a[80:83], a[116:119], v[220:223]
ds_read_b128 a[104:107], v236 offset:10240
ds_read_b64_tr_b16 a[64:65], v238 offset:16384
v_mfma_f32_16x16x32_bf16 v[160:163], a[84:87], a[108:111], v[160:163]
s_lshl_b32 s63, s62, 7
s_add_u32 s63, s63, s66
s_lshl_b32 s64, s62, 19
s_add_u32 s64, s64, s67
v_mfma_f32_16x16x32_bf16 v[192:195], a[84:87], a[112:115], v[192:195]
ds_read_b64_tr_b16 a[66:67], v238 offset:17408
ds_read_b64_tr_b16 a[68:69], v239 offset:16384
v_mfma_f32_16x16x32_bf16 v[224:227], a[84:87], a[116:119], v[224:227]
ds_read_b64_tr_b16 a[70:71], v239 offset:17408
v_mfma_f32_16x16x32_bf16 v[164:167], a[88:91], a[108:111], v[164:167]
s_add_u32 m0, s65, 32768
s_add_u32 s62, s62, 1
v_mfma_f32_16x16x32_bf16 v[196:199], a[88:91], a[112:115], v[196:199]
ds_read_b64_tr_b16 a[72:73], v240 offset:16384
ds_read_b64_tr_b16 a[74:75], v240 offset:17408
v_mfma_f32_16x16x32_bf16 v[228:231], a[88:91], a[116:119], v[228:231]
ds_read_b64_tr_b16 a[76:77], v241 offset:16384
buffer_load_dwordx4 v252, s[20:23], s64 offen lds
v_mfma_f32_16x16x32_bf16 v[168:171], a[92:95], a[108:111], v[168:171]
ds_read_b64_tr_b16 a[78:79], v241 offset:17408
v_mfma_f32_16x16x32_bf16 v[200:203], a[92:95], a[112:115], v[200:203]
buffer_load_dwordx4 v253, s[20:23], s64 offen offset:1024 lds
v_mfma_f32_16x16x32_bf16 v[232:235], a[92:95], a[116:119], v[232:235]
s_waitcnt lgkmcnt(4)
v_mfma_f32_16x16x32_bf16 v[140:143], a[64:67], a[96:99], v[140:143]
ds_read_b64_tr_b16 a[80:81], v242 offset:16384
v_mov_b32 v44, 0
v_mfma_f32_16x16x32_bf16 v[172:175], a[64:67], a[100:103], v[172:175]
ds_read_b64_tr_b16 a[82:83], v242 offset:17408
v_mfma_f32_16x16x32_bf16 v[204:207], a[64:67], a[104:107], v[204:207]
ds_read_b64_tr_b16 a[84:85], v243 offset:16384
buffer_load_dwordx4 v254, s[20:23], s64 offen offset:2048 lds
v_mfma_f32_16x16x32_bf16 v[144:147], a[68:71], a[96:99], v[144:147]
v_mov_b32 v45, 0
ds_read_b64_tr_b16 a[86:87], v243 offset:17408
v_mfma_f32_16x16x32_bf16 v[176:179], a[68:71], a[100:103], v[176:179]
ds_read_b128 a[108:111], v237 offset:6144
v_mfma_f32_16x16x32_bf16 v[208:211], a[68:71], a[104:107], v[208:211]
ds_read_b64_tr_b16 a[88:89], v244 offset:16384
s_waitcnt lgkmcnt(6)
v_mfma_f32_16x16x32_bf16 v[148:151], a[72:75], a[96:99], v[148:151]
buffer_load_dwordx4 v255, s[20:23], s64 offen offset:3072 lds
v_mov_b32 v46, 0
v_mfma_f32_16x16x32_bf16 v[180:183], a[72:75], a[100:103], v[180:183]
ds_read_b64_tr_b16 a[90:91], v244 offset:17408
ds_read_b128 a[112:115], v237 offset:8192
v_mfma_f32_16x16x32_bf16 v[212:215], a[72:75], a[104:107], v[212:215]
ds_read_b64_tr_b16 a[92:93], v245 offset:16384
v_mov_b32 v47, 0
v_mfma_f32_16x16x32_bf16 v[152:155], a[76:79], a[96:99], v[152:155]
ds_read_b64_tr_b16 a[94:95], v245 offset:17408
ds_read_b128 a[116:119], v237 offset:10240
v_mfma_f32_16x16x32_bf16 v[184:187], a[76:79], a[100:103], v[184:187]
s_add_u32 m0, s77, 81920
s_and_b32 s62, s62, 7
v_mfma_f32_16x16x32_bf16 v[216:219], a[76:79], a[104:107], v[216:219]
ds_read_b64_tr_b16 a[64:65], v238 offset:24576
s_waitcnt lgkmcnt(8)
v_mfma_f32_16x16x32_bf16 v[156:159], a[80:83], a[96:99], v[156:159]
v_mov_b32 v48, 0
ds_read_b64_tr_b16 a[66:67], v238 offset:25600
v_mfma_f32_16x16x32_bf16 v[188:191], a[80:83], a[100:103], v[188:191]
buffer_load_dwordx4 v246, s[16:19], s63 offen lds
v_mfma_f32_16x16x32_bf16 v[220:223], a[80:83], a[104:107], v[220:223]
ds_read_b64_tr_b16 a[68:69], v239 offset:24576
v_mov_b32 v49, 0
v_mfma_f32_16x16x32_bf16 v[160:163], a[84:87], a[96:99], v[160:163]
ds_read_b64_tr_b16 a[70:71], v239 offset:25600
v_mfma_f32_16x16x32_bf16 v[192:195], a[84:87], a[100:103], v[192:195]
buffer_load_dwordx4 v247, s[16:19], s63 offen offset:1024 lds
v_mfma_f32_16x16x32_bf16 v[224:227], a[84:87], a[104:107], v[224:227]
ds_read_b64_tr_b16 a[72:73], v240 offset:24576
s_waitcnt lgkmcnt(7)
v_mfma_f32_16x16x32_bf16 v[164:167], a[88:91], a[96:99], v[164:167]
v_mov_b32 v50, 0
ds_read_b64_tr_b16 a[74:75], v240 offset:25600
v_mfma_f32_16x16x32_bf16 v[196:199], a[88:91], a[100:103], v[196:199]
buffer_load_dwordx4 v248, s[16:19], s63 offen offset:2048 lds
v_mfma_f32_16x16x32_bf16 v[228:231], a[88:91], a[104:107], v[228:231]
ds_read_b64_tr_b16 a[76:77], v241 offset:24576
v_mov_b32 v51, 0
s_waitcnt lgkmcnt(8)
v_mfma_f32_16x16x32_bf16 v[168:171], a[92:95], a[96:99], v[168:171]
ds_read_b64_tr_b16 a[78:79], v241 offset:25600
v_mfma_f32_16x16x32_bf16 v[200:203], a[92:95], a[100:103], v[200:203]
v_mfma_f32_16x16x32_bf16 v[232:235], a[92:95], a[104:107], v[232:235]
ds_read_b64_tr_b16 a[80:81], v242 offset:24576
s_waitcnt lgkmcnt(5)
v_mfma_f32_16x16x32_bf16 v[140:143], a[64:67], a[108:111], v[140:143]
buffer_load_dwordx4 v249, s[16:19], s63 offen offset:3072 lds
v_mov_b32 v52, 0
v_mfma_f32_16x16x32_bf16 v[172:175], a[64:67], a[112:115], v[172:175]
ds_read_b64_tr_b16 a[82:83], v242 offset:25600
v_mfma_f32_16x16x32_bf16 v[204:207], a[64:67], a[116:119], v[204:207]
ds_read_b64_tr_b16 a[84:85], v243 offset:24576
v_mov_b32 v53, 0
v_mfma_f32_16x16x32_bf16 v[144:147], a[68:71], a[108:111], v[144:147]
s_add_u32 m0, s77, 86016
s_nop 0
v_mfma_f32_16x16x32_bf16 v[176:179], a[68:71], a[112:115], v[176:179]
ds_read_b64_tr_b16 a[86:87], v243 offset:25600
v_mfma_f32_16x16x32_bf16 v[208:211], a[68:71], a[116:119], v[208:211]
ds_read_b64_tr_b16 a[88:89], v244 offset:24576
s_waitcnt lgkmcnt(5)
v_mfma_f32_16x16x32_bf16 v[148:151], a[72:75], a[108:111], v[148:151]
v_mov_b32 v54, 0
ds_read_b64_tr_b16 a[90:91], v244 offset:25600
v_mfma_f32_16x16x32_bf16 v[180:183], a[72:75], a[112:115], v[180:183]
buffer_load_dwordx4 v250, s[16:19], s63 offen lds
v_mfma_f32_16x16x32_bf16 v[212:215], a[72:75], a[116:119], v[212:215]
ds_read_b64_tr_b16 a[92:93], v245 offset:24576
v_mov_b32 v55, 0
v_mfma_f32_16x16x32_bf16 v[152:155], a[76:79], a[108:111], v[152:155]
ds_read_b64_tr_b16 a[94:95], v245 offset:25600
v_mfma_f32_16x16x32_bf16 v[184:187], a[76:79], a[112:115], v[184:187]
buffer_load_dwordx4 v251, s[16:19], s63 offen offset:1024 lds
v_mfma_f32_16x16x32_bf16 v[216:219], a[76:79], a[116:119], v[216:219]
v_mov_b32 v56, 0
s_waitcnt lgkmcnt(4)
v_mfma_f32_16x16x32_bf16 v[156:159], a[80:83], a[108:111], v[156:159]
s_waitcnt vmcnt(10)
s_waitcnt lgkmcnt(0)
s_barrier
v_mfma_f32_16x16x32_bf16 v[188:191], a[80:83], a[112:115], v[188:191]
ds_read_b128 a[96:99], v236 offset:12288
ds_read_b128 a[100:103], v236 offset:14336
v_mfma_f32_16x16x32_bf16 v[220:223], a[80:83], a[116:119], v[220:223]
ds_read_b128 a[104:107], v236 offset:16384
ds_read_b64_tr_b16 a[64:65], v238 offset:32768
v_mfma_f32_16x16x32_bf16 v[160:163], a[84:87], a[108:111], v[160:163]
s_lshl_b32 s63, s62, 7
s_add_u32 s63, s63, s66
s_lshl_b32 s64, s62, 19
s_add_u32 s64, s64, s67
v_mfma_f32_16x16x32_bf16 v[192:195], a[84:87], a[112:115], v[192:195]
ds_read_b64_tr_b16 a[66:67], v238 offset:33792
v_mov_b32 v57, 0
v_mfma_f32_16x16x32_bf16 v[224:227], a[84:87], a[116:119], v[224:227]
s_add_u32 m0, s65, 49152
s_add_u32 s62, s62, 1
v_mfma_f32_16x16x32_bf16 v[164:167], a[88:91], a[108:111], v[164:167]
ds_read_b64_tr_b16 a[68:69], v239 offset:32768
ds_read_b64_tr_b16 a[70:71], v239 offset:33792
v_mfma_f32_16x16x32_bf16 v[196:199], a[88:91], a[112:115], v[196:199]
buffer_load_dwordx4 v252, s[20:23], s64 offen lds
ds_read_b64_tr_b16 a[72:73], v240 offset:32768
v_mfma_f32_16x16x32_bf16 v[228:231], a[88:91], a[116:119], v[228:231]
v_mov_b32 v58, 0
ds_read_b64_tr_b16 a[74:75], v240 offset:33792
v_mfma_f32_16x16x32_bf16 v[168:171], a[92:95], a[108:111], v[168:171]
ds_read_b64_tr_b16 a[76:77], v241 offset:32768
buffer_load_dwordx4 v253, s[20:23], s64 offen offset:1024 lds
v_mfma_f32_16x16x32_bf16 v[200:203], a[92:95], a[112:115], v[200:203]
ds_read_b64_tr_b16 a[78:79], v241 offset:33792
v_mov_b32 v59, 0
v_mfma_f32_16x16x32_bf16 v[232:235], a[92:95], a[116:119], v[232:235]
buffer_load_dwordx4 v254, s[20:23], s64 offen offset:2048 lds
s_waitcnt lgkmcnt(4)
v_mfma_f32_16x16x32_bf16 v[140:143], a[64:67], a[96:99], v[140:143]
ds_read_b64_tr_b16 a[80:81], v242 offset:32768
v_mov_b32 v60, 0
v_mfma_f32_16x16x32_bf16 v[172:175], a[64:67], a[100:103], v[172:175]
ds_read_b64_tr_b16 a[82:83], v242 offset:33792
buffer_load_dwordx4 v255, s[20:23], s64 offen offset:3072 lds
v_mfma_f32_16x16x32_bf16 v[204:207], a[64:67], a[104:107], v[204:207]
ds_read_b64_tr_b16 a[84:85], v243 offset:32768
v_mov_b32 v61, 0
v_mfma_f32_16x16x32_bf16 v[144:147], a[68:71], a[96:99], v[144:147]
s_add_u32 m0, s77, 88064
s_and_b32 s62, s62, 7
v_mfma_f32_16x16x32_bf16 v[176:179], a[68:71], a[100:103], v[176:179]
ds_read_b64_tr_b16 a[86:87], v243 offset:33792
ds_read_b128 a[108:111], v237 offset:12288
v_mfma_f32_16x16x32_bf16 v[208:211], a[68:71], a[104:107], v[208:211]
buffer_load_dwordx4 v246, s[16:19], s63 offen lds
s_waitcnt lgkmcnt(5)
v_mfma_f32_16x16x32_bf16 v[148:151], a[72:75], a[96:99], v[148:151]
ds_read_b64_tr_b16 a[88:89], v244 offset:32768
v_mov_b32 v62, 0
v_mfma_f32_16x16x32_bf16 v[180:183], a[72:75], a[100:103], v[180:183]
ds_read_b64_tr_b16 a[90:91], v244 offset:33792
ds_read_b128 a[112:115], v237 offset:14336
v_mfma_f32_16x16x32_bf16 v[212:215], a[72:75], a[104:107], v[212:215]
buffer_load_dwordx4 v247, s[16:19], s63 offen offset:1024 lds
ds_read_b64_tr_b16 a[92:93], v245 offset:32768
v_mfma_f32_16x16x32_bf16 v[152:155], a[76:79], a[96:99], v[152:155]
v_mov_b32 v63, 0
ds_read_b64_tr_b16 a[94:95], v245 offset:33792
v_mfma_f32_16x16x32_bf16 v[184:187], a[76:79], a[100:103], v[184:187]
ds_read_b128 a[116:119], v237 offset:16384
buffer_load_dwordx4 v248, s[16:19], s63 offen offset:2048 lds
v_mfma_f32_16x16x32_bf16 v[216:219], a[76:79], a[104:107], v[216:219]
ds_read_b64_tr_b16 a[64:65], v238 offset:40960
s_waitcnt lgkmcnt(8)
v_mfma_f32_16x16x32_bf16 v[156:159], a[80:83], a[96:99], v[156:159]
v_mov_b32 v64, 0
ds_read_b64_tr_b16 a[66:67], v238 offset:41984
v_mfma_f32_16x16x32_bf16 v[188:191], a[80:83], a[100:103], v[188:191]
buffer_load_dwordx4 v249, s[16:19], s63 offen offset:3072 lds
v_mfma_f32_16x16x32_bf16 v[220:223], a[80:83], a[104:107], v[220:223]
ds_read_b64_tr_b16 a[68:69], v239 offset:40960
v_mov_b32 v65, 0
v_mfma_f32_16x16x32_bf16 v[160:163], a[84:87], a[96:99], v[160:163]
s_add_u32 m0, s77, 92160
s_nop 0
v_mfma_f32_16x16x32_bf16 v[192:195], a[84:87], a[100:103], v[192:195]
ds_read_b64_tr_b16 a[70:71], v239 offset:41984
v_mfma_f32_16x16x32_bf16 v[224:227], a[84:87], a[104:107], v[224:227]
ds_read_b64_tr_b16 a[72:73], v240 offset:40960
s_waitcnt lgkmcnt(7)
v_mfma_f32_16x16x32_bf16 v[164:167], a[88:91], a[96:99], v[164:167]
buffer_load_dwordx4 v250, s[16:19], s63 offen lds
v_mov_b32 v66, 0
v_mfma_f32_16x16x32_bf16 v[196:199], a[88:91], a[100:103], v[196:199]
ds_read_b64_tr_b16 a[74:75], v240 offset:41984
buffer_load_dwordx4 v251, s[16:19], s63 offen offset:1024 lds
v_mfma_f32_16x16x32_bf16 v[228:231], a[88:91], a[104:107], v[228:231]
ds_read_b64_tr_b16 a[76:77], v241 offset:40960
v_mov_b32 v67, 0
s_waitcnt lgkmcnt(8)
v_mfma_f32_16x16x32_bf16 v[168:171], a[92:95], a[96:99], v[168:171]
ds_read_b64_tr_b16 a[78:79], v241 offset:41984
s_add_u32 m0, s65, 0
v_mfma_f32_16x16x32_bf16 v[200:203], a[92:95], a[100:103], v[200:203]
v_mfma_f32_16x16x32_bf16 v[232:235], a[92:95], a[104:107], v[232:235]
ds_read_b64_tr_b16 a[80:81], v242 offset:40960
s_waitcnt lgkmcnt(5)
v_mfma_f32_16x16x32_bf16 v[140:143], a[64:67], a[108:111], v[140:143]
v_mov_b32 v68, 0
ds_read_b64_tr_b16 a[82:83], v242 offset:41984
v_mfma_f32_16x16x32_bf16 v[172:175], a[64:67], a[112:115], v[172:175]
buffer_load_dwordx4 v20, s[8:11], s59 offen nt lds
v_mfma_f32_16x16x32_bf16 v[204:207], a[64:67], a[116:119], v[204:207]
ds_read_b64_tr_b16 a[84:85], v243 offset:40960
v_mov_b32 v69, 0
v_mfma_f32_16x16x32_bf16 v[144:147], a[68:71], a[108:111], v[144:147]
buffer_load_dwordx4 v21, s[8:11], s59 offen offset:1024 nt lds
v_mfma_f32_16x16x32_bf16 v[176:179], a[68:71], a[112:115], v[176:179]
ds_read_b64_tr_b16 a[86:87], v243 offset:41984
v_mfma_f32_16x16x32_bf16 v[208:211], a[68:71], a[116:119], v[208:211]
ds_read_b64_tr_b16 a[88:89], v244 offset:40960
s_waitcnt lgkmcnt(5)
v_mfma_f32_16x16x32_bf16 v[148:151], a[72:75], a[108:111], v[148:151]
buffer_load_dwordx4 v22, s[8:11], s59 offen offset:2048 nt lds
v_mfma_f32_16x16x32_bf16 v[180:183], a[72:75], a[112:115], v[180:183]
v_mov_b32 v70, 0
ds_read_b64_tr_b16 a[90:91], v244 offset:41984
v_mfma_f32_16x16x32_bf16 v[212:215], a[72:75], a[116:119], v[212:215]
buffer_load_dwordx4 v23, s[8:11], s59 offen offset:3072 nt lds
v_mfma_f32_16x16x32_bf16 v[152:155], a[76:79], a[108:111], v[152:155]
ds_read_b64_tr_b16 a[92:93], v245 offset:40960
v_mov_b32 v71, 0
v_mfma_f32_16x16x32_bf16 v[184:187], a[76:79], a[112:115], v[184:187]
ds_read_b64_tr_b16 a[94:95], v245 offset:41984
v_mfma_f32_16x16x32_bf16 v[216:219], a[76:79], a[116:119], v[216:219]
v_mov_b32 v72, 0
s_waitcnt lgkmcnt(4)
v_mfma_f32_16x16x32_bf16 v[156:159], a[80:83], a[108:111], v[156:159]
s_add_u32 s59, s59, 16384
s_and_b32 s59, s59, 0x7ffff
s_waitcnt vmcnt(14)
s_waitcnt lgkmcnt(0)
s_barrier
v_mfma_f32_16x16x32_bf16 v[188:191], a[80:83], a[112:115], v[188:191]
ds_read_b128 a[96:99], v236 offset:0
ds_read_b128 a[100:103], v236 offset:2048
v_mfma_f32_16x16x32_bf16 v[220:223], a[80:83], a[116:119], v[220:223]
ds_read_b128 a[104:107], v236 offset:4096
ds_read_b64_tr_b16 a[64:65], v238 offset:0
v_mfma_f32_16x16x32_bf16 v[160:163], a[84:87], a[108:111], v[160:163]
s_lshl_b32 s63, s62, 7
s_add_u32 s63, s63, s66
s_lshl_b32 s64, s62, 19
s_add_u32 s64, s64, s67
v_mfma_f32_16x16x32_bf16 v[192:195], a[84:87], a[112:115], v[192:195]
ds_read_b64_tr_b16 a[66:67], v238 offset:1024
v_mov_b32 v73, 0
v_mfma_f32_16x16x32_bf16 v[224:227], a[84:87], a[116:119], v[224:227]
s_add_u32 m0, s65, 65536
s_add_u32 s62, s62, 1
v_mfma_f32_16x16x32_bf16 v[164:167], a[88:91], a[108:111], v[164:167]
ds_read_b64_tr_b16 a[68:69], v239 offset:0
ds_read_b64_tr_b16 a[70:71], v239 offset:1024
v_mfma_f32_16x16x32_bf16 v[196:199], a[88:91], a[112:115], v[196:199]
buffer_load_dwordx4 v252, s[20:23], s64 offen lds
ds_read_b64_tr_b16 a[72:73], v240 offset:0
v_mfma_f32_16x16x32_bf16 v[228:231], a[88:91], a[116:119], v[228:231]
v_mov_b32 v74, 0
ds_read_b64_tr_b16 a[74:75], v240 offset:1024
v_mfma_f32_16x16x32_bf16 v[168:171], a[92:95], a[108:111], v[168:171]
buffer_load_dwordx4 v253, s[20:23], s64 offen offset:1024 lds
ds_read_b64_tr_b16 a[76:77], v241 offset:0
v_mfma_f32_16x16x32_bf16 v[200:203], a[92:95], a[112:115], v[200:203]
ds_read_b64_tr_b16 a[78:79], v241 offset:1024
v_mov_b32 v75, 0
v_mfma_f32_16x16x32_bf16 v[232:235], a[92:95], a[116:119], v[232:235]
buffer_load_dwordx4 v254, s[20:23], s64 offen offset:2048 lds
s_waitcnt lgkmcnt(4)
v_mfma_f32_16x16x32_bf16 v[140:143], a[64:67], a[96:99], v[140:143]
ds_read_b64_tr_b16 a[80:81], v242 offset:0
buffer_load_dwordx4 v255, s[20:23], s64 offen offset:3072 lds
v_mfma_f32_16x16x32_bf16 v[172:175], a[64:67], a[100:103], v[172:175]
v_mov_b32 v76, 0
ds_read_b64_tr_b16 a[82:83], v242 offset:1024
v_mfma_f32_16x16x32_bf16 v[204:207], a[64:67], a[104:107], v[204:207]
s_add_u32 m0, s77, 94208
s_and_b32 s62, s62, 7
v_mfma_f32_16x16x32_bf16 v[144:147], a[68:71], a[96:99], v[144:147]
ds_read_b64_tr_b16 a[84:85], v243 offset:0
v_mov_b32 v77, 0
v_mfma_f32_16x16x32_bf16 v[176:179], a[68:71], a[100:103], v[176:179]
ds_read_b64_tr_b16 a[86:87], v243 offset:1024
ds_read_b128 a[108:111], v237 offset:0
v_mfma_f32_16x16x32_bf16 v[208:211], a[68:71], a[104:107], v[208:211]
buffer_load_dwordx4 v246, s[16:19], s63 offen lds
s_waitcnt lgkmcnt(5)
v_mfma_f32_16x16x32_bf16 v[148:151], a[72:75], a[96:99], v[148:151]
ds_read_b64_tr_b16 a[88:89], v244 offset:0
v_mov_b32 v78, 0
v_mfma_f32_16x16x32_bf16 v[180:183], a[72:75], a[100:103], v[180:183]
ds_read_b64_tr_b16 a[90:91], v244 offset:1024
ds_read_b128 a[112:115], v237 offset:2048
v_mfma_f32_16x16x32_bf16 v[212:215], a[72:75], a[104:107], v[212:215]
buffer_load_dwordx4 v247, s[16:19], s63 offen offset:1024 lds
ds_read_b64_tr_b16 a[92:93], v245 offset:0
v_mfma_f32_16x16x32_bf16 v[152:155], a[76:79], a[96:99], v[152:155]
buffer_load_dwordx4 v248, s[16:19], s63 offen offset:2048 lds
v_mov_b32 v79, 0
v_mfma_f32_16x16x32_bf16 v[184:187], a[76:79], a[100:103], v[184:187]
ds_read_b64_tr_b16 a[94:95], v245 offset:1024
ds_read_b128 a[116:119], v237 offset:4096
v_mfma_f32_16x16x32_bf16 v[216:219], a[76:79], a[104:107], v[216:219]
ds_read_b64_tr_b16 a[64:65], v238 offset:8192
s_waitcnt lgkmcnt(8)
v_mfma_f32_16x16x32_bf16 v[156:159], a[80:83], a[96:99], v[156:159]
buffer_load_dwordx4 v249, s[16:19], s63 offen offset:3072 lds
v_mov_b32 v80, 0
v_mfma_f32_16x16x32_bf16 v[188:191], a[80:83], a[100:103], v[188:191]
ds_read_b64_tr_b16 a[66:67], v238 offset:9216
v_mfma_f32_16x16x32_bf16 v[220:223], a[80:83], a[104:107], v[220:223]
s_add_u32 m0, s77, 98304
s_nop 0
v_mfma_f32_16x16x32_bf16 v[160:163], a[84:87], a[96:99], v[160:163]
ds_read_b64_tr_b16 a[68:69], v239 offset:8192
v_mov_b32 v81, 0
v_mfma_f32_16x16x32_bf16 v[192:195], a[84:87], a[100:103], v[192:195]
ds_read_b64_tr_b16 a[70:71], v239 offset:9216
buffer_load_dwordx4 v250, s[16:19], s63 offen lds
v_mfma_f32_16x16x32_bf16 v[224:227], a[84:87], a[104:107], v[224:227]
ds_read_b64_tr_b16 a[72:73], v240 offset:8192
s_waitcnt lgkmcnt(7)
v_mfma_f32_16x16x32_bf16 v[164:167], a[88:91], a[96:99], v[164:167]
buffer_load_dwordx4 v251, s[16:19], s63 offen offset:1024 lds
v_mov_b32 v82, 0
v_mfma_f32_16x16x32_bf16 v[196:199], a[88:91], a[100:103], v[196:199]
ds_read_b64_tr_b16 a[74:75], v240 offset:9216
v_mfma_f32_16x16x32_bf16 v[228:231], a[88:91], a[104:107], v[228:231]
ds_read_b64_tr_b16 a[76:77], v241 offset:8192
s_add_u32 m0, s65, 16384
s_waitcnt lgkmcnt(8)
v_mfma_f32_16x16x32_bf16 v[168:171], a[92:95], a[96:99], v[168:171]
v_mov_b32 v83, 0
ds_read_b64_tr_b16 a[78:79], v241 offset:9216
v_mfma_f32_16x16x32_bf16 v[200:203], a[92:95], a[100:103], v[200:203]
buffer_load_dwordx4 v20, s[8:11], s59 offen nt lds
v_mfma_f32_16x16x32_bf16 v[232:235], a[92:95], a[104:107], v[232:235]
ds_read_b64_tr_b16 a[80:81], v242 offset:8192
s_waitcnt lgkmcnt(5)
v_mfma_f32_16x16x32_bf16 v[140:143], a[64:67], a[108:111], v[140:143]
v_mov_b32 v84, 0
ds_read_b64_tr_b16 a[82:83], v242 offset:9216
v_mfma_f32_16x16x32_bf16 v[172:175], a[64:67], a[112:115], v[172:175]
buffer_load_dwordx4 v21, s[8:11], s59 offen offset:1024 nt lds
v_mfma_f32_16x16x32_bf16 v[204:207], a[64:67], a[116:119], v[204:207]
ds_read_b64_tr_b16 a[84:85], v243 offset:8192
v_mov_b32 v85, 0
v_mfma_f32_16x16x32_bf16 v[144:147], a[68:71], a[108:111], v[144:147]
ds_read_b64_tr_b16 a[86:87], v243 offset:9216
v_mfma_f32_16x16x32_bf16 v[176:179], a[68:71], a[112:115], v[176:179]
buffer_load_dwordx4 v22, s[8:11], s59 offen offset:2048 nt lds
v_mfma_f32_16x16x32_bf16 v[208:211], a[68:71], a[116:119], v[208:211]
ds_read_b64_tr_b16 a[88:89], v244 offset:8192
s_waitcnt lgkmcnt(5)
v_mfma_f32_16x16x32_bf16 v[148:151], a[72:75], a[108:111], v[148:151]
buffer_load_dwordx4 v23, s[8:11], s59 offen offset:3072 nt lds
v_mfma_f32_16x16x32_bf16 v[180:183], a[72:75], a[112:115], v[180:183]
v_mov_b32 v86, 0
ds_read_b64_tr_b16 a[90:91], v244 offset:9216
v_mfma_f32_16x16x32_bf16 v[212:215], a[72:75], a[116:119], v[212:215]
s_add_u32 s59, s59, 16384
s_and_b32 s59, s59, 0x7ffff
v_mfma_f32_16x16x32_bf16 v[152:155], a[76:79], a[108:111], v[152:155]
ds_read_b64_tr_b16 a[92:93], v245 offset:8192
v_mov_b32 v87, 0
v_mfma_f32_16x16x32_bf16 v[184:187], a[76:79], a[112:115], v[184:187]
ds_read_b64_tr_b16 a[94:95], v245 offset:9216
v_mfma_f32_16x16x32_bf16 v[216:219], a[76:79], a[116:119], v[216:219]
v_mov_b32 v88, 0
s_waitcnt lgkmcnt(4)
v_mfma_f32_16x16x32_bf16 v[156:159], a[80:83], a[108:111], v[156:159]
v_mov_b32 v3, 0
global_load_dwordx2 v[6:7], v3, s[52:53] sc1
s_waitcnt vmcnt(19)
s_waitcnt lgkmcnt(0)
s_barrier
v_mfma_f32_16x16x32_bf16 v[188:191], a[80:83], a[112:115], v[188:191]
ds_read_b128 a[96:99], v236 offset:6144
ds_read_b128 a[100:103], v236 offset:8192
v_mfma_f32_16x16x32_bf16 v[220:223], a[80:83], a[116:119], v[220:223]
ds_read_b128 a[104:107], v236 offset:10240
ds_read_b64_tr_b16 a[64:65], v238 offset:16384
v_mfma_f32_16x16x32_bf16 v[160:163], a[84:87], a[108:111], v[160:163]
s_lshl_b32 s63, s62, 7
s_add_u32 s63, s63, s66
s_lshl_b32 s64, s62, 19
s_add_u32 s64, s64, s67
v_mfma_f32_16x16x32_bf16 v[192:195], a[84:87], a[112:115], v[192:195]
ds_read_b64_tr_b16 a[66:67], v238 offset:17408
v_mov_b32 v89, 0
v_mfma_f32_16x16x32_bf16 v[224:227], a[84:87], a[116:119], v[224:227]
ds_read_b64_tr_b16 a[68:69], v239 offset:16384
v_mfma_f32_16x16x32_bf16 v[164:167], a[88:91], a[108:111], v[164:167]
s_add_u32 m0, s65, 32768
s_add_u32 s62, s62, 1
v_mfma_f32_16x16x32_bf16 v[196:199], a[88:91], a[112:115], v[196:199]
ds_read_b64_tr_b16 a[70:71], v239 offset:17408
ds_read_b64_tr_b16 a[72:73], v240 offset:16384
v_mfma_f32_16x16x32_bf16 v[228:231], a[88:91], a[116:119], v[228:231]
v_mov_b32 v90, 0
ds_read_b64_tr_b16 a[74:75], v240 offset:17408
v_mfma_f32_16x16x32_bf16 v[168:171], a[92:95], a[108:111], v[168:171]
ds_read_b64_tr_b16 a[76:77], v241 offset:16384
buffer_load_dwordx4 v252, s[20:23], s64 offen lds
v_mfma_f32_16x16x32_bf16 v[200:203], a[92:95], a[112:115], v[200:203]
ds_read_b64_tr_b16 a[78:79], v241 offset:17408
v_mov_b32 v91, 0
v_mfma_f32_16x16x32_bf16 v[232:235], a[92:95], a[116:119], v[232:235]
buffer_load_dwordx4 v253, s[20:23], s64 offen offset:1024 lds
s_waitcnt lgkmcnt(4)
v_mfma_f32_16x16x32_bf16 v[140:143], a[64:67], a[96:99], v[140:143]
ds_read_b64_tr_b16 a[80:81], v242 offset:16384
v_mov_b32 v92, 0
v_mfma_f32_16x16x32_bf16 v[172:175], a[64:67], a[100:103], v[172:175]
ds_read_b64_tr_b16 a[82:83], v242 offset:17408
v_mfma_f32_16x16x32_bf16 v[204:207], a[64:67], a[104:107], v[204:207]
ds_read_b64_tr_b16 a[84:85], v243 offset:16384
buffer_load_dwordx4 v254, s[20:23], s64 offen offset:2048 lds
v_mfma_f32_16x16x32_bf16 v[144:147], a[68:71], a[96:99], v[144:147]
v_mov_b32 v93, 0
ds_read_b64_tr_b16 a[86:87], v243 offset:17408
v_mfma_f32_16x16x32_bf16 v[176:179], a[68:71], a[100:103], v[176:179]
ds_read_b128 a[108:111], v237 offset:6144
v_mfma_f32_16x16x32_bf16 v[208:211], a[68:71], a[104:107], v[208:211]
ds_read_b64_tr_b16 a[88:89], v244 offset:16384
s_waitcnt lgkmcnt(6)
v_mfma_f32_16x16x32_bf16 v[148:151], a[72:75], a[96:99], v[148:151]
buffer_load_dwordx4 v255, s[20:23], s64 offen offset:3072 lds
v_mov_b32 v94, 0
v_mfma_f32_16x16x32_bf16 v[180:183], a[72:75], a[100:103], v[180:183]
ds_read_b64_tr_b16 a[90:91], v244 offset:17408
ds_read_b128 a[112:115], v237 offset:8192
v_mfma_f32_16x16x32_bf16 v[212:215], a[72:75], a[104:107], v[212:215]
ds_read_b64_tr_b16 a[92:93], v245 offset:16384
v_mov_b32 v95, 0
v_mfma_f32_16x16x32_bf16 v[152:155], a[76:79], a[96:99], v[152:155]
ds_read_b64_tr_b16 a[94:95], v245 offset:17408
ds_read_b128 a[116:119], v237 offset:10240
v_mfma_f32_16x16x32_bf16 v[184:187], a[76:79], a[100:103], v[184:187]
s_add_u32 m0, s77, 81920
s_and_b32 s62, s62, 7
v_mfma_f32_16x16x32_bf16 v[216:219], a[76:79], a[104:107], v[216:219]
ds_read_b64_tr_b16 a[64:65], v238 offset:24576
s_waitcnt lgkmcnt(8)
v_mfma_f32_16x16x32_bf16 v[156:159], a[80:83], a[96:99], v[156:159]
v_mov_b32 v96, 0
ds_read_b64_tr_b16 a[66:67], v238 offset:25600
v_mfma_f32_16x16x32_bf16 v[188:191], a[80:83], a[100:103], v[188:191]
buffer_load_dwordx4 v246, s[16:19], s63 offen lds
v_mfma_f32_16x16x32_bf16 v[220:223], a[80:83], a[104:107], v[220:223]
ds_read_b64_tr_b16 a[68:69], v239 offset:24576
v_mov_b32 v97, 0
v_mfma_f32_16x16x32_bf16 v[160:163], a[84:87], a[96:99], v[160:163]
ds_read_b64_tr_b16 a[70:71], v239 offset:25600
v_mfma_f32_16x16x32_bf16 v[192:195], a[84:87], a[100:103], v[192:195]
buffer_load_dwordx4 v247, s[16:19], s63 offen offset:1024 lds
v_mfma_f32_16x16x32_bf16 v[224:227], a[84:87], a[104:107], v[224:227]
ds_read_b64_tr_b16 a[72:73], v240 offset:24576
s_waitcnt lgkmcnt(7)
v_mfma_f32_16x16x32_bf16 v[164:167], a[88:91], a[96:99], v[164:167]
v_mov_b32 v98, 0
ds_read_b64_tr_b16 a[74:75], v240 offset:25600
v_mfma_f32_16x16x32_bf16 v[196:199], a[88:91], a[100:103], v[196:199]
buffer_load_dwordx4 v248, s[16:19], s63 offen offset:2048 lds
v_mfma_f32_16x16x32_bf16 v[228:231], a[88:91], a[104:107], v[228:231]
ds_read_b64_tr_b16 a[76:77], v241 offset:24576
v_mov_b32 v99, 0
s_waitcnt lgkmcnt(8)
v_mfma_f32_16x16x32_bf16 v[168:171], a[92:95], a[96:99], v[168:171]
ds_read_b64_tr_b16 a[78:79], v241 offset:25600
v_mfma_f32_16x16x32_bf16 v[200:203], a[92:95], a[100:103], v[200:203]
v_mfma_f32_16x16x32_bf16 v[232:235], a[92:95], a[104:107], v[232:235]
ds_read_b64_tr_b16 a[80:81], v242 offset:24576
s_waitcnt lgkmcnt(5)
v_mfma_f32_16x16x32_bf16 v[140:143], a[64:67], a[108:111], v[140:143]
buffer_load_dwordx4 v249, s[16:19], s63 offen offset:3072 lds
v_mov_b32 v100, 0
v_mfma_f32_16x16x32_bf16 v[172:175], a[64:67], a[112:115], v[172:175]
ds_read_b64_tr_b16 a[82:83], v242 offset:25600
v_mfma_f32_16x16x32_bf16 v[204:207], a[64:67], a[116:119], v[204:207]
ds_read_b64_tr_b16 a[84:85], v243 offset:24576
v_mov_b32 v101, 0
v_mfma_f32_16x16x32_bf16 v[144:147], a[68:71], a[108:111], v[144:147]
s_add_u32 m0, s77, 86016
s_nop 0
v_mfma_f32_16x16x32_bf16 v[176:179], a[68:71], a[112:115], v[176:179]
ds_read_b64_tr_b16 a[86:87], v243 offset:25600
v_mfma_f32_16x16x32_bf16 v[208:211], a[68:71], a[116:119], v[208:211]
ds_read_b64_tr_b16 a[88:89], v244 offset:24576
s_waitcnt lgkmcnt(5)
v_mfma_f32_16x16x32_bf16 v[148:151], a[72:75], a[108:111], v[148:151]
v_mov_b32 v102, 0
ds_read_b64_tr_b16 a[90:91], v244 offset:25600
v_mfma_f32_16x16x32_bf16 v[180:183], a[72:75], a[112:115], v[180:183]
buffer_load_dwordx4 v250, s[16:19], s63 offen lds
v_mfma_f32_16x16x32_bf16 v[212:215], a[72:75], a[116:119], v[212:215]
ds_read_b64_tr_b16 a[92:93], v245 offset:24576
v_mov_b32 v103, 0
v_mfma_f32_16x16x32_bf16 v[152:155], a[76:79], a[108:111], v[152:155]
ds_read_b64_tr_b16 a[94:95], v245 offset:25600
v_mfma_f32_16x16x32_bf16 v[184:187], a[76:79], a[112:115], v[184:187]
buffer_load_dwordx4 v251, s[16:19], s63 offen offset:1024 lds
v_mfma_f32_16x16x32_bf16 v[216:219], a[76:79], a[116:119], v[216:219]
v_mov_b32 v104, 0
s_waitcnt lgkmcnt(4)
v_mfma_f32_16x16x32_bf16 v[156:159], a[80:83], a[108:111], v[156:159]
s_waitcnt vmcnt(15)
s_waitcnt lgkmcnt(0)
s_barrier
v_mfma_f32_16x16x32_bf16 v[188:191], a[80:83], a[112:115], v[188:191]
ds_read_b128 a[96:99], v236 offset:12288
ds_read_b128 a[100:103], v236 offset:14336
v_mfma_f32_16x16x32_bf16 v[220:223], a[80:83], a[116:119], v[220:223]
ds_read_b128 a[104:107], v236 offset:16384
ds_read_b64_tr_b16 a[64:65], v238 offset:32768
v_mfma_f32_16x16x32_bf16 v[160:163], a[84:87], a[108:111], v[160:163]
s_lshl_b32 s63, s62, 7
s_add_u32 s63, s63, s66
s_lshl_b32 s64, s62, 19
s_add_u32 s64, s64, s67
v_mfma_f32_16x16x32_bf16 v[192:195], a[84:87], a[112:115], v[192:195]
ds_read_b64_tr_b16 a[66:67], v238 offset:33792
v_mov_b32 v105, 0
v_mfma_f32_16x16x32_bf16 v[224:227], a[84:87], a[116:119], v[224:227]
ds_read_b64_tr_b16 a[68:69], v239 offset:32768
v_mfma_f32_16x16x32_bf16 v[164:167], a[88:91], a[108:111], v[164:167]
s_add_u32 m0, s65, 49152
s_add_u32 s62, s62, 1
v_mfma_f32_16x16x32_bf16 v[196:199], a[88:91], a[112:115], v[196:199]
ds_read_b64_tr_b16 a[70:71], v239 offset:33792
ds_read_b64_tr_b16 a[72:73], v240 offset:32768
v_mfma_f32_16x16x32_bf16 v[228:231], a[88:91], a[116:119], v[228:231]
v_mov_b32 v106, 0
ds_read_b64_tr_b16 a[74:75], v240 offset:33792
v_mfma_f32_16x16x32_bf16 v[168:171], a[92:95], a[108:111], v[168:171]
buffer_load_dwordx4 v252, s[20:23], s64 offen lds
ds_read_b64_tr_b16 a[76:77], v241 offset:32768
v_mfma_f32_16x16x32_bf16 v[200:203], a[92:95], a[112:115], v[200:203]
ds_read_b64_tr_b16 a[78:79], v241 offset:33792
v_mov_b32 v107, 0
v_mfma_f32_16x16x32_bf16 v[232:235], a[92:95], a[116:119], v[232:235]
buffer_load_dwordx4 v253, s[20:23], s64 offen offset:1024 lds
s_waitcnt lgkmcnt(4)
v_mfma_f32_16x16x32_bf16 v[140:143], a[64:67], a[96:99], v[140:143]
ds_read_b64_tr_b16 a[80:81], v242 offset:32768
v_mov_b32 v108, 0
v_mfma_f32_16x16x32_bf16 v[172:175], a[64:67], a[100:103], v[172:175]
ds_read_b64_tr_b16 a[82:83], v242 offset:33792
buffer_load_dwordx4 v254, s[20:23], s64 offen offset:2048 lds
v_mfma_f32_16x16x32_bf16 v[204:207], a[64:67], a[104:107], v[204:207]
ds_read_b64_tr_b16 a[84:85], v243 offset:32768
v_mov_b32 v109, 0
v_mfma_f32_16x16x32_bf16 v[144:147], a[68:71], a[96:99], v[144:147]
ds_read_b64_tr_b16 a[86:87], v243 offset:33792
ds_read_b128 a[108:111], v237 offset:12288
v_mfma_f32_16x16x32_bf16 v[176:179], a[68:71], a[100:103], v[176:179]
buffer_load_dwordx4 v255, s[20:23], s64 offen offset:3072 lds
v_mfma_f32_16x16x32_bf16 v[208:211], a[68:71], a[104:107], v[208:211]
ds_read_b64_tr_b16 a[88:89], v244 offset:32768
s_waitcnt lgkmcnt(6)
v_mfma_f32_16x16x32_bf16 v[148:151], a[72:75], a[96:99], v[148:151]
v_mov_b32 v110, 0
ds_read_b64_tr_b16 a[90:91], v244 offset:33792
v_mfma_f32_16x16x32_bf16 v[180:183], a[72:75], a[100:103], v[180:183]
ds_read_b128 a[112:115], v237 offset:14336
v_mfma_f32_16x16x32_bf16 v[212:215], a[72:75], a[104:107], v[212:215]
s_add_u32 m0, s77, 88064
s_and_b32 s62, s62, 7
v_mfma_f32_16x16x32_bf16 v[152:155], a[76:79], a[96:99], v[152:155]
ds_read_b64_tr_b16 a[92:93], v245 offset:32768
v_mov_b32 v111, 0
v_mfma_f32_16x16x32_bf16 v[184:187], a[76:79], a[100:103], v[184:187]
ds_read_b64_tr_b16 a[94:95], v245 offset:33792
ds_read_b128 a[116:119], v237 offset:16384
v_mfma_f32_16x16x32_bf16 v[216:219], a[76:79], a[104:107], v[216:219]
ds_read_b64_tr_b16 a[64:65], v238 offset:40960
s_waitcnt lgkmcnt(8)
v_mfma_f32_16x16x32_bf16 v[156:159], a[80:83], a[96:99], v[156:159]
buffer_load_dwordx4 v246, s[16:19], s63 offen lds
v_mov_b32 v112, 0
v_mfma_f32_16x16x32_bf16 v[188:191], a[80:83], a[100:103], v[188:191]
ds_read_b64_tr_b16 a[66:67], v238 offset:41984
v_mfma_f32_16x16x32_bf16 v[220:223], a[80:83], a[104:107], v[220:223]
ds_read_b64_tr_b16 a[68:69], v239 offset:40960
buffer_load_dwordx4 v247, s[16:19], s63 offen offset:1024 lds
v_mfma_f32_16x16x32_bf16 v[160:163], a[84:87], a[96:99], v[160:163]
v_mov_b32 v113, 0
ds_read_b64_tr_b16 a[70:71], v239 offset:41984
v_mfma_f32_16x16x32_bf16 v[192:195], a[84:87], a[100:103], v[192:195]
v_mfma_f32_16x16x32_bf16 v[224:227], a[84:87], a[104:107], v[224:227]
ds_read_b64_tr_b16 a[72:73], v240 offset:40960
s_waitcnt lgkmcnt(7)
v_mfma_f32_16x16x32_bf16 v[164:167], a[88:91], a[96:99], v[164:167]
buffer_load_dwordx4 v248, s[16:19], s63 offen offset:2048 lds
v_mov_b32 v114, 0
v_mfma_f32_16x16x32_bf16 v[196:199], a[88:91], a[100:103], v[196:199]
ds_read_b64_tr_b16 a[74:75], v240 offset:41984
v_mfma_f32_16x16x32_bf16 v[228:231], a[88:91], a[104:107], v[228:231]
ds_read_b64_tr_b16 a[76:77], v241 offset:40960
buffer_load_dwordx4 v249, s[16:19], s63 offen offset:3072 lds
s_waitcnt lgkmcnt(8)
v_mfma_f32_16x16x32_bf16 v[168:171], a[92:95], a[96:99], v[168:171]
v_mov_b32 v115, 0
ds_read_b64_tr_b16 a[78:79], v241 offset:41984
v_mfma_f32_16x16x32_bf16 v[200:203], a[92:95], a[100:103], v[200:203]
v_mfma_f32_16x16x32_bf16 v[232:235], a[92:95], a[104:107], v[232:235]
ds_read_b64_tr_b16 a[80:81], v242 offset:40960
s_waitcnt lgkmcnt(5)
v_mfma_f32_16x16x32_bf16 v[140:143], a[64:67], a[108:111], v[140:143]
v_mov_b32 v116, 0
ds_read_b64_tr_b16 a[82:83], v242 offset:41984
v_mfma_f32_16x16x32_bf16 v[172:175], a[64:67], a[112:115], v[172:175]
s_add_u32 m0, s77, 92160
s_nop 0
v_mfma_f32_16x16x32_bf16 v[204:207], a[64:67], a[116:119], v[204:207]
ds_read_b64_tr_b16 a[84:85], v243 offset:40960
v_mov_b32 v117, 0
v_mfma_f32_16x16x32_bf16 v[144:147], a[68:71], a[108:111], v[144:147]
ds_read_b64_tr_b16 a[86:87], v243 offset:41984
buffer_load_dwordx4 v250, s[16:19], s63 offen lds
v_mfma_f32_16x16x32_bf16 v[176:179], a[68:71], a[112:115], v[176:179]
v_mfma_f32_16x16x32_bf16 v[208:211], a[68:71], a[116:119], v[208:211]
ds_read_b64_tr_b16 a[88:89], v244 offset:40960
s_waitcnt lgkmcnt(5)
v_mfma_f32_16x16x32_bf16 v[148:151], a[72:75], a[108:111], v[148:151]
v_mov_b32 v118, 0
ds_read_b64_tr_b16 a[90:91], v244 offset:41984
v_mfma_f32_16x16x32_bf16 v[180:183], a[72:75], a[112:115], v[180:183]
buffer_load_dwordx4 v251, s[16:19], s63 offen offset:1024 lds
v_mfma_f32_16x16x32_bf16 v[212:215], a[72:75], a[116:119], v[212:215]
ds_read_b64_tr_b16 a[92:93], v245 offset:40960
v_mov_b32 v119, 0
v_mfma_f32_16x16x32_bf16 v[152:155], a[76:79], a[108:111], v[152:155]
ds_read_b64_tr_b16 a[94:95], v245 offset:41984
v_mfma_f32_16x16x32_bf16 v[184:187], a[76:79], a[112:115], v[184:187]
v_mfma_f32_16x16x32_bf16 v[216:219], a[76:79], a[116:119], v[216:219]
v_mov_b32 v120, 0
s_waitcnt lgkmcnt(4)
v_mfma_f32_16x16x32_bf16 v[156:159], a[80:83], a[108:111], v[156:159]
s_lshl_b32 s6, s2, 2
s_add_u32 s6, s6, s56
s_lshl_b32 s6, s6, 12
s_add_u32 s6, s48, s6
s_addc_u32 s7, s49, 0
v_and_b32 v3, 31, v27
v_lshlrev_b32 v3, 7, v3
s_mov_b32 exec_hi, 0
global_load_dword v0, v3, s[6:7]
s_mov_b32 exec_hi, -1
s_waitcnt vmcnt(11)
s_waitcnt lgkmcnt(0)
s_barrier
v_mfma_f32_16x16x32_bf16 v[188:191], a[80:83], a[112:115], v[188:191]
ds_read_b128 a[96:99], v236 offset:0
ds_read_b128 a[100:103], v236 offset:2048
v_mfma_f32_16x16x32_bf16 v[220:223], a[80:83], a[116:119], v[220:223]
ds_read_b128 a[104:107], v236 offset:4096
s_add_u32 m0, s65, 65536
v_mfma_f32_16x16x32_bf16 v[160:163], a[84:87], a[108:111], v[160:163]
ds_read_b64_tr_b16 a[64:65], v238 offset:0
ds_read_b64_tr_b16 a[66:67], v238 offset:1024
v_mfma_f32_16x16x32_bf16 v[192:195], a[84:87], a[112:115], v[192:195]
v_mov_b32 v121, 0
ds_read_b64_tr_b16 a[68:69], v239 offset:0
v_mfma_f32_16x16x32_bf16 v[224:227], a[84:87], a[116:119], v[224:227]
ds_read_b64_tr_b16 a[70:71], v239 offset:1024
v_mfma_f32_16x16x32_bf16 v[164:167], a[88:91], a[108:111], v[164:167]
ds_read_b64_tr_b16 a[72:73], v240 offset:0
v_mov_b32 v122, 0
v_mfma_f32_16x16x32_bf16 v[196:199], a[88:91], a[112:115], v[196:199]
ds_read_b64_tr_b16 a[74:75], v240 offset:1024
ds_read_b64_tr_b16 a[76:77], v241 offset:0
v_mfma_f32_16x16x32_bf16 v[228:231], a[88:91], a[116:119], v[228:231]
ds_read_b64_tr_b16 a[78:79], v241 offset:1024
v_mov_b32 v123, 0
v_mfma_f32_16x16x32_bf16 v[168:171], a[92:95], a[108:111], v[168:171]
buffer_load_dwordx4 v24, s[12:15], s60 offen nt lds
v_mfma_f32_16x16x32_bf16 v[200:203], a[92:95], a[112:115], v[200:203]
v_mfma_f32_16x16x32_bf16 v[232:235], a[92:95], a[116:119], v[232:235]
s_waitcnt lgkmcnt(4)
v_mfma_f32_16x16x32_bf16 v[140:143], a[64:67], a[96:99], v[140:143]
ds_read_b64_tr_b16 a[80:81], v242 offset:0
v_mov_b32 v124, 0
v_mfma_f32_16x16x32_bf16 v[172:175], a[64:67], a[100:103], v[172:175]
ds_read_b64_tr_b16 a[82:83], v242 offset:1024
v_mfma_f32_16x16x32_bf16 v[204:207], a[64:67], a[104:107], v[204:207]
ds_read_b64_tr_b16 a[84:85], v243 offset:0
v_mov_b32 v125, 0
v_mfma_f32_16x16x32_bf16 v[144:147], a[68:71], a[96:99], v[144:147]
ds_read_b64_tr_b16 a[86:87], v243 offset:1024
ds_read_b128 a[108:111], v237 offset:0
v_mfma_f32_16x16x32_bf16 v[176:179], a[68:71], a[100:103], v[176:179]
v_mfma_f32_16x16x32_bf16 v[208:211], a[68:71], a[104:107], v[208:211]
ds_read_b64_tr_b16 a[88:89], v244 offset:0
s_waitcnt lgkmcnt(6)
v_mfma_f32_16x16x32_bf16 v[148:151], a[72:75], a[96:99], v[148:151]
v_mov_b32 v126, 0
ds_read_b64_tr_b16 a[90:91], v244 offset:1024
v_mfma_f32_16x16x32_bf16 v[180:183], a[72:75], a[100:103], v[180:183]
ds_read_b128 a[112:115], v237 offset:2048
v_mfma_f32_16x16x32_bf16 v[212:215], a[72:75], a[104:107], v[212:215]
buffer_load_dwordx4 v25, s[12:15], s60 offen offset:1024 nt lds
v_mfma_f32_16x16x32_bf16 v[152:155], a[76:79], a[96:99], v[152:155]
ds_read_b64_tr_b16 a[92:93], v245 offset:0
v_mov_b32 v127, 0
v_mfma_f32_16x16x32_bf16 v[184:187], a[76:79], a[100:103], v[184:187]
ds_read_b64_tr_b16 a[94:95], v245 offset:1024
ds_read_b128 a[116:119], v237 offset:4096
v_mfma_f32_16x16x32_bf16 v[216:219], a[76:79], a[104:107], v[216:219]
ds_read_b64_tr_b16 a[64:65], v238 offset:8192
s_waitcnt lgkmcnt(8)
v_mfma_f32_16x16x32_bf16 v[156:159], a[80:83], a[96:99], v[156:159]
v_mov_b32 v128, 0
ds_read_b64_tr_b16 a[66:67], v238 offset:9216
v_mfma_f32_16x16x32_bf16 v[188:191], a[80:83], a[100:103], v[188:191]
v_mfma_f32_16x16x32_bf16 v[220:223], a[80:83], a[104:107], v[220:223]
ds_read_b64_tr_b16 a[68:69], v239 offset:8192
v_mov_b32 v129, 0
v_mfma_f32_16x16x32_bf16 v[160:163], a[84:87], a[96:99], v[160:163]
ds_read_b64_tr_b16 a[70:71], v239 offset:9216
v_mfma_f32_16x16x32_bf16 v[192:195], a[84:87], a[100:103], v[192:195]
buffer_load_dwordx4 v24, s[12:15], s60 offen offset:2048 nt lds
v_mfma_f32_16x16x32_bf16 v[224:227], a[84:87], a[104:107], v[224:227]
ds_read_b64_tr_b16 a[72:73], v240 offset:8192
s_waitcnt lgkmcnt(7)
v_mfma_f32_16x16x32_bf16 v[164:167], a[88:91], a[96:99], v[164:167]
v_mov_b32 v130, 0
ds_read_b64_tr_b16 a[74:75], v240 offset:9216
v_mfma_f32_16x16x32_bf16 v[196:199], a[88:91], a[100:103], v[196:199]
v_mfma_f32_16x16x32_bf16 v[228:231], a[88:91], a[104:107], v[228:231]
ds_read_b64_tr_b16 a[76:77], v241 offset:8192
v_mov_b32 v131, 0
s_waitcnt lgkmcnt(8)
v_mfma_f32_16x16x32_bf16 v[168:171], a[92:95], a[96:99], v[168:171]
ds_read_b64_tr_b16 a[78:79], v241 offset:9216
v_mfma_f32_16x16x32_bf16 v[200:203], a[92:95], a[100:103], v[200:203]
v_mfma_f32_16x16x32_bf16 v[232:235], a[92:95], a[104:107], v[232:235]
ds_read_b64_tr_b16 a[80:81], v242 offset:8192
s_waitcnt lgkmcnt(5)
v_mfma_f32_16x16x32_bf16 v[140:143], a[64:67], a[108:111], v[140:143]
v_mov_b32 v132, 0
ds_read_b64_tr_b16 a[82:83], v242 offset:9216
v_mfma_f32_16x16x32_bf16 v[172:175], a[64:67], a[112:115], v[172:175]
buffer_load_dwordx4 v25, s[12:15], s60 offen offset:3072 nt lds
v_mfma_f32_16x16x32_bf16 v[204:207], a[64:67], a[116:119], v[204:207]
ds_read_b64_tr_b16 a[84:85], v243 offset:8192
v_mov_b32 v133, 0
v_mfma_f32_16x16x32_bf16 v[144:147], a[68:71], a[108:111], v[144:147]
ds_read_b64_tr_b16 a[86:87], v243 offset:9216
v_mfma_f32_16x16x32_bf16 v[176:179], a[68:71], a[112:115], v[176:179]
v_mfma_f32_16x16x32_bf16 v[208:211], a[68:71], a[116:119], v[208:211]
ds_read_b64_tr_b16 a[88:89], v244 offset:8192
s_waitcnt lgkmcnt(5)
v_mfma_f32_16x16x32_bf16 v[148:151], a[72:75], a[108:111], v[148:151]
v_mov_b32 v134, 0
ds_read_b64_tr_b16 a[90:91], v244 offset:9216
v_mfma_f32_16x16x32_bf16 v[180:183], a[72:75], a[112:115], v[180:183]
v_mfma_f32_16x16x32_bf16 v[212:215], a[72:75], a[116:119], v[212:215]
ds_read_b64_tr_b16 a[92:93], v245 offset:8192
v_mov_b32 v135, 0
v_mfma_f32_16x16x32_bf16 v[152:155], a[76:79], a[108:111], v[152:155]
ds_read_b64_tr_b16 a[94:95], v245 offset:9216
v_mfma_f32_16x16x32_bf16 v[184:187], a[76:79], a[112:115], v[184:187]
s_add_u32 s60, s60, 16384
s_and_b32 s60, s60, 0x7ffff
v_mfma_f32_16x16x32_bf16 v[216:219], a[76:79], a[116:119], v[216:219]
v_mov_b32 v136, 0
s_waitcnt lgkmcnt(4)
v_mfma_f32_16x16x32_bf16 v[156:159], a[80:83], a[108:111], v[156:159]
s_waitcnt vmcnt(5)
s_waitcnt lgkmcnt(0)
s_barrier
v_mfma_f32_16x16x32_bf16 v[188:191], a[80:83], a[112:115], v[188:191]
ds_read_b128 a[96:99], v236 offset:6144
ds_read_b128 a[100:103], v236 offset:8192
v_mfma_f32_16x16x32_bf16 v[220:223], a[80:83], a[116:119], v[220:223]
ds_read_b128 a[104:107], v236 offset:10240
s_add_u32 m0, s65, 32768
v_mfma_f32_16x16x32_bf16 v[160:163], a[84:87], a[108:111], v[160:163]
ds_read_b64_tr_b16 a[64:65], v238 offset:16384
ds_read_b64_tr_b16 a[66:67], v238 offset:17408
v_mfma_f32_16x16x32_bf16 v[192:195], a[84:87], a[112:115], v[192:195]
v_mov_b32 v137, 0
ds_read_b64_tr_b16 a[68:69], v239 offset:16384
v_mfma_f32_16x16x32_bf16 v[224:227], a[84:87], a[116:119], v[224:227]
ds_read_b64_tr_b16 a[70:71], v239 offset:17408
v_mfma_f32_16x16x32_bf16 v[164:167], a[88:91], a[108:111], v[164:167]
ds_read_b64_tr_b16 a[72:73], v240 offset:16384
v_mov_b32 v138, 0
v_mfma_f32_16x16x32_bf16 v[196:199], a[88:91], a[112:115], v[196:199]
ds_read_b64_tr_b16 a[74:75], v240 offset:17408
ds_read_b64_tr_b16 a[76:77], v241 offset:16384
v_mfma_f32_16x16x32_bf16 v[228:231], a[88:91], a[116:119], v[228:231]
ds_read_b64_tr_b16 a[78:79], v241 offset:17408
v_mov_b32 v139, 0
v_mfma_f32_16x16x32_bf16 v[168:171], a[92:95], a[108:111], v[168:171]
buffer_load_dwordx4 v20, s[8:11], s59 offen nt lds
v_mfma_f32_16x16x32_bf16 v[200:203], a[92:95], a[112:115], v[200:203]
v_mfma_f32_16x16x32_bf16 v[232:235], a[92:95], a[116:119], v[232:235]
s_waitcnt lgkmcnt(4)
v_mfma_f32_16x16x32_bf16 v[140:143], a[64:67], a[96:99], v[140:143]
ds_read_b64_tr_b16 a[80:81], v242 offset:16384
v_accvgpr_write_b32 a48, 0
v_mfma_f32_16x16x32_bf16 v[172:175], a[64:67], a[100:103], v[172:175]
ds_read_b64_tr_b16 a[82:83], v242 offset:17408
v_mfma_f32_16x16x32_bf16 v[204:207], a[64:67], a[104:107], v[204:207]
ds_read_b64_tr_b16 a[84:85], v243 offset:16384
v_accvgpr_write_b32 a49, 0
v_mfma_f32_16x16x32_bf16 v[144:147], a[68:71], a[96:99], v[144:147]
ds_read_b64_tr_b16 a[86:87], v243 offset:17408
ds_read_b128 a[108:111], v237 offset:6144
v_mfma_f32_16x16x32_bf16 v[176:179], a[68:71], a[100:103], v[176:179]
v_mfma_f32_16x16x32_bf16 v[208:211], a[68:71], a[104:107], v[208:211]
ds_read_b64_tr_b16 a[88:89], v244 offset:16384
s_waitcnt lgkmcnt(6)
v_mfma_f32_16x16x32_bf16 v[148:151], a[72:75], a[96:99], v[148:151]
v_accvgpr_write_b32 a50, 0
ds_read_b64_tr_b16 a[90:91], v244 offset:17408
v_mfma_f32_16x16x32_bf16 v[180:183], a[72:75], a[100:103], v[180:183]
ds_read_b128 a[112:115], v237 offset:8192
v_mfma_f32_16x16x32_bf16 v[212:215], a[72:75], a[104:107], v[212:215]
buffer_load_dwordx4 v21, s[8:11], s59 offen offset:1024 nt lds
v_mfma_f32_16x16x32_bf16 v[152:155], a[76:79], a[96:99], v[152:155]
ds_read_b64_tr_b16 a[92:93], v245 offset:16384
v_accvgpr_write_b32 a51, 0
v_mfma_f32_16x16x32_bf16 v[184:187], a[76:79], a[100:103], v[184:187]
ds_read_b64_tr_b16 a[94:95], v245 offset:17408
ds_read_b128 a[116:119], v237 offset:10240
v_mfma_f32_16x16x32_bf16 v[216:219], a[76:79], a[104:107], v[216:219]
ds_read_b64_tr_b16 a[64:65], v238 offset:24576
s_waitcnt lgkmcnt(8)
v_mfma_f32_16x16x32_bf16 v[156:159], a[80:83], a[96:99], v[156:159]
v_accvgpr_write_b32 a52, 0
ds_read_b64_tr_b16 a[66:67], v238 offset:25600
v_mfma_f32_16x16x32_bf16 v[188:191], a[80:83], a[100:103], v[188:191]
v_mfma_f32_16x16x32_bf16 v[220:223], a[80:83], a[104:107], v[220:223]
ds_read_b64_tr_b16 a[68:69], v239 offset:24576
v_accvgpr_write_b32 a53, 0
v_mfma_f32_16x16x32_bf16 v[160:163], a[84:87], a[96:99], v[160:163]
ds_read_b64_tr_b16 a[70:71], v239 offset:25600
v_mfma_f32_16x16x32_bf16 v[192:195], a[84:87], a[100:103], v[192:195]
buffer_load_dwordx4 v22, s[8:11], s59 offen offset:2048 nt lds
v_mfma_f32_16x16x32_bf16 v[224:227], a[84:87], a[104:107], v[224:227]
ds_read_b64_tr_b16 a[72:73], v240 offset:24576
s_waitcnt lgkmcnt(7)
v_mfma_f32_16x16x32_bf16 v[164:167], a[88:91], a[96:99], v[164:167]
v_accvgpr_write_b32 a54, 0
ds_read_b64_tr_b16 a[74:75], v240 offset:25600
v_mfma_f32_16x16x32_bf16 v[196:199], a[88:91], a[100:103], v[196:199]
v_mfma_f32_16x16x32_bf16 v[228:231], a[88:91], a[104:107], v[228:231]
ds_read_b64_tr_b16 a[76:77], v241 offset:24576
v_accvgpr_write_b32 a55, 0
s_waitcnt lgkmcnt(8)
v_mfma_f32_16x16x32_bf16 v[168:171], a[92:95], a[96:99], v[168:171]
ds_read_b64_tr_b16 a[78:79], v241 offset:25600
v_mfma_f32_16x16x32_bf16 v[200:203], a[92:95], a[100:103], v[200:203]
v_mfma_f32_16x16x32_bf16 v[232:235], a[92:95], a[104:107], v[232:235]
ds_read_b64_tr_b16 a[80:81], v242 offset:24576
s_waitcnt lgkmcnt(5)
v_mfma_f32_16x16x32_bf16 v[140:143], a[64:67], a[108:111], v[140:143]
v_accvgpr_write_b32 a56, 0
ds_read_b64_tr_b16 a[82:83], v242 offset:25600
v_mfma_f32_16x16x32_bf16 v[172:175], a[64:67], a[112:115], v[172:175]
buffer_load_dwordx4 v23, s[8:11], s59 offen offset:3072 nt lds
v_mfma_f32_16x16x32_bf16 v[204:207], a[64:67], a[116:119], v[204:207]
ds_read_b64_tr_b16 a[84:85], v243 offset:24576
v_accvgpr_write_b32 a57, 0
v_mfma_f32_16x16x32_bf16 v[144:147], a[68:71], a[108:111], v[144:147]
ds_read_b64_tr_b16 a[86:87], v243 offset:25600
v_mfma_f32_16x16x32_bf16 v[176:179], a[68:71], a[112:115], v[176:179]
v_mfma_f32_16x16x32_bf16 v[208:211], a[68:71], a[116:119], v[208:211]
ds_read_b64_tr_b16 a[88:89], v244 offset:24576
s_waitcnt lgkmcnt(5)
v_mfma_f32_16x16x32_bf16 v[148:151], a[72:75], a[108:111], v[148:151]
v_accvgpr_write_b32 a58, 0
ds_read_b64_tr_b16 a[90:91], v244 offset:25600
v_mfma_f32_16x16x32_bf16 v[180:183], a[72:75], a[112:115], v[180:183]
v_mfma_f32_16x16x32_bf16 v[212:215], a[72:75], a[116:119], v[212:215]
ds_read_b64_tr_b16 a[92:93], v245 offset:24576
v_accvgpr_write_b32 a59, 0
v_mfma_f32_16x16x32_bf16 v[152:155], a[76:79], a[108:111], v[152:155]
ds_read_b64_tr_b16 a[94:95], v245 offset:25600
v_mfma_f32_16x16x32_bf16 v[184:187], a[76:79], a[112:115], v[184:187]
s_add_u32 s59, s59, 16384
s_and_b32 s59, s59, 0x7ffff
v_mfma_f32_16x16x32_bf16 v[216:219], a[76:79], a[116:119], v[216:219]
s_waitcnt lgkmcnt(4)
v_mfma_f32_16x16x32_bf16 v[156:159], a[80:83], a[108:111], v[156:159]
s_waitcnt lgkmcnt(0)
s_barrier
v_mfma_f32_16x16x32_bf16 v[188:191], a[80:83], a[112:115], v[188:191]
s_add_u32 m0, s65, 49152
v_mfma_f32_16x16x32_bf16 v[220:223], a[80:83], a[116:119], v[220:223]
buffer_load_dwordx4 v20, s[8:11], s59 offen nt lds
v_mfma_f32_16x16x32_bf16 v[160:163], a[84:87], a[108:111], v[160:163]
v_mfma_f32_16x16x32_bf16 v[192:195], a[84:87], a[112:115], v[192:195]
buffer_load_dwordx4 v21, s[8:11], s59 offen offset:1024 nt lds
v_mfma_f32_16x16x32_bf16 v[224:227], a[84:87], a[116:119], v[224:227]
v_mfma_f32_16x16x32_bf16 v[164:167], a[88:91], a[108:111], v[164:167]
v_mfma_f32_16x16x32_bf16 v[196:199], a[88:91], a[112:115], v[196:199]
buffer_load_dwordx4 v22, s[8:11], s59 offen offset:2048 nt lds
v_mfma_f32_16x16x32_bf16 v[228:231], a[88:91], a[116:119], v[228:231]
v_mfma_f32_16x16x32_bf16 v[168:171], a[92:95], a[108:111], v[168:171]
v_mfma_f32_16x16x32_bf16 v[200:203], a[92:95], a[112:115], v[200:203]
buffer_load_dwordx4 v23, s[8:11], s59 offen offset:3072 nt lds
v_mfma_f32_16x16x32_bf16 v[232:235], a[92:95], a[116:119], v[232:235]
s_add_u32 s59, s59, 16384
s_and_b32 s59, s59, 0x7ffff
ds_read_b128 a[64:67], v8 offset:0
ds_read_b128 a[68:71], v9 offset:0
ds_read_b128 a[72:75], v10 offset:0
ds_read_b128 a[76:79], v11 offset:0
s_mov_b32 s6, 0x3e0293ee
s_mov_b32 s7, s6
s_nop 1
v_pk_mul_f32 v[140:141], v[140:141], s[6:7]
v_pk_mul_f32 v[142:143], v[142:143], s[6:7]
v_pk_mul_f32 v[144:145], v[144:145], s[6:7]
v_pk_mul_f32 v[146:147], v[146:147], s[6:7]
v_cvt_pk_bf16_f32 v140, v140, v141
v_cvt_pk_bf16_f32 v141, v142, v143
v_cvt_pk_bf16_f32 v142, v144, v145
v_cvt_pk_bf16_f32 v143, v146, v147
v_pk_mul_f32 v[148:149], v[148:149], s[6:7]
v_pk_mul_f32 v[150:151], v[150:151], s[6:7]
v_pk_mul_f32 v[152:153], v[152:153], s[6:7]
v_pk_mul_f32 v[154:155], v[154:155], s[6:7]
v_cvt_pk_bf16_f32 v148, v148, v149
v_cvt_pk_bf16_f32 v149, v150, v151
v_cvt_pk_bf16_f32 v150, v152, v153
v_cvt_pk_bf16_f32 v151, v154, v155
v_pk_mul_f32 v[156:157], v[156:157], s[6:7]
v_pk_mul_f32 v[158:159], v[158:159], s[6:7]
v_pk_mul_f32 v[160:161], v[160:161], s[6:7]
v_pk_mul_f32 v[162:163], v[162:163], s[6:7]
v_cvt_pk_bf16_f32 v156, v156, v157
v_cvt_pk_bf16_f32 v157, v158, v159
v_cvt_pk_bf16_f32 v158, v160, v161
v_cvt_pk_bf16_f32 v159, v162, v163
v_pk_mul_f32 v[164:165], v[164:165], s[6:7]
v_pk_mul_f32 v[166:167], v[166:167], s[6:7]
v_pk_mul_f32 v[168:169], v[168:169], s[6:7]
v_pk_mul_f32 v[170:171], v[170:171], s[6:7]
v_cvt_pk_bf16_f32 v164, v164, v165
v_cvt_pk_bf16_f32 v165, v166, v167
v_cvt_pk_bf16_f32 v166, v168, v169
v_cvt_pk_bf16_f32 v167, v170, v171
s_mov_b32 exec_lo, 0xffff0000
s_mov_b32 exec_hi, 0xffff0000
v_swap_b32 v140, v142
v_swap_b32 v141, v143
v_swap_b32 v148, v150
v_swap_b32 v149, v151
v_swap_b32 v156, v158
v_swap_b32 v157, v159
v_swap_b32 v164, v166
v_swap_b32 v165, v167
s_mov_b64 exec, -1
v_accvgpr_write_b32 a0, v140
v_accvgpr_write_b32 a1, v141
v_accvgpr_write_b32 a2, v142
v_accvgpr_write_b32 a3, v143
s_waitcnt lgkmcnt(3)
v_mfma_f32_16x16x32_bf16 v[32:35], a[64:67], v[140:143], 0
v_accvgpr_write_b32 a4, v148
v_accvgpr_write_b32 a5, v149
v_accvgpr_write_b32 a6, v150
v_accvgpr_write_b32 a7, v151
s_waitcnt lgkmcnt(2)
v_mfma_f32_16x16x32_bf16 v[32:35], a[68:71], v[148:151], v[32:35]
v_accvgpr_write_b32 a8, v156
v_accvgpr_write_b32 a9, v157
v_accvgpr_write_b32 a10, v158
v_accvgpr_write_b32 a11, v159
s_waitcnt lgkmcnt(1)
v_mfma_f32_16x16x32_bf16 v[32:35], a[72:75], v[156:159], v[32:35]
v_accvgpr_write_b32 a12, v164
v_accvgpr_write_b32 a13, v165
v_accvgpr_write_b32 a14, v166
v_accvgpr_write_b32 a15, v167
s_waitcnt lgkmcnt(0)
v_mfma_f32_16x16x32_bf16 v[32:35], a[76:79], v[164:167], v[32:35]
v_pk_mul_f32 v[172:173], v[172:173], s[6:7]
v_pk_mul_f32 v[174:175], v[174:175], s[6:7]
v_pk_mul_f32 v[176:177], v[176:177], s[6:7]
v_pk_mul_f32 v[178:179], v[178:179], s[6:7]
v_cvt_pk_bf16_f32 v172, v172, v173
v_cvt_pk_bf16_f32 v173, v174, v175
v_cvt_pk_bf16_f32 v174, v176, v177
v_cvt_pk_bf16_f32 v175, v178, v179
v_pk_mul_f32 v[180:181], v[180:181], s[6:7]
v_pk_mul_f32 v[182:183], v[182:183], s[6:7]
v_pk_mul_f32 v[184:185], v[184:185], s[6:7]
v_pk_mul_f32 v[186:187], v[186:187], s[6:7]
v_cvt_pk_bf16_f32 v180, v180, v181
v_cvt_pk_bf16_f32 v181, v182, v183
v_cvt_pk_bf16_f32 v182, v184, v185
v_cvt_pk_bf16_f32 v183, v186, v187
v_pk_mul_f32 v[188:189], v[188:189], s[6:7]
v_pk_mul_f32 v[190:191], v[190:191], s[6:7]
v_pk_mul_f32 v[192:193], v[192:193], s[6:7]
v_pk_mul_f32 v[194:195], v[194:195], s[6:7]
v_cvt_pk_bf16_f32 v188, v188, v189
v_cvt_pk_bf16_f32 v189, v190, v191
v_cvt_pk_bf16_f32 v190, v192, v193
v_cvt_pk_bf16_f32 v191, v194, v195
v_pk_mul_f32 v[196:197], v[196:197], s[6:7]
v_pk_mul_f32 v[198:199], v[198:199], s[6:7]
v_pk_mul_f32 v[200:201], v[200:201], s[6:7]
v_pk_mul_f32 v[202:203], v[202:203], s[6:7]
v_cvt_pk_bf16_f32 v196, v196, v197
v_cvt_pk_bf16_f32 v197, v198, v199
v_cvt_pk_bf16_f32 v198, v200, v201
v_cvt_pk_bf16_f32 v199, v202, v203
s_mov_b32 exec_lo, 0xffff0000
s_mov_b32 exec_hi, 0xffff0000
v_swap_b32 v172, v174
v_swap_b32 v173, v175
v_swap_b32 v180, v182
v_swap_b32 v181, v183
v_swap_b32 v188, v190
v_swap_b32 v189, v191
v_swap_b32 v196, v198
v_swap_b32 v197, v199
s_mov_b64 exec, -1
v_accvgpr_write_b32 a16, v172
v_accvgpr_write_b32 a17, v173
v_accvgpr_write_b32 a18, v174
v_accvgpr_write_b32 a19, v175
v_mfma_f32_16x16x32_bf16 v[36:39], a[64:67], v[172:175], 0
v_accvgpr_write_b32 a20, v180
v_accvgpr_write_b32 a21, v181
v_accvgpr_write_b32 a22, v182
v_accvgpr_write_b32 a23, v183
v_mfma_f32_16x16x32_bf16 v[36:39], a[68:71], v[180:183], v[36:39]
v_accvgpr_write_b32 a24, v188
v_accvgpr_write_b32 a25, v189
v_accvgpr_write_b32 a26, v190
v_accvgpr_write_b32 a27, v191
v_mfma_f32_16x16x32_bf16 v[36:39], a[72:75], v[188:191], v[36:39]
v_accvgpr_write_b32 a28, v196
v_accvgpr_write_b32 a29, v197
v_accvgpr_write_b32 a30, v198
v_accvgpr_write_b32 a31, v199
v_mfma_f32_16x16x32_bf16 v[36:39], a[76:79], v[196:199], v[36:39]
v_pk_mul_f32 v[204:205], v[204:205], s[6:7]
v_pk_mul_f32 v[206:207], v[206:207], s[6:7]
v_pk_mul_f32 v[208:209], v[208:209], s[6:7]
v_pk_mul_f32 v[210:211], v[210:211], s[6:7]
v_cvt_pk_bf16_f32 v204, v204, v205
v_cvt_pk_bf16_f32 v205, v206, v207
v_cvt_pk_bf16_f32 v206, v208, v209
v_cvt_pk_bf16_f32 v207, v210, v211
v_pk_mul_f32 v[212:213], v[212:213], s[6:7]
v_pk_mul_f32 v[214:215], v[214:215], s[6:7]
v_pk_mul_f32 v[216:217], v[216:217], s[6:7]
v_pk_mul_f32 v[218:219], v[218:219], s[6:7]
v_cvt_pk_bf16_f32 v212, v212, v213
v_cvt_pk_bf16_f32 v213, v214, v215
v_cvt_pk_bf16_f32 v214, v216, v217
v_cvt_pk_bf16_f32 v215, v218, v219
v_pk_mul_f32 v[220:221], v[220:221], s[6:7]
v_pk_mul_f32 v[222:223], v[222:223], s[6:7]
v_pk_mul_f32 v[224:225], v[224:225], s[6:7]
v_pk_mul_f32 v[226:227], v[226:227], s[6:7]
v_cvt_pk_bf16_f32 v220, v220, v221
v_cvt_pk_bf16_f32 v221, v222, v223
v_cvt_pk_bf16_f32 v222, v224, v225
v_cvt_pk_bf16_f32 v223, v226, v227
v_pk_mul_f32 v[228:229], v[228:229], s[6:7]
v_pk_mul_f32 v[230:231], v[230:231], s[6:7]
v_pk_mul_f32 v[232:233], v[232:233], s[6:7]
v_pk_mul_f32 v[234:235], v[234:235], s[6:7]
v_cvt_pk_bf16_f32 v228, v228, v229
v_cvt_pk_bf16_f32 v229, v230, v231
v_cvt_pk_bf16_f32 v230, v232, v233
v_cvt_pk_bf16_f32 v231, v234, v235
s_mov_b32 exec_lo, 0xffff0000
s_mov_b32 exec_hi, 0xffff0000
v_swap_b32 v204, v206
v_swap_b32 v205, v207
v_swap_b32 v212, v214
v_swap_b32 v213, v215
v_swap_b32 v220, v222
v_swap_b32 v221, v223
v_swap_b32 v228, v230
v_swap_b32 v229, v231
s_mov_b64 exec, -1
v_accvgpr_write_b32 a32, v204
v_accvgpr_write_b32 a33, v205
v_accvgpr_write_b32 a34, v206
v_accvgpr_write_b32 a35, v207
v_mfma_f32_16x16x32_bf16 v[40:43], a[64:67], v[204:207], 0
v_accvgpr_write_b32 a36, v212
v_accvgpr_write_b32 a37, v213
v_accvgpr_write_b32 a38, v214
v_accvgpr_write_b32 a39, v215
v_mfma_f32_16x16x32_bf16 v[40:43], a[68:71], v[212:215], v[40:43]
v_accvgpr_write_b32 a40, v220
v_accvgpr_write_b32 a41, v221
v_accvgpr_write_b32 a42, v222
v_accvgpr_write_b32 a43, v223
v_mfma_f32_16x16x32_bf16 v[40:43], a[72:75], v[220:223], v[40:43]
v_accvgpr_write_b32 a44, v228
v_accvgpr_write_b32 a45, v229
v_accvgpr_write_b32 a46, v230
v_accvgpr_write_b32 a47, v231
v_mfma_f32_16x16x32_bf16 v[40:43], a[76:79], v[228:231], v[40:43]
v_readfirstlane_b32 s68, v6
v_readfirstlane_b32 s69, v7
v_max3_f32 v249, v32, v33, v34
v_max_f32 v249, v249, v35
v_max3_f32 v250, v36, v37, v38
v_max_f32 v250, v250, v39
s_nop 2
v_max3_f32 v251, v40, v41, v42
v_max_f32 v251, v251, v43
v_mov_b32 v1, v249
v_mov_b32 v2, v250
v_mov_b32 v3, v251
s_nop 0
v_permlane16_swap_b32 v249, v1
v_permlane16_swap_b32 v250, v2
v_permlane16_swap_b32 v251, v3
v_max_f32 v249, v249, v1
v_max_f32 v250, v250, v2
v_max_f32 v251, v251, v3
v_mov_b32 v1, v249
v_mov_b32 v2, v250
v_mov_b32 v3, v251
s_nop 0
v_permlane32_swap_b32 v249, v1
v_permlane32_swap_b32 v250, v2
v_permlane32_swap_b32 v251, v3
v_max_f32 v249, v249, v1
v_max_f32 v250, v250, v2
v_max_f32 v251, v251, v3
v_sub_f32 v32, 0, v249
v_sub_f32 v33, 0, v249
v_sub_f32 v34, 0, v249
v_sub_f32 v35, 0, v249
v_sub_f32 v36, 0, v250
v_sub_f32 v37, 0, v250
v_sub_f32 v38, 0, v250
v_sub_f32 v39, 0, v250
v_sub_f32 v40, 0, v251
v_sub_f32 v41, 0, v251
v_sub_f32 v42, 0, v251
v_sub_f32 v43, 0, v251
L_start:
v_mfma_f32_16x16x32_bf16 v[140:143], a[64:67], a[0:3], v[32:35]
ds_read_b128 a[80:83], v8 offset:4096
s_add_u32 m0, s65, 81920
v_mfma_f32_16x16x32_bf16 v[140:143], a[68:71], a[4:7], v[140:143]
ds_read_b128 a[84:87], v9 offset:4096
v_mfma_f32_16x16x32_bf16 v[140:143], a[72:75], a[8:11], v[140:143]
v_mfma_f32_16x16x32_bf16 v[140:143], a[76:79], a[12:15], v[140:143]
buffer_load_dwordx4 v24, s[12:15], s60 offen nt lds
v_mfma_f32_16x16x32_bf16 v[156:159], a[76:79], a[28:31], v[36:39]
ds_read_b128 a[88:91], v10 offset:4096
ds_read_b128 a[92:95], v11 offset:4096
v_mfma_f32_16x16x32_bf16 v[156:159], a[72:75], a[24:27], v[156:159]
v_mfma_f32_16x16x32_bf16 v[156:159], a[68:71], a[20:23], v[156:159]
v_mfma_f32_16x16x32_bf16 v[156:159], a[64:67], a[16:19], v[156:159]
buffer_load_dwordx4 v25, s[12:15], s60 offen offset:1024 nt lds
v_mfma_f32_16x16x32_bf16 v[172:175], a[64:67], a[32:35], v[40:43]
v_exp_f32 v140, v140
v_mfma_f32_16x16x32_bf16 v[172:175], a[68:71], a[36:39], v[172:175]
v_exp_f32 v141, v141
v_mfma_f32_16x16x32_bf16 v[172:175], a[72:75], a[40:43], v[172:175]
v_exp_f32 v142, v142
v_mfma_f32_16x16x32_bf16 v[172:175], a[76:79], a[44:47], v[172:175]
v_cvt_pk_bf16_f32 v140, v140, v141
s_waitcnt lgkmcnt(0)
v_mfma_f32_16x16x32_bf16 v[144:147], a[80:83], a[0:3], v[32:35]
v_exp_f32 v143, v143
v_mfma_f32_16x16x32_bf16 v[144:147], a[84:87], a[4:7], v[144:147]
v_exp_f32 v156, v156
v_mfma_f32_16x16x32_bf16 v[144:147], a[88:91], a[8:11], v[144:147]
v_exp_f32 v157, v157
v_mfma_f32_16x16x32_bf16 v[144:147], a[92:95], a[12:15], v[144:147]
ds_read_b128 a[64:67], v8 offset:8192
v_cvt_pk_bf16_f32 v141, v142, v143
v_mfma_f32_16x16x32_bf16 v[160:163], a[92:95], a[28:31], v[36:39]
v_exp_f32 v158, v158
v_mfma_f32_16x16x32_bf16 v[160:163], a[88:91], a[24:27], v[160:163]
v_cvt_pk_bf16_f32 v156, v156, v157
ds_read_b128 a[68:71], v9 offset:8192
v_mfma_f32_16x16x32_bf16 v[160:163], a[84:87], a[20:23], v[160:163]
v_exp_f32 v159, v159
v_mfma_f32_16x16x32_bf16 v[160:163], a[80:83], a[16:19], v[160:163]
buffer_load_dwordx4 v24, s[12:15], s60 offen offset:2048 nt lds
ds_read_b128 a[72:75], v10 offset:8192
ds_read_b128 a[76:79], v11 offset:8192
v_mfma_f32_16x16x32_bf16 v[176:179], a[80:83], a[32:35], v[40:43]
v_exp_f32 v172, v172
v_mfma_f32_16x16x32_bf16 v[176:179], a[84:87], a[36:39], v[176:179]
v_exp_f32 v173, v173
v_mfma_f32_16x16x32_bf16 v[176:179], a[88:91], a[40:43], v[176:179]
v_cvt_pk_bf16_f32 v157, v158, v159
v_mfma_f32_16x16x32_bf16 v[176:179], a[92:95], a[44:47], v[176:179]
buffer_load_dwordx4 v25, s[12:15], s60 offen offset:3072 nt lds
s_add_u32 s60, s60, 16384
s_and_b32 s60, s60, 0x7ffff
s_waitcnt lgkmcnt(0)
v_mfma_f32_16x16x32_bf16 v[148:151], a[64:67], a[0:3], v[32:35]
v_exp_f32 v174, v174
v_mfma_f32_16x16x32_bf16 v[148:151], a[68:71], a[4:7], v[148:151]
v_cvt_pk_bf16_f32 v172, v172, v173
ds_read_b128 a[80:83], v8 offset:12288
v_mfma_f32_16x16x32_bf16 v[148:151], a[72:75], a[8:11], v[148:151]
v_exp_f32 v175, v175
v_mfma_f32_16x16x32_bf16 v[148:151], a[76:79], a[12:15], v[148:151]
v_exp_f32 v144, v144
v_mfma_f32_16x16x32_bf16 v[164:167], a[76:79], a[28:31], v[36:39]
v_exp_f32 v145, v145
v_mfma_f32_16x16x32_bf16 v[164:167], a[72:75], a[24:27], v[164:167]
v_cvt_pk_bf16_f32 v173, v174, v175
ds_read_b128 a[84:87], v9 offset:12288
v_mfma_f32_16x16x32_bf16 v[164:167], a[68:71], a[20:23], v[164:167]
v_exp_f32 v146, v146
v_mfma_f32_16x16x32_bf16 v[164:167], a[64:67], a[16:19], v[164:167]
ds_read_b128 a[88:91], v10 offset:12288
ds_read_b128 a[92:95], v11 offset:12288
v_mfma_f32_16x16x32_bf16 v[180:183], a[64:67], a[32:35], v[40:43]
v_cvt_pk_bf16_f32 v142, v144, v145
v_mfma_f32_16x16x32_bf16 v[180:183], a[68:71], a[36:39], v[180:183]
v_exp_f32 v147, v147
v_mfma_f32_16x16x32_bf16 v[180:183], a[72:75], a[40:43], v[180:183]
v_exp_f32 v160, v160
v_mfma_f32_16x16x32_bf16 v[180:183], a[76:79], a[44:47], v[180:183]
s_waitcnt lgkmcnt(0)
v_mfma_f32_16x16x32_bf16 v[152:155], a[80:83], a[0:3], v[32:35]
v_exp_f32 v161, v161
v_mfma_f32_16x16x32_bf16 v[152:155], a[84:87], a[4:7], v[152:155]
v_cvt_pk_bf16_f32 v143, v146, v147
v_mfma_f32_16x16x32_bf16 v[152:155], a[88:91], a[8:11], v[152:155]
v_exp_f32 v162, v162
v_mfma_f32_16x16x32_bf16 v[152:155], a[92:95], a[12:15], v[152:155]
s_waitcnt vmcnt(12)
s_barrier
ds_read_b128 a[64:67], v8 offset:16384
v_mfma_f32_16x16x32_bf16 v[168:171], a[92:95], a[28:31], v[36:39]
v_cvt_pk_bf16_f32 v158, v160, v161
ds_read_b128 a[68:71], v9 offset:16384
v_mfma_f32_16x16x32_bf16 v[168:171], a[88:91], a[24:27], v[168:171]
v_exp_f32 v163, v163
v_mfma_f32_16x16x32_bf16 v[168:171], a[84:87], a[20:23], v[168:171]
v_exp_f32 v176, v176
v_mfma_f32_16x16x32_bf16 v[168:171], a[80:83], a[16:19], v[168:171]
ds_read_b128 a[72:75], v10 offset:16384
ds_read_b128 a[76:79], v11 offset:16384
v_mfma_f32_16x16x32_bf16 v[184:187], a[80:83], a[32:35], v[40:43]
v_exp_f32 v177, v177
v_mfma_f32_16x16x32_bf16 v[184:187], a[84:87], a[36:39], v[184:187]
v_cvt_pk_bf16_f32 v159, v162, v163
v_mfma_f32_16x16x32_bf16 v[184:187], a[88:91], a[40:43], v[184:187]
v_exp_f32 v178, v178
v_mfma_f32_16x16x32_bf16 v[184:187], a[92:95], a[44:47], v[184:187]
v_cvt_pk_bf16_f32 v174, v176, v177
v_exp_f32 v179, v179
s_waitcnt lgkmcnt(0)
v_mfma_f32_16x16x32_bf16 v[188:191], a[64:67], a[0:3], v[32:35]
v_exp_f32 v148, v148
v_mfma_f32_16x16x32_bf16 v[188:191], a[68:71], a[4:7], v[188:191]
s_add_u32 m0, s65, 0
v_mfma_f32_16x16x32_bf16 v[188:191], a[72:75], a[8:11], v[188:191]
v_exp_f32 v149, v149
v_mfma_f32_16x16x32_bf16 v[188:191], a[76:79], a[12:15], v[188:191]
ds_read_b128 a[80:83], v8 offset:20480
ds_read_b128 a[84:87], v9 offset:20480
ds_read_b128 a[88:91], v10 offset:20480
v_mfma_f32_16x16x32_bf16 v[204:207], a[76:79], a[28:31], v[36:39]
v_cvt_pk_bf16_f32 v175, v178, v179
v_mfma_f32_16x16x32_bf16 v[204:207], a[72:75], a[24:27], v[204:207]
v_exp_f32 v150, v150
v_mfma_f32_16x16x32_bf16 v[204:207], a[68:71], a[20:23], v[204:207]
v_cvt_pk_bf16_f32 v148, v148, v149
v_mfma_f32_16x16x32_bf16 v[204:207], a[64:67], a[16:19], v[204:207]
s_waitcnt vmcnt(9)
buffer_load_dwordx4 v20, s[8:11], s59 offen nt lds
ds_read_b128 a[92:95], v11 offset:20480
v_mfma_f32_16x16x32_bf16 v[220:223], a[64:67], a[32:35], v[40:43]
v_exp_f32 v151, v151
v_mfma_f32_16x16x32_bf16 v[220:223], a[68:71], a[36:39], v[220:223]
v_exp_f32 v164, v164
v_mfma_f32_16x16x32_bf16 v[220:223], a[72:75], a[40:43], v[220:223]
v_exp_f32 v165, v165
v_mfma_f32_16x16x32_bf16 v[220:223], a[76:79], a[44:47], v[220:223]
v_cvt_pk_bf16_f32 v149, v150, v151
s_waitcnt lgkmcnt(0)
v_mfma_f32_16x16x32_bf16 v[192:195], a[80:83], a[0:3], v[32:35]
v_exp_f32 v166, v166
v_mfma_f32_16x16x32_bf16 v[192:195], a[84:87], a[4:7], v[192:195]
v_cvt_pk_bf16_f32 v164, v164, v165
v_mfma_f32_16x16x32_bf16 v[192:195], a[88:91], a[8:11], v[192:195]
v_exp_f32 v167, v167
v_mfma_f32_16x16x32_bf16 v[192:195], a[92:95], a[12:15], v[192:195]
ds_read_b128 a[64:67], v8 offset:24576
s_waitcnt vmcnt(9)
buffer_load_dwordx4 v21, s[8:11], s59 offen offset:1024 nt lds
ds_read_b128 a[68:71], v9 offset:24576
ds_read_b128 a[72:75], v10 offset:24576
v_mfma_f32_16x16x32_bf16 v[208:211], a[92:95], a[28:31], v[36:39]
v_exp_f32 v180, v180
v_mfma_f32_16x16x32_bf16 v[208:211], a[88:91], a[24:27], v[208:211]
v_exp_f32 v181, v181
v_mfma_f32_16x16x32_bf16 v[208:211], a[84:87], a[20:23], v[208:211]
v_cvt_pk_bf16_f32 v165, v166, v167
v_mfma_f32_16x16x32_bf16 v[208:211], a[80:83], a[16:19], v[208:211]
ds_read_b128 a[76:79], v11 offset:24576
v_mfma_f32_16x16x32_bf16 v[224:227], a[80:83], a[32:35], v[40:43]
v_exp_f32 v182, v182
v_mfma_f32_16x16x32_bf16 v[224:227], a[84:87], a[36:39], v[224:227]
v_cvt_pk_bf16_f32 v180, v180, v181
v_mfma_f32_16x16x32_bf16 v[224:227], a[88:91], a[40:43], v[224:227]
v_exp_f32 v183, v183
v_mfma_f32_16x16x32_bf16 v[224:227], a[92:95], a[44:47], v[224:227]
s_waitcnt lgkmcnt(0)
v_mfma_f32_16x16x32_bf16 v[196:199], a[64:67], a[0:3], v[32:35]
v_exp_f32 v152, v152
v_mfma_f32_16x16x32_bf16 v[196:199], a[68:71], a[4:7], v[196:199]
v_exp_f32 v153, v153
v_mfma_f32_16x16x32_bf16 v[196:199], a[72:75], a[8:11], v[196:199]
v_cvt_pk_bf16_f32 v181, v182, v183
v_mfma_f32_16x16x32_bf16 v[196:199], a[76:79], a[12:15], v[196:199]
s_waitcnt vmcnt(8)
buffer_load_dwordx4 v22, s[8:11], s59 offen offset:2048 nt lds
ds_read_b128 a[80:83], v8 offset:28672
ds_read_b128 a[84:87], v9 offset:28672
ds_read_b128 a[88:91], v10 offset:28672
v_mfma_f32_16x16x32_bf16 v[212:215], a[76:79], a[28:31], v[36:39]
v_exp_f32 v154, v154
v_mfma_f32_16x16x32_bf16 v[212:215], a[72:75], a[24:27], v[212:215]
v_cvt_pk_bf16_f32 v150, v152, v153
v_mfma_f32_16x16x32_bf16 v[212:215], a[68:71], a[20:23], v[212:215]
v_exp_f32 v155, v155
v_mfma_f32_16x16x32_bf16 v[212:215], a[64:67], a[16:19], v[212:215]
ds_read_b128 a[92:95], v11 offset:28672
v_mfma_f32_16x16x32_bf16 v[228:231], a[64:67], a[32:35], v[40:43]
v_exp_f32 v168, v168
v_mfma_f32_16x16x32_bf16 v[228:231], a[68:71], a[36:39], v[228:231]
v_exp_f32 v169, v169
v_mfma_f32_16x16x32_bf16 v[228:231], a[72:75], a[40:43], v[228:231]
v_cvt_pk_bf16_f32 v151, v154, v155
v_mfma_f32_16x16x32_bf16 v[228:231], a[76:79], a[44:47], v[228:231]
v_exp_f32 v170, v170
v_cvt_pk_bf16_f32 v166, v168, v169
ds_read_b64_tr_b16 a[96:97], v12 offset:0
ds_read_b64_tr_b16 a[98:99], v12 offset:4096
s_waitcnt lgkmcnt(2)
v_mfma_f32_16x16x32_bf16 v[200:203], a[80:83], a[0:3], v[32:35]
v_exp_f32 v171, v171
v_mfma_f32_16x16x32_bf16 v[200:203], a[84:87], a[4:7], v[200:203]
v_exp_f32 v184, v184
v_mfma_f32_16x16x32_bf16 v[200:203], a[88:91], a[8:11], v[200:203]
v_exp_f32 v185, v185
v_mfma_f32_16x16x32_bf16 v[200:203], a[92:95], a[12:15], v[200:203]
s_waitcnt vmcnt(7)
buffer_load_dwordx4 v23, s[8:11], s59 offen offset:3072 nt lds
s_add_u32 s59, s59, 16384
s_and_b32 s59, s59, 0x7ffff
ds_read_b64_tr_b16 a[100:101], v12 offset:8192
ds_read_b64_tr_b16 a[102:103], v12 offset:12288
v_mfma_f32_16x16x32_bf16 v[216:219], a[92:95], a[28:31], v[36:39]
v_cvt_pk_bf16_f32 v167, v170, v171
v_mfma_f32_16x16x32_bf16 v[216:219], a[88:91], a[24:27], v[216:219]
v_exp_f32 v186, v186
v_mfma_f32_16x16x32_bf16 v[216:219], a[84:87], a[20:23], v[216:219]
v_cvt_pk_bf16_f32 v182, v184, v185
s_add_u32 m0, s65, 98304
v_mfma_f32_16x16x32_bf16 v[216:219], a[80:83], a[16:19], v[216:219]
ds_read_b64_tr_b16 a[104:105], v13 offset:0
ds_read_b64_tr_b16 a[106:107], v13 offset:4096
ds_read_b64_tr_b16 a[108:109], v13 offset:8192
ds_read_b64_tr_b16 a[110:111], v13 offset:12288
v_mfma_f32_16x16x32_bf16 v[232:235], a[80:83], a[32:35], v[40:43]
v_exp_f32 v187, v187
v_mfma_f32_16x16x32_bf16 v[232:235], a[84:87], a[36:39], v[232:235]
v_cvt_pk_bf16_f32 v183, v186, v187
v_mfma_f32_16x16x32_bf16 v[232:235], a[88:91], a[40:43], v[232:235]
v_exp_f32 v188, v188
v_mfma_f32_16x16x32_bf16 v[232:235], a[92:95], a[44:47], v[232:235]
ds_read_b64_tr_b16 a[112:113], v14 offset:0
s_waitcnt lgkmcnt(5)
v_mfma_f32_16x16x32_bf16 v[44:47], a[96:99], v[140:143], v[44:47]
v_exp_f32 v189, v189
v_mfma_f32_16x16x32_bf16 v[44:47], a[100:103], v[148:151], v[44:47]
s_waitcnt vmcnt(6)
buffer_load_dwordx4 v24, s[12:15], s60 offen nt lds
ds_read_b64_tr_b16 a[114:115], v14 offset:4096
v_mfma_f32_16x16x32_bf16 v[76:79], a[100:103], v[164:167], v[76:79]
v_exp_f32 v190, v190
v_mfma_f32_16x16x32_bf16 v[76:79], a[96:99], v[156:159], v[76:79]
ds_read_b64_tr_b16 a[116:117], v14 offset:8192
ds_read_b64_tr_b16 a[118:119], v14 offset:12288
v_mfma_f32_16x16x32_bf16 v[108:111], a[96:99], v[172:175], v[108:111]
v_cvt_pk_bf16_f32 v188, v188, v189
v_mfma_f32_16x16x32_bf16 v[108:111], a[100:103], v[180:183], v[108:111]
ds_read_b64_tr_b16 a[120:121], v15 offset:0
s_waitcnt lgkmcnt(5)
v_mfma_f32_16x16x32_bf16 v[48:51], a[104:107], v[140:143], v[48:51]
v_exp_f32 v191, v191
v_mfma_f32_16x16x32_bf16 v[48:51], a[108:111], v[148:151], v[48:51]
ds_read_b64_tr_b16 a[122:123], v15 offset:4096
ds_read_b64_tr_b16 a[124:125], v15 offset:8192
v_mfma_f32_16x16x32_bf16 v[80:83], a[108:111], v[164:167], v[80:83]
v_exp_f32 v204, v204
v_mfma_f32_16x16x32_bf16 v[80:83], a[104:107], v[156:159], v[80:83]
ds_read_b64_tr_b16 a[126:127], v15 offset:12288
v_mfma_f32_16x16x32_bf16 v[112:115], a[104:107], v[172:175], v[112:115]
v_exp_f32 v205, v205
v_mfma_f32_16x16x32_bf16 v[112:115], a[108:111], v[180:183], v[112:115]
v_cvt_pk_bf16_f32 v189, v190, v191
s_waitcnt vmcnt(5)
buffer_load_dwordx4 v25, s[12:15], s60 offen offset:1024 nt lds
v_mfma_f32_16x16x32_bf16 a[48:51], a[60:63], v[140:143], a[48:51]
v_exp_f32 v206, v206
v_mfma_f32_16x16x32_bf16 a[48:51], a[60:63], v[148:151], a[48:51]
v_cvt_pk_bf16_f32 v204, v204, v205
s_waitcnt lgkmcnt(4)
v_mfma_f32_16x16x32_bf16 v[52:55], a[112:115], v[140:143], v[52:55]
v_exp_f32 v207, v207
v_mfma_f32_16x16x32_bf16 v[52:55], a[116:119], v[148:151], v[52:55]
ds_read_b64_tr_b16 a[96:97], v16 offset:0
ds_read_b64_tr_b16 a[98:99], v16 offset:4096
v_mfma_f32_16x16x32_bf16 v[84:87], a[116:119], v[164:167], v[84:87]
v_exp_f32 v220, v220
v_mfma_f32_16x16x32_bf16 v[84:87], a[112:115], v[156:159], v[84:87]
ds_read_b64_tr_b16 a[100:101], v16 offset:8192
ds_read_b64_tr_b16 a[102:103], v16 offset:12288
v_mfma_f32_16x16x32_bf16 v[116:119], a[112:115], v[172:175], v[116:119]
v_exp_f32 v221, v221
v_mfma_f32_16x16x32_bf16 v[116:119], a[116:119], v[180:183], v[116:119]
v_cvt_pk_bf16_f32 v205, v206, v207
s_waitcnt lgkmcnt(4)
v_mfma_f32_16x16x32_bf16 v[56:59], a[120:123], v[140:143], v[56:59]
v_exp_f32 v222, v222
v_mfma_f32_16x16x32_bf16 v[56:59], a[124:127], v[148:151], v[56:59]
ds_read_b64_tr_b16 a[104:105], v17 offset:0
ds_read_b64_tr_b16 a[106:107], v17 offset:4096
v_mfma_f32_16x16x32_bf16 v[88:91], a[124:127], v[164:167], v[88:91]
v_cvt_pk_bf16_f32 v220, v220, v221
v_mfma_f32_16x16x32_bf16 v[88:91], a[120:123], v[156:159], v[88:91]
s_waitcnt vmcnt(4)
buffer_load_dwordx4 v24, s[12:15], s60 offen offset:2048 nt lds
ds_read_b64_tr_b16 a[108:109], v17 offset:8192
ds_read_b64_tr_b16 a[110:111], v17 offset:12288
v_mfma_f32_16x16x32_bf16 v[120:123], a[120:123], v[172:175], v[120:123]
v_exp_f32 v223, v223
v_mfma_f32_16x16x32_bf16 v[120:123], a[124:127], v[180:183], v[120:123]
v_exp_f32 v192, v192
v_mfma_f32_16x16x32_bf16 a[52:55], a[60:63], v[156:159], a[52:55]
v_exp_f32 v193, v193
v_mfma_f32_16x16x32_bf16 a[52:55], a[60:63], v[164:167], a[52:55]
v_cvt_pk_bf16_f32 v221, v222, v223
s_waitcnt lgkmcnt(4)
v_mfma_f32_16x16x32_bf16 v[60:63], a[96:99], v[140:143], v[60:63]
v_exp_f32 v194, v194
v_mfma_f32_16x16x32_bf16 v[60:63], a[100:103], v[148:151], v[60:63]
ds_read_b64_tr_b16 a[112:113], v18 offset:0
ds_read_b64_tr_b16 a[114:115], v18 offset:4096
v_mfma_f32_16x16x32_bf16 v[92:95], a[100:103], v[164:167], v[92:95]
v_cvt_pk_bf16_f32 v190, v192, v193
v_mfma_f32_16x16x32_bf16 v[92:95], a[96:99], v[156:159], v[92:95]
ds_read_b64_tr_b16 a[116:117], v18 offset:8192
ds_read_b64_tr_b16 a[118:119], v18 offset:12288
v_mfma_f32_16x16x32_bf16 v[124:127], a[96:99], v[172:175], v[124:127]
v_exp_f32 v195, v195
v_mfma_f32_16x16x32_bf16 v[124:127], a[100:103], v[180:183], v[124:127]
s_waitcnt vmcnt(4)
buffer_load_dwordx4 v25, s[12:15], s60 offen offset:3072 nt lds
s_waitcnt lgkmcnt(4)
v_mfma_f32_16x16x32_bf16 v[64:67], a[104:107], v[140:143], v[64:67]
v_exp_f32 v208, v208
v_mfma_f32_16x16x32_bf16 v[64:67], a[108:111], v[148:151], v[64:67]
s_add_u32 s60, s60, 16384
s_and_b32 s60, s60, 0x7ffff
ds_read_b64_tr_b16 a[120:121], v19 offset:0
ds_read_b64_tr_b16 a[122:123], v19 offset:4096
v_mfma_f32_16x16x32_bf16 v[96:99], a[108:111], v[164:167], v[96:99]
v_exp_f32 v209, v209
v_mfma_f32_16x16x32_bf16 v[96:99], a[104:107], v[156:159], v[96:99]
ds_read_b64_tr_b16 a[124:125], v19 offset:8192
s_barrier
ds_read_b64_tr_b16 a[126:127], v19 offset:12288
v_mfma_f32_16x16x32_bf16 v[128:131], a[104:107], v[172:175], v[128:131]
v_cvt_pk_bf16_f32 v191, v194, v195
v_mfma_f32_16x16x32_bf16 v[128:131], a[108:111], v[180:183], v[128:131]
v_exp_f32 v210, v210
v_mfma_f32_16x16x32_bf16 a[56:59], a[60:63], v[172:175], a[56:59]
v_cvt_pk_bf16_f32 v206, v208, v209
v_mfma_f32_16x16x32_bf16 a[56:59], a[60:63], v[180:183], a[56:59]
ds_read_b128 a[64:67], v8 offset:32768
s_waitcnt lgkmcnt(5)
v_mfma_f32_16x16x32_bf16 v[68:71], a[112:115], v[140:143], v[68:71]
v_exp_f32 v211, v211
v_mfma_f32_16x16x32_bf16 v[68:71], a[116:119], v[148:151], v[68:71]
v_exp_f32 v224, v224
ds_read_b128 a[68:71], v9 offset:32768
v_mfma_f32_16x16x32_bf16 v[100:103], a[116:119], v[164:167], v[100:103]
v_exp_f32 v225, v225
v_mfma_f32_16x16x32_bf16 v[100:103], a[112:115], v[156:159], v[100:103]
ds_read_b128 a[72:75], v10 offset:32768
v_cvt_pk_bf16_f32 v207, v210, v211
v_mfma_f32_16x16x32_bf16 v[132:135], a[112:115], v[172:175], v[132:135]
v_exp_f32 v226, v226
v_mfma_f32_16x16x32_bf16 v[132:135], a[116:119], v[180:183], v[132:135]
ds_read_b128 a[76:79], v11 offset:32768
s_waitcnt lgkmcnt(4)
v_mfma_f32_16x16x32_bf16 v[72:75], a[120:123], v[140:143], v[72:75]
v_cvt_pk_bf16_f32 v222, v224, v225
v_mfma_f32_16x16x32_bf16 v[72:75], a[124:127], v[148:151], v[72:75]
v_exp_f32 v227, v227
v_mfma_f32_16x16x32_bf16 v[104:107], a[124:127], v[164:167], v[104:107]
v_exp_f32 v196, v196
v_mfma_f32_16x16x32_bf16 v[104:107], a[120:123], v[156:159], v[104:107]
v_exp_f32 v197, v197
v_mfma_f32_16x16x32_bf16 v[136:139], a[120:123], v[172:175], v[136:139]
v_cvt_pk_bf16_f32 v223, v226, v227
v_mfma_f32_16x16x32_bf16 v[136:139], a[124:127], v[180:183], v[136:139]
v_exp_f32 v198, v198
v_cvt_pk_bf16_f32 v196, v196, v197
v_exp_f32 v199, v199
s_waitcnt lgkmcnt(0)
v_mfma_f32_16x16x32_bf16 v[140:143], a[64:67], a[0:3], v[32:35]
v_exp_f32 v212, v212
v_mfma_f32_16x16x32_bf16 v[140:143], a[68:71], a[4:7], v[140:143]
s_add_u32 m0, s65, 16384
v_mfma_f32_16x16x32_bf16 v[140:143], a[72:75], a[8:11], v[140:143]
v_exp_f32 v213, v213
v_mfma_f32_16x16x32_bf16 v[140:143], a[76:79], a[12:15], v[140:143]
ds_read_b128 a[80:83], v8 offset:36864
ds_read_b128 a[84:87], v9 offset:36864
ds_read_b128 a[88:91], v10 offset:36864
v_mfma_f32_16x16x32_bf16 v[156:159], a[76:79], a[28:31], v[36:39]
v_cvt_pk_bf16_f32 v197, v198, v199
v_mfma_f32_16x16x32_bf16 v[156:159], a[72:75], a[24:27], v[156:159]
v_exp_f32 v214, v214
v_mfma_f32_16x16x32_bf16 v[156:159], a[68:71], a[20:23], v[156:159]
v_cvt_pk_bf16_f32 v212, v212, v213
v_mfma_f32_16x16x32_bf16 v[156:159], a[64:67], a[16:19], v[156:159]
s_waitcnt vmcnt(4)
buffer_load_dwordx4 v20, s[8:11], s59 offen nt lds
ds_read_b128 a[92:95], v11 offset:36864
v_mfma_f32_16x16x32_bf16 v[172:175], a[64:67], a[32:35], v[40:43]
v_exp_f32 v215, v215
v_mfma_f32_16x16x32_bf16 v[172:175], a[68:71], a[36:39], v[172:175]
v_exp_f32 v228, v228
v_mfma_f32_16x16x32_bf16 v[172:175], a[72:75], a[40:43], v[172:175]
v_exp_f32 v229, v229
v_mfma_f32_16x16x32_bf16 v[172:175], a[76:79], a[44:47], v[172:175]
v_cvt_pk_bf16_f32 v213, v214, v215
s_waitcnt lgkmcnt(0)
v_mfma_f32_16x16x32_bf16 v[144:147], a[80:83], a[0:3], v[32:35]
v_exp_f32 v230, v230
v_mfma_f32_16x16x32_bf16 v[144:147], a[84:87], a[4:7], v[144:147]
v_cvt_pk_bf16_f32 v228, v228, v229
v_mfma_f32_16x16x32_bf16 v[144:147], a[88:91], a[8:11], v[144:147]
v_exp_f32 v231, v231
v_mfma_f32_16x16x32_bf16 v[144:147], a[92:95], a[12:15], v[144:147]
ds_read_b128 a[64:67], v8 offset:40960
s_waitcnt vmcnt(4)
buffer_load_dwordx4 v21, s[8:11], s59 offen offset:1024 nt lds
ds_read_b128 a[68:71], v9 offset:40960
ds_read_b128 a[72:75], v10 offset:40960
v_mfma_f32_16x16x32_bf16 v[160:163], a[92:95], a[28:31], v[36:39]
v_exp_f32 v200, v200
v_mfma_f32_16x16x32_bf16 v[160:163], a[88:91], a[24:27], v[160:163]
v_exp_f32 v201, v201
v_mfma_f32_16x16x32_bf16 v[160:163], a[84:87], a[20:23], v[160:163]
v_cvt_pk_bf16_f32 v229, v230, v231
v_mfma_f32_16x16x32_bf16 v[160:163], a[80:83], a[16:19], v[160:163]
ds_read_b128 a[76:79], v11 offset:40960
v_mfma_f32_16x16x32_bf16 v[176:179], a[80:83], a[32:35], v[40:43]
v_exp_f32 v202, v202
v_mfma_f32_16x16x32_bf16 v[176:179], a[84:87], a[36:39], v[176:179]
v_cvt_pk_bf16_f32 v198, v200, v201
v_mfma_f32_16x16x32_bf16 v[176:179], a[88:91], a[40:43], v[176:179]
v_exp_f32 v203, v203
v_mfma_f32_16x16x32_bf16 v[176:179], a[92:95], a[44:47], v[176:179]
s_waitcnt lgkmcnt(0)
v_mfma_f32_16x16x32_bf16 v[148:151], a[64:67], a[0:3], v[32:35]
v_exp_f32 v216, v216
v_mfma_f32_16x16x32_bf16 v[148:151], a[68:71], a[4:7], v[148:151]
v_exp_f32 v217, v217
v_mfma_f32_16x16x32_bf16 v[148:151], a[72:75], a[8:11], v[148:151]
v_cvt_pk_bf16_f32 v199, v202, v203
v_mfma_f32_16x16x32_bf16 v[148:151], a[76:79], a[12:15], v[148:151]
s_waitcnt vmcnt(4)
buffer_load_dwordx4 v22, s[8:11], s59 offen offset:2048 nt lds
ds_read_b128 a[80:83], v8 offset:45056
ds_read_b128 a[84:87], v9 offset:45056
ds_read_b128 a[88:91], v10 offset:45056
v_mfma_f32_16x16x32_bf16 v[164:167], a[76:79], a[28:31], v[36:39]
v_exp_f32 v218, v218
v_mfma_f32_16x16x32_bf16 v[164:167], a[72:75], a[24:27], v[164:167]
v_cvt_pk_bf16_f32 v214, v216, v217
v_mfma_f32_16x16x32_bf16 v[164:167], a[68:71], a[20:23], v[164:167]
v_exp_f32 v219, v219
v_mfma_f32_16x16x32_bf16 v[164:167], a[64:67], a[16:19], v[164:167]
ds_read_b128 a[92:95], v11 offset:45056
v_mfma_f32_16x16x32_bf16 v[180:183], a[64:67], a[32:35], v[40:43]
v_exp_f32 v232, v232
v_mfma_f32_16x16x32_bf16 v[180:183], a[68:71], a[36:39], v[180:183]
v_exp_f32 v233, v233
v_mfma_f32_16x16x32_bf16 v[180:183], a[72:75], a[40:43], v[180:183]
v_cvt_pk_bf16_f32 v215, v218, v219
v_mfma_f32_16x16x32_bf16 v[180:183], a[76:79], a[44:47], v[180:183]
v_exp_f32 v234, v234
ds_read_b64_tr_b16 a[96:97], v12 offset:16384
ds_read_b64_tr_b16 a[98:99], v12 offset:20480
s_waitcnt lgkmcnt(2)
v_mfma_f32_16x16x32_bf16 v[152:155], a[80:83], a[0:3], v[32:35]
v_cvt_pk_bf16_f32 v230, v232, v233
v_mfma_f32_16x16x32_bf16 v[152:155], a[84:87], a[4:7], v[152:155]
v_exp_f32 v235, v235
v_mfma_f32_16x16x32_bf16 v[152:155], a[88:91], a[8:11], v[152:155]
v_cvt_pk_bf16_f32 v231, v234, v235
v_mfma_f32_16x16x32_bf16 v[152:155], a[92:95], a[12:15], v[152:155]
s_waitcnt vmcnt(4)
buffer_load_dwordx4 v23, s[8:11], s59 offen offset:3072 nt lds
s_add_u32 s59, s59, 16384
s_and_b32 s59, s59, 0x7ffff
ds_read_b64_tr_b16 a[100:101], v12 offset:24576
ds_read_b64_tr_b16 a[102:103], v12 offset:28672
v_mfma_f32_16x16x32_bf16 v[168:171], a[92:95], a[28:31], v[36:39]
v_exp_f32 v140, v140
v_mfma_f32_16x16x32_bf16 v[168:171], a[88:91], a[24:27], v[168:171]
v_exp_f32 v141, v141
v_mfma_f32_16x16x32_bf16 v[168:171], a[84:87], a[20:23], v[168:171]
v_exp_f32 v142, v142
v_mfma_f32_16x16x32_bf16 v[168:171], a[80:83], a[16:19], v[168:171]
ds_read_b64_tr_b16 a[104:105], v13 offset:16384
ds_read_b64_tr_b16 a[106:107], v13 offset:20480
ds_read_b64_tr_b16 a[108:109], v13 offset:24576
ds_read_b64_tr_b16 a[110:111], v13 offset:28672
v_mfma_f32_16x16x32_bf16 v[184:187], a[80:83], a[32:35], v[40:43]
v_cvt_pk_bf16_f32 v140, v140, v141
s_add_u32 m0, s65, 114688
v_mfma_f32_16x16x32_bf16 v[184:187], a[84:87], a[36:39], v[184:187]
v_exp_f32 v143, v143
v_mfma_f32_16x16x32_bf16 v[184:187], a[88:91], a[40:43], v[184:187]
v_exp_f32 v156, v156
v_mfma_f32_16x16x32_bf16 v[184:187], a[92:95], a[44:47], v[184:187]
ds_read_b64_tr_b16 a[112:113], v14 offset:16384
s_waitcnt lgkmcnt(5)
v_mfma_f32_16x16x32_bf16 v[44:47], a[96:99], v[188:191], v[44:47]
v_exp_f32 v157, v157
v_mfma_f32_16x16x32_bf16 v[44:47], a[100:103], v[196:199], v[44:47]
s_waitcnt vmcnt(4)
buffer_load_dwordx4 v24, s[12:15], s60 offen nt lds
ds_read_b64_tr_b16 a[114:115], v14 offset:20480
v_mfma_f32_16x16x32_bf16 v[76:79], a[100:103], v[212:215], v[76:79]
v_cvt_pk_bf16_f32 v141, v142, v143
v_mfma_f32_16x16x32_bf16 v[76:79], a[96:99], v[204:207], v[76:79]
ds_read_b64_tr_b16 a[116:117], v14 offset:24576
ds_read_b64_tr_b16 a[118:119], v14 offset:28672
v_mfma_f32_16x16x32_bf16 v[108:111], a[96:99], v[220:223], v[108:111]
v_exp_f32 v158, v158
v_mfma_f32_16x16x32_bf16 v[108:111], a[100:103], v[228:231], v[108:111]
v_cvt_pk_bf16_f32 v156, v156, v157
s_waitcnt lgkmcnt(4)
v_mfma_f32_16x16x32_bf16 v[48:51], a[104:107], v[188:191], v[48:51]
v_exp_f32 v159, v159
v_mfma_f32_16x16x32_bf16 v[48:51], a[108:111], v[196:199], v[48:51]
ds_read_b64_tr_b16 a[120:121], v15 offset:16384
ds_read_b64_tr_b16 a[122:123], v15 offset:20480
v_mfma_f32_16x16x32_bf16 v[80:83], a[108:111], v[212:215], v[80:83]
v_exp_f32 v172, v172
v_mfma_f32_16x16x32_bf16 v[80:83], a[104:107], v[204:207], v[80:83]
ds_read_b64_tr_b16 a[124:125], v15 offset:24576
ds_read_b64_tr_b16 a[126:127], v15 offset:28672
v_mfma_f32_16x16x32_bf16 v[112:115], a[104:107], v[220:223], v[112:115]
v_exp_f32 v173, v173
v_mfma_f32_16x16x32_bf16 v[112:115], a[108:111], v[228:231], v[112:115]
s_waitcnt vmcnt(4)
buffer_load_dwordx4 v25, s[12:15], s60 offen offset:1024 nt lds
v_mfma_f32_16x16x32_bf16 a[48:51], a[60:63], v[188:191], a[48:51]
v_cvt_pk_bf16_f32 v157, v158, v159
v_mfma_f32_16x16x32_bf16 a[48:51], a[60:63], v[196:199], a[48:51]
ds_read_b64_tr_b16 a[96:97], v16 offset:16384
s_waitcnt lgkmcnt(5)
v_mfma_f32_16x16x32_bf16 v[52:55], a[112:115], v[188:191], v[52:55]
v_exp_f32 v174, v174
v_mfma_f32_16x16x32_bf16 v[52:55], a[116:119], v[196:199], v[52:55]
v_cvt_pk_bf16_f32 v172, v172, v173
v_exp_f32 v175, v175
ds_read_b64_tr_b16 a[98:99], v16 offset:20480
v_mfma_f32_16x16x32_bf16 v[84:87], a[116:119], v[212:215], v[84:87]
v_exp_f32 v144, v144
v_mfma_f32_16x16x32_bf16 v[84:87], a[112:115], v[204:207], v[84:87]
ds_read_b64_tr_b16 a[100:101], v16 offset:24576
ds_read_b64_tr_b16 a[102:103], v16 offset:28672
v_mfma_f32_16x16x32_bf16 v[116:119], a[112:115], v[220:223], v[116:119]
v_exp_f32 v145, v145
v_mfma_f32_16x16x32_bf16 v[116:119], a[116:119], v[228:231], v[116:119]
v_cvt_pk_bf16_f32 v173, v174, v175
s_waitcnt lgkmcnt(4)
v_mfma_f32_16x16x32_bf16 v[56:59], a[120:123], v[188:191], v[56:59]
v_exp_f32 v146, v146
v_mfma_f32_16x16x32_bf16 v[56:59], a[124:127], v[196:199], v[56:59]
ds_read_b64_tr_b16 a[104:105], v17 offset:16384
ds_read_b64_tr_b16 a[106:107], v17 offset:20480
v_mfma_f32_16x16x32_bf16 v[88:91], a[124:127], v[212:215], v[88:91]
v_cvt_pk_bf16_f32 v142, v144, v145
v_mfma_f32_16x16x32_bf16 v[88:91], a[120:123], v[204:207], v[88:91]
s_waitcnt vmcnt(4)
buffer_load_dwordx4 v24, s[12:15], s60 offen offset:2048 nt lds
ds_read_b64_tr_b16 a[108:109], v17 offset:24576
ds_read_b64_tr_b16 a[110:111], v17 offset:28672
v_mfma_f32_16x16x32_bf16 v[120:123], a[120:123], v[220:223], v[120:123]
v_exp_f32 v147, v147
v_mfma_f32_16x16x32_bf16 v[120:123], a[124:127], v[228:231], v[120:123]
v_exp_f32 v160, v160
v_mfma_f32_16x16x32_bf16 a[52:55], a[60:63], v[204:207], a[52:55]
v_exp_f32 v161, v161
v_mfma_f32_16x16x32_bf16 a[52:55], a[60:63], v[212:215], a[52:55]
v_cvt_pk_bf16_f32 v143, v146, v147
s_waitcnt lgkmcnt(4)
v_mfma_f32_16x16x32_bf16 v[60:63], a[96:99], v[188:191], v[60:63]
v_exp_f32 v162, v162
v_mfma_f32_16x16x32_bf16 v[60:63], a[100:103], v[196:199], v[60:63]
ds_read_b64_tr_b16 a[112:113], v18 offset:16384
ds_read_b64_tr_b16 a[114:115], v18 offset:20480
v_mfma_f32_16x16x32_bf16 v[92:95], a[100:103], v[212:215], v[92:95]
v_cvt_pk_bf16_f32 v158, v160, v161
v_mfma_f32_16x16x32_bf16 v[92:95], a[96:99], v[204:207], v[92:95]
ds_read_b64_tr_b16 a[116:117], v18 offset:24576
ds_read_b64_tr_b16 a[118:119], v18 offset:28672
v_mfma_f32_16x16x32_bf16 v[124:127], a[96:99], v[220:223], v[124:127]
v_exp_f32 v163, v163
v_mfma_f32_16x16x32_bf16 v[124:127], a[100:103], v[228:231], v[124:127]
s_waitcnt vmcnt(4)
buffer_load_dwordx4 v25, s[12:15], s60 offen offset:3072 nt lds
s_waitcnt lgkmcnt(4)
v_mfma_f32_16x16x32_bf16 v[64:67], a[104:107], v[188:191], v[64:67]
s_add_u32 s60, s60, 16384
s_and_b32 s60, s60, 0x7ffff
v_mfma_f32_16x16x32_bf16 v[64:67], a[108:111], v[196:199], v[64:67]
ds_read_b64_tr_b16 a[120:121], v19 offset:16384
ds_read_b64_tr_b16 a[122:123], v19 offset:20480
v_mfma_f32_16x16x32_bf16 v[96:99], a[108:111], v[212:215], v[96:99]
v_exp_f32 v176, v176
v_mfma_f32_16x16x32_bf16 v[96:99], a[104:107], v[204:207], v[96:99]
v_exp_f32 v177, v177
ds_read_b64_tr_b16 a[124:125], v19 offset:24576
s_barrier
ds_read_b64_tr_b16 a[126:127], v19 offset:28672
v_mfma_f32_16x16x32_bf16 v[128:131], a[104:107], v[220:223], v[128:131]
v_cvt_pk_bf16_f32 v159, v162, v163
v_mfma_f32_16x16x32_bf16 v[128:131], a[108:111], v[228:231], v[128:131]
v_exp_f32 v178, v178
v_mfma_f32_16x16x32_bf16 a[56:59], a[60:63], v[220:223], a[56:59]
v_cvt_pk_bf16_f32 v174, v176, v177
v_mfma_f32_16x16x32_bf16 a[56:59], a[60:63], v[228:231], a[56:59]
ds_read_b128 a[64:67], v8 offset:49152
s_waitcnt lgkmcnt(5)
v_mfma_f32_16x16x32_bf16 v[68:71], a[112:115], v[188:191], v[68:71]
v_exp_f32 v179, v179
v_mfma_f32_16x16x32_bf16 v[68:71], a[116:119], v[196:199], v[68:71]
ds_read_b128 a[68:71], v9 offset:49152
ds_read_b128 a[72:75], v10 offset:49152
v_mfma_f32_16x16x32_bf16 v[100:103], a[116:119], v[212:215], v[100:103]
v_exp_f32 v148, v148
v_mfma_f32_16x16x32_bf16 v[100:103], a[112:115], v[204:207], v[100:103]
v_exp_f32 v149, v149
v_mfma_f32_16x16x32_bf16 v[132:135], a[112:115], v[220:223], v[132:135]
v_cvt_pk_bf16_f32 v175, v178, v179
v_mfma_f32_16x16x32_bf16 v[132:135], a[116:119], v[228:231], v[132:135]
ds_read_b128 a[76:79], v11 offset:49152
s_waitcnt lgkmcnt(4)
v_mfma_f32_16x16x32_bf16 v[72:75], a[120:123], v[188:191], v[72:75]
v_exp_f32 v150, v150
v_mfma_f32_16x16x32_bf16 v[72:75], a[124:127], v[196:199], v[72:75]
v_cvt_pk_bf16_f32 v148, v148, v149
v_mfma_f32_16x16x32_bf16 v[104:107], a[124:127], v[212:215], v[104:107]
v_exp_f32 v151, v151
v_mfma_f32_16x16x32_bf16 v[104:107], a[120:123], v[204:207], v[104:107]
v_exp_f32 v164, v164
v_mfma_f32_16x16x32_bf16 v[136:139], a[120:123], v[220:223], v[136:139]
v_exp_f32 v165, v165
v_mfma_f32_16x16x32_bf16 v[136:139], a[124:127], v[228:231], v[136:139]
v_cvt_pk_bf16_f32 v149, v150, v151
v_exp_f32 v166, v166
v_cvt_pk_bf16_f32 v164, v164, v165
v_exp_f32 v167, v167
s_waitcnt lgkmcnt(0)
v_mfma_f32_16x16x32_bf16 v[188:191], a[64:67], a[0:3], v[32:35]
v_exp_f32 v180, v180
v_mfma_f32_16x16x32_bf16 v[188:191], a[68:71], a[4:7], v[188:191]
s_add_u32 m0, s65, 32768
v_mfma_f32_16x16x32_bf16 v[188:191], a[72:75], a[8:11], v[188:191]
v_exp_f32 v181, v181
v_mfma_f32_16x16x32_bf16 v[188:191], a[76:79], a[12:15], v[188:191]
ds_read_b128 a[80:83], v8 offset:53248
ds_read_b128 a[84:87], v9 offset:53248
ds_read_b128 a[88:91], v10 offset:53248
v_mfma_f32_16x16x32_bf16 v[204:207], a[76:79], a[28:31], v[36:39]
v_cvt_pk_bf16_f32 v165, v166, v167
v_mfma_f32_16x16x32_bf16 v[204:207], a[72:75], a[24:27], v[204:207]
v_exp_f32 v182, v182
v_mfma_f32_16x16x32_bf16 v[204:207], a[68:71], a[20:23], v[204:207]
v_cvt_pk_bf16_f32 v180, v180, v181
v_mfma_f32_16x16x32_bf16 v[204:207], a[64:67], a[16:19], v[204:207]
s_waitcnt vmcnt(4)
buffer_load_dwordx4 v20, s[8:11], s59 offen nt lds
ds_read_b128 a[92:95], v11 offset:53248
v_mfma_f32_16x16x32_bf16 v[220:223], a[64:67], a[32:35], v[40:43]
v_exp_f32 v183, v183
v_mfma_f32_16x16x32_bf16 v[220:223], a[68:71], a[36:39], v[220:223]
v_exp_f32 v152, v152
v_mfma_f32_16x16x32_bf16 v[220:223], a[72:75], a[40:43], v[220:223]
v_exp_f32 v153, v153
v_mfma_f32_16x16x32_bf16 v[220:223], a[76:79], a[44:47], v[220:223]
v_cvt_pk_bf16_f32 v181, v182, v183
s_waitcnt lgkmcnt(0)
v_mfma_f32_16x16x32_bf16 v[192:195], a[80:83], a[0:3], v[32:35]
v_exp_f32 v154, v154
v_mfma_f32_16x16x32_bf16 v[192:195], a[84:87], a[4:7], v[192:195]
v_cvt_pk_bf16_f32 v150, v152, v153
v_mfma_f32_16x16x32_bf16 v[192:195], a[88:91], a[8:11], v[192:195]
v_exp_f32 v155, v155
v_mfma_f32_16x16x32_bf16 v[192:195], a[92:95], a[12:15], v[192:195]
ds_read_b128 a[64:67], v8 offset:57344
s_waitcnt vmcnt(4)
buffer_load_dwordx4 v21, s[8:11], s59 offen offset:1024 nt lds
ds_read_b128 a[68:71], v9 offset:57344
ds_read_b128 a[72:75], v10 offset:57344
v_mfma_f32_16x16x32_bf16 v[208:211], a[92:95], a[28:31], v[36:39]
v_exp_f32 v168, v168
v_mfma_f32_16x16x32_bf16 v[208:211], a[88:91], a[24:27], v[208:211]
v_exp_f32 v169, v169
v_mfma_f32_16x16x32_bf16 v[208:211], a[84:87], a[20:23], v[208:211]
v_cvt_pk_bf16_f32 v151, v154, v155
v_mfma_f32_16x16x32_bf16 v[208:211], a[80:83], a[16:19], v[208:211]
ds_read_b128 a[76:79], v11 offset:57344
v_mfma_f32_16x16x32_bf16 v[224:227], a[80:83], a[32:35], v[40:43]
v_exp_f32 v170, v170
v_mfma_f32_16x16x32_bf16 v[224:227], a[84:87], a[36:39], v[224:227]
v_cvt_pk_bf16_f32 v166, v168, v169
v_mfma_f32_16x16x32_bf16 v[224:227], a[88:91], a[40:43], v[224:227]
v_exp_f32 v171, v171
v_mfma_f32_16x16x32_bf16 v[224:227], a[92:95], a[44:47], v[224:227]
s_waitcnt lgkmcnt(0)
v_mfma_f32_16x16x32_bf16 v[196:199], a[64:67], a[0:3], v[32:35]
v_exp_f32 v184, v184
v_mfma_f32_16x16x32_bf16 v[196:199], a[68:71], a[4:7], v[196:199]
v_exp_f32 v185, v185
v_mfma_f32_16x16x32_bf16 v[196:199], a[72:75], a[8:11], v[196:199]
v_cvt_pk_bf16_f32 v167, v170, v171
v_mfma_f32_16x16x32_bf16 v[196:199], a[76:79], a[12:15], v[196:199]
s_waitcnt vmcnt(4)
buffer_load_dwordx4 v22, s[8:11], s59 offen offset:2048 nt lds
ds_read_b128 a[80:83], v8 offset:61440
ds_read_b128 a[84:87], v9 offset:61440
ds_read_b128 a[88:91], v10 offset:61440
v_mfma_f32_16x16x32_bf16 v[212:215], a[76:79], a[28:31], v[36:39]
v_exp_f32 v186, v186
v_mfma_f32_16x16x32_bf16 v[212:215], a[72:75], a[24:27], v[212:215]
v_cvt_pk_bf16_f32 v182, v184, v185
v_mfma_f32_16x16x32_bf16 v[212:215], a[68:71], a[20:23], v[212:215]
v_exp_f32 v187, v187
v_mfma_f32_16x16x32_bf16 v[212:215], a[64:67], a[16:19], v[212:215]
ds_read_b128 a[92:95], v11 offset:61440
v_cvt_pk_bf16_f32 v183, v186, v187
v_mfma_f32_16x16x32_bf16 v[228:231], a[64:67], a[32:35], v[40:43]
v_exp_f32 v188, v188
v_mfma_f32_16x16x32_bf16 v[228:231], a[68:71], a[36:39], v[228:231]
v_exp_f32 v189, v189
v_mfma_f32_16x16x32_bf16 v[228:231], a[72:75], a[40:43], v[228:231]
v_exp_f32 v190, v190
v_mfma_f32_16x16x32_bf16 v[228:231], a[76:79], a[44:47], v[228:231]
ds_read_b64_tr_b16 a[96:97], v12 offset:32768
ds_read_b64_tr_b16 a[98:99], v12 offset:36864
s_waitcnt lgkmcnt(2)
v_mfma_f32_16x16x32_bf16 v[200:203], a[80:83], a[0:3], v[32:35]
v_cvt_pk_bf16_f32 v188, v188, v189
v_mfma_f32_16x16x32_bf16 v[200:203], a[84:87], a[4:7], v[200:203]
v_exp_f32 v191, v191
v_mfma_f32_16x16x32_bf16 v[200:203], a[88:91], a[8:11], v[200:203]
v_exp_f32 v204, v204
v_mfma_f32_16x16x32_bf16 v[200:203], a[92:95], a[12:15], v[200:203]
s_waitcnt vmcnt(4)
buffer_load_dwordx4 v23, s[8:11], s59 offen offset:3072 nt lds
s_add_u32 s59, s59, 16384
s_and_b32 s59, s59, 0x7ffff
ds_read_b64_tr_b16 a[100:101], v12 offset:40960
ds_read_b64_tr_b16 a[102:103], v12 offset:45056
v_mfma_f32_16x16x32_bf16 v[216:219], a[92:95], a[28:31], v[36:39]
v_exp_f32 v205, v205
v_mfma_f32_16x16x32_bf16 v[216:219], a[88:91], a[24:27], v[216:219]
v_cvt_pk_bf16_f32 v189, v190, v191
v_mfma_f32_16x16x32_bf16 v[216:219], a[84:87], a[20:23], v[216:219]
v_exp_f32 v206, v206
v_mfma_f32_16x16x32_bf16 v[216:219], a[80:83], a[16:19], v[216:219]
ds_read_b64_tr_b16 a[104:105], v13 offset:32768
ds_read_b64_tr_b16 a[106:107], v13 offset:36864
ds_read_b64_tr_b16 a[108:109], v13 offset:40960
ds_read_b64_tr_b16 a[110:111], v13 offset:45056
v_mfma_f32_16x16x32_bf16 v[232:235], a[80:83], a[32:35], v[40:43]
v_cvt_pk_bf16_f32 v204, v204, v205
s_add_u32 m0, s65, 65536
v_mfma_f32_16x16x32_bf16 v[232:235], a[84:87], a[36:39], v[232:235]
v_exp_f32 v207, v207
v_mfma_f32_16x16x32_bf16 v[232:235], a[88:91], a[40:43], v[232:235]
v_exp_f32 v220, v220
v_mfma_f32_16x16x32_bf16 v[232:235], a[92:95], a[44:47], v[232:235]
ds_read_b64_tr_b16 a[112:113], v14 offset:32768
s_waitcnt lgkmcnt(5)
v_mfma_f32_16x16x32_bf16 v[44:47], a[96:99], v[140:143], v[44:47]
v_exp_f32 v221, v221
v_mfma_f32_16x16x32_bf16 v[44:47], a[100:103], v[148:151], v[44:47]
s_waitcnt vmcnt(4)
buffer_load_dwordx4 v24, s[12:15], s60 offen nt lds
ds_read_b64_tr_b16 a[114:115], v14 offset:36864
v_mfma_f32_16x16x32_bf16 v[76:79], a[100:103], v[164:167], v[76:79]
v_cvt_pk_bf16_f32 v205, v206, v207
v_mfma_f32_16x16x32_bf16 v[76:79], a[96:99], v[156:159], v[76:79]
ds_read_b64_tr_b16 a[116:117], v14 offset:40960
ds_read_b64_tr_b16 a[118:119], v14 offset:45056
v_mfma_f32_16x16x32_bf16 v[108:111], a[96:99], v[172:175], v[108:111]
v_exp_f32 v222, v222
v_mfma_f32_16x16x32_bf16 v[108:111], a[100:103], v[180:183], v[108:111]
v_cvt_pk_bf16_f32 v220, v220, v221
s_waitcnt lgkmcnt(4)
v_mfma_f32_16x16x32_bf16 v[48:51], a[104:107], v[140:143], v[48:51]
v_exp_f32 v223, v223
v_mfma_f32_16x16x32_bf16 v[48:51], a[108:111], v[148:151], v[48:51]
ds_read_b64_tr_b16 a[120:121], v15 offset:32768
ds_read_b64_tr_b16 a[122:123], v15 offset:36864
v_mfma_f32_16x16x32_bf16 v[80:83], a[108:111], v[164:167], v[80:83]
v_exp_f32 v192, v192
v_mfma_f32_16x16x32_bf16 v[80:83], a[104:107], v[156:159], v[80:83]
ds_read_b64_tr_b16 a[124:125], v15 offset:40960
ds_read_b64_tr_b16 a[126:127], v15 offset:45056
v_mfma_f32_16x16x32_bf16 v[112:115], a[104:107], v[172:175], v[112:115]
v_exp_f32 v193, v193
v_mfma_f32_16x16x32_bf16 v[112:115], a[108:111], v[180:183], v[112:115]
s_waitcnt vmcnt(4)
buffer_load_dwordx4 v25, s[12:15], s60 offen offset:1024 nt lds
v_mfma_f32_16x16x32_bf16 a[48:51], a[60:63], v[140:143], a[48:51]
v_cvt_pk_bf16_f32 v221, v222, v223
v_mfma_f32_16x16x32_bf16 a[48:51], a[60:63], v[148:151], a[48:51]
ds_read_b64_tr_b16 a[96:97], v16 offset:32768
s_waitcnt lgkmcnt(5)
v_mfma_f32_16x16x32_bf16 v[52:55], a[112:115], v[140:143], v[52:55]
v_exp_f32 v194, v194
v_mfma_f32_16x16x32_bf16 v[52:55], a[116:119], v[148:151], v[52:55]
v_cvt_pk_bf16_f32 v190, v192, v193
ds_read_b64_tr_b16 a[98:99], v16 offset:36864
v_mfma_f32_16x16x32_bf16 v[84:87], a[116:119], v[164:167], v[84:87]
v_exp_f32 v195, v195
v_mfma_f32_16x16x32_bf16 v[84:87], a[112:115], v[156:159], v[84:87]
v_exp_f32 v208, v208
ds_read_b64_tr_b16 a[100:101], v16 offset:40960
ds_read_b64_tr_b16 a[102:103], v16 offset:45056
v_mfma_f32_16x16x32_bf16 v[116:119], a[112:115], v[172:175], v[116:119]
v_exp_f32 v209, v209
v_mfma_f32_16x16x32_bf16 v[116:119], a[116:119], v[180:183], v[116:119]
v_cvt_pk_bf16_f32 v191, v194, v195
s_waitcnt lgkmcnt(4)
v_mfma_f32_16x16x32_bf16 v[56:59], a[120:123], v[140:143], v[56:59]
v_exp_f32 v210, v210
v_mfma_f32_16x16x32_bf16 v[56:59], a[124:127], v[148:151], v[56:59]
ds_read_b64_tr_b16 a[104:105], v17 offset:32768
ds_read_b64_tr_b16 a[106:107], v17 offset:36864
v_mfma_f32_16x16x32_bf16 v[88:91], a[124:127], v[164:167], v[88:91]
v_cvt_pk_bf16_f32 v206, v208, v209
v_mfma_f32_16x16x32_bf16 v[88:91], a[120:123], v[156:159], v[88:91]
s_waitcnt vmcnt(4)
buffer_load_dwordx4 v24, s[12:15], s60 offen offset:2048 nt lds
ds_read_b64_tr_b16 a[108:109], v17 offset:40960
ds_read_b64_tr_b16 a[110:111], v17 offset:45056
v_mfma_f32_16x16x32_bf16 v[120:123], a[120:123], v[172:175], v[120:123]
v_exp_f32 v211, v211
v_mfma_f32_16x16x32_bf16 v[120:123], a[124:127], v[180:183], v[120:123]
v_exp_f32 v224, v224
v_mfma_f32_16x16x32_bf16 a[52:55], a[60:63], v[156:159], a[52:55]
v_exp_f32 v225, v225
v_mfma_f32_16x16x32_bf16 a[52:55], a[60:63], v[164:167], a[52:55]
v_cvt_pk_bf16_f32 v207, v210, v211
s_waitcnt lgkmcnt(4)
v_mfma_f32_16x16x32_bf16 v[60:63], a[96:99], v[140:143], v[60:63]
v_exp_f32 v226, v226
v_mfma_f32_16x16x32_bf16 v[60:63], a[100:103], v[148:151], v[60:63]
ds_read_b64_tr_b16 a[112:113], v18 offset:32768
ds_read_b64_tr_b16 a[114:115], v18 offset:36864
v_mfma_f32_16x16x32_bf16 v[92:95], a[100:103], v[164:167], v[92:95]
v_cvt_pk_bf16_f32 v222, v224, v225
v_mfma_f32_16x16x32_bf16 v[92:95], a[96:99], v[156:159], v[92:95]
ds_read_b64_tr_b16 a[116:117], v18 offset:40960
ds_read_b64_tr_b16 a[118:119], v18 offset:45056
v_mfma_f32_16x16x32_bf16 v[124:127], a[96:99], v[172:175], v[124:127]
v_exp_f32 v227, v227
v_mfma_f32_16x16x32_bf16 v[124:127], a[100:103], v[180:183], v[124:127]
s_waitcnt vmcnt(4)
buffer_load_dwordx4 v25, s[12:15], s60 offen offset:3072 nt lds
s_waitcnt lgkmcnt(4)
v_mfma_f32_16x16x32_bf16 v[64:67], a[104:107], v[140:143], v[64:67]
s_add_u32 s60, s60, 16384
s_and_b32 s60, s60, 0x7ffff
v_mfma_f32_16x16x32_bf16 v[64:67], a[108:111], v[148:151], v[64:67]
ds_read_b64_tr_b16 a[120:121], v19 offset:32768
ds_read_b64_tr_b16 a[122:123], v19 offset:36864
v_mfma_f32_16x16x32_bf16 v[96:99], a[108:111], v[164:167], v[96:99]
v_exp_f32 v196, v196
v_mfma_f32_16x16x32_bf16 v[96:99], a[104:107], v[156:159], v[96:99]
ds_read_b64_tr_b16 a[124:125], v19 offset:40960
s_barrier
ds_read_b64_tr_b16 a[126:127], v19 offset:45056
v_mfma_f32_16x16x32_bf16 v[128:131], a[104:107], v[172:175], v[128:131]
v_exp_f32 v197, v197
v_mfma_f32_16x16x32_bf16 v[128:131], a[108:111], v[180:183], v[128:131]
v_cvt_pk_bf16_f32 v223, v226, v227
v_mfma_f32_16x16x32_bf16 a[56:59], a[60:63], v[172:175], a[56:59]
v_exp_f32 v198, v198
v_mfma_f32_16x16x32_bf16 a[56:59], a[60:63], v[180:183], a[56:59]
v_cvt_pk_bf16_f32 v196, v196, v197
s_waitcnt lgkmcnt(4)
v_mfma_f32_16x16x32_bf16 v[68:71], a[112:115], v[140:143], v[68:71]
v_exp_f32 v199, v199
v_mfma_f32_16x16x32_bf16 v[68:71], a[116:119], v[148:151], v[68:71]
ds_read_b128 a[64:67], v8 offset:0
ds_read_b128 a[68:71], v9 offset:0
v_mfma_f32_16x16x32_bf16 v[100:103], a[116:119], v[164:167], v[100:103]
v_exp_f32 v212, v212
v_mfma_f32_16x16x32_bf16 v[100:103], a[112:115], v[156:159], v[100:103]
ds_read_b128 a[72:75], v10 offset:0
ds_read_b128 a[76:79], v11 offset:0
v_mfma_f32_16x16x32_bf16 v[132:135], a[112:115], v[172:175], v[132:135]
v_exp_f32 v213, v213
v_mfma_f32_16x16x32_bf16 v[132:135], a[116:119], v[180:183], v[132:135]
v_cvt_pk_bf16_f32 v197, v198, v199
s_waitcnt lgkmcnt(4)
v_mfma_f32_16x16x32_bf16 v[72:75], a[120:123], v[140:143], v[72:75]
v_exp_f32 v214, v214
v_mfma_f32_16x16x32_bf16 v[72:75], a[124:127], v[148:151], v[72:75]
v_cvt_pk_bf16_f32 v212, v212, v213
v_mfma_f32_16x16x32_bf16 v[104:107], a[124:127], v[164:167], v[104:107]
v_exp_f32 v215, v215
v_mfma_f32_16x16x32_bf16 v[104:107], a[120:123], v[156:159], v[104:107]
v_exp_f32 v228, v228
v_mfma_f32_16x16x32_bf16 v[136:139], a[120:123], v[172:175], v[136:139]
v_exp_f32 v229, v229
v_mfma_f32_16x16x32_bf16 v[136:139], a[124:127], v[180:183], v[136:139]
v_cvt_pk_bf16_f32 v213, v214, v215
v_exp_f32 v230, v230
v_cvt_pk_bf16_f32 v228, v228, v229
s_waitcnt lgkmcnt(0)
v_mfma_f32_16x16x32_bf16 v[140:143], a[64:67], a[0:3], v[32:35]
v_exp_f32 v231, v231
v_mfma_f32_16x16x32_bf16 v[140:143], a[68:71], a[4:7], v[140:143]
s_add_u32 m0, s65, 49152
v_mfma_f32_16x16x32_bf16 v[140:143], a[72:75], a[8:11], v[140:143]
v_exp_f32 v200, v200
v_mfma_f32_16x16x32_bf16 v[140:143], a[76:79], a[12:15], v[140:143]
ds_read_b128 a[80:83], v8 offset:4096
ds_read_b128 a[84:87], v9 offset:4096
ds_read_b128 a[88:91], v10 offset:4096
v_mfma_f32_16x16x32_bf16 v[156:159], a[76:79], a[28:31], v[36:39]
v_exp_f32 v201, v201
v_mfma_f32_16x16x32_bf16 v[156:159], a[72:75], a[24:27], v[156:159]
v_cvt_pk_bf16_f32 v229, v230, v231
v_mfma_f32_16x16x32_bf16 v[156:159], a[68:71], a[20:23], v[156:159]
v_exp_f32 v202, v202
v_mfma_f32_16x16x32_bf16 v[156:159], a[64:67], a[16:19], v[156:159]
s_waitcnt vmcnt(4)
buffer_load_dwordx4 v20, s[8:11], s59 offen nt lds
ds_read_b128 a[92:95], v11 offset:4096
v_mfma_f32_16x16x32_bf16 v[172:175], a[64:67], a[32:35], v[40:43]
v_cvt_pk_bf16_f32 v198, v200, v201
v_mfma_f32_16x16x32_bf16 v[172:175], a[68:71], a[36:39], v[172:175]
v_exp_f32 v203, v203
v_mfma_f32_16x16x32_bf16 v[172:175], a[72:75], a[40:43], v[172:175]
v_exp_f32 v216, v216
v_mfma_f32_16x16x32_bf16 v[172:175], a[76:79], a[44:47], v[172:175]
s_waitcnt lgkmcnt(0)
v_mfma_f32_16x16x32_bf16 v[144:147], a[80:83], a[0:3], v[32:35]
v_exp_f32 v217, v217
v_mfma_f32_16x16x32_bf16 v[144:147], a[84:87], a[4:7], v[144:147]
v_cvt_pk_bf16_f32 v199, v202, v203
v_mfma_f32_16x16x32_bf16 v[144:147], a[88:91], a[8:11], v[144:147]
v_exp_f32 v218, v218
v_mfma_f32_16x16x32_bf16 v[144:147], a[92:95], a[12:15], v[144:147]
ds_read_b128 a[64:67], v8 offset:8192
s_waitcnt vmcnt(4)
buffer_load_dwordx4 v21, s[8:11], s59 offen offset:1024 nt lds
ds_read_b128 a[68:71], v9 offset:8192
ds_read_b128 a[72:75], v10 offset:8192
v_mfma_f32_16x16x32_bf16 v[160:163], a[92:95], a[28:31], v[36:39]
v_cvt_pk_bf16_f32 v214, v216, v217
v_mfma_f32_16x16x32_bf16 v[160:163], a[88:91], a[24:27], v[160:163]
v_exp_f32 v219, v219
v_mfma_f32_16x16x32_bf16 v[160:163], a[84:87], a[20:23], v[160:163]
v_exp_f32 v232, v232
v_mfma_f32_16x16x32_bf16 v[160:163], a[80:83], a[16:19], v[160:163]
ds_read_b128 a[76:79], v11 offset:8192
v_mfma_f32_16x16x32_bf16 v[176:179], a[80:83], a[32:35], v[40:43]
v_exp_f32 v233, v233
v_mfma_f32_16x16x32_bf16 v[176:179], a[84:87], a[36:39], v[176:179]
v_cvt_pk_bf16_f32 v215, v218, v219
v_mfma_f32_16x16x32_bf16 v[176:179], a[88:91], a[40:43], v[176:179]
v_exp_f32 v234, v234
v_mfma_f32_16x16x32_bf16 v[176:179], a[92:95], a[44:47], v[176:179]
v_cvt_pk_bf16_f32 v230, v232, v233
s_waitcnt lgkmcnt(0)
v_mfma_f32_16x16x32_bf16 v[148:151], a[64:67], a[0:3], v[32:35]
v_exp_f32 v235, v235
v_mfma_f32_16x16x32_bf16 v[148:151], a[68:71], a[4:7], v[148:151]
v_cvt_pk_bf16_f32 v231, v234, v235
v_mfma_f32_16x16x32_bf16 v[148:151], a[72:75], a[8:11], v[148:151]
v_exp_f32 v140, v140
v_mfma_f32_16x16x32_bf16 v[148:151], a[76:79], a[12:15], v[148:151]
s_waitcnt vmcnt(4)
buffer_load_dwordx4 v22, s[8:11], s59 offen offset:2048 nt lds
ds_read_b128 a[80:83], v8 offset:12288
ds_read_b128 a[84:87], v9 offset:12288
ds_read_b128 a[88:91], v10 offset:12288
v_mfma_f32_16x16x32_bf16 v[164:167], a[76:79], a[28:31], v[36:39]
v_exp_f32 v141, v141
v_mfma_f32_16x16x32_bf16 v[164:167], a[72:75], a[24:27], v[164:167]
v_exp_f32 v142, v142
v_mfma_f32_16x16x32_bf16 v[164:167], a[68:71], a[20:23], v[164:167]
v_cvt_pk_bf16_f32 v140, v140, v141
v_mfma_f32_16x16x32_bf16 v[164:167], a[64:67], a[16:19], v[164:167]
ds_read_b128 a[92:95], v11 offset:12288
v_mfma_f32_16x16x32_bf16 v[180:183], a[64:67], a[32:35], v[40:43]
v_exp_f32 v143, v143
v_mfma_f32_16x16x32_bf16 v[180:183], a[68:71], a[36:39], v[180:183]
v_exp_f32 v156, v156
v_mfma_f32_16x16x32_bf16 v[180:183], a[72:75], a[40:43], v[180:183]
v_exp_f32 v157, v157
v_mfma_f32_16x16x32_bf16 v[180:183], a[76:79], a[44:47], v[180:183]
ds_read_b64_tr_b16 a[96:97], v12 offset:49152
ds_read_b64_tr_b16 a[98:99], v12 offset:53248
s_waitcnt lgkmcnt(2)
v_mfma_f32_16x16x32_bf16 v[152:155], a[80:83], a[0:3], v[32:35]
v_cvt_pk_bf16_f32 v141, v142, v143
v_mfma_f32_16x16x32_bf16 v[152:155], a[84:87], a[4:7], v[152:155]
v_exp_f32 v158, v158
v_mfma_f32_16x16x32_bf16 v[152:155], a[88:91], a[8:11], v[152:155]
v_cvt_pk_bf16_f32 v156, v156, v157
v_mfma_f32_16x16x32_bf16 v[152:155], a[92:95], a[12:15], v[152:155]
s_waitcnt vmcnt(4)
buffer_load_dwordx4 v23, s[8:11], s59 offen offset:3072 nt lds
s_add_u32 s59, s59, 16384
s_and_b32 s59, s59, 0x7ffff
ds_read_b64_tr_b16 a[100:101], v12 offset:57344
ds_read_b64_tr_b16 a[102:103], v12 offset:61440
v_mfma_f32_16x16x32_bf16 v[168:171], a[92:95], a[28:31], v[36:39]
v_exp_f32 v159, v159
v_mfma_f32_16x16x32_bf16 v[168:171], a[88:91], a[24:27], v[168:171]
v_exp_f32 v172, v172
v_mfma_f32_16x16x32_bf16 v[168:171], a[84:87], a[20:23], v[168:171]
v_exp_f32 v173, v173
v_mfma_f32_16x16x32_bf16 v[168:171], a[80:83], a[16:19], v[168:171]
ds_read_b64_tr_b16 a[104:105], v13 offset:49152
ds_read_b64_tr_b16 a[106:107], v13 offset:53248
ds_read_b64_tr_b16 a[108:109], v13 offset:57344
ds_read_b64_tr_b16 a[110:111], v13 offset:61440
v_mfma_f32_16x16x32_bf16 v[184:187], a[80:83], a[32:35], v[40:43]
v_cvt_pk_bf16_f32 v157, v158, v159
s_add_u32 m0, s65, 81920
v_mfma_f32_16x16x32_bf16 v[184:187], a[84:87], a[36:39], v[184:187]
v_exp_f32 v174, v174
v_mfma_f32_16x16x32_bf16 v[184:187], a[88:91], a[40:43], v[184:187]
v_cvt_pk_bf16_f32 v172, v172, v173
v_mfma_f32_16x16x32_bf16 v[184:187], a[92:95], a[44:47], v[184:187]
ds_read_b64_tr_b16 a[112:113], v14 offset:49152
s_waitcnt lgkmcnt(5)
v_mfma_f32_16x16x32_bf16 v[44:47], a[96:99], v[188:191], v[44:47]
v_exp_f32 v175, v175
v_mfma_f32_16x16x32_bf16 v[44:47], a[100:103], v[196:199], v[44:47]
s_waitcnt vmcnt(4)
buffer_load_dwordx4 v24, s[12:15], s60 offen nt lds
ds_read_b64_tr_b16 a[114:115], v14 offset:53248
v_mfma_f32_16x16x32_bf16 v[76:79], a[100:103], v[212:215], v[76:79]
v_exp_f32 v144, v144
v_mfma_f32_16x16x32_bf16 v[76:79], a[96:99], v[204:207], v[76:79]
ds_read_b64_tr_b16 a[116:117], v14 offset:57344
ds_read_b64_tr_b16 a[118:119], v14 offset:61440
v_mfma_f32_16x16x32_bf16 v[108:111], a[96:99], v[220:223], v[108:111]
v_exp_f32 v145, v145
v_mfma_f32_16x16x32_bf16 v[108:111], a[100:103], v[228:231], v[108:111]
v_cvt_pk_bf16_f32 v173, v174, v175
s_waitcnt lgkmcnt(4)
v_mfma_f32_16x16x32_bf16 v[48:51], a[104:107], v[188:191], v[48:51]
v_exp_f32 v146, v146
v_mfma_f32_16x16x32_bf16 v[48:51], a[108:111], v[196:199], v[48:51]
ds_read_b64_tr_b16 a[120:121], v15 offset:49152
ds_read_b64_tr_b16 a[122:123], v15 offset:53248
v_mfma_f32_16x16x32_bf16 v[80:83], a[108:111], v[212:215], v[80:83]
v_cvt_pk_bf16_f32 v142, v144, v145
v_mfma_f32_16x16x32_bf16 v[80:83], a[104:107], v[204:207], v[80:83]
v_exp_f32 v147, v147
ds_read_b64_tr_b16 a[124:125], v15 offset:57344
ds_read_b64_tr_b16 a[126:127], v15 offset:61440
v_mfma_f32_16x16x32_bf16 v[112:115], a[104:107], v[220:223], v[112:115]
v_exp_f32 v160, v160
v_mfma_f32_16x16x32_bf16 v[112:115], a[108:111], v[228:231], v[112:115]
s_waitcnt vmcnt(4)
buffer_load_dwordx4 v25, s[12:15], s60 offen offset:1024 nt lds
v_mfma_f32_16x16x32_bf16 a[48:51], a[60:63], v[188:191], a[48:51]
v_exp_f32 v161, v161
v_mfma_f32_16x16x32_bf16 a[48:51], a[60:63], v[196:199], a[48:51]
v_cvt_pk_bf16_f32 v143, v146, v147
s_waitcnt lgkmcnt(4)
v_mfma_f32_16x16x32_bf16 v[52:55], a[112:115], v[188:191], v[52:55]
v_exp_f32 v162, v162
v_mfma_f32_16x16x32_bf16 v[52:55], a[116:119], v[196:199], v[52:55]
ds_read_b64_tr_b16 a[96:97], v16 offset:49152
ds_read_b64_tr_b16 a[98:99], v16 offset:53248
v_mfma_f32_16x16x32_bf16 v[84:87], a[116:119], v[212:215], v[84:87]
v_cvt_pk_bf16_f32 v158, v160, v161
v_mfma_f32_16x16x32_bf16 v[84:87], a[112:115], v[204:207], v[84:87]
v_exp_f32 v163, v163
ds_read_b64_tr_b16 a[100:101], v16 offset:57344
ds_read_b64_tr_b16 a[102:103], v16 offset:61440
v_mfma_f32_16x16x32_bf16 v[116:119], a[112:115], v[220:223], v[116:119]
v_exp_f32 v176, v176
v_mfma_f32_16x16x32_bf16 v[116:119], a[116:119], v[228:231], v[116:119]
ds_read_b64_tr_b16 a[104:105], v17 offset:49152
s_waitcnt lgkmcnt(5)
v_mfma_f32_16x16x32_bf16 v[56:59], a[120:123], v[188:191], v[56:59]
v_exp_f32 v177, v177
v_mfma_f32_16x16x32_bf16 v[56:59], a[124:127], v[196:199], v[56:59]
ds_read_b64_tr_b16 a[106:107], v17 offset:53248
v_cvt_pk_bf16_f32 v159, v162, v163
v_mfma_f32_16x16x32_bf16 v[88:91], a[124:127], v[212:215], v[88:91]
v_exp_f32 v178, v178
v_mfma_f32_16x16x32_bf16 v[88:91], a[120:123], v[204:207], v[88:91]
s_waitcnt vmcnt(4)
buffer_load_dwordx4 v24, s[12:15], s60 offen offset:2048 nt lds
ds_read_b64_tr_b16 a[108:109], v17 offset:57344
ds_read_b64_tr_b16 a[110:111], v17 offset:61440
v_mfma_f32_16x16x32_bf16 v[120:123], a[120:123], v[220:223], v[120:123]
v_cvt_pk_bf16_f32 v174, v176, v177
v_mfma_f32_16x16x32_bf16 v[120:123], a[124:127], v[228:231], v[120:123]
v_exp_f32 v179, v179
v_mfma_f32_16x16x32_bf16 a[52:55], a[60:63], v[204:207], a[52:55]
v_exp_f32 v148, v148
v_mfma_f32_16x16x32_bf16 a[52:55], a[60:63], v[212:215], a[52:55]
ds_read_b64_tr_b16 a[112:113], v18 offset:49152
s_waitcnt lgkmcnt(5)
v_mfma_f32_16x16x32_bf16 v[60:63], a[96:99], v[188:191], v[60:63]
v_exp_f32 v149, v149
v_mfma_f32_16x16x32_bf16 v[60:63], a[100:103], v[196:199], v[60:63]
ds_read_b64_tr_b16 a[114:115], v18 offset:53248
v_cvt_pk_bf16_f32 v175, v178, v179
v_mfma_f32_16x16x32_bf16 v[92:95], a[100:103], v[212:215], v[92:95]
v_exp_f32 v150, v150
v_mfma_f32_16x16x32_bf16 v[92:95], a[96:99], v[204:207], v[92:95]
ds_read_b64_tr_b16 a[116:117], v18 offset:57344
ds_read_b64_tr_b16 a[118:119], v18 offset:61440
v_mfma_f32_16x16x32_bf16 v[124:127], a[96:99], v[220:223], v[124:127]
v_cvt_pk_bf16_f32 v148, v148, v149
v_mfma_f32_16x16x32_bf16 v[124:127], a[100:103], v[228:231], v[124:127]
s_waitcnt vmcnt(4)
buffer_load_dwordx4 v25, s[12:15], s60 offen offset:3072 nt lds
s_waitcnt lgkmcnt(4)
v_mfma_f32_16x16x32_bf16 v[64:67], a[104:107], v[188:191], v[64:67]
s_add_u32 s60, s60, 16384
s_and_b32 s60, s60, 0x7ffff
v_mfma_f32_16x16x32_bf16 v[64:67], a[108:111], v[196:199], v[64:67]
ds_read_b64_tr_b16 a[120:121], v19 offset:49152
ds_read_b64_tr_b16 a[122:123], v19 offset:53248
v_mfma_f32_16x16x32_bf16 v[96:99], a[108:111], v[212:215], v[96:99]
v_exp_f32 v151, v151
v_mfma_f32_16x16x32_bf16 v[96:99], a[104:107], v[204:207], v[96:99]
v_exp_f32 v164, v164
ds_read_b64_tr_b16 a[124:125], v19 offset:57344
s_barrier
ds_read_b64_tr_b16 a[126:127], v19 offset:61440
v_mfma_f32_16x16x32_bf16 v[128:131], a[104:107], v[220:223], v[128:131]
v_exp_f32 v165, v165
v_mfma_f32_16x16x32_bf16 v[128:131], a[108:111], v[228:231], v[128:131]
v_cvt_pk_bf16_f32 v149, v150, v151
v_mfma_f32_16x16x32_bf16 a[56:59], a[60:63], v[220:223], a[56:59]
v_exp_f32 v166, v166
v_mfma_f32_16x16x32_bf16 a[56:59], a[60:63], v[228:231], a[56:59]
v_cvt_pk_bf16_f32 v164, v164, v165
s_waitcnt lgkmcnt(4)
v_mfma_f32_16x16x32_bf16 v[68:71], a[112:115], v[188:191], v[68:71]
v_exp_f32 v167, v167
v_mfma_f32_16x16x32_bf16 v[68:71], a[116:119], v[196:199], v[68:71]
ds_read_b128 a[64:67], v8 offset:16384
ds_read_b128 a[68:71], v9 offset:16384
v_mfma_f32_16x16x32_bf16 v[100:103], a[116:119], v[212:215], v[100:103]
v_exp_f32 v180, v180
v_mfma_f32_16x16x32_bf16 v[100:103], a[112:115], v[204:207], v[100:103]
ds_read_b128 a[72:75], v10 offset:16384
ds_read_b128 a[76:79], v11 offset:16384
v_mfma_f32_16x16x32_bf16 v[132:135], a[112:115], v[220:223], v[132:135]
v_exp_f32 v181, v181
v_mfma_f32_16x16x32_bf16 v[132:135], a[116:119], v[228:231], v[132:135]
v_cvt_pk_bf16_f32 v165, v166, v167
s_waitcnt lgkmcnt(4)
v_mfma_f32_16x16x32_bf16 v[72:75], a[120:123], v[188:191], v[72:75]
v_exp_f32 v182, v182
v_mfma_f32_16x16x32_bf16 v[72:75], a[124:127], v[196:199], v[72:75]
v_cvt_pk_bf16_f32 v180, v180, v181
v_mfma_f32_16x16x32_bf16 v[104:107], a[124:127], v[212:215], v[104:107]
v_exp_f32 v183, v183
v_mfma_f32_16x16x32_bf16 v[104:107], a[120:123], v[204:207], v[104:107]
v_exp_f32 v152, v152
v_mfma_f32_16x16x32_bf16 v[136:139], a[120:123], v[220:223], v[136:139]
v_exp_f32 v153, v153
v_mfma_f32_16x16x32_bf16 v[136:139], a[124:127], v[228:231], v[136:139]
v_cvt_pk_bf16_f32 v181, v182, v183
v_exp_f32 v154, v154
v_cvt_pk_bf16_f32 v150, v152, v153
s_waitcnt lgkmcnt(0)
v_mfma_f32_16x16x32_bf16 v[188:191], a[64:67], a[0:3], v[32:35]
v_exp_f32 v155, v155
v_mfma_f32_16x16x32_bf16 v[188:191], a[68:71], a[4:7], v[188:191]
s_add_u32 m0, s65, 0
v_mfma_f32_16x16x32_bf16 v[188:191], a[72:75], a[8:11], v[188:191]
v_exp_f32 v168, v168
v_mfma_f32_16x16x32_bf16 v[188:191], a[76:79], a[12:15], v[188:191]
ds_read_b128 a[80:83], v8 offset:20480
ds_read_b128 a[84:87], v9 offset:20480
ds_read_b128 a[88:91], v10 offset:20480
v_mfma_f32_16x16x32_bf16 v[204:207], a[76:79], a[28:31], v[36:39]
v_exp_f32 v169, v169
v_mfma_f32_16x16x32_bf16 v[204:207], a[72:75], a[24:27], v[204:207]
v_cvt_pk_bf16_f32 v151, v154, v155
v_mfma_f32_16x16x32_bf16 v[204:207], a[68:71], a[20:23], v[204:207]
v_exp_f32 v170, v170
v_mfma_f32_16x16x32_bf16 v[204:207], a[64:67], a[16:19], v[204:207]
s_waitcnt vmcnt(4)
buffer_load_dwordx4 v20, s[8:11], s59 offen nt lds
ds_read_b128 a[92:95], v11 offset:20480
v_mfma_f32_16x16x32_bf16 v[220:223], a[64:67], a[32:35], v[40:43]
v_cvt_pk_bf16_f32 v166, v168, v169
v_mfma_f32_16x16x32_bf16 v[220:223], a[68:71], a[36:39], v[220:223]
v_exp_f32 v171, v171
v_mfma_f32_16x16x32_bf16 v[220:223], a[72:75], a[40:43], v[220:223]
v_exp_f32 v184, v184
v_mfma_f32_16x16x32_bf16 v[220:223], a[76:79], a[44:47], v[220:223]
s_waitcnt lgkmcnt(0)
v_mfma_f32_16x16x32_bf16 v[192:195], a[80:83], a[0:3], v[32:35]
v_exp_f32 v185, v185
v_mfma_f32_16x16x32_bf16 v[192:195], a[84:87], a[4:7], v[192:195]
v_cvt_pk_bf16_f32 v167, v170, v171
v_mfma_f32_16x16x32_bf16 v[192:195], a[88:91], a[8:11], v[192:195]
v_exp_f32 v186, v186
v_mfma_f32_16x16x32_bf16 v[192:195], a[92:95], a[12:15], v[192:195]
ds_read_b128 a[64:67], v8 offset:24576
s_waitcnt vmcnt(4)
buffer_load_dwordx4 v21, s[8:11], s59 offen offset:1024 nt lds
ds_read_b128 a[68:71], v9 offset:24576
ds_read_b128 a[72:75], v10 offset:24576
v_mfma_f32_16x16x32_bf16 v[208:211], a[92:95], a[28:31], v[36:39]
v_cvt_pk_bf16_f32 v182, v184, v185
v_mfma_f32_16x16x32_bf16 v[208:211], a[88:91], a[24:27], v[208:211]
v_exp_f32 v187, v187
v_mfma_f32_16x16x32_bf16 v[208:211], a[84:87], a[20:23], v[208:211]
v_cvt_pk_bf16_f32 v183, v186, v187
v_mfma_f32_16x16x32_bf16 v[208:211], a[80:83], a[16:19], v[208:211]
ds_read_b128 a[76:79], v11 offset:24576
v_mfma_f32_16x16x32_bf16 v[224:227], a[80:83], a[32:35], v[40:43]
v_exp_f32 v188, v188
v_mfma_f32_16x16x32_bf16 v[224:227], a[84:87], a[36:39], v[224:227]
v_exp_f32 v189, v189
v_mfma_f32_16x16x32_bf16 v[224:227], a[88:91], a[40:43], v[224:227]
v_exp_f32 v190, v190
v_mfma_f32_16x16x32_bf16 v[224:227], a[92:95], a[44:47], v[224:227]
v_cvt_pk_bf16_f32 v188, v188, v189
s_waitcnt lgkmcnt(0)
v_mfma_f32_16x16x32_bf16 v[196:199], a[64:67], a[0:3], v[32:35]
v_exp_f32 v191, v191
v_mfma_f32_16x16x32_bf16 v[196:199], a[68:71], a[4:7], v[196:199]
v_exp_f32 v204, v204
v_mfma_f32_16x16x32_bf16 v[196:199], a[72:75], a[8:11], v[196:199]
v_exp_f32 v205, v205
v_mfma_f32_16x16x32_bf16 v[196:199], a[76:79], a[12:15], v[196:199]
s_waitcnt vmcnt(4)
buffer_load_dwordx4 v22, s[8:11], s59 offen offset:2048 nt lds
ds_read_b128 a[80:83], v8 offset:28672
ds_read_b128 a[84:87], v9 offset:28672
ds_read_b128 a[88:91], v10 offset:28672
v_mfma_f32_16x16x32_bf16 v[212:215], a[76:79], a[28:31], v[36:39]
v_cvt_pk_bf16_f32 v189, v190, v191
v_mfma_f32_16x16x32_bf16 v[212:215], a[72:75], a[24:27], v[212:215]
v_exp_f32 v206, v206
v_mfma_f32_16x16x32_bf16 v[212:215], a[68:71], a[20:23], v[212:215]
v_cvt_pk_bf16_f32 v204, v204, v205
v_mfma_f32_16x16x32_bf16 v[212:215], a[64:67], a[16:19], v[212:215]
ds_read_b128 a[92:95], v11 offset:28672
v_mfma_f32_16x16x32_bf16 v[228:231], a[64:67], a[32:35], v[40:43]
v_exp_f32 v207, v207
v_mfma_f32_16x16x32_bf16 v[228:231], a[68:71], a[36:39], v[228:231]
v_exp_f32 v220, v220
v_mfma_f32_16x16x32_bf16 v[228:231], a[72:75], a[40:43], v[228:231]
v_exp_f32 v221, v221
v_mfma_f32_16x16x32_bf16 v[228:231], a[76:79], a[44:47], v[228:231]
ds_read_b64_tr_b16 a[96:97], v12 offset:0
ds_read_b64_tr_b16 a[98:99], v12 offset:4096
s_waitcnt lgkmcnt(2)
v_mfma_f32_16x16x32_bf16 v[200:203], a[80:83], a[0:3], v[32:35]
v_cvt_pk_bf16_f32 v205, v206, v207
v_mfma_f32_16x16x32_bf16 v[200:203], a[84:87], a[4:7], v[200:203]
v_exp_f32 v222, v222
v_mfma_f32_16x16x32_bf16 v[200:203], a[88:91], a[8:11], v[200:203]
v_cvt_pk_bf16_f32 v220, v220, v221
v_mfma_f32_16x16x32_bf16 v[200:203], a[92:95], a[12:15], v[200:203]
s_waitcnt vmcnt(4)
buffer_load_dwordx4 v23, s[8:11], s59 offen offset:3072 nt lds
s_add_u32 s59, s59, 16384
s_and_b32 s59, s59, 0x7ffff
ds_read_b64_tr_b16 a[100:101], v12 offset:8192
ds_read_b64_tr_b16 a[102:103], v12 offset:12288
v_mfma_f32_16x16x32_bf16 v[216:219], a[92:95], a[28:31], v[36:39]
v_exp_f32 v223, v223
v_mfma_f32_16x16x32_bf16 v[216:219], a[88:91], a[24:27], v[216:219]
v_exp_f32 v192, v192
v_mfma_f32_16x16x32_bf16 v[216:219], a[84:87], a[20:23], v[216:219]
v_exp_f32 v193, v193
v_mfma_f32_16x16x32_bf16 v[216:219], a[80:83], a[16:19], v[216:219]
ds_read_b64_tr_b16 a[104:105], v13 offset:0
ds_read_b64_tr_b16 a[106:107], v13 offset:4096
ds_read_b64_tr_b16 a[108:109], v13 offset:8192
ds_read_b64_tr_b16 a[110:111], v13 offset:12288
v_mfma_f32_16x16x32_bf16 v[232:235], a[80:83], a[32:35], v[40:43]
v_cvt_pk_bf16_f32 v221, v222, v223
s_add_u32 m0, s65, 98304
v_mfma_f32_16x16x32_bf16 v[232:235], a[84:87], a[36:39], v[232:235]
v_exp_f32 v194, v194
v_mfma_f32_16x16x32_bf16 v[232:235], a[88:91], a[40:43], v[232:235]
v_cvt_pk_bf16_f32 v190, v192, v193
v_mfma_f32_16x16x32_bf16 v[232:235], a[92:95], a[44:47], v[232:235]
ds_read_b64_tr_b16 a[112:113], v14 offset:0
s_waitcnt lgkmcnt(5)
v_mfma_f32_16x16x32_bf16 v[44:47], a[96:99], v[140:143], v[44:47]
v_exp_f32 v195, v195
v_mfma_f32_16x16x32_bf16 v[44:47], a[100:103], v[148:151], v[44:47]
s_waitcnt vmcnt(4)
buffer_load_dwordx4 v24, s[12:15], s60 offen nt lds
ds_read_b64_tr_b16 a[114:115], v14 offset:4096
v_mfma_f32_16x16x32_bf16 v[76:79], a[100:103], v[164:167], v[76:79]
v_exp_f32 v208, v208
v_mfma_f32_16x16x32_bf16 v[76:79], a[96:99], v[156:159], v[76:79]
ds_read_b64_tr_b16 a[116:117], v14 offset:8192
ds_read_b64_tr_b16 a[118:119], v14 offset:12288
v_mfma_f32_16x16x32_bf16 v[108:111], a[96:99], v[172:175], v[108:111]
v_exp_f32 v209, v209
v_mfma_f32_16x16x32_bf16 v[108:111], a[100:103], v[180:183], v[108:111]
v_cvt_pk_bf16_f32 v191, v194, v195
s_waitcnt lgkmcnt(4)
v_mfma_f32_16x16x32_bf16 v[48:51], a[104:107], v[140:143], v[48:51]
v_exp_f32 v210, v210
v_mfma_f32_16x16x32_bf16 v[48:51], a[108:111], v[148:151], v[48:51]
ds_read_b64_tr_b16 a[120:121], v15 offset:0
ds_read_b64_tr_b16 a[122:123], v15 offset:4096
v_mfma_f32_16x16x32_bf16 v[80:83], a[108:111], v[164:167], v[80:83]
v_cvt_pk_bf16_f32 v206, v208, v209
v_mfma_f32_16x16x32_bf16 v[80:83], a[104:107], v[156:159], v[80:83]
ds_read_b64_tr_b16 a[124:125], v15 offset:8192
ds_read_b64_tr_b16 a[126:127], v15 offset:12288
v_mfma_f32_16x16x32_bf16 v[112:115], a[104:107], v[172:175], v[112:115]
v_exp_f32 v211, v211
v_mfma_f32_16x16x32_bf16 v[112:115], a[108:111], v[180:183], v[112:115]
s_waitcnt vmcnt(4)
buffer_load_dwordx4 v25, s[12:15], s60 offen offset:1024 nt lds
v_mfma_f32_16x16x32_bf16 a[48:51], a[60:63], v[140:143], a[48:51]
v_exp_f32 v224, v224
v_mfma_f32_16x16x32_bf16 a[48:51], a[60:63], v[148:151], a[48:51]
ds_read_b64_tr_b16 a[96:97], v16 offset:0
s_waitcnt lgkmcnt(5)
v_mfma_f32_16x16x32_bf16 v[52:55], a[112:115], v[140:143], v[52:55]
v_exp_f32 v225, v225
v_mfma_f32_16x16x32_bf16 v[52:55], a[116:119], v[148:151], v[52:55]
ds_read_b64_tr_b16 a[98:99], v16 offset:4096
v_cvt_pk_bf16_f32 v207, v210, v211
v_mfma_f32_16x16x32_bf16 v[84:87], a[116:119], v[164:167], v[84:87]
v_exp_f32 v226, v226
v_mfma_f32_16x16x32_bf16 v[84:87], a[112:115], v[156:159], v[84:87]
ds_read_b64_tr_b16 a[100:101], v16 offset:8192
ds_read_b64_tr_b16 a[102:103], v16 offset:12288
v_mfma_f32_16x16x32_bf16 v[116:119], a[112:115], v[172:175], v[116:119]
v_cvt_pk_bf16_f32 v222, v224, v225
v_mfma_f32_16x16x32_bf16 v[116:119], a[116:119], v[180:183], v[116:119]
ds_read_b64_tr_b16 a[104:105], v17 offset:0
s_waitcnt lgkmcnt(5)
v_mfma_f32_16x16x32_bf16 v[56:59], a[120:123], v[140:143], v[56:59]
v_exp_f32 v227, v227
v_mfma_f32_16x16x32_bf16 v[56:59], a[124:127], v[148:151], v[56:59]
ds_read_b64_tr_b16 a[106:107], v17 offset:4096
ds_read_b64_tr_b16 a[108:109], v17 offset:8192
v_mfma_f32_16x16x32_bf16 v[88:91], a[124:127], v[164:167], v[88:91]
v_exp_f32 v196, v196
v_mfma_f32_16x16x32_bf16 v[88:91], a[120:123], v[156:159], v[88:91]
s_waitcnt vmcnt(4)
buffer_load_dwordx4 v24, s[12:15], s60 offen offset:2048 nt lds
ds_read_b64_tr_b16 a[110:111], v17 offset:12288
v_mfma_f32_16x16x32_bf16 v[120:123], a[120:123], v[172:175], v[120:123]
v_exp_f32 v197, v197
v_mfma_f32_16x16x32_bf16 v[120:123], a[124:127], v[180:183], v[120:123]
v_cvt_pk_bf16_f32 v223, v226, v227
v_mfma_f32_16x16x32_bf16 a[52:55], a[60:63], v[156:159], a[52:55]
v_exp_f32 v198, v198
v_mfma_f32_16x16x32_bf16 a[52:55], a[60:63], v[164:167], a[52:55]
v_cvt_pk_bf16_f32 v196, v196, v197
s_waitcnt lgkmcnt(4)
v_mfma_f32_16x16x32_bf16 v[60:63], a[96:99], v[140:143], v[60:63]
v_exp_f32 v199, v199
v_mfma_f32_16x16x32_bf16 v[60:63], a[100:103], v[148:151], v[60:63]
ds_read_b64_tr_b16 a[112:113], v18 offset:0
ds_read_b64_tr_b16 a[114:115], v18 offset:4096
v_mfma_f32_16x16x32_bf16 v[92:95], a[100:103], v[164:167], v[92:95]
v_exp_f32 v212, v212
v_mfma_f32_16x16x32_bf16 v[92:95], a[96:99], v[156:159], v[92:95]
ds_read_b64_tr_b16 a[116:117], v18 offset:8192
ds_read_b64_tr_b16 a[118:119], v18 offset:12288
v_mfma_f32_16x16x32_bf16 v[124:127], a[96:99], v[172:175], v[124:127]
v_exp_f32 v213, v213
v_mfma_f32_16x16x32_bf16 v[124:127], a[100:103], v[180:183], v[124:127]
s_waitcnt vmcnt(4)
buffer_load_dwordx4 v25, s[12:15], s60 offen offset:3072 nt lds
s_waitcnt lgkmcnt(4)
v_mfma_f32_16x16x32_bf16 v[64:67], a[104:107], v[140:143], v[64:67]
s_add_u32 s60, s60, 16384
s_and_b32 s60, s60, 0x7ffff
v_mfma_f32_16x16x32_bf16 v[64:67], a[108:111], v[148:151], v[64:67]
ds_read_b64_tr_b16 a[120:121], v19 offset:0
ds_read_b64_tr_b16 a[122:123], v19 offset:4096
v_mfma_f32_16x16x32_bf16 v[96:99], a[108:111], v[164:167], v[96:99]
v_cvt_pk_bf16_f32 v197, v198, v199
v_mfma_f32_16x16x32_bf16 v[96:99], a[104:107], v[156:159], v[96:99]
ds_read_b64_tr_b16 a[124:125], v19 offset:8192
s_barrier
ds_read_b64_tr_b16 a[126:127], v19 offset:12288
v_mfma_f32_16x16x32_bf16 v[128:131], a[104:107], v[172:175], v[128:131]
v_exp_f32 v214, v214
v_mfma_f32_16x16x32_bf16 v[128:131], a[108:111], v[180:183], v[128:131]
v_cvt_pk_bf16_f32 v212, v212, v213
v_mfma_f32_16x16x32_bf16 a[56:59], a[60:63], v[172:175], a[56:59]
v_exp_f32 v215, v215
v_mfma_f32_16x16x32_bf16 a[56:59], a[60:63], v[180:183], a[56:59]
ds_read_b128 a[64:67], v8 offset:32768
s_waitcnt lgkmcnt(5)
v_mfma_f32_16x16x32_bf16 v[68:71], a[112:115], v[140:143], v[68:71]
v_exp_f32 v228, v228
v_mfma_f32_16x16x32_bf16 v[68:71], a[116:119], v[148:151], v[68:71]
ds_read_b128 a[68:71], v9 offset:32768
ds_read_b128 a[72:75], v10 offset:32768
v_mfma_f32_16x16x32_bf16 v[100:103], a[116:119], v[164:167], v[100:103]
v_exp_f32 v229, v229
v_mfma_f32_16x16x32_bf16 v[100:103], a[112:115], v[156:159], v[100:103]
v_cvt_pk_bf16_f32 v213, v214, v215
ds_read_b128 a[76:79], v11 offset:32768
v_mfma_f32_16x16x32_bf16 v[132:135], a[112:115], v[172:175], v[132:135]
v_exp_f32 v230, v230
v_mfma_f32_16x16x32_bf16 v[132:135], a[116:119], v[180:183], v[132:135]
v_cvt_pk_bf16_f32 v228, v228, v229
s_waitcnt lgkmcnt(4)
v_mfma_f32_16x16x32_bf16 v[72:75], a[120:123], v[140:143], v[72:75]
v_exp_f32 v231, v231
v_mfma_f32_16x16x32_bf16 v[72:75], a[124:127], v[148:151], v[72:75]
v_exp_f32 v200, v200
v_mfma_f32_16x16x32_bf16 v[104:107], a[124:127], v[164:167], v[104:107]
v_exp_f32 v201, v201
v_mfma_f32_16x16x32_bf16 v[104:107], a[120:123], v[156:159], v[104:107]
v_cvt_pk_bf16_f32 v229, v230, v231
v_mfma_f32_16x16x32_bf16 v[136:139], a[120:123], v[172:175], v[136:139]
v_exp_f32 v202, v202
v_mfma_f32_16x16x32_bf16 v[136:139], a[124:127], v[180:183], v[136:139]
v_cvt_pk_bf16_f32 v198, v200, v201
v_exp_f32 v203, v203
s_waitcnt lgkmcnt(0)
v_mfma_f32_16x16x32_bf16 v[140:143], a[64:67], a[0:3], v[32:35]
v_exp_f32 v216, v216
v_mfma_f32_16x16x32_bf16 v[140:143], a[68:71], a[4:7], v[140:143]
s_add_u32 m0, s65, 16384
v_mfma_f32_16x16x32_bf16 v[140:143], a[72:75], a[8:11], v[140:143]
v_exp_f32 v217, v217
v_mfma_f32_16x16x32_bf16 v[140:143], a[76:79], a[12:15], v[140:143]
ds_read_b128 a[80:83], v8 offset:36864
ds_read_b128 a[84:87], v9 offset:36864
ds_read_b128 a[88:91], v10 offset:36864
v_mfma_f32_16x16x32_bf16 v[156:159], a[76:79], a[28:31], v[36:39]
v_cvt_pk_bf16_f32 v199, v202, v203
v_mfma_f32_16x16x32_bf16 v[156:159], a[72:75], a[24:27], v[156:159]
v_exp_f32 v218, v218
v_mfma_f32_16x16x32_bf16 v[156:159], a[68:71], a[20:23], v[156:159]
v_cvt_pk_bf16_f32 v214, v216, v217
v_mfma_f32_16x16x32_bf16 v[156:159], a[64:67], a[16:19], v[156:159]
s_waitcnt vmcnt(4)
buffer_load_dwordx4 v20, s[8:11], s59 offen nt lds
ds_read_b128 a[92:95], v11 offset:36864
v_mfma_f32_16x16x32_bf16 v[172:175], a[64:67], a[32:35], v[40:43]
v_exp_f32 v219, v219
v_mfma_f32_16x16x32_bf16 v[172:175], a[68:71], a[36:39], v[172:175]
v_exp_f32 v232, v232
v_mfma_f32_16x16x32_bf16 v[172:175], a[72:75], a[40:43], v[172:175]
v_exp_f32 v233, v233
v_mfma_f32_16x16x32_bf16 v[172:175], a[76:79], a[44:47], v[172:175]
v_cvt_pk_bf16_f32 v215, v218, v219
s_waitcnt lgkmcnt(0)
v_mfma_f32_16x16x32_bf16 v[144:147], a[80:83], a[0:3], v[32:35]
v_exp_f32 v234, v234
v_mfma_f32_16x16x32_bf16 v[144:147], a[84:87], a[4:7], v[144:147]
v_cvt_pk_bf16_f32 v230, v232, v233
v_mfma_f32_16x16x32_bf16 v[144:147], a[88:91], a[8:11], v[144:147]
v_exp_f32 v235, v235
v_mfma_f32_16x16x32_bf16 v[144:147], a[92:95], a[12:15], v[144:147]
ds_read_b128 a[64:67], v8 offset:40960
s_waitcnt vmcnt(4)
buffer_load_dwordx4 v21, s[8:11], s59 offen offset:1024 nt lds
ds_read_b128 a[68:71], v9 offset:40960
ds_read_b128 a[72:75], v10 offset:40960
v_mfma_f32_16x16x32_bf16 v[160:163], a[92:95], a[28:31], v[36:39]
v_cvt_pk_bf16_f32 v231, v234, v235
v_mfma_f32_16x16x32_bf16 v[160:163], a[88:91], a[24:27], v[160:163]
v_exp_f32 v140, v140
v_mfma_f32_16x16x32_bf16 v[160:163], a[84:87], a[20:23], v[160:163]
v_exp_f32 v141, v141
v_mfma_f32_16x16x32_bf16 v[160:163], a[80:83], a[16:19], v[160:163]
ds_read_b128 a[76:79], v11 offset:40960
v_mfma_f32_16x16x32_bf16 v[176:179], a[80:83], a[32:35], v[40:43]
v_exp_f32 v142, v142
v_mfma_f32_16x16x32_bf16 v[176:179], a[84:87], a[36:39], v[176:179]
v_cvt_pk_bf16_f32 v140, v140, v141
v_mfma_f32_16x16x32_bf16 v[176:179], a[88:91], a[40:43], v[176:179]
v_exp_f32 v143, v143
v_mfma_f32_16x16x32_bf16 v[176:179], a[92:95], a[44:47], v[176:179]
s_waitcnt lgkmcnt(0)
v_mfma_f32_16x16x32_bf16 v[148:151], a[64:67], a[0:3], v[32:35]
v_exp_f32 v156, v156
v_mfma_f32_16x16x32_bf16 v[148:151], a[68:71], a[4:7], v[148:151]
v_exp_f32 v157, v157
v_mfma_f32_16x16x32_bf16 v[148:151], a[72:75], a[8:11], v[148:151]
v_cvt_pk_bf16_f32 v141, v142, v143
v_mfma_f32_16x16x32_bf16 v[148:151], a[76:79], a[12:15], v[148:151]
s_waitcnt vmcnt(4)
buffer_load_dwordx4 v22, s[8:11], s59 offen offset:2048 nt lds
ds_read_b128 a[80:83], v8 offset:45056
ds_read_b128 a[84:87], v9 offset:45056
ds_read_b128 a[88:91], v10 offset:45056
v_mfma_f32_16x16x32_bf16 v[164:167], a[76:79], a[28:31], v[36:39]
v_exp_f32 v158, v158
v_mfma_f32_16x16x32_bf16 v[164:167], a[72:75], a[24:27], v[164:167]
v_cvt_pk_bf16_f32 v156, v156, v157
v_mfma_f32_16x16x32_bf16 v[164:167], a[68:71], a[20:23], v[164:167]
v_exp_f32 v159, v159
v_mfma_f32_16x16x32_bf16 v[164:167], a[64:67], a[16:19], v[164:167]
ds_read_b128 a[92:95], v11 offset:45056
v_mfma_f32_16x16x32_bf16 v[180:183], a[64:67], a[32:35], v[40:43]
v_exp_f32 v172, v172
v_mfma_f32_16x16x32_bf16 v[180:183], a[68:71], a[36:39], v[180:183]
v_exp_f32 v173, v173
v_mfma_f32_16x16x32_bf16 v[180:183], a[72:75], a[40:43], v[180:183]
v_cvt_pk_bf16_f32 v157, v158, v159
v_mfma_f32_16x16x32_bf16 v[180:183], a[76:79], a[44:47], v[180:183]
ds_read_b64_tr_b16 a[96:97], v12 offset:16384
ds_read_b64_tr_b16 a[98:99], v12 offset:20480
s_waitcnt lgkmcnt(2)
v_mfma_f32_16x16x32_bf16 v[152:155], a[80:83], a[0:3], v[32:35]
v_exp_f32 v174, v174
v_mfma_f32_16x16x32_bf16 v[152:155], a[84:87], a[4:7], v[152:155]
v_cvt_pk_bf16_f32 v172, v172, v173
v_mfma_f32_16x16x32_bf16 v[152:155], a[88:91], a[8:11], v[152:155]
v_exp_f32 v175, v175
v_mfma_f32_16x16x32_bf16 v[152:155], a[92:95], a[12:15], v[152:155]
s_waitcnt vmcnt(4)
buffer_load_dwordx4 v23, s[8:11], s59 offen offset:3072 nt lds
s_add_u32 s59, s59, 16384
s_and_b32 s59, s59, 0x7ffff
ds_read_b64_tr_b16 a[100:101], v12 offset:24576
ds_read_b64_tr_b16 a[102:103], v12 offset:28672
v_mfma_f32_16x16x32_bf16 v[168:171], a[92:95], a[28:31], v[36:39]
v_exp_f32 v144, v144
v_mfma_f32_16x16x32_bf16 v[168:171], a[88:91], a[24:27], v[168:171]
v_exp_f32 v145, v145
v_mfma_f32_16x16x32_bf16 v[168:171], a[84:87], a[20:23], v[168:171]
v_cvt_pk_bf16_f32 v173, v174, v175
s_add_u32 m0, s65, 114688
v_mfma_f32_16x16x32_bf16 v[168:171], a[80:83], a[16:19], v[168:171]
ds_read_b64_tr_b16 a[104:105], v13 offset:16384
ds_read_b64_tr_b16 a[106:107], v13 offset:20480
ds_read_b64_tr_b16 a[108:109], v13 offset:24576
ds_read_b64_tr_b16 a[110:111], v13 offset:28672
v_mfma_f32_16x16x32_bf16 v[184:187], a[80:83], a[32:35], v[40:43]
v_exp_f32 v146, v146
v_mfma_f32_16x16x32_bf16 v[184:187], a[84:87], a[36:39], v[184:187]
v_cvt_pk_bf16_f32 v142, v144, v145
v_mfma_f32_16x16x32_bf16 v[184:187], a[88:91], a[40:43], v[184:187]
v_exp_f32 v147, v147
v_mfma_f32_16x16x32_bf16 v[184:187], a[92:95], a[44:47], v[184:187]
ds_read_b64_tr_b16 a[112:113], v14 offset:16384
s_waitcnt lgkmcnt(5)
v_mfma_f32_16x16x32_bf16 v[44:47], a[96:99], v[188:191], v[44:47]
v_exp_f32 v160, v160
v_mfma_f32_16x16x32_bf16 v[44:47], a[100:103], v[196:199], v[44:47]
s_waitcnt vmcnt(4)
buffer_load_dwordx4 v24, s[12:15], s60 offen nt lds
ds_read_b64_tr_b16 a[114:115], v14 offset:20480
v_mfma_f32_16x16x32_bf16 v[76:79], a[100:103], v[212:215], v[76:79]
v_exp_f32 v161, v161
v_mfma_f32_16x16x32_bf16 v[76:79], a[96:99], v[204:207], v[76:79]
ds_read_b64_tr_b16 a[116:117], v14 offset:24576
ds_read_b64_tr_b16 a[118:119], v14 offset:28672
v_mfma_f32_16x16x32_bf16 v[108:111], a[96:99], v[220:223], v[108:111]
v_cvt_pk_bf16_f32 v143, v146, v147
v_mfma_f32_16x16x32_bf16 v[108:111], a[100:103], v[228:231], v[108:111]
ds_read_b64_tr_b16 a[120:121], v15 offset:16384
s_waitcnt lgkmcnt(5)
v_mfma_f32_16x16x32_bf16 v[48:51], a[104:107], v[188:191], v[48:51]
v_exp_f32 v162, v162
v_mfma_f32_16x16x32_bf16 v[48:51], a[108:111], v[196:199], v[48:51]
ds_read_b64_tr_b16 a[122:123], v15 offset:20480
v_cvt_pk_bf16_f32 v158, v160, v161
v_mfma_f32_16x16x32_bf16 v[80:83], a[108:111], v[212:215], v[80:83]
v_exp_f32 v163, v163
v_mfma_f32_16x16x32_bf16 v[80:83], a[104:107], v[204:207], v[80:83]
ds_read_b64_tr_b16 a[124:125], v15 offset:24576
ds_read_b64_tr_b16 a[126:127], v15 offset:28672
v_mfma_f32_16x16x32_bf16 v[112:115], a[104:107], v[220:223], v[112:115]
v_exp_f32 v176, v176
v_mfma_f32_16x16x32_bf16 v[112:115], a[108:111], v[228:231], v[112:115]
s_waitcnt vmcnt(4)
buffer_load_dwordx4 v25, s[12:15], s60 offen offset:1024 nt lds
v_mfma_f32_16x16x32_bf16 a[48:51], a[60:63], v[188:191], a[48:51]
v_exp_f32 v177, v177
v_mfma_f32_16x16x32_bf16 a[48:51], a[60:63], v[196:199], a[48:51]
v_cvt_pk_bf16_f32 v159, v162, v163
s_waitcnt lgkmcnt(4)
v_mfma_f32_16x16x32_bf16 v[52:55], a[112:115], v[188:191], v[52:55]
v_exp_f32 v178, v178
v_mfma_f32_16x16x32_bf16 v[52:55], a[116:119], v[196:199], v[52:55]
ds_read_b64_tr_b16 a[96:97], v16 offset:16384
ds_read_b64_tr_b16 a[98:99], v16 offset:20480
v_mfma_f32_16x16x32_bf16 v[84:87], a[116:119], v[212:215], v[84:87]
v_cvt_pk_bf16_f32 v174, v176, v177
v_mfma_f32_16x16x32_bf16 v[84:87], a[112:115], v[204:207], v[84:87]
ds_read_b64_tr_b16 a[100:101], v16 offset:24576
ds_read_b64_tr_b16 a[102:103], v16 offset:28672
v_mfma_f32_16x16x32_bf16 v[116:119], a[112:115], v[220:223], v[116:119]
v_exp_f32 v179, v179
v_mfma_f32_16x16x32_bf16 v[116:119], a[116:119], v[228:231], v[116:119]
ds_read_b64_tr_b16 a[104:105], v17 offset:16384
s_waitcnt lgkmcnt(5)
v_mfma_f32_16x16x32_bf16 v[56:59], a[120:123], v[188:191], v[56:59]
v_exp_f32 v148, v148
v_mfma_f32_16x16x32_bf16 v[56:59], a[124:127], v[196:199], v[56:59]
ds_read_b64_tr_b16 a[106:107], v17 offset:20480
ds_read_b64_tr_b16 a[108:109], v17 offset:24576
v_mfma_f32_16x16x32_bf16 v[88:91], a[124:127], v[212:215], v[88:91]
v_exp_f32 v149, v149
v_mfma_f32_16x16x32_bf16 v[88:91], a[120:123], v[204:207], v[88:91]
s_waitcnt vmcnt(4)
buffer_load_dwordx4 v24, s[12:15], s60 offen offset:2048 nt lds
ds_read_b64_tr_b16 a[110:111], v17 offset:28672
v_mfma_f32_16x16x32_bf16 v[120:123], a[120:123], v[220:223], v[120:123]
v_cvt_pk_bf16_f32 v175, v178, v179
v_mfma_f32_16x16x32_bf16 v[120:123], a[124:127], v[228:231], v[120:123]
v_exp_f32 v150, v150
v_mfma_f32_16x16x32_bf16 a[52:55], a[60:63], v[204:207], a[52:55]
v_cvt_pk_bf16_f32 v148, v148, v149
v_mfma_f32_16x16x32_bf16 a[52:55], a[60:63], v[212:215], a[52:55]
ds_read_b64_tr_b16 a[112:113], v18 offset:16384
s_waitcnt lgkmcnt(5)
v_mfma_f32_16x16x32_bf16 v[60:63], a[96:99], v[188:191], v[60:63]
v_exp_f32 v151, v151
v_mfma_f32_16x16x32_bf16 v[60:63], a[100:103], v[196:199], v[60:63]
ds_read_b64_tr_b16 a[114:115], v18 offset:20480
ds_read_b64_tr_b16 a[116:117], v18 offset:24576
v_mfma_f32_16x16x32_bf16 v[92:95], a[100:103], v[212:215], v[92:95]
v_exp_f32 v164, v164
v_mfma_f32_16x16x32_bf16 v[92:95], a[96:99], v[204:207], v[92:95]
ds_read_b64_tr_b16 a[118:119], v18 offset:28672
v_mfma_f32_16x16x32_bf16 v[124:127], a[96:99], v[220:223], v[124:127]
v_exp_f32 v165, v165
v_mfma_f32_16x16x32_bf16 v[124:127], a[100:103], v[228:231], v[124:127]
s_waitcnt vmcnt(4)
buffer_load_dwordx4 v25, s[12:15], s60 offen offset:3072 nt lds
s_waitcnt lgkmcnt(4)
v_mfma_f32_16x16x32_bf16 v[64:67], a[104:107], v[188:191], v[64:67]
s_add_u32 s60, s60, 16384
s_and_b32 s60, s60, 0x7ffff
v_mfma_f32_16x16x32_bf16 v[64:67], a[108:111], v[196:199], v[64:67]
ds_read_b64_tr_b16 a[120:121], v19 offset:16384
ds_read_b64_tr_b16 a[122:123], v19 offset:20480
v_mfma_f32_16x16x32_bf16 v[96:99], a[108:111], v[212:215], v[96:99]
v_cvt_pk_bf16_f32 v149, v150, v151
v_mfma_f32_16x16x32_bf16 v[96:99], a[104:107], v[204:207], v[96:99]
ds_read_b64_tr_b16 a[124:125], v19 offset:24576
s_barrier
ds_read_b64_tr_b16 a[126:127], v19 offset:28672
v_mfma_f32_16x16x32_bf16 v[128:131], a[104:107], v[220:223], v[128:131]
v_exp_f32 v166, v166
v_mfma_f32_16x16x32_bf16 v[128:131], a[108:111], v[228:231], v[128:131]
v_cvt_pk_bf16_f32 v164, v164, v165
v_mfma_f32_16x16x32_bf16 a[56:59], a[60:63], v[220:223], a[56:59]
v_exp_f32 v167, v167
v_mfma_f32_16x16x32_bf16 a[56:59], a[60:63], v[228:231], a[56:59]
ds_read_b128 a[64:67], v8 offset:49152
s_waitcnt lgkmcnt(5)
v_mfma_f32_16x16x32_bf16 v[68:71], a[112:115], v[188:191], v[68:71]
v_exp_f32 v180, v180
v_mfma_f32_16x16x32_bf16 v[68:71], a[116:119], v[196:199], v[68:71]
ds_read_b128 a[68:71], v9 offset:49152
ds_read_b128 a[72:75], v10 offset:49152
v_mfma_f32_16x16x32_bf16 v[100:103], a[116:119], v[212:215], v[100:103]
v_exp_f32 v181, v181
v_mfma_f32_16x16x32_bf16 v[100:103], a[112:115], v[204:207], v[100:103]
v_cvt_pk_bf16_f32 v165, v166, v167
ds_read_b128 a[76:79], v11 offset:49152
v_mfma_f32_16x16x32_bf16 v[132:135], a[112:115], v[220:223], v[132:135]
v_exp_f32 v182, v182
v_mfma_f32_16x16x32_bf16 v[132:135], a[116:119], v[228:231], v[132:135]
v_cvt_pk_bf16_f32 v180, v180, v181
s_waitcnt lgkmcnt(4)
v_mfma_f32_16x16x32_bf16 v[72:75], a[120:123], v[188:191], v[72:75]
v_exp_f32 v183, v183
v_mfma_f32_16x16x32_bf16 v[72:75], a[124:127], v[196:199], v[72:75]
v_exp_f32 v152, v152
v_mfma_f32_16x16x32_bf16 v[104:107], a[124:127], v[212:215], v[104:107]
v_exp_f32 v153, v153
v_mfma_f32_16x16x32_bf16 v[104:107], a[120:123], v[204:207], v[104:107]
v_cvt_pk_bf16_f32 v181, v182, v183
v_mfma_f32_16x16x32_bf16 v[136:139], a[120:123], v[220:223], v[136:139]
v_exp_f32 v154, v154
v_mfma_f32_16x16x32_bf16 v[136:139], a[124:127], v[228:231], v[136:139]
v_cvt_pk_bf16_f32 v150, v152, v153
v_exp_f32 v155, v155
s_waitcnt lgkmcnt(0)
v_mfma_f32_16x16x32_bf16 v[188:191], a[64:67], a[0:3], v[32:35]
v_exp_f32 v168, v168
v_mfma_f32_16x16x32_bf16 v[188:191], a[68:71], a[4:7], v[188:191]
s_add_u32 m0, s65, 32768
v_lshrrev_b32 v1, 4, v27
v_mfma_f32_16x16x32_bf16 v[188:191], a[72:75], a[8:11], v[188:191]
v_exp_f32 v169, v169
v_mfma_f32_16x16x32_bf16 v[188:191], a[76:79], a[12:15], v[188:191]
ds_read_b128 a[80:83], v8 offset:53248
ds_read_b128 a[84:87], v9 offset:53248
ds_read_b128 a[88:91], v10 offset:53248
v_mfma_f32_16x16x32_bf16 v[204:207], a[76:79], a[28:31], v[36:39]
v_cvt_pk_bf16_f32 v151, v154, v155
v_and_b32 v2, 15, v27
v_mfma_f32_16x16x32_bf16 v[204:207], a[72:75], a[24:27], v[204:207]
v_exp_f32 v170, v170
v_mfma_f32_16x16x32_bf16 v[204:207], a[68:71], a[20:23], v[204:207]
v_cvt_pk_bf16_f32 v166, v168, v169
v_mfma_f32_16x16x32_bf16 v[204:207], a[64:67], a[16:19], v[204:207]
s_waitcnt vmcnt(4)
buffer_load_dwordx4 v20, s[8:11], s59 offen nt lds
ds_read_b128 a[92:95], v11 offset:53248
v_mfma_f32_16x16x32_bf16 v[220:223], a[64:67], a[32:35], v[40:43]
v_exp_f32 v171, v171
v_mfma_f32_16x16x32_bf16 v[220:223], a[68:71], a[36:39], v[220:223]
v_exp_f32 v184, v184
v_mfma_f32_16x16x32_bf16 v[220:223], a[72:75], a[40:43], v[220:223]
v_exp_f32 v185, v185
v_mfma_f32_16x16x32_bf16 v[220:223], a[76:79], a[44:47], v[220:223]
v_lshrrev_b32 v4, 2, v2
s_waitcnt lgkmcnt(0)
v_mfma_f32_16x16x32_bf16 v[192:195], a[80:83], a[0:3], v[32:35]
v_cvt_pk_bf16_f32 v167, v170, v171
v_and_b32 v5, 3, v27
v_mfma_f32_16x16x32_bf16 v[192:195], a[84:87], a[4:7], v[192:195]
v_exp_f32 v186, v186
v_mfma_f32_16x16x32_bf16 v[192:195], a[88:91], a[8:11], v[192:195]
v_cvt_pk_bf16_f32 v182, v184, v185
v_lshl_add_u32 v6, v1, 2, v4
v_mfma_f32_16x16x32_bf16 v[192:195], a[92:95], a[12:15], v[192:195]
ds_read_b128 a[64:67], v8 offset:57344
s_waitcnt vmcnt(4)
buffer_load_dwordx4 v21, s[8:11], s59 offen offset:1024 nt lds
ds_read_b128 a[68:71], v9 offset:57344
ds_read_b128 a[72:75], v10 offset:57344
v_mfma_f32_16x16x32_bf16 v[208:211], a[92:95], a[28:31], v[36:39]
v_exp_f32 v187, v187
v_mfma_f32_16x16x32_bf16 v[208:211], a[88:91], a[24:27], v[208:211]
v_cvt_pk_bf16_f32 v183, v186, v187
v_and_b32 v3, 6, v6
v_mfma_f32_16x16x32_bf16 v[208:211], a[84:87], a[20:23], v[208:211]
v_exp_f32 v188, v188
v_mfma_f32_16x16x32_bf16 v[208:211], a[80:83], a[16:19], v[208:211]
ds_read_b128 a[76:79], v11 offset:57344
v_lshrrev_b32 v7, 1, v5
v_mfma_f32_16x16x32_bf16 v[224:227], a[80:83], a[32:35], v[40:43]
v_exp_f32 v189, v189
v_mfma_f32_16x16x32_bf16 v[224:227], a[84:87], a[36:39], v[224:227]
v_exp_f32 v190, v190
v_mfma_f32_16x16x32_bf16 v[224:227], a[88:91], a[40:43], v[224:227]
v_cvt_pk_bf16_f32 v188, v188, v189
v_or_b32 v3, v3, v7
v_mfma_f32_16x16x32_bf16 v[224:227], a[92:95], a[44:47], v[224:227]
s_waitcnt lgkmcnt(0)
v_mfma_f32_16x16x32_bf16 v[196:199], a[64:67], a[0:3], v[32:35]
v_exp_f32 v191, v191
v_mfma_f32_16x16x32_bf16 v[196:199], a[68:71], a[4:7], v[196:199]
v_exp_f32 v204, v204
v_mfma_f32_16x16x32_bf16 v[196:199], a[72:75], a[8:11], v[196:199]
v_exp_f32 v205, v205
v_mfma_f32_16x16x32_bf16 v[196:199], a[76:79], a[12:15], v[196:199]
s_waitcnt vmcnt(4)
buffer_load_dwordx4 v22, s[8:11], s59 offen offset:2048 nt lds
ds_read_b128 a[80:83], v8 offset:61440
ds_read_b128 a[84:87], v9 offset:61440
ds_read_b128 a[88:91], v10 offset:61440
v_mfma_f32_16x16x32_bf16 v[212:215], a[76:79], a[28:31], v[36:39]
v_cvt_pk_bf16_f32 v189, v190, v191
v_lshlrev_b32 v3, 4, v3
v_mfma_f32_16x16x32_bf16 v[212:215], a[72:75], a[24:27], v[212:215]
v_exp_f32 v206, v206
v_mfma_f32_16x16x32_bf16 v[212:215], a[68:71], a[20:23], v[212:215]
v_cvt_pk_bf16_f32 v204, v204, v205
v_lshl_add_u32 v3, v6, 7, v3
v_mfma_f32_16x16x32_bf16 v[212:215], a[64:67], a[16:19], v[212:215]
ds_read_b128 a[92:95], v11 offset:61440
v_and_b32 v7, 1, v5
v_mfma_f32_16x16x32_bf16 v[228:231], a[64:67], a[32:35], v[40:43]
v_exp_f32 v207, v207
v_mfma_f32_16x16x32_bf16 v[228:231], a[68:71], a[36:39], v[228:231]
v_exp_f32 v220, v220
v_mfma_f32_16x16x32_bf16 v[228:231], a[72:75], a[40:43], v[228:231]
v_exp_f32 v221, v221
v_mfma_f32_16x16x32_bf16 v[228:231], a[76:79], a[44:47], v[228:231]
ds_read_b64_tr_b16 a[96:97], v12 offset:32768
ds_read_b64_tr_b16 a[98:99], v12 offset:36864
s_waitcnt lgkmcnt(2)
v_mfma_f32_16x16x32_bf16 v[200:203], a[80:83], a[0:3], v[32:35]
v_cvt_pk_bf16_f32 v205, v206, v207
v_lshl_add_u32 v3, v7, 3, v3
v_mfma_f32_16x16x32_bf16 v[200:203], a[84:87], a[4:7], v[200:203]
v_exp_f32 v222, v222
v_mfma_f32_16x16x32_bf16 v[200:203], a[88:91], a[8:11], v[200:203]
v_cvt_pk_bf16_f32 v220, v220, v221
v_add_u32 v3, s65, v3
v_mfma_f32_16x16x32_bf16 v[200:203], a[92:95], a[12:15], v[200:203]
s_waitcnt vmcnt(4)
buffer_load_dwordx4 v23, s[8:11], s59 offen offset:3072 nt lds
s_add_u32 s59, s59, 16384
s_and_b32 s59, s59, 0x7ffff
ds_read_b64_tr_b16 a[100:101], v12 offset:40960
ds_read_b64_tr_b16 a[102:103], v12 offset:45056
v_mfma_f32_16x16x32_bf16 v[216:219], a[92:95], a[28:31], v[36:39]
v_exp_f32 v223, v223
v_mfma_f32_16x16x32_bf16 v[216:219], a[88:91], a[24:27], v[216:219]
v_exp_f32 v192, v192
v_mfma_f32_16x16x32_bf16 v[216:219], a[84:87], a[20:23], v[216:219]
v_exp_f32 v193, v193
v_mfma_f32_16x16x32_bf16 v[216:219], a[80:83], a[16:19], v[216:219]
ds_read_b64_tr_b16 a[104:105], v13 offset:32768
ds_read_b64_tr_b16 a[106:107], v13 offset:36864
ds_read_b64_tr_b16 a[108:109], v13 offset:40960
ds_read_b64_tr_b16 a[110:111], v13 offset:45056
v_mfma_f32_16x16x32_bf16 v[232:235], a[80:83], a[32:35], v[40:43]
v_cvt_pk_bf16_f32 v221, v222, v223
v_xor_b32 v236, 0, v3
v_mfma_f32_16x16x32_bf16 v[232:235], a[84:87], a[36:39], v[232:235]
v_exp_f32 v194, v194
v_mfma_f32_16x16x32_bf16 v[232:235], a[88:91], a[40:43], v[232:235]
s_add_u32 m0, s65, 65536
v_xor_b32 v237, 32, v3
v_mfma_f32_16x16x32_bf16 v[232:235], a[92:95], a[44:47], v[232:235]
v_cvt_pk_bf16_f32 v190, v192, v193
s_waitcnt lgkmcnt(4)
v_mfma_f32_16x16x32_bf16 v[44:47], a[96:99], v[140:143], v[44:47]
v_exp_f32 v195, v195
v_mfma_f32_16x16x32_bf16 v[44:47], a[100:103], v[148:151], v[44:47]
s_waitcnt vmcnt(4)
buffer_load_dwordx4 v24, s[12:15], s60 offen nt lds
ds_read_b64_tr_b16 a[112:113], v14 offset:32768
ds_read_b64_tr_b16 a[114:115], v14 offset:36864
v_mfma_f32_16x16x32_bf16 v[76:79], a[100:103], v[164:167], v[76:79]
v_xor_b32 v238, 64, v3
v_xor_b32 v239, 96, v3
v_mfma_f32_16x16x32_bf16 v[76:79], a[96:99], v[156:159], v[76:79]
ds_read_b64_tr_b16 a[116:117], v14 offset:40960
ds_read_b64_tr_b16 a[118:119], v14 offset:45056
v_mfma_f32_16x16x32_bf16 v[108:111], a[96:99], v[172:175], v[108:111]
v_exp_f32 v208, v208
v_mfma_f32_16x16x32_bf16 v[108:111], a[100:103], v[180:183], v[108:111]
ds_read_b64_tr_b16 a[120:121], v15 offset:32768
s_waitcnt lgkmcnt(5)
v_mfma_f32_16x16x32_bf16 v[48:51], a[104:107], v[140:143], v[48:51]
v_exp_f32 v209, v209
v_mfma_f32_16x16x32_bf16 v[48:51], a[108:111], v[148:151], v[48:51]
ds_read_b64_tr_b16 a[122:123], v15 offset:36864
v_cvt_pk_bf16_f32 v191, v194, v195
v_mfma_f32_16x16x32_bf16 v[80:83], a[108:111], v[164:167], v[80:83]
v_exp_f32 v210, v210
v_mfma_f32_16x16x32_bf16 v[80:83], a[104:107], v[156:159], v[80:83]
v_xor_b32 v240, 0, v3
ds_read_b64_tr_b16 a[124:125], v15 offset:40960
ds_read_b64_tr_b16 a[126:127], v15 offset:45056
v_mfma_f32_16x16x32_bf16 v[112:115], a[104:107], v[172:175], v[112:115]
v_cvt_pk_bf16_f32 v206, v208, v209
v_add_u32 v240, 65536, v240
v_mfma_f32_16x16x32_bf16 v[112:115], a[108:111], v[180:183], v[112:115]
s_waitcnt vmcnt(4)
buffer_load_dwordx4 v25, s[12:15], s60 offen offset:1024 nt lds
v_mfma_f32_16x16x32_bf16 a[48:51], a[60:63], v[140:143], a[48:51]
v_exp_f32 v211, v211
v_mfma_f32_16x16x32_bf16 a[48:51], a[60:63], v[148:151], a[48:51]
v_xor_b32 v241, 32, v3
s_waitcnt lgkmcnt(4)
v_mfma_f32_16x16x32_bf16 v[52:55], a[112:115], v[140:143], v[52:55]
v_exp_f32 v224, v224
v_mfma_f32_16x16x32_bf16 v[52:55], a[116:119], v[148:151], v[52:55]
v_exp_f32 v225, v225
ds_read_b64_tr_b16 a[96:97], v16 offset:32768
ds_read_b64_tr_b16 a[98:99], v16 offset:36864
v_mfma_f32_16x16x32_bf16 v[84:87], a[116:119], v[164:167], v[84:87]
v_cvt_pk_bf16_f32 v207, v210, v211
v_add_u32 v241, 65536, v241
v_mfma_f32_16x16x32_bf16 v[84:87], a[112:115], v[156:159], v[84:87]
ds_read_b64_tr_b16 a[100:101], v16 offset:40960
ds_read_b64_tr_b16 a[102:103], v16 offset:45056
v_mfma_f32_16x16x32_bf16 v[116:119], a[112:115], v[172:175], v[116:119]
v_exp_f32 v226, v226
v_mfma_f32_16x16x32_bf16 v[116:119], a[116:119], v[180:183], v[116:119]
v_cvt_pk_bf16_f32 v222, v224, v225
s_waitcnt lgkmcnt(4)
v_mfma_f32_16x16x32_bf16 v[56:59], a[120:123], v[140:143], v[56:59]
v_exp_f32 v227, v227
v_mfma_f32_16x16x32_bf16 v[56:59], a[124:127], v[148:151], v[56:59]
v_xor_b32 v242, 64, v3
ds_read_b64_tr_b16 a[104:105], v17 offset:32768
ds_read_b64_tr_b16 a[106:107], v17 offset:36864
v_mfma_f32_16x16x32_bf16 v[88:91], a[124:127], v[164:167], v[88:91]
v_exp_f32 v196, v196
v_mfma_f32_16x16x32_bf16 v[88:91], a[120:123], v[156:159], v[88:91]
s_waitcnt vmcnt(4)
buffer_load_dwordx4 v24, s[12:15], s60 offen offset:2048 nt lds
ds_read_b64_tr_b16 a[108:109], v17 offset:40960
ds_read_b64_tr_b16 a[110:111], v17 offset:45056
v_mfma_f32_16x16x32_bf16 v[120:123], a[120:123], v[172:175], v[120:123]
v_add_u32 v242, 65536, v242
v_xor_b32 v243, 96, v3
v_mfma_f32_16x16x32_bf16 v[120:123], a[124:127], v[180:183], v[120:123]
v_exp_f32 v197, v197
v_mfma_f32_16x16x32_bf16 a[52:55], a[60:63], v[156:159], a[52:55]
v_cvt_pk_bf16_f32 v223, v226, v227
v_add_u32 v243, 65536, v243
v_mfma_f32_16x16x32_bf16 a[52:55], a[60:63], v[164:167], a[52:55]
ds_read_b64_tr_b16 a[112:113], v18 offset:32768
s_waitcnt lgkmcnt(5)
v_mfma_f32_16x16x32_bf16 v[60:63], a[96:99], v[140:143], v[60:63]
v_exp_f32 v198, v198
v_mfma_f32_16x16x32_bf16 v[60:63], a[100:103], v[148:151], v[60:63]
v_cvt_pk_bf16_f32 v196, v196, v197
ds_read_b64_tr_b16 a[114:115], v18 offset:36864
v_mfma_f32_16x16x32_bf16 v[92:95], a[100:103], v[164:167], v[92:95]
v_exp_f32 v199, v199
v_mfma_f32_16x16x32_bf16 v[92:95], a[96:99], v[156:159], v[92:95]
ds_read_b64_tr_b16 a[116:117], v18 offset:40960
ds_read_b64_tr_b16 a[118:119], v18 offset:45056
v_mfma_f32_16x16x32_bf16 v[124:127], a[96:99], v[172:175], v[124:127]
v_exp_f32 v212, v212
v_mfma_f32_16x16x32_bf16 v[124:127], a[100:103], v[180:183], v[124:127]
s_waitcnt vmcnt(4)
buffer_load_dwordx4 v25, s[12:15], s60 offen offset:3072 nt lds
v_xor_b32 v244, 0, v3
s_waitcnt lgkmcnt(4)
v_mfma_f32_16x16x32_bf16 v[64:67], a[104:107], v[140:143], v[64:67]
s_add_u32 s60, s60, 16384
s_and_b32 s60, s60, 0x7ffff
v_mfma_f32_16x16x32_bf16 v[64:67], a[108:111], v[148:151], v[64:67]
ds_read_b64_tr_b16 a[120:121], v19 offset:32768
ds_read_b64_tr_b16 a[122:123], v19 offset:36864
v_mfma_f32_16x16x32_bf16 v[96:99], a[108:111], v[164:167], v[96:99]
v_exp_f32 v213, v213
v_mfma_f32_16x16x32_bf16 v[96:99], a[104:107], v[156:159], v[96:99]
v_cvt_pk_bf16_f32 v197, v198, v199
v_add_u32 v244, 131072, v244
ds_read_b64_tr_b16 a[124:125], v19 offset:40960
s_barrier
ds_read_b64_tr_b16 a[126:127], v19 offset:45056
v_mfma_f32_16x16x32_bf16 v[128:131], a[104:107], v[172:175], v[128:131]
v_exp_f32 v214, v214
v_mfma_f32_16x16x32_bf16 v[128:131], a[108:111], v[180:183], v[128:131]
v_xor_b32 v245, 32, v3
v_cvt_pk_bf16_f32 v212, v212, v213
v_mfma_f32_16x16x32_bf16 a[56:59], a[60:63], v[172:175], a[56:59]
v_exp_f32 v215, v215
v_mfma_f32_16x16x32_bf16 a[56:59], a[60:63], v[180:183], a[56:59]
v_add_u32 v245, 131072, v245
s_waitcnt lgkmcnt(4)
v_mfma_f32_16x16x32_bf16 v[68:71], a[112:115], v[140:143], v[68:71]
v_exp_f32 v228, v228
v_mfma_f32_16x16x32_bf16 v[68:71], a[116:119], v[148:151], v[68:71]
ds_read_b128 a[64:67], v8 offset:0
ds_read_b128 a[68:71], v9 offset:0
v_mfma_f32_16x16x32_bf16 v[100:103], a[116:119], v[164:167], v[100:103]
v_exp_f32 v229, v229
v_mfma_f32_16x16x32_bf16 v[100:103], a[112:115], v[156:159], v[100:103]
v_cvt_pk_bf16_f32 v213, v214, v215
v_xor_b32 v246, 64, v3
ds_read_b128 a[72:75], v10 offset:0
v_mfma_f32_16x16x32_bf16 v[132:135], a[112:115], v[172:175], v[132:135]
v_exp_f32 v230, v230
v_mfma_f32_16x16x32_bf16 v[132:135], a[116:119], v[180:183], v[132:135]
ds_read_b128 a[76:79], v11 offset:0
s_waitcnt lgkmcnt(4)
v_mfma_f32_16x16x32_bf16 v[72:75], a[120:123], v[140:143], v[72:75]
v_cvt_pk_bf16_f32 v228, v228, v229
v_add_u32 v246, 131072, v246
v_mfma_f32_16x16x32_bf16 v[72:75], a[124:127], v[148:151], v[72:75]
v_exp_f32 v231, v231
v_mfma_f32_16x16x32_bf16 v[104:107], a[124:127], v[164:167], v[104:107]
v_exp_f32 v200, v200
v_mfma_f32_16x16x32_bf16 v[104:107], a[120:123], v[156:159], v[104:107]
v_xor_b32 v247, 96, v3
v_add_u32 v247, 131072, v247
v_mfma_f32_16x16x32_bf16 v[136:139], a[120:123], v[172:175], v[136:139]
v_exp_f32 v201, v201
v_mfma_f32_16x16x32_bf16 v[136:139], a[124:127], v[180:183], v[136:139]
v_cvt_pk_bf16_f32 v229, v230, v231
v_exp_f32 v202, v202
v_cvt_pk_bf16_f32 v198, v200, v201
v_exp_f32 v203, v203
s_waitcnt lgkmcnt(0)
v_mfma_f32_16x16x32_bf16 v[140:143], a[64:67], a[0:3], v[32:35]
v_exp_f32 v216, v216
v_mfma_f32_16x16x32_bf16 v[140:143], a[68:71], a[4:7], v[140:143]
s_add_u32 m0, s65, 49152
v_mfma_f32_16x16x32_bf16 v[140:143], a[72:75], a[8:11], v[140:143]
v_exp_f32 v217, v217
v_mfma_f32_16x16x32_bf16 v[140:143], a[76:79], a[12:15], v[140:143]
ds_read_b128 a[80:83], v8 offset:4096
ds_read_b128 a[84:87], v9 offset:4096
ds_read_b128 a[88:91], v10 offset:4096
v_mfma_f32_16x16x32_bf16 v[156:159], a[76:79], a[28:31], v[36:39]
v_cvt_pk_bf16_f32 v199, v202, v203
v_mfma_f32_16x16x32_bf16 v[156:159], a[72:75], a[24:27], v[156:159]
v_exp_f32 v218, v218
v_mfma_f32_16x16x32_bf16 v[156:159], a[68:71], a[20:23], v[156:159]
v_cvt_pk_bf16_f32 v214, v216, v217
v_mfma_f32_16x16x32_bf16 v[156:159], a[64:67], a[16:19], v[156:159]
s_waitcnt vmcnt(4)
buffer_load_dwordx4 v20, s[8:11], s59 offen nt lds
ds_read_b128 a[92:95], v11 offset:4096
v_mfma_f32_16x16x32_bf16 v[172:175], a[64:67], a[32:35], v[40:43]
v_exp_f32 v219, v219
v_mfma_f32_16x16x32_bf16 v[172:175], a[68:71], a[36:39], v[172:175]
v_exp_f32 v232, v232
v_mfma_f32_16x16x32_bf16 v[172:175], a[72:75], a[40:43], v[172:175]
v_exp_f32 v233, v233
v_mfma_f32_16x16x32_bf16 v[172:175], a[76:79], a[44:47], v[172:175]
v_cvt_pk_bf16_f32 v215, v218, v219
s_waitcnt lgkmcnt(0)
v_mfma_f32_16x16x32_bf16 v[144:147], a[80:83], a[0:3], v[32:35]
v_exp_f32 v234, v234
v_mfma_f32_16x16x32_bf16 v[144:147], a[84:87], a[4:7], v[144:147]
v_cvt_pk_bf16_f32 v230, v232, v233
v_mfma_f32_16x16x32_bf16 v[144:147], a[88:91], a[8:11], v[144:147]
v_exp_f32 v235, v235
v_mfma_f32_16x16x32_bf16 v[144:147], a[92:95], a[12:15], v[144:147]
ds_read_b128 a[64:67], v8 offset:8192
s_waitcnt vmcnt(4)
buffer_load_dwordx4 v21, s[8:11], s59 offen offset:1024 nt lds
ds_read_b128 a[68:71], v9 offset:8192
ds_read_b128 a[72:75], v10 offset:8192
v_mfma_f32_16x16x32_bf16 v[160:163], a[92:95], a[28:31], v[36:39]
v_cvt_pk_bf16_f32 v231, v234, v235
v_mfma_f32_16x16x32_bf16 v[160:163], a[88:91], a[24:27], v[160:163]
v_exp_f32 v140, v140
v_mfma_f32_16x16x32_bf16 v[160:163], a[84:87], a[20:23], v[160:163]
v_exp_f32 v141, v141
v_mfma_f32_16x16x32_bf16 v[160:163], a[80:83], a[16:19], v[160:163]
ds_read_b128 a[76:79], v11 offset:8192
v_mfma_f32_16x16x32_bf16 v[176:179], a[80:83], a[32:35], v[40:43]
v_exp_f32 v142, v142
v_mfma_f32_16x16x32_bf16 v[176:179], a[84:87], a[36:39], v[176:179]
v_cvt_pk_bf16_f32 v140, v140, v141
v_mfma_f32_16x16x32_bf16 v[176:179], a[88:91], a[40:43], v[176:179]
v_exp_f32 v143, v143
v_mfma_f32_16x16x32_bf16 v[176:179], a[92:95], a[44:47], v[176:179]
s_waitcnt lgkmcnt(0)
v_mfma_f32_16x16x32_bf16 v[148:151], a[64:67], a[0:3], v[32:35]
v_exp_f32 v156, v156
v_mfma_f32_16x16x32_bf16 v[148:151], a[68:71], a[4:7], v[148:151]
v_exp_f32 v157, v157
v_mfma_f32_16x16x32_bf16 v[148:151], a[72:75], a[8:11], v[148:151]
v_cvt_pk_bf16_f32 v141, v142, v143
v_mfma_f32_16x16x32_bf16 v[148:151], a[76:79], a[12:15], v[148:151]
s_waitcnt vmcnt(4)
buffer_load_dwordx4 v22, s[8:11], s59 offen offset:2048 nt lds
ds_read_b128 a[80:83], v8 offset:12288
ds_read_b128 a[84:87], v9 offset:12288
ds_read_b128 a[88:91], v10 offset:12288
v_mfma_f32_16x16x32_bf16 v[164:167], a[76:79], a[28:31], v[36:39]
v_exp_f32 v158, v158
v_mfma_f32_16x16x32_bf16 v[164:167], a[72:75], a[24:27], v[164:167]
v_cvt_pk_bf16_f32 v156, v156, v157
v_mfma_f32_16x16x32_bf16 v[164:167], a[68:71], a[20:23], v[164:167]
v_exp_f32 v159, v159
v_mfma_f32_16x16x32_bf16 v[164:167], a[64:67], a[16:19], v[164:167]
ds_read_b128 a[92:95], v11 offset:12288
v_mfma_f32_16x16x32_bf16 v[180:183], a[64:67], a[32:35], v[40:43]
v_exp_f32 v172, v172
v_mfma_f32_16x16x32_bf16 v[180:183], a[68:71], a[36:39], v[180:183]
v_exp_f32 v173, v173
v_mfma_f32_16x16x32_bf16 v[180:183], a[72:75], a[40:43], v[180:183]
v_cvt_pk_bf16_f32 v157, v158, v159
v_mfma_f32_16x16x32_bf16 v[180:183], a[76:79], a[44:47], v[180:183]
ds_read_b64_tr_b16 a[96:97], v12 offset:49152
ds_read_b64_tr_b16 a[98:99], v12 offset:53248
s_waitcnt lgkmcnt(2)
v_mfma_f32_16x16x32_bf16 v[152:155], a[80:83], a[0:3], v[32:35]
v_exp_f32 v174, v174
v_mfma_f32_16x16x32_bf16 v[152:155], a[84:87], a[4:7], v[152:155]
v_cvt_pk_bf16_f32 v172, v172, v173
v_mfma_f32_16x16x32_bf16 v[152:155], a[88:91], a[8:11], v[152:155]
v_exp_f32 v175, v175
v_mfma_f32_16x16x32_bf16 v[152:155], a[92:95], a[12:15], v[152:155]
s_waitcnt vmcnt(4)
buffer_load_dwordx4 v23, s[8:11], s59 offen offset:3072 nt lds
s_add_u32 s59, s59, 16384
s_and_b32 s59, s59, 0x7ffff
ds_read_b64_tr_b16 a[100:101], v12 offset:57344
ds_read_b64_tr_b16 a[102:103], v12 offset:61440
v_mfma_f32_16x16x32_bf16 v[168:171], a[92:95], a[28:31], v[36:39]
v_exp_f32 v144, v144
v_mfma_f32_16x16x32_bf16 v[168:171], a[88:91], a[24:27], v[168:171]
v_exp_f32 v145, v145
v_mfma_f32_16x16x32_bf16 v[168:171], a[84:87], a[20:23], v[168:171]
v_cvt_pk_bf16_f32 v173, v174, v175
s_add_u32 m0, s65, 81920
v_mfma_f32_16x16x32_bf16 v[168:171], a[80:83], a[16:19], v[168:171]
ds_read_b64_tr_b16 a[104:105], v13 offset:49152
ds_read_b64_tr_b16 a[106:107], v13 offset:53248
ds_read_b64_tr_b16 a[108:109], v13 offset:57344
ds_read_b64_tr_b16 a[110:111], v13 offset:61440
v_mfma_f32_16x16x32_bf16 v[184:187], a[80:83], a[32:35], v[40:43]
v_exp_f32 v146, v146
v_mfma_f32_16x16x32_bf16 v[184:187], a[84:87], a[36:39], v[184:187]
v_cvt_pk_bf16_f32 v142, v144, v145
v_mfma_f32_16x16x32_bf16 v[184:187], a[88:91], a[40:43], v[184:187]
v_exp_f32 v147, v147
v_mfma_f32_16x16x32_bf16 v[184:187], a[92:95], a[44:47], v[184:187]
ds_read_b64_tr_b16 a[112:113], v14 offset:49152
s_waitcnt lgkmcnt(5)
v_mfma_f32_16x16x32_bf16 v[44:47], a[96:99], v[188:191], v[44:47]
v_exp_f32 v160, v160
v_mfma_f32_16x16x32_bf16 v[44:47], a[100:103], v[196:199], v[44:47]
s_waitcnt vmcnt(4)
buffer_load_dwordx4 v24, s[12:15], s60 offen nt lds
ds_read_b64_tr_b16 a[114:115], v14 offset:53248
v_mfma_f32_16x16x32_bf16 v[76:79], a[100:103], v[212:215], v[76:79]
v_exp_f32 v161, v161
v_mfma_f32_16x16x32_bf16 v[76:79], a[96:99], v[204:207], v[76:79]
ds_read_b64_tr_b16 a[116:117], v14 offset:57344
ds_read_b64_tr_b16 a[118:119], v14 offset:61440
v_mfma_f32_16x16x32_bf16 v[108:111], a[96:99], v[220:223], v[108:111]
v_cvt_pk_bf16_f32 v143, v146, v147
v_mfma_f32_16x16x32_bf16 v[108:111], a[100:103], v[228:231], v[108:111]
ds_read_b64_tr_b16 a[120:121], v15 offset:49152
s_waitcnt lgkmcnt(5)
v_mfma_f32_16x16x32_bf16 v[48:51], a[104:107], v[188:191], v[48:51]
v_exp_f32 v162, v162
v_mfma_f32_16x16x32_bf16 v[48:51], a[108:111], v[196:199], v[48:51]
ds_read_b64_tr_b16 a[122:123], v15 offset:53248
v_cvt_pk_bf16_f32 v158, v160, v161
v_mfma_f32_16x16x32_bf16 v[80:83], a[108:111], v[212:215], v[80:83]
v_exp_f32 v163, v163
v_mfma_f32_16x16x32_bf16 v[80:83], a[104:107], v[204:207], v[80:83]
ds_read_b64_tr_b16 a[124:125], v15 offset:57344
ds_read_b64_tr_b16 a[126:127], v15 offset:61440
v_mfma_f32_16x16x32_bf16 v[112:115], a[104:107], v[220:223], v[112:115]
v_exp_f32 v176, v176
v_mfma_f32_16x16x32_bf16 v[112:115], a[108:111], v[228:231], v[112:115]
s_waitcnt vmcnt(4)
buffer_load_dwordx4 v25, s[12:15], s60 offen offset:1024 nt lds
v_mfma_f32_16x16x32_bf16 a[48:51], a[60:63], v[188:191], a[48:51]
v_exp_f32 v177, v177
v_mfma_f32_16x16x32_bf16 a[48:51], a[60:63], v[196:199], a[48:51]
v_cvt_pk_bf16_f32 v159, v162, v163
s_waitcnt lgkmcnt(4)
v_mfma_f32_16x16x32_bf16 v[52:55], a[112:115], v[188:191], v[52:55]
v_exp_f32 v178, v178
v_mfma_f32_16x16x32_bf16 v[52:55], a[116:119], v[196:199], v[52:55]
ds_read_b64_tr_b16 a[96:97], v16 offset:49152
ds_read_b64_tr_b16 a[98:99], v16 offset:53248
v_mfma_f32_16x16x32_bf16 v[84:87], a[116:119], v[212:215], v[84:87]
v_cvt_pk_bf16_f32 v174, v176, v177
v_mfma_f32_16x16x32_bf16 v[84:87], a[112:115], v[204:207], v[84:87]
ds_read_b64_tr_b16 a[100:101], v16 offset:57344
ds_read_b64_tr_b16 a[102:103], v16 offset:61440
v_mfma_f32_16x16x32_bf16 v[116:119], a[112:115], v[220:223], v[116:119]
v_exp_f32 v179, v179
v_mfma_f32_16x16x32_bf16 v[116:119], a[116:119], v[228:231], v[116:119]
ds_read_b64_tr_b16 a[104:105], v17 offset:49152
s_waitcnt lgkmcnt(5)
v_mfma_f32_16x16x32_bf16 v[56:59], a[120:123], v[188:191], v[56:59]
v_exp_f32 v148, v148
v_mfma_f32_16x16x32_bf16 v[56:59], a[124:127], v[196:199], v[56:59]
ds_read_b64_tr_b16 a[106:107], v17 offset:53248
ds_read_b64_tr_b16 a[108:109], v17 offset:57344
v_mfma_f32_16x16x32_bf16 v[88:91], a[124:127], v[212:215], v[88:91]
v_exp_f32 v149, v149
v_mfma_f32_16x16x32_bf16 v[88:91], a[120:123], v[204:207], v[88:91]
s_waitcnt vmcnt(4)
buffer_load_dwordx4 v24, s[12:15], s60 offen offset:2048 nt lds
ds_read_b64_tr_b16 a[110:111], v17 offset:61440
v_mfma_f32_16x16x32_bf16 v[120:123], a[120:123], v[220:223], v[120:123]
v_cvt_pk_bf16_f32 v175, v178, v179
v_mfma_f32_16x16x32_bf16 v[120:123], a[124:127], v[228:231], v[120:123]
v_exp_f32 v150, v150
v_mfma_f32_16x16x32_bf16 a[52:55], a[60:63], v[204:207], a[52:55]
v_cvt_pk_bf16_f32 v148, v148, v149
v_mfma_f32_16x16x32_bf16 a[52:55], a[60:63], v[212:215], a[52:55]
ds_read_b64_tr_b16 a[112:113], v18 offset:49152
s_waitcnt lgkmcnt(5)
v_mfma_f32_16x16x32_bf16 v[60:63], a[96:99], v[188:191], v[60:63]
v_exp_f32 v151, v151
v_mfma_f32_16x16x32_bf16 v[60:63], a[100:103], v[196:199], v[60:63]
ds_read_b64_tr_b16 a[114:115], v18 offset:53248
ds_read_b64_tr_b16 a[116:117], v18 offset:57344
v_mfma_f32_16x16x32_bf16 v[92:95], a[100:103], v[212:215], v[92:95]
v_exp_f32 v164, v164
v_mfma_f32_16x16x32_bf16 v[92:95], a[96:99], v[204:207], v[92:95]
ds_read_b64_tr_b16 a[118:119], v18 offset:61440
v_mfma_f32_16x16x32_bf16 v[124:127], a[96:99], v[220:223], v[124:127]
v_exp_f32 v165, v165
v_mfma_f32_16x16x32_bf16 v[124:127], a[100:103], v[228:231], v[124:127]
s_waitcnt vmcnt(4)
buffer_load_dwordx4 v25, s[12:15], s60 offen offset:3072 nt lds
s_waitcnt lgkmcnt(4)
v_mfma_f32_16x16x32_bf16 v[64:67], a[104:107], v[188:191], v[64:67]
s_add_u32 s60, s60, 16384
s_and_b32 s60, s60, 0x7ffff
v_mfma_f32_16x16x32_bf16 v[64:67], a[108:111], v[196:199], v[64:67]
ds_read_b64_tr_b16 a[120:121], v19 offset:49152
ds_read_b64_tr_b16 a[122:123], v19 offset:53248
v_mfma_f32_16x16x32_bf16 v[96:99], a[108:111], v[212:215], v[96:99]
v_cvt_pk_bf16_f32 v149, v150, v151
v_mfma_f32_16x16x32_bf16 v[96:99], a[104:107], v[204:207], v[96:99]
ds_read_b64_tr_b16 a[124:125], v19 offset:57344
s_barrier
ds_read_b64_tr_b16 a[126:127], v19 offset:61440
v_mfma_f32_16x16x32_bf16 v[128:131], a[104:107], v[220:223], v[128:131]
v_exp_f32 v166, v166
v_mfma_f32_16x16x32_bf16 v[128:131], a[108:111], v[228:231], v[128:131]
v_cvt_pk_bf16_f32 v164, v164, v165
v_mfma_f32_16x16x32_bf16 a[56:59], a[60:63], v[220:223], a[56:59]
v_exp_f32 v167, v167
v_mfma_f32_16x16x32_bf16 a[56:59], a[60:63], v[228:231], a[56:59]
ds_read_b128 a[64:67], v8 offset:16384
s_waitcnt lgkmcnt(5)
v_mfma_f32_16x16x32_bf16 v[68:71], a[112:115], v[188:191], v[68:71]
v_exp_f32 v180, v180
v_mfma_f32_16x16x32_bf16 v[68:71], a[116:119], v[196:199], v[68:71]
ds_read_b128 a[68:71], v9 offset:16384
ds_read_b128 a[72:75], v10 offset:16384
v_mfma_f32_16x16x32_bf16 v[100:103], a[116:119], v[212:215], v[100:103]
v_exp_f32 v181, v181
v_mfma_f32_16x16x32_bf16 v[100:103], a[112:115], v[204:207], v[100:103]
v_cvt_pk_bf16_f32 v165, v166, v167
ds_read_b128 a[76:79], v11 offset:16384
v_mfma_f32_16x16x32_bf16 v[132:135], a[112:115], v[220:223], v[132:135]
v_exp_f32 v182, v182
v_mfma_f32_16x16x32_bf16 v[132:135], a[116:119], v[228:231], v[132:135]
v_cvt_pk_bf16_f32 v180, v180, v181
s_waitcnt lgkmcnt(4)
v_mfma_f32_16x16x32_bf16 v[72:75], a[120:123], v[188:191], v[72:75]
v_exp_f32 v183, v183
v_mfma_f32_16x16x32_bf16 v[72:75], a[124:127], v[196:199], v[72:75]
v_exp_f32 v152, v152
v_mfma_f32_16x16x32_bf16 v[104:107], a[124:127], v[212:215], v[104:107]
v_exp_f32 v153, v153
v_mfma_f32_16x16x32_bf16 v[104:107], a[120:123], v[204:207], v[104:107]
v_cvt_pk_bf16_f32 v181, v182, v183
v_mfma_f32_16x16x32_bf16 v[136:139], a[120:123], v[220:223], v[136:139]
v_exp_f32 v154, v154
v_mfma_f32_16x16x32_bf16 v[136:139], a[124:127], v[228:231], v[136:139]
v_cvt_pk_bf16_f32 v150, v152, v153
v_exp_f32 v155, v155
s_waitcnt lgkmcnt(0)
v_mfma_f32_16x16x32_bf16 v[188:191], a[64:67], a[0:3], v[32:35]
v_exp_f32 v168, v168
v_mfma_f32_16x16x32_bf16 v[188:191], a[68:71], a[4:7], v[188:191]
s_add_u32 m0, s65, 0
v_mfma_f32_16x16x32_bf16 v[188:191], a[72:75], a[8:11], v[188:191]
v_exp_f32 v169, v169
v_mfma_f32_16x16x32_bf16 v[188:191], a[76:79], a[12:15], v[188:191]
ds_read_b128 a[80:83], v8 offset:20480
ds_read_b128 a[84:87], v9 offset:20480
ds_read_b128 a[88:91], v10 offset:20480
v_mfma_f32_16x16x32_bf16 v[204:207], a[76:79], a[28:31], v[36:39]
v_cvt_pk_bf16_f32 v151, v154, v155
v_mfma_f32_16x16x32_bf16 v[204:207], a[72:75], a[24:27], v[204:207]
v_exp_f32 v170, v170
v_mfma_f32_16x16x32_bf16 v[204:207], a[68:71], a[20:23], v[204:207]
v_cvt_pk_bf16_f32 v166, v168, v169
v_mfma_f32_16x16x32_bf16 v[204:207], a[64:67], a[16:19], v[204:207]
s_waitcnt vmcnt(4)
buffer_load_dwordx4 v20, s[8:11], s59 offen nt lds
ds_read_b128 a[92:95], v11 offset:20480
v_mfma_f32_16x16x32_bf16 v[220:223], a[64:67], a[32:35], v[40:43]
v_exp_f32 v171, v171
v_mfma_f32_16x16x32_bf16 v[220:223], a[68:71], a[36:39], v[220:223]
v_exp_f32 v184, v184
v_mfma_f32_16x16x32_bf16 v[220:223], a[72:75], a[40:43], v[220:223]
v_exp_f32 v185, v185
v_mfma_f32_16x16x32_bf16 v[220:223], a[76:79], a[44:47], v[220:223]
v_cvt_pk_bf16_f32 v167, v170, v171
s_waitcnt lgkmcnt(0)
v_mfma_f32_16x16x32_bf16 v[192:195], a[80:83], a[0:3], v[32:35]
v_exp_f32 v186, v186
v_mfma_f32_16x16x32_bf16 v[192:195], a[84:87], a[4:7], v[192:195]
v_cvt_pk_bf16_f32 v182, v184, v185
v_mfma_f32_16x16x32_bf16 v[192:195], a[88:91], a[8:11], v[192:195]
v_exp_f32 v187, v187
v_mfma_f32_16x16x32_bf16 v[192:195], a[92:95], a[12:15], v[192:195]
ds_read_b128 a[64:67], v8 offset:24576
s_waitcnt vmcnt(4)
buffer_load_dwordx4 v21, s[8:11], s59 offen offset:1024 nt lds
ds_read_b128 a[68:71], v9 offset:24576
ds_read_b128 a[72:75], v10 offset:24576
v_mfma_f32_16x16x32_bf16 v[208:211], a[92:95], a[28:31], v[36:39]
v_cvt_pk_bf16_f32 v183, v186, v187
v_mfma_f32_16x16x32_bf16 v[208:211], a[88:91], a[24:27], v[208:211]
v_exp_f32 v188, v188
v_mfma_f32_16x16x32_bf16 v[208:211], a[84:87], a[20:23], v[208:211]
v_exp_f32 v189, v189
v_mfma_f32_16x16x32_bf16 v[208:211], a[80:83], a[16:19], v[208:211]
ds_read_b128 a[76:79], v11 offset:24576
v_mfma_f32_16x16x32_bf16 v[224:227], a[80:83], a[32:35], v[40:43]
v_exp_f32 v190, v190
v_mfma_f32_16x16x32_bf16 v[224:227], a[84:87], a[36:39], v[224:227]
v_cvt_pk_bf16_f32 v188, v188, v189
v_mfma_f32_16x16x32_bf16 v[224:227], a[88:91], a[40:43], v[224:227]
v_exp_f32 v191, v191
v_mfma_f32_16x16x32_bf16 v[224:227], a[92:95], a[44:47], v[224:227]
s_waitcnt lgkmcnt(0)
v_mfma_f32_16x16x32_bf16 v[196:199], a[64:67], a[0:3], v[32:35]
v_exp_f32 v204, v204
v_mfma_f32_16x16x32_bf16 v[196:199], a[68:71], a[4:7], v[196:199]
v_exp_f32 v205, v205
v_mfma_f32_16x16x32_bf16 v[196:199], a[72:75], a[8:11], v[196:199]
v_cvt_pk_bf16_f32 v189, v190, v191
v_mfma_f32_16x16x32_bf16 v[196:199], a[76:79], a[12:15], v[196:199]
s_waitcnt vmcnt(4)
buffer_load_dwordx4 v22, s[8:11], s59 offen offset:2048 nt lds
ds_read_b128 a[80:83], v8 offset:28672
ds_read_b128 a[84:87], v9 offset:28672
ds_read_b128 a[88:91], v10 offset:28672
v_mfma_f32_16x16x32_bf16 v[212:215], a[76:79], a[28:31], v[36:39]
v_exp_f32 v206, v206
v_mfma_f32_16x16x32_bf16 v[212:215], a[72:75], a[24:27], v[212:215]
v_cvt_pk_bf16_f32 v204, v204, v205
v_mfma_f32_16x16x32_bf16 v[212:215], a[68:71], a[20:23], v[212:215]
v_exp_f32 v207, v207
v_mfma_f32_16x16x32_bf16 v[212:215], a[64:67], a[16:19], v[212:215]
ds_read_b128 a[92:95], v11 offset:28672
v_mfma_f32_16x16x32_bf16 v[228:231], a[64:67], a[32:35], v[40:43]
v_exp_f32 v220, v220
v_mfma_f32_16x16x32_bf16 v[228:231], a[68:71], a[36:39], v[228:231]
v_exp_f32 v221, v221
v_mfma_f32_16x16x32_bf16 v[228:231], a[72:75], a[40:43], v[228:231]
v_cvt_pk_bf16_f32 v205, v206, v207
v_mfma_f32_16x16x32_bf16 v[228:231], a[76:79], a[44:47], v[228:231]
ds_read_b64_tr_b16 a[96:97], v12 offset:0
ds_read_b64_tr_b16 a[98:99], v12 offset:4096
s_waitcnt lgkmcnt(2)
v_mfma_f32_16x16x32_bf16 v[200:203], a[80:83], a[0:3], v[32:35]
v_exp_f32 v222, v222
v_mfma_f32_16x16x32_bf16 v[200:203], a[84:87], a[4:7], v[200:203]
v_cvt_pk_bf16_f32 v220, v220, v221
v_mfma_f32_16x16x32_bf16 v[200:203], a[88:91], a[8:11], v[200:203]
v_exp_f32 v223, v223
v_mfma_f32_16x16x32_bf16 v[200:203], a[92:95], a[12:15], v[200:203]
s_waitcnt vmcnt(4)
buffer_load_dwordx4 v23, s[8:11], s59 offen offset:3072 nt lds
s_add_u32 s59, s59, 16384
s_and_b32 s59, s59, 0x7ffff
ds_read_b64_tr_b16 a[100:101], v12 offset:8192
ds_read_b64_tr_b16 a[102:103], v12 offset:12288
v_mfma_f32_16x16x32_bf16 v[216:219], a[92:95], a[28:31], v[36:39]
v_exp_f32 v192, v192
v_mfma_f32_16x16x32_bf16 v[216:219], a[88:91], a[24:27], v[216:219]
v_exp_f32 v193, v193
v_mfma_f32_16x16x32_bf16 v[216:219], a[84:87], a[20:23], v[216:219]
v_cvt_pk_bf16_f32 v221, v222, v223
s_add_u32 m0, s65, 98304
v_mfma_f32_16x16x32_bf16 v[216:219], a[80:83], a[16:19], v[216:219]
ds_read_b64_tr_b16 a[104:105], v13 offset:0
ds_read_b64_tr_b16 a[106:107], v13 offset:4096
ds_read_b64_tr_b16 a[108:109], v13 offset:8192
ds_read_b64_tr_b16 a[110:111], v13 offset:12288
v_mfma_f32_16x16x32_bf16 v[232:235], a[80:83], a[32:35], v[40:43]
v_exp_f32 v194, v194
v_mfma_f32_16x16x32_bf16 v[232:235], a[84:87], a[36:39], v[232:235]
v_cvt_pk_bf16_f32 v190, v192, v193
v_mfma_f32_16x16x32_bf16 v[232:235], a[88:91], a[40:43], v[232:235]
v_exp_f32 v195, v195
v_mfma_f32_16x16x32_bf16 v[232:235], a[92:95], a[44:47], v[232:235]
ds_read_b64_tr_b16 a[112:113], v14 offset:0
s_waitcnt lgkmcnt(5)
v_mfma_f32_16x16x32_bf16 v[44:47], a[96:99], v[140:143], v[44:47]
v_exp_f32 v208, v208
v_mfma_f32_16x16x32_bf16 v[44:47], a[100:103], v[148:151], v[44:47]
s_waitcnt vmcnt(4)
buffer_load_dwordx4 v24, s[12:15], s60 offen nt lds
ds_read_b64_tr_b16 a[114:115], v14 offset:4096
v_mfma_f32_16x16x32_bf16 v[76:79], a[100:103], v[164:167], v[76:79]
v_exp_f32 v209, v209
v_mfma_f32_16x16x32_bf16 v[76:79], a[96:99], v[156:159], v[76:79]
ds_read_b64_tr_b16 a[116:117], v14 offset:8192
ds_read_b64_tr_b16 a[118:119], v14 offset:12288
v_mfma_f32_16x16x32_bf16 v[108:111], a[96:99], v[172:175], v[108:111]
v_cvt_pk_bf16_f32 v191, v194, v195
v_mfma_f32_16x16x32_bf16 v[108:111], a[100:103], v[180:183], v[108:111]
ds_read_b64_tr_b16 a[120:121], v15 offset:0
s_waitcnt lgkmcnt(5)
v_mfma_f32_16x16x32_bf16 v[48:51], a[104:107], v[140:143], v[48:51]
v_exp_f32 v210, v210
v_mfma_f32_16x16x32_bf16 v[48:51], a[108:111], v[148:151], v[48:51]
ds_read_b64_tr_b16 a[122:123], v15 offset:4096
v_cvt_pk_bf16_f32 v206, v208, v209
v_mfma_f32_16x16x32_bf16 v[80:83], a[108:111], v[164:167], v[80:83]
v_exp_f32 v211, v211
v_mfma_f32_16x16x32_bf16 v[80:83], a[104:107], v[156:159], v[80:83]
ds_read_b64_tr_b16 a[124:125], v15 offset:8192
ds_read_b64_tr_b16 a[126:127], v15 offset:12288
v_mfma_f32_16x16x32_bf16 v[112:115], a[104:107], v[172:175], v[112:115]
v_exp_f32 v224, v224
v_mfma_f32_16x16x32_bf16 v[112:115], a[108:111], v[180:183], v[112:115]
s_waitcnt vmcnt(4)
buffer_load_dwordx4 v25, s[12:15], s60 offen offset:1024 nt lds
v_mfma_f32_16x16x32_bf16 a[48:51], a[60:63], v[140:143], a[48:51]
v_exp_f32 v225, v225
v_mfma_f32_16x16x32_bf16 a[48:51], a[60:63], v[148:151], a[48:51]
v_cvt_pk_bf16_f32 v207, v210, v211
s_waitcnt lgkmcnt(4)
v_mfma_f32_16x16x32_bf16 v[52:55], a[112:115], v[140:143], v[52:55]
v_exp_f32 v226, v226
v_mfma_f32_16x16x32_bf16 v[52:55], a[116:119], v[148:151], v[52:55]
ds_read_b64_tr_b16 a[96:97], v16 offset:0
ds_read_b64_tr_b16 a[98:99], v16 offset:4096
v_mfma_f32_16x16x32_bf16 v[84:87], a[116:119], v[164:167], v[84:87]
v_cvt_pk_bf16_f32 v222, v224, v225
v_mfma_f32_16x16x32_bf16 v[84:87], a[112:115], v[156:159], v[84:87]
ds_read_b64_tr_b16 a[100:101], v16 offset:8192
ds_read_b64_tr_b16 a[102:103], v16 offset:12288
v_mfma_f32_16x16x32_bf16 v[116:119], a[112:115], v[172:175], v[116:119]
v_exp_f32 v227, v227
v_mfma_f32_16x16x32_bf16 v[116:119], a[116:119], v[180:183], v[116:119]
ds_read_b64_tr_b16 a[104:105], v17 offset:0
s_waitcnt lgkmcnt(5)
v_mfma_f32_16x16x32_bf16 v[56:59], a[120:123], v[140:143], v[56:59]
v_exp_f32 v196, v196
v_mfma_f32_16x16x32_bf16 v[56:59], a[124:127], v[148:151], v[56:59]
ds_read_b64_tr_b16 a[106:107], v17 offset:4096
ds_read_b64_tr_b16 a[108:109], v17 offset:8192
v_mfma_f32_16x16x32_bf16 v[88:91], a[124:127], v[164:167], v[88:91]
v_exp_f32 v197, v197
v_mfma_f32_16x16x32_bf16 v[88:91], a[120:123], v[156:159], v[88:91]
s_waitcnt vmcnt(4)
buffer_load_dwordx4 v24, s[12:15], s60 offen offset:2048 nt lds
ds_read_b64_tr_b16 a[110:111], v17 offset:12288
v_mfma_f32_16x16x32_bf16 v[120:123], a[120:123], v[172:175], v[120:123]
v_cvt_pk_bf16_f32 v223, v226, v227
v_mfma_f32_16x16x32_bf16 v[120:123], a[124:127], v[180:183], v[120:123]
v_exp_f32 v198, v198
v_mfma_f32_16x16x32_bf16 a[52:55], a[60:63], v[156:159], a[52:55]
v_cvt_pk_bf16_f32 v196, v196, v197
v_mfma_f32_16x16x32_bf16 a[52:55], a[60:63], v[164:167], a[52:55]
ds_read_b64_tr_b16 a[112:113], v18 offset:0
s_waitcnt lgkmcnt(5)
v_mfma_f32_16x16x32_bf16 v[60:63], a[96:99], v[140:143], v[60:63]
v_exp_f32 v199, v199
v_mfma_f32_16x16x32_bf16 v[60:63], a[100:103], v[148:151], v[60:63]
ds_read_b64_tr_b16 a[114:115], v18 offset:4096
ds_read_b64_tr_b16 a[116:117], v18 offset:8192
v_mfma_f32_16x16x32_bf16 v[92:95], a[100:103], v[164:167], v[92:95]
v_exp_f32 v212, v212
v_mfma_f32_16x16x32_bf16 v[92:95], a[96:99], v[156:159], v[92:95]
ds_read_b64_tr_b16 a[118:119], v18 offset:12288
v_mfma_f32_16x16x32_bf16 v[124:127], a[96:99], v[172:175], v[124:127]
v_exp_f32 v213, v213
v_mfma_f32_16x16x32_bf16 v[124:127], a[100:103], v[180:183], v[124:127]
s_waitcnt vmcnt(4)
buffer_load_dwordx4 v25, s[12:15], s60 offen offset:3072 nt lds
s_waitcnt lgkmcnt(4)
v_mfma_f32_16x16x32_bf16 v[64:67], a[104:107], v[140:143], v[64:67]
s_add_u32 s60, s60, 16384
s_and_b32 s60, s60, 0x7ffff
v_mfma_f32_16x16x32_bf16 v[64:67], a[108:111], v[148:151], v[64:67]
ds_read_b64_tr_b16 a[120:121], v19 offset:0
ds_read_b64_tr_b16 a[122:123], v19 offset:4096
v_mfma_f32_16x16x32_bf16 v[96:99], a[108:111], v[164:167], v[96:99]
v_cvt_pk_bf16_f32 v197, v198, v199
v_mfma_f32_16x16x32_bf16 v[96:99], a[104:107], v[156:159], v[96:99]
ds_read_b64_tr_b16 a[124:125], v19 offset:8192
s_barrier
ds_read_b64_tr_b16 a[126:127], v19 offset:12288
v_mfma_f32_16x16x32_bf16 v[128:131], a[104:107], v[172:175], v[128:131]
v_exp_f32 v214, v214
v_mfma_f32_16x16x32_bf16 v[128:131], a[108:111], v[180:183], v[128:131]
v_cvt_pk_bf16_f32 v212, v212, v213
v_mfma_f32_16x16x32_bf16 a[56:59], a[60:63], v[172:175], a[56:59]
v_exp_f32 v215, v215
v_mfma_f32_16x16x32_bf16 a[56:59], a[60:63], v[180:183], a[56:59]
ds_read_b128 a[64:67], v8 offset:32768
s_waitcnt lgkmcnt(5)
v_mfma_f32_16x16x32_bf16 v[68:71], a[112:115], v[140:143], v[68:71]
v_exp_f32 v228, v228
v_mfma_f32_16x16x32_bf16 v[68:71], a[116:119], v[148:151], v[68:71]
ds_read_b128 a[68:71], v9 offset:32768
ds_read_b128 a[72:75], v10 offset:32768
v_mfma_f32_16x16x32_bf16 v[100:103], a[116:119], v[164:167], v[100:103]
v_exp_f32 v229, v229
v_mfma_f32_16x16x32_bf16 v[100:103], a[112:115], v[156:159], v[100:103]
v_cvt_pk_bf16_f32 v213, v214, v215
ds_read_b128 a[76:79], v11 offset:32768
v_mfma_f32_16x16x32_bf16 v[132:135], a[112:115], v[172:175], v[132:135]
v_exp_f32 v230, v230
v_mfma_f32_16x16x32_bf16 v[132:135], a[116:119], v[180:183], v[132:135]
v_cvt_pk_bf16_f32 v228, v228, v229
s_waitcnt lgkmcnt(4)
v_mfma_f32_16x16x32_bf16 v[72:75], a[120:123], v[140:143], v[72:75]
v_exp_f32 v231, v231
v_mfma_f32_16x16x32_bf16 v[72:75], a[124:127], v[148:151], v[72:75]
v_exp_f32 v200, v200
v_mfma_f32_16x16x32_bf16 v[104:107], a[124:127], v[164:167], v[104:107]
v_exp_f32 v201, v201
v_mfma_f32_16x16x32_bf16 v[104:107], a[120:123], v[156:159], v[104:107]
v_cvt_pk_bf16_f32 v229, v230, v231
v_mfma_f32_16x16x32_bf16 v[136:139], a[120:123], v[172:175], v[136:139]
v_exp_f32 v202, v202
v_mfma_f32_16x16x32_bf16 v[136:139], a[124:127], v[180:183], v[136:139]
v_cvt_pk_bf16_f32 v198, v200, v201
v_exp_f32 v203, v203
s_waitcnt lgkmcnt(0)
v_mfma_f32_16x16x32_bf16 v[140:143], a[64:67], a[0:3], v[32:35]
v_exp_f32 v216, v216
v_mfma_f32_16x16x32_bf16 v[140:143], a[68:71], a[4:7], v[140:143]
s_add_u32 m0, s65, 16384
v_mfma_f32_16x16x32_bf16 v[140:143], a[72:75], a[8:11], v[140:143]
v_exp_f32 v217, v217
v_mfma_f32_16x16x32_bf16 v[140:143], a[76:79], a[12:15], v[140:143]
ds_read_b128 a[80:83], v8 offset:36864
ds_read_b128 a[84:87], v9 offset:36864
ds_read_b128 a[88:91], v10 offset:36864
v_mfma_f32_16x16x32_bf16 v[156:159], a[76:79], a[28:31], v[36:39]
v_cvt_pk_bf16_f32 v199, v202, v203
v_mfma_f32_16x16x32_bf16 v[156:159], a[72:75], a[24:27], v[156:159]
v_exp_f32 v218, v218
v_mfma_f32_16x16x32_bf16 v[156:159], a[68:71], a[20:23], v[156:159]
v_cvt_pk_bf16_f32 v214, v216, v217
v_mfma_f32_16x16x32_bf16 v[156:159], a[64:67], a[16:19], v[156:159]
s_waitcnt vmcnt(4)
buffer_load_dwordx4 v20, s[8:11], s59 offen nt lds
ds_read_b128 a[92:95], v11 offset:36864
v_mfma_f32_16x16x32_bf16 v[172:175], a[64:67], a[32:35], v[40:43]
v_exp_f32 v219, v219
v_mfma_f32_16x16x32_bf16 v[172:175], a[68:71], a[36:39], v[172:175]
v_exp_f32 v232, v232
v_mfma_f32_16x16x32_bf16 v[172:175], a[72:75], a[40:43], v[172:175]
v_exp_f32 v233, v233
v_mfma_f32_16x16x32_bf16 v[172:175], a[76:79], a[44:47], v[172:175]
v_cvt_pk_bf16_f32 v215, v218, v219
s_waitcnt lgkmcnt(0)
v_mfma_f32_16x16x32_bf16 v[144:147], a[80:83], a[0:3], v[32:35]
v_exp_f32 v234, v234
v_mfma_f32_16x16x32_bf16 v[144:147], a[84:87], a[4:7], v[144:147]
v_cvt_pk_bf16_f32 v230, v232, v233
v_mfma_f32_16x16x32_bf16 v[144:147], a[88:91], a[8:11], v[144:147]
v_exp_f32 v235, v235
v_mfma_f32_16x16x32_bf16 v[144:147], a[92:95], a[12:15], v[144:147]
ds_read_b128 a[64:67], v8 offset:40960
s_waitcnt vmcnt(4)
buffer_load_dwordx4 v21, s[8:11], s59 offen offset:1024 nt lds
ds_read_b128 a[68:71], v9 offset:40960
ds_read_b128 a[72:75], v10 offset:40960
v_mfma_f32_16x16x32_bf16 v[160:163], a[92:95], a[28:31], v[36:39]
v_cvt_pk_bf16_f32 v231, v234, v235
v_mfma_f32_16x16x32_bf16 v[160:163], a[88:91], a[24:27], v[160:163]
v_exp_f32 v140, v140
v_mfma_f32_16x16x32_bf16 v[160:163], a[84:87], a[20:23], v[160:163]
v_exp_f32 v141, v141
v_mfma_f32_16x16x32_bf16 v[160:163], a[80:83], a[16:19], v[160:163]
ds_read_b128 a[76:79], v11 offset:40960
v_mfma_f32_16x16x32_bf16 v[176:179], a[80:83], a[32:35], v[40:43]
v_exp_f32 v142, v142
v_mfma_f32_16x16x32_bf16 v[176:179], a[84:87], a[36:39], v[176:179]
v_cvt_pk_bf16_f32 v140, v140, v141
v_mfma_f32_16x16x32_bf16 v[176:179], a[88:91], a[40:43], v[176:179]
v_exp_f32 v143, v143
v_mfma_f32_16x16x32_bf16 v[176:179], a[92:95], a[44:47], v[176:179]
s_waitcnt lgkmcnt(0)
v_mfma_f32_16x16x32_bf16 v[148:151], a[64:67], a[0:3], v[32:35]
v_exp_f32 v156, v156
v_mfma_f32_16x16x32_bf16 v[148:151], a[68:71], a[4:7], v[148:151]
v_exp_f32 v157, v157
v_mfma_f32_16x16x32_bf16 v[148:151], a[72:75], a[8:11], v[148:151]
v_cvt_pk_bf16_f32 v141, v142, v143
v_mfma_f32_16x16x32_bf16 v[148:151], a[76:79], a[12:15], v[148:151]
s_waitcnt vmcnt(4)
buffer_load_dwordx4 v22, s[8:11], s59 offen offset:2048 nt lds
ds_read_b128 a[80:83], v8 offset:45056
ds_read_b128 a[84:87], v9 offset:45056
ds_read_b128 a[88:91], v10 offset:45056
v_mfma_f32_16x16x32_bf16 v[164:167], a[76:79], a[28:31], v[36:39]
v_exp_f32 v158, v158
v_mfma_f32_16x16x32_bf16 v[164:167], a[72:75], a[24:27], v[164:167]
v_cvt_pk_bf16_f32 v156, v156, v157
v_mfma_f32_16x16x32_bf16 v[164:167], a[68:71], a[20:23], v[164:167]
v_exp_f32 v159, v159
v_mfma_f32_16x16x32_bf16 v[164:167], a[64:67], a[16:19], v[164:167]
ds_read_b128 a[92:95], v11 offset:45056
v_mfma_f32_16x16x32_bf16 v[180:183], a[64:67], a[32:35], v[40:43]
v_exp_f32 v172, v172
v_mfma_f32_16x16x32_bf16 v[180:183], a[68:71], a[36:39], v[180:183]
v_exp_f32 v173, v173
v_mfma_f32_16x16x32_bf16 v[180:183], a[72:75], a[40:43], v[180:183]
v_cvt_pk_bf16_f32 v157, v158, v159
v_mfma_f32_16x16x32_bf16 v[180:183], a[76:79], a[44:47], v[180:183]
ds_read_b64_tr_b16 a[96:97], v12 offset:16384
ds_read_b64_tr_b16 a[98:99], v12 offset:20480
s_waitcnt lgkmcnt(2)
v_mfma_f32_16x16x32_bf16 v[152:155], a[80:83], a[0:3], v[32:35]
v_exp_f32 v174, v174
v_mfma_f32_16x16x32_bf16 v[152:155], a[84:87], a[4:7], v[152:155]
v_cvt_pk_bf16_f32 v172, v172, v173
v_mfma_f32_16x16x32_bf16 v[152:155], a[88:91], a[8:11], v[152:155]
v_exp_f32 v175, v175
v_mfma_f32_16x16x32_bf16 v[152:155], a[92:95], a[12:15], v[152:155]
s_waitcnt vmcnt(4)
buffer_load_dwordx4 v23, s[8:11], s59 offen offset:3072 nt lds
s_add_u32 s59, s59, 16384
s_and_b32 s59, s59, 0x7ffff
ds_read_b64_tr_b16 a[100:101], v12 offset:24576
ds_read_b64_tr_b16 a[102:103], v12 offset:28672
v_mfma_f32_16x16x32_bf16 v[168:171], a[92:95], a[28:31], v[36:39]
v_exp_f32 v144, v144
v_mfma_f32_16x16x32_bf16 v[168:171], a[88:91], a[24:27], v[168:171]
v_exp_f32 v145, v145
v_mfma_f32_16x16x32_bf16 v[168:171], a[84:87], a[20:23], v[168:171]
v_cvt_pk_bf16_f32 v173, v174, v175
s_add_u32 m0, s65, 114688
v_mfma_f32_16x16x32_bf16 v[168:171], a[80:83], a[16:19], v[168:171]
ds_read_b64_tr_b16 a[104:105], v13 offset:16384
ds_read_b64_tr_b16 a[106:107], v13 offset:20480
ds_read_b64_tr_b16 a[108:109], v13 offset:24576
ds_read_b64_tr_b16 a[110:111], v13 offset:28672
v_mfma_f32_16x16x32_bf16 v[184:187], a[80:83], a[32:35], v[40:43]
v_exp_f32 v146, v146
v_mfma_f32_16x16x32_bf16 v[184:187], a[84:87], a[36:39], v[184:187]
v_cvt_pk_bf16_f32 v142, v144, v145
v_mfma_f32_16x16x32_bf16 v[184:187], a[88:91], a[40:43], v[184:187]
v_exp_f32 v147, v147
v_mfma_f32_16x16x32_bf16 v[184:187], a[92:95], a[44:47], v[184:187]
ds_read_b64_tr_b16 a[112:113], v14 offset:16384
s_waitcnt lgkmcnt(5)
v_mfma_f32_16x16x32_bf16 v[44:47], a[96:99], v[188:191], v[44:47]
v_exp_f32 v160, v160
v_mfma_f32_16x16x32_bf16 v[44:47], a[100:103], v[196:199], v[44:47]
s_waitcnt vmcnt(4)
buffer_load_dwordx4 v24, s[12:15], s60 offen nt lds
ds_read_b64_tr_b16 a[114:115], v14 offset:20480
v_mfma_f32_16x16x32_bf16 v[76:79], a[100:103], v[212:215], v[76:79]
v_exp_f32 v161, v161
v_mfma_f32_16x16x32_bf16 v[76:79], a[96:99], v[204:207], v[76:79]
ds_read_b64_tr_b16 a[116:117], v14 offset:24576
ds_read_b64_tr_b16 a[118:119], v14 offset:28672
v_mfma_f32_16x16x32_bf16 v[108:111], a[96:99], v[220:223], v[108:111]
v_cvt_pk_bf16_f32 v143, v146, v147
v_mfma_f32_16x16x32_bf16 v[108:111], a[100:103], v[228:231], v[108:111]
ds_read_b64_tr_b16 a[120:121], v15 offset:16384
s_waitcnt lgkmcnt(5)
v_mfma_f32_16x16x32_bf16 v[48:51], a[104:107], v[188:191], v[48:51]
v_exp_f32 v162, v162
v_mfma_f32_16x16x32_bf16 v[48:51], a[108:111], v[196:199], v[48:51]
ds_read_b64_tr_b16 a[122:123], v15 offset:20480
v_cvt_pk_bf16_f32 v158, v160, v161
v_mfma_f32_16x16x32_bf16 v[80:83], a[108:111], v[212:215], v[80:83]
v_exp_f32 v163, v163
v_mfma_f32_16x16x32_bf16 v[80:83], a[104:107], v[204:207], v[80:83]
ds_read_b64_tr_b16 a[124:125], v15 offset:24576
ds_read_b64_tr_b16 a[126:127], v15 offset:28672
v_mfma_f32_16x16x32_bf16 v[112:115], a[104:107], v[220:223], v[112:115]
v_exp_f32 v176, v176
v_mfma_f32_16x16x32_bf16 v[112:115], a[108:111], v[228:231], v[112:115]
s_waitcnt vmcnt(4)
buffer_load_dwordx4 v25, s[12:15], s60 offen offset:1024 nt lds
v_mfma_f32_16x16x32_bf16 a[48:51], a[60:63], v[188:191], a[48:51]
v_exp_f32 v177, v177
v_mfma_f32_16x16x32_bf16 a[48:51], a[60:63], v[196:199], a[48:51]
v_cvt_pk_bf16_f32 v159, v162, v163
s_waitcnt lgkmcnt(4)
v_mfma_f32_16x16x32_bf16 v[52:55], a[112:115], v[188:191], v[52:55]
v_exp_f32 v178, v178
v_mfma_f32_16x16x32_bf16 v[52:55], a[116:119], v[196:199], v[52:55]
ds_read_b64_tr_b16 a[96:97], v16 offset:16384
ds_read_b64_tr_b16 a[98:99], v16 offset:20480
v_mfma_f32_16x16x32_bf16 v[84:87], a[116:119], v[212:215], v[84:87]
v_cvt_pk_bf16_f32 v174, v176, v177
v_mfma_f32_16x16x32_bf16 v[84:87], a[112:115], v[204:207], v[84:87]
ds_read_b64_tr_b16 a[100:101], v16 offset:24576
ds_read_b64_tr_b16 a[102:103], v16 offset:28672
v_mfma_f32_16x16x32_bf16 v[116:119], a[112:115], v[220:223], v[116:119]
v_exp_f32 v179, v179
v_mfma_f32_16x16x32_bf16 v[116:119], a[116:119], v[228:231], v[116:119]
ds_read_b64_tr_b16 a[104:105], v17 offset:16384
s_waitcnt lgkmcnt(5)
v_mfma_f32_16x16x32_bf16 v[56:59], a[120:123], v[188:191], v[56:59]
v_exp_f32 v148, v148
v_mfma_f32_16x16x32_bf16 v[56:59], a[124:127], v[196:199], v[56:59]
ds_read_b64_tr_b16 a[106:107], v17 offset:20480
ds_read_b64_tr_b16 a[108:109], v17 offset:24576
v_mfma_f32_16x16x32_bf16 v[88:91], a[124:127], v[212:215], v[88:91]
v_exp_f32 v149, v149
v_mfma_f32_16x16x32_bf16 v[88:91], a[120:123], v[204:207], v[88:91]
s_waitcnt vmcnt(4)
buffer_load_dwordx4 v24, s[12:15], s60 offen offset:2048 nt lds
ds_read_b64_tr_b16 a[110:111], v17 offset:28672
v_mfma_f32_16x16x32_bf16 v[120:123], a[120:123], v[220:223], v[120:123]
v_cvt_pk_bf16_f32 v175, v178, v179
v_mfma_f32_16x16x32_bf16 v[120:123], a[124:127], v[228:231], v[120:123]
v_exp_f32 v150, v150
v_mfma_f32_16x16x32_bf16 a[52:55], a[60:63], v[204:207], a[52:55]
v_cvt_pk_bf16_f32 v148, v148, v149
v_mfma_f32_16x16x32_bf16 a[52:55], a[60:63], v[212:215], a[52:55]
ds_read_b64_tr_b16 a[112:113], v18 offset:16384
s_waitcnt lgkmcnt(5)
v_mfma_f32_16x16x32_bf16 v[60:63], a[96:99], v[188:191], v[60:63]
v_exp_f32 v151, v151
v_mfma_f32_16x16x32_bf16 v[60:63], a[100:103], v[196:199], v[60:63]
ds_read_b64_tr_b16 a[114:115], v18 offset:20480
ds_read_b64_tr_b16 a[116:117], v18 offset:24576
v_mfma_f32_16x16x32_bf16 v[92:95], a[100:103], v[212:215], v[92:95]
v_exp_f32 v164, v164
v_mfma_f32_16x16x32_bf16 v[92:95], a[96:99], v[204:207], v[92:95]
ds_read_b64_tr_b16 a[118:119], v18 offset:28672
v_mfma_f32_16x16x32_bf16 v[124:127], a[96:99], v[220:223], v[124:127]
v_exp_f32 v165, v165
v_mfma_f32_16x16x32_bf16 v[124:127], a[100:103], v[228:231], v[124:127]
s_waitcnt vmcnt(4)
buffer_load_dwordx4 v25, s[12:15], s60 offen offset:3072 nt lds
s_waitcnt lgkmcnt(4)
v_mfma_f32_16x16x32_bf16 v[64:67], a[104:107], v[188:191], v[64:67]
s_add_u32 s60, s60, 16384
s_and_b32 s60, s60, 0x7ffff
v_mfma_f32_16x16x32_bf16 v[64:67], a[108:111], v[196:199], v[64:67]
ds_read_b64_tr_b16 a[120:121], v19 offset:16384
ds_read_b64_tr_b16 a[122:123], v19 offset:20480
v_mfma_f32_16x16x32_bf16 v[96:99], a[108:111], v[212:215], v[96:99]
v_cvt_pk_bf16_f32 v149, v150, v151
v_mfma_f32_16x16x32_bf16 v[96:99], a[104:107], v[204:207], v[96:99]
ds_read_b64_tr_b16 a[124:125], v19 offset:24576
s_barrier
ds_read_b64_tr_b16 a[126:127], v19 offset:28672
v_mfma_f32_16x16x32_bf16 v[128:131], a[104:107], v[220:223], v[128:131]
v_exp_f32 v166, v166
v_mfma_f32_16x16x32_bf16 v[128:131], a[108:111], v[228:231], v[128:131]
v_cvt_pk_bf16_f32 v164, v164, v165
v_mfma_f32_16x16x32_bf16 a[56:59], a[60:63], v[220:223], a[56:59]
v_exp_f32 v167, v167
v_mfma_f32_16x16x32_bf16 a[56:59], a[60:63], v[228:231], a[56:59]
ds_read_b128 a[64:67], v8 offset:49152
s_waitcnt lgkmcnt(5)
v_mfma_f32_16x16x32_bf16 v[68:71], a[112:115], v[188:191], v[68:71]
v_exp_f32 v180, v180
v_mfma_f32_16x16x32_bf16 v[68:71], a[116:119], v[196:199], v[68:71]
ds_read_b128 a[68:71], v9 offset:49152
ds_read_b128 a[72:75], v10 offset:49152
v_mfma_f32_16x16x32_bf16 v[100:103], a[116:119], v[212:215], v[100:103]
v_exp_f32 v181, v181
v_mfma_f32_16x16x32_bf16 v[100:103], a[112:115], v[204:207], v[100:103]
v_cvt_pk_bf16_f32 v165, v166, v167
ds_read_b128 a[76:79], v11 offset:49152
v_mfma_f32_16x16x32_bf16 v[132:135], a[112:115], v[220:223], v[132:135]
v_exp_f32 v182, v182
v_mfma_f32_16x16x32_bf16 v[132:135], a[116:119], v[228:231], v[132:135]
v_cvt_pk_bf16_f32 v180, v180, v181
s_waitcnt lgkmcnt(4)
v_mfma_f32_16x16x32_bf16 v[72:75], a[120:123], v[188:191], v[72:75]
v_exp_f32 v183, v183
v_mfma_f32_16x16x32_bf16 v[72:75], a[124:127], v[196:199], v[72:75]
v_exp_f32 v152, v152
v_mfma_f32_16x16x32_bf16 v[104:107], a[124:127], v[212:215], v[104:107]
v_exp_f32 v153, v153
v_mfma_f32_16x16x32_bf16 v[104:107], a[120:123], v[204:207], v[104:107]
v_cvt_pk_bf16_f32 v181, v182, v183
v_mfma_f32_16x16x32_bf16 v[136:139], a[120:123], v[220:223], v[136:139]
v_exp_f32 v154, v154
v_mfma_f32_16x16x32_bf16 v[136:139], a[124:127], v[228:231], v[136:139]
v_cvt_pk_bf16_f32 v150, v152, v153
v_exp_f32 v155, v155
s_waitcnt lgkmcnt(0)
v_mfma_f32_16x16x32_bf16 v[188:191], a[64:67], a[0:3], v[32:35]
v_exp_f32 v168, v168
v_mfma_f32_16x16x32_bf16 v[188:191], a[68:71], a[4:7], v[188:191]
s_add_u32 m0, s65, 32768
v_mfma_f32_16x16x32_bf16 v[188:191], a[72:75], a[8:11], v[188:191]
v_exp_f32 v169, v169
v_mfma_f32_16x16x32_bf16 v[188:191], a[76:79], a[12:15], v[188:191]
ds_read_b128 a[80:83], v8 offset:53248
ds_read_b128 a[84:87], v9 offset:53248
ds_read_b128 a[88:91], v10 offset:53248
v_mfma_f32_16x16x32_bf16 v[204:207], a[76:79], a[28:31], v[36:39]
v_cvt_pk_bf16_f32 v151, v154, v155
v_mfma_f32_16x16x32_bf16 v[204:207], a[72:75], a[24:27], v[204:207]
v_exp_f32 v170, v170
v_mfma_f32_16x16x32_bf16 v[204:207], a[68:71], a[20:23], v[204:207]
v_cvt_pk_bf16_f32 v166, v168, v169
v_mfma_f32_16x16x32_bf16 v[204:207], a[64:67], a[16:19], v[204:207]
s_waitcnt vmcnt(4)
buffer_load_dwordx4 v20, s[8:11], s59 offen nt lds
ds_read_b128 a[92:95], v11 offset:53248
v_mfma_f32_16x16x32_bf16 v[220:223], a[64:67], a[32:35], v[40:43]
v_exp_f32 v171, v171
v_mfma_f32_16x16x32_bf16 v[220:223], a[68:71], a[36:39], v[220:223]
v_exp_f32 v184, v184
v_mfma_f32_16x16x32_bf16 v[220:223], a[72:75], a[40:43], v[220:223]
v_exp_f32 v185, v185
v_mfma_f32_16x16x32_bf16 v[220:223], a[76:79], a[44:47], v[220:223]
v_cvt_pk_bf16_f32 v167, v170, v171
s_waitcnt lgkmcnt(0)
v_mfma_f32_16x16x32_bf16 v[192:195], a[80:83], a[0:3], v[32:35]
v_exp_f32 v186, v186
v_mfma_f32_16x16x32_bf16 v[192:195], a[84:87], a[4:7], v[192:195]
v_cvt_pk_bf16_f32 v182, v184, v185
v_mfma_f32_16x16x32_bf16 v[192:195], a[88:91], a[8:11], v[192:195]
v_exp_f32 v187, v187
v_mfma_f32_16x16x32_bf16 v[192:195], a[92:95], a[12:15], v[192:195]
ds_read_b128 a[64:67], v8 offset:57344
s_waitcnt vmcnt(4)
buffer_load_dwordx4 v21, s[8:11], s59 offen offset:1024 nt lds
ds_read_b128 a[68:71], v9 offset:57344
ds_read_b128 a[72:75], v10 offset:57344
v_mfma_f32_16x16x32_bf16 v[208:211], a[92:95], a[28:31], v[36:39]
v_cvt_pk_bf16_f32 v183, v186, v187
v_mfma_f32_16x16x32_bf16 v[208:211], a[88:91], a[24:27], v[208:211]
v_exp_f32 v188, v188
v_mfma_f32_16x16x32_bf16 v[208:211], a[84:87], a[20:23], v[208:211]
v_exp_f32 v189, v189
v_mfma_f32_16x16x32_bf16 v[208:211], a[80:83], a[16:19], v[208:211]
ds_read_b128 a[76:79], v11 offset:57344
v_mfma_f32_16x16x32_bf16 v[224:227], a[80:83], a[32:35], v[40:43]
v_exp_f32 v190, v190
v_mfma_f32_16x16x32_bf16 v[224:227], a[84:87], a[36:39], v[224:227]
v_cvt_pk_bf16_f32 v188, v188, v189
v_mfma_f32_16x16x32_bf16 v[224:227], a[88:91], a[40:43], v[224:227]
v_exp_f32 v191, v191
v_mfma_f32_16x16x32_bf16 v[224:227], a[92:95], a[44:47], v[224:227]
s_waitcnt lgkmcnt(0)
v_mfma_f32_16x16x32_bf16 v[196:199], a[64:67], a[0:3], v[32:35]
v_exp_f32 v204, v204
v_mfma_f32_16x16x32_bf16 v[196:199], a[68:71], a[4:7], v[196:199]
v_exp_f32 v205, v205
v_mfma_f32_16x16x32_bf16 v[196:199], a[72:75], a[8:11], v[196:199]
v_cvt_pk_bf16_f32 v189, v190, v191
v_mfma_f32_16x16x32_bf16 v[196:199], a[76:79], a[12:15], v[196:199]
s_waitcnt vmcnt(4)
buffer_load_dwordx4 v22, s[8:11], s59 offen offset:2048 nt lds
ds_read_b128 a[80:83], v8 offset:61440
ds_read_b128 a[84:87], v9 offset:61440
ds_read_b128 a[88:91], v10 offset:61440
v_mfma_f32_16x16x32_bf16 v[212:215], a[76:79], a[28:31], v[36:39]
v_exp_f32 v206, v206
v_mfma_f32_16x16x32_bf16 v[212:215], a[72:75], a[24:27], v[212:215]
v_cvt_pk_bf16_f32 v204, v204, v205
v_mfma_f32_16x16x32_bf16 v[212:215], a[68:71], a[20:23], v[212:215]
v_exp_f32 v207, v207
v_mfma_f32_16x16x32_bf16 v[212:215], a[64:67], a[16:19], v[212:215]
ds_read_b128 a[92:95], v11 offset:61440
v_mfma_f32_16x16x32_bf16 v[228:231], a[64:67], a[32:35], v[40:43]
v_exp_f32 v220, v220
v_mfma_f32_16x16x32_bf16 v[228:231], a[68:71], a[36:39], v[228:231]
v_exp_f32 v221, v221
v_mfma_f32_16x16x32_bf16 v[228:231], a[72:75], a[40:43], v[228:231]
v_cvt_pk_bf16_f32 v205, v206, v207
v_mfma_f32_16x16x32_bf16 v[228:231], a[76:79], a[44:47], v[228:231]
ds_read_b64_tr_b16 a[96:97], v12 offset:32768
ds_read_b64_tr_b16 a[98:99], v12 offset:36864
s_waitcnt lgkmcnt(2)
v_mfma_f32_16x16x32_bf16 v[200:203], a[80:83], a[0:3], v[32:35]
v_exp_f32 v222, v222
v_mfma_f32_16x16x32_bf16 v[200:203], a[84:87], a[4:7], v[200:203]
v_cvt_pk_bf16_f32 v220, v220, v221
v_mfma_f32_16x16x32_bf16 v[200:203], a[88:91], a[8:11], v[200:203]
v_exp_f32 v223, v223
v_mfma_f32_16x16x32_bf16 v[200:203], a[92:95], a[12:15], v[200:203]
s_waitcnt vmcnt(4)
buffer_load_dwordx4 v23, s[8:11], s59 offen offset:3072 nt lds
s_add_u32 s59, s59, 16384
s_and_b32 s59, s59, 0x7ffff
ds_read_b64_tr_b16 a[100:101], v12 offset:40960
ds_read_b64_tr_b16 a[102:103], v12 offset:45056
v_mfma_f32_16x16x32_bf16 v[216:219], a[92:95], a[28:31], v[36:39]
v_exp_f32 v192, v192
v_mfma_f32_16x16x32_bf16 v[216:219], a[88:91], a[24:27], v[216:219]
v_exp_f32 v193, v193
v_mfma_f32_16x16x32_bf16 v[216:219], a[84:87], a[20:23], v[216:219]
v_cvt_pk_bf16_f32 v221, v222, v223
s_add_u32 m0, s65, 65536
v_mfma_f32_16x16x32_bf16 v[216:219], a[80:83], a[16:19], v[216:219]
ds_read_b64_tr_b16 a[104:105], v13 offset:32768
ds_read_b64_tr_b16 a[106:107], v13 offset:36864
ds_read_b64_tr_b16 a[108:109], v13 offset:40960
ds_read_b64_tr_b16 a[110:111], v13 offset:45056
v_mfma_f32_16x16x32_bf16 v[232:235], a[80:83], a[32:35], v[40:43]
v_exp_f32 v194, v194
v_mfma_f32_16x16x32_bf16 v[232:235], a[84:87], a[36:39], v[232:235]
v_cvt_pk_bf16_f32 v190, v192, v193
v_mfma_f32_16x16x32_bf16 v[232:235], a[88:91], a[40:43], v[232:235]
v_exp_f32 v195, v195
v_mfma_f32_16x16x32_bf16 v[232:235], a[92:95], a[44:47], v[232:235]
ds_read_b64_tr_b16 a[112:113], v14 offset:32768
s_waitcnt lgkmcnt(5)
v_mfma_f32_16x16x32_bf16 v[44:47], a[96:99], v[140:143], v[44:47]
v_exp_f32 v208, v208
v_mfma_f32_16x16x32_bf16 v[44:47], a[100:103], v[148:151], v[44:47]
s_waitcnt vmcnt(4)
buffer_load_dwordx4 v24, s[12:15], s60 offen nt lds
ds_read_b64_tr_b16 a[114:115], v14 offset:36864
v_mfma_f32_16x16x32_bf16 v[76:79], a[100:103], v[164:167], v[76:79]
v_exp_f32 v209, v209
v_mfma_f32_16x16x32_bf16 v[76:79], a[96:99], v[156:159], v[76:79]
ds_read_b64_tr_b16 a[116:117], v14 offset:40960
ds_read_b64_tr_b16 a[118:119], v14 offset:45056
v_mfma_f32_16x16x32_bf16 v[108:111], a[96:99], v[172:175], v[108:111]
v_cvt_pk_bf16_f32 v191, v194, v195
v_mfma_f32_16x16x32_bf16 v[108:111], a[100:103], v[180:183], v[108:111]
ds_read_b64_tr_b16 a[120:121], v15 offset:32768
s_waitcnt lgkmcnt(5)
v_mfma_f32_16x16x32_bf16 v[48:51], a[104:107], v[140:143], v[48:51]
v_exp_f32 v210, v210
v_mfma_f32_16x16x32_bf16 v[48:51], a[108:111], v[148:151], v[48:51]
ds_read_b64_tr_b16 a[122:123], v15 offset:36864
v_cvt_pk_bf16_f32 v206, v208, v209
v_mfma_f32_16x16x32_bf16 v[80:83], a[108:111], v[164:167], v[80:83]
v_exp_f32 v211, v211
v_mfma_f32_16x16x32_bf16 v[80:83], a[104:107], v[156:159], v[80:83]
ds_read_b64_tr_b16 a[124:125], v15 offset:40960
ds_read_b64_tr_b16 a[126:127], v15 offset:45056
v_mfma_f32_16x16x32_bf16 v[112:115], a[104:107], v[172:175], v[112:115]
v_exp_f32 v224, v224
v_mfma_f32_16x16x32_bf16 v[112:115], a[108:111], v[180:183], v[112:115]
s_waitcnt vmcnt(4)
buffer_load_dwordx4 v25, s[12:15], s60 offen offset:1024 nt lds
v_mfma_f32_16x16x32_bf16 a[48:51], a[60:63], v[140:143], a[48:51]
v_exp_f32 v225, v225
v_mfma_f32_16x16x32_bf16 a[48:51], a[60:63], v[148:151], a[48:51]
v_cvt_pk_bf16_f32 v207, v210, v211
s_waitcnt lgkmcnt(4)
v_mfma_f32_16x16x32_bf16 v[52:55], a[112:115], v[140:143], v[52:55]
v_exp_f32 v226, v226
v_mfma_f32_16x16x32_bf16 v[52:55], a[116:119], v[148:151], v[52:55]
ds_read_b64_tr_b16 a[96:97], v16 offset:32768
ds_read_b64_tr_b16 a[98:99], v16 offset:36864
v_mfma_f32_16x16x32_bf16 v[84:87], a[116:119], v[164:167], v[84:87]
v_cvt_pk_bf16_f32 v222, v224, v225
v_mfma_f32_16x16x32_bf16 v[84:87], a[112:115], v[156:159], v[84:87]
ds_read_b64_tr_b16 a[100:101], v16 offset:40960
ds_read_b64_tr_b16 a[102:103], v16 offset:45056
v_mfma_f32_16x16x32_bf16 v[116:119], a[112:115], v[172:175], v[116:119]
v_exp_f32 v227, v227
v_mfma_f32_16x16x32_bf16 v[116:119], a[116:119], v[180:183], v[116:119]
ds_read_b64_tr_b16 a[104:105], v17 offset:32768
s_waitcnt lgkmcnt(5)
v_mfma_f32_16x16x32_bf16 v[56:59], a[120:123], v[140:143], v[56:59]
v_exp_f32 v196, v196
v_mfma_f32_16x16x32_bf16 v[56:59], a[124:127], v[148:151], v[56:59]
ds_read_b64_tr_b16 a[106:107], v17 offset:36864
ds_read_b64_tr_b16 a[108:109], v17 offset:40960
v_mfma_f32_16x16x32_bf16 v[88:91], a[124:127], v[164:167], v[88:91]
v_exp_f32 v197, v197
v_mfma_f32_16x16x32_bf16 v[88:91], a[120:123], v[156:159], v[88:91]
s_waitcnt vmcnt(4)
buffer_load_dwordx4 v24, s[12:15], s60 offen offset:2048 nt lds
ds_read_b64_tr_b16 a[110:111], v17 offset:45056
v_mfma_f32_16x16x32_bf16 v[120:123], a[120:123], v[172:175], v[120:123]
v_cvt_pk_bf16_f32 v223, v226, v227
v_mfma_f32_16x16x32_bf16 v[120:123], a[124:127], v[180:183], v[120:123]
v_exp_f32 v198, v198
v_mfma_f32_16x16x32_bf16 a[52:55], a[60:63], v[156:159], a[52:55]
v_cvt_pk_bf16_f32 v196, v196, v197
v_mfma_f32_16x16x32_bf16 a[52:55], a[60:63], v[164:167], a[52:55]
ds_read_b64_tr_b16 a[112:113], v18 offset:32768
s_waitcnt lgkmcnt(5)
v_mfma_f32_16x16x32_bf16 v[60:63], a[96:99], v[140:143], v[60:63]
v_exp_f32 v199, v199
v_mfma_f32_16x16x32_bf16 v[60:63], a[100:103], v[148:151], v[60:63]
ds_read_b64_tr_b16 a[114:115], v18 offset:36864
ds_read_b64_tr_b16 a[116:117], v18 offset:40960
v_mfma_f32_16x16x32_bf16 v[92:95], a[100:103], v[164:167], v[92:95]
v_exp_f32 v212, v212
v_mfma_f32_16x16x32_bf16 v[92:95], a[96:99], v[156:159], v[92:95]
ds_read_b64_tr_b16 a[118:119], v18 offset:45056
v_mfma_f32_16x16x32_bf16 v[124:127], a[96:99], v[172:175], v[124:127]
v_exp_f32 v213, v213
v_mfma_f32_16x16x32_bf16 v[124:127], a[100:103], v[180:183], v[124:127]
s_waitcnt vmcnt(4)
buffer_load_dwordx4 v25, s[12:15], s60 offen offset:3072 nt lds
s_waitcnt lgkmcnt(4)
v_mfma_f32_16x16x32_bf16 v[64:67], a[104:107], v[140:143], v[64:67]
s_add_u32 s60, s60, 16384
s_and_b32 s60, s60, 0x7ffff
v_mfma_f32_16x16x32_bf16 v[64:67], a[108:111], v[148:151], v[64:67]
ds_read_b64_tr_b16 a[120:121], v19 offset:32768
ds_read_b64_tr_b16 a[122:123], v19 offset:36864
v_mfma_f32_16x16x32_bf16 v[96:99], a[108:111], v[164:167], v[96:99]
v_cvt_pk_bf16_f32 v197, v198, v199
v_mfma_f32_16x16x32_bf16 v[96:99], a[104:107], v[156:159], v[96:99]
ds_read_b64_tr_b16 a[124:125], v19 offset:40960
s_barrier
ds_read_b64_tr_b16 a[126:127], v19 offset:45056
v_mfma_f32_16x16x32_bf16 v[128:131], a[104:107], v[172:175], v[128:131]
v_exp_f32 v214, v214
v_mfma_f32_16x16x32_bf16 v[128:131], a[108:111], v[180:183], v[128:131]
v_cvt_pk_bf16_f32 v212, v212, v213
v_mfma_f32_16x16x32_bf16 a[56:59], a[60:63], v[172:175], a[56:59]
v_exp_f32 v215, v215
v_mfma_f32_16x16x32_bf16 a[56:59], a[60:63], v[180:183], a[56:59]
ds_read_b128 a[64:67], v8 offset:0
s_waitcnt lgkmcnt(5)
v_mfma_f32_16x16x32_bf16 v[68:71], a[112:115], v[140:143], v[68:71]
v_exp_f32 v228, v228
v_mfma_f32_16x16x32_bf16 v[68:71], a[116:119], v[148:151], v[68:71]
ds_read_b128 a[68:71], v9 offset:0
ds_read_b128 a[72:75], v10 offset:0
v_mfma_f32_16x16x32_bf16 v[100:103], a[116:119], v[164:167], v[100:103]
v_exp_f32 v229, v229
v_mfma_f32_16x16x32_bf16 v[100:103], a[112:115], v[156:159], v[100:103]
v_cvt_pk_bf16_f32 v213, v214, v215
ds_read_b128 a[76:79], v11 offset:0
v_mfma_f32_16x16x32_bf16 v[132:135], a[112:115], v[172:175], v[132:135]
v_exp_f32 v230, v230
v_mfma_f32_16x16x32_bf16 v[132:135], a[116:119], v[180:183], v[132:135]
v_cvt_pk_bf16_f32 v228, v228, v229
s_waitcnt lgkmcnt(4)
v_mfma_f32_16x16x32_bf16 v[72:75], a[120:123], v[140:143], v[72:75]
v_exp_f32 v231, v231
v_mfma_f32_16x16x32_bf16 v[72:75], a[124:127], v[148:151], v[72:75]
v_exp_f32 v200, v200
v_mfma_f32_16x16x32_bf16 v[104:107], a[124:127], v[164:167], v[104:107]
v_exp_f32 v201, v201
v_mfma_f32_16x16x32_bf16 v[104:107], a[120:123], v[156:159], v[104:107]
v_cvt_pk_bf16_f32 v229, v230, v231
v_mfma_f32_16x16x32_bf16 v[136:139], a[120:123], v[172:175], v[136:139]
v_exp_f32 v202, v202
v_mfma_f32_16x16x32_bf16 v[136:139], a[124:127], v[180:183], v[136:139]
v_cvt_pk_bf16_f32 v198, v200, v201
v_exp_f32 v203, v203
s_waitcnt lgkmcnt(0)
v_mfma_f32_16x16x32_bf16 v[140:143], a[64:67], a[0:3], v[32:35]
v_exp_f32 v216, v216
v_mfma_f32_16x16x32_bf16 v[140:143], a[68:71], a[4:7], v[140:143]
s_add_u32 m0, s65, 49152
v_mfma_f32_16x16x32_bf16 v[140:143], a[72:75], a[8:11], v[140:143]
v_exp_f32 v217, v217
v_mfma_f32_16x16x32_bf16 v[140:143], a[76:79], a[12:15], v[140:143]
ds_read_b128 a[80:83], v8 offset:4096
ds_read_b128 a[84:87], v9 offset:4096
ds_read_b128 a[88:91], v10 offset:4096
v_mfma_f32_16x16x32_bf16 v[156:159], a[76:79], a[28:31], v[36:39]
v_cvt_pk_bf16_f32 v199, v202, v203
v_mfma_f32_16x16x32_bf16 v[156:159], a[72:75], a[24:27], v[156:159]
v_exp_f32 v218, v218
v_mfma_f32_16x16x32_bf16 v[156:159], a[68:71], a[20:23], v[156:159]
v_cvt_pk_bf16_f32 v214, v216, v217
v_mfma_f32_16x16x32_bf16 v[156:159], a[64:67], a[16:19], v[156:159]
s_waitcnt vmcnt(4)
buffer_load_dwordx4 v20, s[8:11], s59 offen nt lds
ds_read_b128 a[92:95], v11 offset:4096
v_mfma_f32_16x16x32_bf16 v[172:175], a[64:67], a[32:35], v[40:43]
v_exp_f32 v219, v219
v_mfma_f32_16x16x32_bf16 v[172:175], a[68:71], a[36:39], v[172:175]
v_exp_f32 v232, v232
v_mfma_f32_16x16x32_bf16 v[172:175], a[72:75], a[40:43], v[172:175]
v_exp_f32 v233, v233
v_mfma_f32_16x16x32_bf16 v[172:175], a[76:79], a[44:47], v[172:175]
v_cvt_pk_bf16_f32 v215, v218, v219
s_waitcnt lgkmcnt(0)
v_mfma_f32_16x16x32_bf16 v[144:147], a[80:83], a[0:3], v[32:35]
v_exp_f32 v234, v234
v_mfma_f32_16x16x32_bf16 v[144:147], a[84:87], a[4:7], v[144:147]
v_cvt_pk_bf16_f32 v230, v232, v233
v_mfma_f32_16x16x32_bf16 v[144:147], a[88:91], a[8:11], v[144:147]
v_exp_f32 v235, v235
v_mfma_f32_16x16x32_bf16 v[144:147], a[92:95], a[12:15], v[144:147]
ds_read_b128 a[64:67], v8 offset:8192
s_waitcnt vmcnt(4)
buffer_load_dwordx4 v21, s[8:11], s59 offen offset:1024 nt lds
ds_read_b128 a[68:71], v9 offset:8192
ds_read_b128 a[72:75], v10 offset:8192
v_mfma_f32_16x16x32_bf16 v[160:163], a[92:95], a[28:31], v[36:39]
v_cvt_pk_bf16_f32 v231, v234, v235
v_mfma_f32_16x16x32_bf16 v[160:163], a[88:91], a[24:27], v[160:163]
v_exp_f32 v140, v140
v_mfma_f32_16x16x32_bf16 v[160:163], a[84:87], a[20:23], v[160:163]
v_exp_f32 v141, v141
v_mfma_f32_16x16x32_bf16 v[160:163], a[80:83], a[16:19], v[160:163]
ds_read_b128 a[76:79], v11 offset:8192
v_mfma_f32_16x16x32_bf16 v[176:179], a[80:83], a[32:35], v[40:43]
v_exp_f32 v142, v142
v_mfma_f32_16x16x32_bf16 v[176:179], a[84:87], a[36:39], v[176:179]
v_cvt_pk_bf16_f32 v140, v140, v141
v_mfma_f32_16x16x32_bf16 v[176:179], a[88:91], a[40:43], v[176:179]
v_exp_f32 v143, v143
v_mfma_f32_16x16x32_bf16 v[176:179], a[92:95], a[44:47], v[176:179]
s_waitcnt lgkmcnt(0)
v_mfma_f32_16x16x32_bf16 v[148:151], a[64:67], a[0:3], v[32:35]
v_exp_f32 v156, v156
v_mfma_f32_16x16x32_bf16 v[148:151], a[68:71], a[4:7], v[148:151]
v_exp_f32 v157, v157
v_mfma_f32_16x16x32_bf16 v[148:151], a[72:75], a[8:11], v[148:151]
v_cvt_pk_bf16_f32 v141, v142, v143
v_mfma_f32_16x16x32_bf16 v[148:151], a[76:79], a[12:15], v[148:151]
s_waitcnt vmcnt(4)
buffer_load_dwordx4 v22, s[8:11], s59 offen offset:2048 nt lds
ds_read_b128 a[80:83], v8 offset:12288
ds_read_b128 a[84:87], v9 offset:12288
ds_read_b128 a[88:91], v10 offset:12288
v_mfma_f32_16x16x32_bf16 v[164:167], a[76:79], a[28:31], v[36:39]
v_exp_f32 v158, v158
v_mfma_f32_16x16x32_bf16 v[164:167], a[72:75], a[24:27], v[164:167]
v_cvt_pk_bf16_f32 v156, v156, v157
v_mfma_f32_16x16x32_bf16 v[164:167], a[68:71], a[20:23], v[164:167]
v_exp_f32 v159, v159
v_mfma_f32_16x16x32_bf16 v[164:167], a[64:67], a[16:19], v[164:167]
ds_read_b128 a[92:95], v11 offset:12288
v_mfma_f32_16x16x32_bf16 v[180:183], a[64:67], a[32:35], v[40:43]
v_exp_f32 v172, v172
v_mfma_f32_16x16x32_bf16 v[180:183], a[68:71], a[36:39], v[180:183]
v_exp_f32 v173, v173
v_mfma_f32_16x16x32_bf16 v[180:183], a[72:75], a[40:43], v[180:183]
v_cvt_pk_bf16_f32 v157, v158, v159
v_mfma_f32_16x16x32_bf16 v[180:183], a[76:79], a[44:47], v[180:183]
ds_read_b64_tr_b16 a[96:97], v12 offset:49152
ds_read_b64_tr_b16 a[98:99], v12 offset:53248
s_waitcnt lgkmcnt(2)
v_mfma_f32_16x16x32_bf16 v[152:155], a[80:83], a[0:3], v[32:35]
v_exp_f32 v174, v174
v_mfma_f32_16x16x32_bf16 v[152:155], a[84:87], a[4:7], v[152:155]
v_cvt_pk_bf16_f32 v172, v172, v173
v_mfma_f32_16x16x32_bf16 v[152:155], a[88:91], a[8:11], v[152:155]
v_exp_f32 v175, v175
v_mfma_f32_16x16x32_bf16 v[152:155], a[92:95], a[12:15], v[152:155]
s_waitcnt vmcnt(4)
buffer_load_dwordx4 v23, s[8:11], s59 offen offset:3072 nt lds
s_add_u32 s59, s59, 16384
s_and_b32 s59, s59, 0x7ffff
ds_read_b64_tr_b16 a[100:101], v12 offset:57344
ds_read_b64_tr_b16 a[102:103], v12 offset:61440
v_mfma_f32_16x16x32_bf16 v[168:171], a[92:95], a[28:31], v[36:39]
v_exp_f32 v144, v144
v_mfma_f32_16x16x32_bf16 v[168:171], a[88:91], a[24:27], v[168:171]
v_exp_f32 v145, v145
v_mfma_f32_16x16x32_bf16 v[168:171], a[84:87], a[20:23], v[168:171]
v_cvt_pk_bf16_f32 v173, v174, v175
s_add_u32 m0, s65, 81920
v_mfma_f32_16x16x32_bf16 v[168:171], a[80:83], a[16:19], v[168:171]
ds_read_b64_tr_b16 a[104:105], v13 offset:49152
ds_read_b64_tr_b16 a[106:107], v13 offset:53248
ds_read_b64_tr_b16 a[108:109], v13 offset:57344
ds_read_b64_tr_b16 a[110:111], v13 offset:61440
v_mfma_f32_16x16x32_bf16 v[184:187], a[80:83], a[32:35], v[40:43]
v_exp_f32 v146, v146
v_mfma_f32_16x16x32_bf16 v[184:187], a[84:87], a[36:39], v[184:187]
v_cvt_pk_bf16_f32 v142, v144, v145
v_mfma_f32_16x16x32_bf16 v[184:187], a[88:91], a[40:43], v[184:187]
v_exp_f32 v147, v147
v_mfma_f32_16x16x32_bf16 v[184:187], a[92:95], a[44:47], v[184:187]
ds_read_b64_tr_b16 a[112:113], v14 offset:49152
s_waitcnt lgkmcnt(5)
v_mfma_f32_16x16x32_bf16 v[44:47], a[96:99], v[188:191], v[44:47]
v_exp_f32 v160, v160
v_mfma_f32_16x16x32_bf16 v[44:47], a[100:103], v[196:199], v[44:47]
s_waitcnt vmcnt(4)
buffer_load_dwordx4 v24, s[12:15], s60 offen nt lds
ds_read_b64_tr_b16 a[114:115], v14 offset:53248
v_mfma_f32_16x16x32_bf16 v[76:79], a[100:103], v[212:215], v[76:79]
v_exp_f32 v161, v161
v_mfma_f32_16x16x32_bf16 v[76:79], a[96:99], v[204:207], v[76:79]
ds_read_b64_tr_b16 a[116:117], v14 offset:57344
ds_read_b64_tr_b16 a[118:119], v14 offset:61440
v_mfma_f32_16x16x32_bf16 v[108:111], a[96:99], v[220:223], v[108:111]
v_cvt_pk_bf16_f32 v143, v146, v147
v_mfma_f32_16x16x32_bf16 v[108:111], a[100:103], v[228:231], v[108:111]
ds_read_b64_tr_b16 a[120:121], v15 offset:49152
s_waitcnt lgkmcnt(5)
v_mfma_f32_16x16x32_bf16 v[48:51], a[104:107], v[188:191], v[48:51]
v_exp_f32 v162, v162
v_mfma_f32_16x16x32_bf16 v[48:51], a[108:111], v[196:199], v[48:51]
ds_read_b64_tr_b16 a[122:123], v15 offset:53248
v_cvt_pk_bf16_f32 v158, v160, v161
v_mfma_f32_16x16x32_bf16 v[80:83], a[108:111], v[212:215], v[80:83]
v_exp_f32 v163, v163
v_mfma_f32_16x16x32_bf16 v[80:83], a[104:107], v[204:207], v[80:83]
ds_read_b64_tr_b16 a[124:125], v15 offset:57344
ds_read_b64_tr_b16 a[126:127], v15 offset:61440
v_mfma_f32_16x16x32_bf16 v[112:115], a[104:107], v[220:223], v[112:115]
v_exp_f32 v176, v176
v_mfma_f32_16x16x32_bf16 v[112:115], a[108:111], v[228:231], v[112:115]
s_waitcnt vmcnt(4)
buffer_load_dwordx4 v25, s[12:15], s60 offen offset:1024 nt lds
v_mfma_f32_16x16x32_bf16 a[48:51], a[60:63], v[188:191], a[48:51]
v_exp_f32 v177, v177
v_mfma_f32_16x16x32_bf16 a[48:51], a[60:63], v[196:199], a[48:51]
v_cvt_pk_bf16_f32 v159, v162, v163
s_waitcnt lgkmcnt(4)
v_mfma_f32_16x16x32_bf16 v[52:55], a[112:115], v[188:191], v[52:55]
v_exp_f32 v178, v178
v_mfma_f32_16x16x32_bf16 v[52:55], a[116:119], v[196:199], v[52:55]
ds_read_b64_tr_b16 a[96:97], v16 offset:49152
ds_read_b64_tr_b16 a[98:99], v16 offset:53248
v_mfma_f32_16x16x32_bf16 v[84:87], a[116:119], v[212:215], v[84:87]
v_cvt_pk_bf16_f32 v174, v176, v177
v_mfma_f32_16x16x32_bf16 v[84:87], a[112:115], v[204:207], v[84:87]
ds_read_b64_tr_b16 a[100:101], v16 offset:57344
ds_read_b64_tr_b16 a[102:103], v16 offset:61440
v_mfma_f32_16x16x32_bf16 v[116:119], a[112:115], v[220:223], v[116:119]
v_exp_f32 v179, v179
v_mfma_f32_16x16x32_bf16 v[116:119], a[116:119], v[228:231], v[116:119]
ds_read_b64_tr_b16 a[104:105], v17 offset:49152
s_waitcnt lgkmcnt(5)
v_mfma_f32_16x16x32_bf16 v[56:59], a[120:123], v[188:191], v[56:59]
v_exp_f32 v148, v148
v_mfma_f32_16x16x32_bf16 v[56:59], a[124:127], v[196:199], v[56:59]
ds_read_b64_tr_b16 a[106:107], v17 offset:53248
ds_read_b64_tr_b16 a[108:109], v17 offset:57344
v_mfma_f32_16x16x32_bf16 v[88:91], a[124:127], v[212:215], v[88:91]
v_exp_f32 v149, v149
v_mfma_f32_16x16x32_bf16 v[88:91], a[120:123], v[204:207], v[88:91]
s_waitcnt vmcnt(4)
buffer_load_dwordx4 v24, s[12:15], s60 offen offset:2048 nt lds
ds_read_b64_tr_b16 a[110:111], v17 offset:61440
v_mfma_f32_16x16x32_bf16 v[120:123], a[120:123], v[220:223], v[120:123]
v_cvt_pk_bf16_f32 v175, v178, v179
v_mfma_f32_16x16x32_bf16 v[120:123], a[124:127], v[228:231], v[120:123]
v_exp_f32 v150, v150
v_mfma_f32_16x16x32_bf16 a[52:55], a[60:63], v[204:207], a[52:55]
v_cvt_pk_bf16_f32 v148, v148, v149
v_mfma_f32_16x16x32_bf16 a[52:55], a[60:63], v[212:215], a[52:55]
ds_read_b64_tr_b16 a[112:113], v18 offset:49152
s_waitcnt lgkmcnt(5)
v_mfma_f32_16x16x32_bf16 v[60:63], a[96:99], v[188:191], v[60:63]
v_exp_f32 v151, v151
v_mfma_f32_16x16x32_bf16 v[60:63], a[100:103], v[196:199], v[60:63]
ds_read_b64_tr_b16 a[114:115], v18 offset:53248
ds_read_b64_tr_b16 a[116:117], v18 offset:57344
v_mfma_f32_16x16x32_bf16 v[92:95], a[100:103], v[212:215], v[92:95]
v_exp_f32 v164, v164
v_mfma_f32_16x16x32_bf16 v[92:95], a[96:99], v[204:207], v[92:95]
ds_read_b64_tr_b16 a[118:119], v18 offset:61440
v_mfma_f32_16x16x32_bf16 v[124:127], a[96:99], v[220:223], v[124:127]
v_exp_f32 v165, v165
v_mfma_f32_16x16x32_bf16 v[124:127], a[100:103], v[228:231], v[124:127]
s_waitcnt vmcnt(3)
buffer_load_dwordx4 v25, s[12:15], s60 offen offset:3072 nt lds
s_waitcnt lgkmcnt(4)
v_mfma_f32_16x16x32_bf16 v[64:67], a[104:107], v[188:191], v[64:67]
s_add_u32 s60, s60, 16384
s_and_b32 s60, s60, 0x7ffff
v_mfma_f32_16x16x32_bf16 v[64:67], a[108:111], v[196:199], v[64:67]
ds_read_b64_tr_b16 a[120:121], v19 offset:49152
ds_read_b64_tr_b16 a[122:123], v19 offset:53248
v_mfma_f32_16x16x32_bf16 v[96:99], a[108:111], v[212:215], v[96:99]
v_cvt_pk_bf16_f32 v149, v150, v151
v_mfma_f32_16x16x32_bf16 v[96:99], a[104:107], v[204:207], v[96:99]
ds_read_b64_tr_b16 a[124:125], v19 offset:57344
s_barrier
ds_read_b64_tr_b16 a[126:127], v19 offset:61440
v_mfma_f32_16x16x32_bf16 v[128:131], a[104:107], v[220:223], v[128:131]
v_exp_f32 v166, v166
v_mfma_f32_16x16x32_bf16 v[128:131], a[108:111], v[228:231], v[128:131]
v_cvt_pk_bf16_f32 v164, v164, v165
v_mfma_f32_16x16x32_bf16 a[56:59], a[60:63], v[220:223], a[56:59]
v_exp_f32 v167, v167
v_mfma_f32_16x16x32_bf16 a[56:59], a[60:63], v[228:231], a[56:59]
ds_read_b128 a[64:67], v8 offset:16384
s_waitcnt lgkmcnt(5)
v_mfma_f32_16x16x32_bf16 v[68:71], a[112:115], v[188:191], v[68:71]
v_exp_f32 v180, v180
v_mfma_f32_16x16x32_bf16 v[68:71], a[116:119], v[196:199], v[68:71]
ds_read_b128 a[68:71], v9 offset:16384
ds_read_b128 a[72:75], v10 offset:16384
v_mfma_f32_16x16x32_bf16 v[100:103], a[116:119], v[212:215], v[100:103]
v_exp_f32 v181, v181
v_mfma_f32_16x16x32_bf16 v[100:103], a[112:115], v[204:207], v[100:103]
v_cvt_pk_bf16_f32 v165, v166, v167
ds_read_b128 a[76:79], v11 offset:16384
v_mfma_f32_16x16x32_bf16 v[132:135], a[112:115], v[220:223], v[132:135]
v_exp_f32 v182, v182
v_mfma_f32_16x16x32_bf16 v[132:135], a[116:119], v[228:231], v[132:135]
v_cvt_pk_bf16_f32 v180, v180, v181
s_waitcnt lgkmcnt(4)
v_mfma_f32_16x16x32_bf16 v[72:75], a[120:123], v[188:191], v[72:75]
v_exp_f32 v183, v183
v_mfma_f32_16x16x32_bf16 v[72:75], a[124:127], v[196:199], v[72:75]
v_exp_f32 v152, v152
v_mfma_f32_16x16x32_bf16 v[104:107], a[124:127], v[212:215], v[104:107]
v_exp_f32 v153, v153
v_mfma_f32_16x16x32_bf16 v[104:107], a[120:123], v[204:207], v[104:107]
v_cvt_pk_bf16_f32 v181, v182, v183
v_mfma_f32_16x16x32_bf16 v[136:139], a[120:123], v[220:223], v[136:139]
v_exp_f32 v154, v154
v_mfma_f32_16x16x32_bf16 v[136:139], a[124:127], v[228:231], v[136:139]
v_cvt_pk_bf16_f32 v150, v152, v153
v_exp_f32 v155, v155
s_waitcnt lgkmcnt(0)
v_mfma_f32_16x16x32_bf16 v[188:191], a[64:67], a[0:3], v[32:35]
v_exp_f32 v168, v168
v_mfma_f32_16x16x32_bf16 v[188:191], a[68:71], a[4:7], v[188:191]
s_add_u32 m0, s65, 0
v_mfma_f32_16x16x32_bf16 v[188:191], a[72:75], a[8:11], v[188:191]
v_exp_f32 v169, v169
v_mfma_f32_16x16x32_bf16 v[188:191], a[76:79], a[12:15], v[188:191]
ds_read_b128 a[80:83], v8 offset:20480
ds_read_b128 a[84:87], v9 offset:20480
ds_read_b128 a[88:91], v10 offset:20480
v_mfma_f32_16x16x32_bf16 v[204:207], a[76:79], a[28:31], v[36:39]
v_cvt_pk_bf16_f32 v151, v154, v155
v_mfma_f32_16x16x32_bf16 v[204:207], a[72:75], a[24:27], v[204:207]
v_exp_f32 v170, v170
v_mfma_f32_16x16x32_bf16 v[204:207], a[68:71], a[20:23], v[204:207]
v_cvt_pk_bf16_f32 v166, v168, v169
v_mfma_f32_16x16x32_bf16 v[204:207], a[64:67], a[16:19], v[204:207]
buffer_load_dwordx4 v20, s[8:11], s59 offen nt lds
ds_read_b128 a[92:95], v11 offset:20480
v_mfma_f32_16x16x32_bf16 v[220:223], a[64:67], a[32:35], v[40:43]
v_exp_f32 v171, v171
v_mfma_f32_16x16x32_bf16 v[220:223], a[68:71], a[36:39], v[220:223]
v_exp_f32 v184, v184
v_mfma_f32_16x16x32_bf16 v[220:223], a[72:75], a[40:43], v[220:223]
v_exp_f32 v185, v185
v_mfma_f32_16x16x32_bf16 v[220:223], a[76:79], a[44:47], v[220:223]
v_cvt_pk_bf16_f32 v167, v170, v171
s_waitcnt lgkmcnt(0)
v_mfma_f32_16x16x32_bf16 v[192:195], a[80:83], a[0:3], v[32:35]
v_exp_f32 v186, v186
v_mfma_f32_16x16x32_bf16 v[192:195], a[84:87], a[4:7], v[192:195]
v_cvt_pk_bf16_f32 v182, v184, v185
v_mfma_f32_16x16x32_bf16 v[192:195], a[88:91], a[8:11], v[192:195]
v_exp_f32 v187, v187
v_mfma_f32_16x16x32_bf16 v[192:195], a[92:95], a[12:15], v[192:195]
ds_read_b128 a[64:67], v8 offset:24576
s_waitcnt vmcnt(4)
buffer_load_dwordx4 v21, s[8:11], s59 offen offset:1024 nt lds
ds_read_b128 a[68:71], v9 offset:24576
ds_read_b128 a[72:75], v10 offset:24576
v_mfma_f32_16x16x32_bf16 v[208:211], a[92:95], a[28:31], v[36:39]
v_cvt_pk_bf16_f32 v183, v186, v187
v_mfma_f32_16x16x32_bf16 v[208:211], a[88:91], a[24:27], v[208:211]
v_exp_f32 v188, v188
v_mfma_f32_16x16x32_bf16 v[208:211], a[84:87], a[20:23], v[208:211]
v_exp_f32 v189, v189
v_mfma_f32_16x16x32_bf16 v[208:211], a[80:83], a[16:19], v[208:211]
ds_read_b128 a[76:79], v11 offset:24576
v_mfma_f32_16x16x32_bf16 v[224:227], a[80:83], a[32:35], v[40:43]
v_exp_f32 v190, v190
v_mfma_f32_16x16x32_bf16 v[224:227], a[84:87], a[36:39], v[224:227]
v_cvt_pk_bf16_f32 v188, v188, v189
v_mfma_f32_16x16x32_bf16 v[224:227], a[88:91], a[40:43], v[224:227]
v_exp_f32 v191, v191
v_mfma_f32_16x16x32_bf16 v[224:227], a[92:95], a[44:47], v[224:227]
s_waitcnt lgkmcnt(0)
v_mfma_f32_16x16x32_bf16 v[196:199], a[64:67], a[0:3], v[32:35]
v_exp_f32 v204, v204
v_mfma_f32_16x16x32_bf16 v[196:199], a[68:71], a[4:7], v[196:199]
v_exp_f32 v205, v205
v_mfma_f32_16x16x32_bf16 v[196:199], a[72:75], a[8:11], v[196:199]
v_cvt_pk_bf16_f32 v189, v190, v191
v_mfma_f32_16x16x32_bf16 v[196:199], a[76:79], a[12:15], v[196:199]
s_waitcnt vmcnt(4)
buffer_load_dwordx4 v22, s[8:11], s59 offen offset:2048 nt lds
ds_read_b128 a[80:83], v8 offset:28672
ds_read_b128 a[84:87], v9 offset:28672
ds_read_b128 a[88:91], v10 offset:28672
v_mfma_f32_16x16x32_bf16 v[212:215], a[76:79], a[28:31], v[36:39]
v_exp_f32 v206, v206
v_mfma_f32_16x16x32_bf16 v[212:215], a[72:75], a[24:27], v[212:215]
v_cvt_pk_bf16_f32 v204, v204, v205
v_mfma_f32_16x16x32_bf16 v[212:215], a[68:71], a[20:23], v[212:215]
v_exp_f32 v207, v207
v_mfma_f32_16x16x32_bf16 v[212:215], a[64:67], a[16:19], v[212:215]
ds_read_b128 a[92:95], v11 offset:28672
v_mfma_f32_16x16x32_bf16 v[228:231], a[64:67], a[32:35], v[40:43]
v_exp_f32 v220, v220
v_mfma_f32_16x16x32_bf16 v[228:231], a[68:71], a[36:39], v[228:231]
v_exp_f32 v221, v221
v_mfma_f32_16x16x32_bf16 v[228:231], a[72:75], a[40:43], v[228:231]
v_cvt_pk_bf16_f32 v205, v206, v207
v_mfma_f32_16x16x32_bf16 v[228:231], a[76:79], a[44:47], v[228:231]
ds_read_b64_tr_b16 a[96:97], v12 offset:0
ds_read_b64_tr_b16 a[98:99], v12 offset:4096
s_waitcnt lgkmcnt(2)
v_mfma_f32_16x16x32_bf16 v[200:203], a[80:83], a[0:3], v[32:35]
v_exp_f32 v222, v222
v_mfma_f32_16x16x32_bf16 v[200:203], a[84:87], a[4:7], v[200:203]
v_cvt_pk_bf16_f32 v220, v220, v221
v_mfma_f32_16x16x32_bf16 v[200:203], a[88:91], a[8:11], v[200:203]
v_exp_f32 v223, v223
v_mfma_f32_16x16x32_bf16 v[200:203], a[92:95], a[12:15], v[200:203]
s_waitcnt vmcnt(4)
buffer_load_dwordx4 v23, s[8:11], s59 offen offset:3072 nt lds
s_add_u32 s59, s59, 16384
s_and_b32 s59, s59, 0x7ffff
ds_read_b64_tr_b16 a[100:101], v12 offset:8192
ds_read_b64_tr_b16 a[102:103], v12 offset:12288
v_mfma_f32_16x16x32_bf16 v[216:219], a[92:95], a[28:31], v[36:39]
v_exp_f32 v192, v192
v_mfma_f32_16x16x32_bf16 v[216:219], a[88:91], a[24:27], v[216:219]
v_exp_f32 v193, v193
v_mfma_f32_16x16x32_bf16 v[216:219], a[84:87], a[20:23], v[216:219]
v_cvt_pk_bf16_f32 v221, v222, v223
s_add_u32 m0, s65, 98304
v_mfma_f32_16x16x32_bf16 v[216:219], a[80:83], a[16:19], v[216:219]
ds_read_b64_tr_b16 a[104:105], v13 offset:0
ds_read_b64_tr_b16 a[106:107], v13 offset:4096
ds_read_b64_tr_b16 a[108:109], v13 offset:8192
ds_read_b64_tr_b16 a[110:111], v13 offset:12288
v_mfma_f32_16x16x32_bf16 v[232:235], a[80:83], a[32:35], v[40:43]
v_exp_f32 v194, v194
v_mfma_f32_16x16x32_bf16 v[232:235], a[84:87], a[36:39], v[232:235]
v_cvt_pk_bf16_f32 v190, v192, v193
v_mfma_f32_16x16x32_bf16 v[232:235], a[88:91], a[40:43], v[232:235]
v_exp_f32 v195, v195
v_mfma_f32_16x16x32_bf16 v[232:235], a[92:95], a[44:47], v[232:235]
ds_read_b64_tr_b16 a[112:113], v14 offset:0
s_waitcnt lgkmcnt(5)
v_mfma_f32_16x16x32_bf16 v[44:47], a[96:99], v[140:143], v[44:47]
v_exp_f32 v208, v208
v_mfma_f32_16x16x32_bf16 v[44:47], a[100:103], v[148:151], v[44:47]
s_waitcnt vmcnt(4)
buffer_load_dwordx4 v24, s[12:15], s60 offen nt lds
ds_read_b64_tr_b16 a[114:115], v14 offset:4096
v_mfma_f32_16x16x32_bf16 v[76:79], a[100:103], v[164:167], v[76:79]
v_exp_f32 v209, v209
v_mfma_f32_16x16x32_bf16 v[76:79], a[96:99], v[156:159], v[76:79]
ds_read_b64_tr_b16 a[116:117], v14 offset:8192
ds_read_b64_tr_b16 a[118:119], v14 offset:12288
v_mfma_f32_16x16x32_bf16 v[108:111], a[96:99], v[172:175], v[108:111]
v_cvt_pk_bf16_f32 v191, v194, v195
v_mfma_f32_16x16x32_bf16 v[108:111], a[100:103], v[180:183], v[108:111]
ds_read_b64_tr_b16 a[120:121], v15 offset:0
s_waitcnt lgkmcnt(5)
v_mfma_f32_16x16x32_bf16 v[48:51], a[104:107], v[140:143], v[48:51]
v_exp_f32 v210, v210
v_mfma_f32_16x16x32_bf16 v[48:51], a[108:111], v[148:151], v[48:51]
ds_read_b64_tr_b16 a[122:123], v15 offset:4096
v_cvt_pk_bf16_f32 v206, v208, v209
v_mfma_f32_16x16x32_bf16 v[80:83], a[108:111], v[164:167], v[80:83]
v_exp_f32 v211, v211
v_mfma_f32_16x16x32_bf16 v[80:83], a[104:107], v[156:159], v[80:83]
ds_read_b64_tr_b16 a[124:125], v15 offset:8192
ds_read_b64_tr_b16 a[126:127], v15 offset:12288
v_mfma_f32_16x16x32_bf16 v[112:115], a[104:107], v[172:175], v[112:115]
v_exp_f32 v224, v224
v_mfma_f32_16x16x32_bf16 v[112:115], a[108:111], v[180:183], v[112:115]
s_waitcnt vmcnt(4)
buffer_load_dwordx4 v25, s[12:15], s60 offen offset:1024 nt lds
v_mfma_f32_16x16x32_bf16 a[48:51], a[60:63], v[140:143], a[48:51]
v_exp_f32 v225, v225
v_mfma_f32_16x16x32_bf16 a[48:51], a[60:63], v[148:151], a[48:51]
v_cvt_pk_bf16_f32 v207, v210, v211
s_waitcnt lgkmcnt(4)
v_mfma_f32_16x16x32_bf16 v[52:55], a[112:115], v[140:143], v[52:55]
v_exp_f32 v226, v226
v_mfma_f32_16x16x32_bf16 v[52:55], a[116:119], v[148:151], v[52:55]
ds_read_b64_tr_b16 a[96:97], v16 offset:0
ds_read_b64_tr_b16 a[98:99], v16 offset:4096
v_mfma_f32_16x16x32_bf16 v[84:87], a[116:119], v[164:167], v[84:87]
v_cvt_pk_bf16_f32 v222, v224, v225
v_mfma_f32_16x16x32_bf16 v[84:87], a[112:115], v[156:159], v[84:87]
ds_read_b64_tr_b16 a[100:101], v16 offset:8192
ds_read_b64_tr_b16 a[102:103], v16 offset:12288
v_mfma_f32_16x16x32_bf16 v[116:119], a[112:115], v[172:175], v[116:119]
v_exp_f32 v227, v227
v_mfma_f32_16x16x32_bf16 v[116:119], a[116:119], v[180:183], v[116:119]
ds_read_b64_tr_b16 a[104:105], v17 offset:0
s_waitcnt lgkmcnt(5)
v_mfma_f32_16x16x32_bf16 v[56:59], a[120:123], v[140:143], v[56:59]
v_exp_f32 v196, v196
v_mfma_f32_16x16x32_bf16 v[56:59], a[124:127], v[148:151], v[56:59]
ds_read_b64_tr_b16 a[106:107], v17 offset:4096
ds_read_b64_tr_b16 a[108:109], v17 offset:8192
v_mfma_f32_16x16x32_bf16 v[88:91], a[124:127], v[164:167], v[88:91]
v_exp_f32 v197, v197
v_mfma_f32_16x16x32_bf16 v[88:91], a[120:123], v[156:159], v[88:91]
s_waitcnt vmcnt(4)
buffer_load_dwordx4 v24, s[12:15], s60 offen offset:2048 nt lds
ds_read_b64_tr_b16 a[110:111], v17 offset:12288
v_mfma_f32_16x16x32_bf16 v[120:123], a[120:123], v[172:175], v[120:123]
v_cvt_pk_bf16_f32 v223, v226, v227
v_mfma_f32_16x16x32_bf16 v[120:123], a[124:127], v[180:183], v[120:123]
v_exp_f32 v198, v198
v_mfma_f32_16x16x32_bf16 a[52:55], a[60:63], v[156:159], a[52:55]
v_cvt_pk_bf16_f32 v196, v196, v197
v_mfma_f32_16x16x32_bf16 a[52:55], a[60:63], v[164:167], a[52:55]
ds_read_b64_tr_b16 a[112:113], v18 offset:0
s_waitcnt lgkmcnt(5)
v_mfma_f32_16x16x32_bf16 v[60:63], a[96:99], v[140:143], v[60:63]
v_exp_f32 v199, v199
v_mfma_f32_16x16x32_bf16 v[60:63], a[100:103], v[148:151], v[60:63]
ds_read_b64_tr_b16 a[114:115], v18 offset:4096
ds_read_b64_tr_b16 a[116:117], v18 offset:8192
v_mfma_f32_16x16x32_bf16 v[92:95], a[100:103], v[164:167], v[92:95]
v_exp_f32 v212, v212
v_mfma_f32_16x16x32_bf16 v[92:95], a[96:99], v[156:159], v[92:95]
ds_read_b64_tr_b16 a[118:119], v18 offset:12288
v_mfma_f32_16x16x32_bf16 v[124:127], a[96:99], v[172:175], v[124:127]
v_exp_f32 v213, v213
v_mfma_f32_16x16x32_bf16 v[124:127], a[100:103], v[180:183], v[124:127]
s_waitcnt vmcnt(3)
buffer_load_dwordx4 v25, s[12:15], s60 offen offset:3072 nt lds
s_waitcnt lgkmcnt(4)
v_mfma_f32_16x16x32_bf16 v[64:67], a[104:107], v[140:143], v[64:67]
s_add_u32 s60, s60, 16384
s_and_b32 s60, s60, 0x7ffff
v_mfma_f32_16x16x32_bf16 v[64:67], a[108:111], v[148:151], v[64:67]
ds_read_b64_tr_b16 a[120:121], v19 offset:0
ds_read_b64_tr_b16 a[122:123], v19 offset:4096
v_mfma_f32_16x16x32_bf16 v[96:99], a[108:111], v[164:167], v[96:99]
v_cvt_pk_bf16_f32 v197, v198, v199
v_mfma_f32_16x16x32_bf16 v[96:99], a[104:107], v[156:159], v[96:99]
ds_read_b64_tr_b16 a[124:125], v19 offset:8192
s_barrier
ds_read_b64_tr_b16 a[126:127], v19 offset:12288
v_mfma_f32_16x16x32_bf16 v[128:131], a[104:107], v[172:175], v[128:131]
v_exp_f32 v214, v214
v_mfma_f32_16x16x32_bf16 v[128:131], a[108:111], v[180:183], v[128:131]
v_cvt_pk_bf16_f32 v212, v212, v213
v_mfma_f32_16x16x32_bf16 a[56:59], a[60:63], v[172:175], a[56:59]
v_exp_f32 v215, v215
v_mfma_f32_16x16x32_bf16 a[56:59], a[60:63], v[180:183], a[56:59]
ds_read_b128 a[64:67], v8 offset:32768
s_waitcnt lgkmcnt(5)
v_mfma_f32_16x16x32_bf16 v[68:71], a[112:115], v[140:143], v[68:71]
v_exp_f32 v228, v228
v_mfma_f32_16x16x32_bf16 v[68:71], a[116:119], v[148:151], v[68:71]
ds_read_b128 a[68:71], v9 offset:32768
ds_read_b128 a[72:75], v10 offset:32768
v_mfma_f32_16x16x32_bf16 v[100:103], a[116:119], v[164:167], v[100:103]
v_exp_f32 v229, v229
v_mfma_f32_16x16x32_bf16 v[100:103], a[112:115], v[156:159], v[100:103]
v_cvt_pk_bf16_f32 v213, v214, v215
ds_read_b128 a[76:79], v11 offset:32768
v_mfma_f32_16x16x32_bf16 v[132:135], a[112:115], v[172:175], v[132:135]
v_exp_f32 v230, v230
v_mfma_f32_16x16x32_bf16 v[132:135], a[116:119], v[180:183], v[132:135]
v_cvt_pk_bf16_f32 v228, v228, v229
s_waitcnt lgkmcnt(4)
v_mfma_f32_16x16x32_bf16 v[72:75], a[120:123], v[140:143], v[72:75]
v_exp_f32 v231, v231
v_mfma_f32_16x16x32_bf16 v[72:75], a[124:127], v[148:151], v[72:75]
v_exp_f32 v200, v200
v_mfma_f32_16x16x32_bf16 v[104:107], a[124:127], v[164:167], v[104:107]
v_exp_f32 v201, v201
v_mfma_f32_16x16x32_bf16 v[104:107], a[120:123], v[156:159], v[104:107]
v_cvt_pk_bf16_f32 v229, v230, v231
v_mfma_f32_16x16x32_bf16 v[136:139], a[120:123], v[172:175], v[136:139]
v_exp_f32 v202, v202
v_mfma_f32_16x16x32_bf16 v[136:139], a[124:127], v[180:183], v[136:139]
v_cvt_pk_bf16_f32 v198, v200, v201
v_exp_f32 v203, v203
s_waitcnt lgkmcnt(0)
v_mfma_f32_16x16x32_bf16 v[140:143], a[64:67], a[0:3], v[32:35]
v_exp_f32 v216, v216
v_mfma_f32_16x16x32_bf16 v[140:143], a[68:71], a[4:7], v[140:143]
s_add_u32 m0, s65, 16384
v_mfma_f32_16x16x32_bf16 v[140:143], a[72:75], a[8:11], v[140:143]
v_exp_f32 v217, v217
v_mfma_f32_16x16x32_bf16 v[140:143], a[76:79], a[12:15], v[140:143]
ds_read_b128 a[80:83], v8 offset:36864
ds_read_b128 a[84:87], v9 offset:36864
ds_read_b128 a[88:91], v10 offset:36864
v_mfma_f32_16x16x32_bf16 v[156:159], a[76:79], a[28:31], v[36:39]
v_cvt_pk_bf16_f32 v199, v202, v203
v_mfma_f32_16x16x32_bf16 v[156:159], a[72:75], a[24:27], v[156:159]
v_exp_f32 v218, v218
v_mfma_f32_16x16x32_bf16 v[156:159], a[68:71], a[20:23], v[156:159]
v_cvt_pk_bf16_f32 v214, v216, v217
v_mfma_f32_16x16x32_bf16 v[156:159], a[64:67], a[16:19], v[156:159]
buffer_load_dwordx4 v20, s[8:11], s59 offen nt lds
ds_read_b128 a[92:95], v11 offset:36864
v_mfma_f32_16x16x32_bf16 v[172:175], a[64:67], a[32:35], v[40:43]
v_exp_f32 v219, v219
v_mfma_f32_16x16x32_bf16 v[172:175], a[68:71], a[36:39], v[172:175]
v_exp_f32 v232, v232
v_mfma_f32_16x16x32_bf16 v[172:175], a[72:75], a[40:43], v[172:175]
v_exp_f32 v233, v233
v_mfma_f32_16x16x32_bf16 v[172:175], a[76:79], a[44:47], v[172:175]
v_cvt_pk_bf16_f32 v215, v218, v219
s_waitcnt lgkmcnt(0)
v_mfma_f32_16x16x32_bf16 v[144:147], a[80:83], a[0:3], v[32:35]
v_exp_f32 v234, v234
v_mfma_f32_16x16x32_bf16 v[144:147], a[84:87], a[4:7], v[144:147]
v_cvt_pk_bf16_f32 v230, v232, v233
v_mfma_f32_16x16x32_bf16 v[144:147], a[88:91], a[8:11], v[144:147]
v_exp_f32 v235, v235
v_mfma_f32_16x16x32_bf16 v[144:147], a[92:95], a[12:15], v[144:147]
ds_read_b128 a[64:67], v8 offset:40960
s_waitcnt vmcnt(4)
buffer_load_dwordx4 v21, s[8:11], s59 offen offset:1024 nt lds
ds_read_b128 a[68:71], v9 offset:40960
ds_read_b128 a[72:75], v10 offset:40960
v_mfma_f32_16x16x32_bf16 v[160:163], a[92:95], a[28:31], v[36:39]
v_cvt_pk_bf16_f32 v231, v234, v235
v_mfma_f32_16x16x32_bf16 v[160:163], a[88:91], a[24:27], v[160:163]
v_exp_f32 v140, v140
v_mfma_f32_16x16x32_bf16 v[160:163], a[84:87], a[20:23], v[160:163]
v_exp_f32 v141, v141
v_mfma_f32_16x16x32_bf16 v[160:163], a[80:83], a[16:19], v[160:163]
ds_read_b128 a[76:79], v11 offset:40960
v_mfma_f32_16x16x32_bf16 v[176:179], a[80:83], a[32:35], v[40:43]
v_exp_f32 v142, v142
v_mfma_f32_16x16x32_bf16 v[176:179], a[84:87], a[36:39], v[176:179]
v_cvt_pk_bf16_f32 v140, v140, v141
v_mfma_f32_16x16x32_bf16 v[176:179], a[88:91], a[40:43], v[176:179]
v_exp_f32 v143, v143
v_mfma_f32_16x16x32_bf16 v[176:179], a[92:95], a[44:47], v[176:179]
s_waitcnt lgkmcnt(0)
v_mfma_f32_16x16x32_bf16 v[148:151], a[64:67], a[0:3], v[32:35]
v_exp_f32 v156, v156
v_mfma_f32_16x16x32_bf16 v[148:151], a[68:71], a[4:7], v[148:151]
v_exp_f32 v157, v157
v_mfma_f32_16x16x32_bf16 v[148:151], a[72:75], a[8:11], v[148:151]
v_cvt_pk_bf16_f32 v141, v142, v143
v_mfma_f32_16x16x32_bf16 v[148:151], a[76:79], a[12:15], v[148:151]
s_waitcnt vmcnt(4)
buffer_load_dwordx4 v22, s[8:11], s59 offen offset:2048 nt lds
ds_read_b128 a[80:83], v8 offset:45056
ds_read_b128 a[84:87], v9 offset:45056
ds_read_b128 a[88:91], v10 offset:45056
v_mfma_f32_16x16x32_bf16 v[164:167], a[76:79], a[28:31], v[36:39]
v_exp_f32 v158, v158
v_mfma_f32_16x16x32_bf16 v[164:167], a[72:75], a[24:27], v[164:167]
v_cvt_pk_bf16_f32 v156, v156, v157
v_mfma_f32_16x16x32_bf16 v[164:167], a[68:71], a[20:23], v[164:167]
v_exp_f32 v159, v159
v_mfma_f32_16x16x32_bf16 v[164:167], a[64:67], a[16:19], v[164:167]
ds_read_b128 a[92:95], v11 offset:45056
v_mfma_f32_16x16x32_bf16 v[180:183], a[64:67], a[32:35], v[40:43]
v_exp_f32 v172, v172
v_mfma_f32_16x16x32_bf16 v[180:183], a[68:71], a[36:39], v[180:183]
v_exp_f32 v173, v173
v_mfma_f32_16x16x32_bf16 v[180:183], a[72:75], a[40:43], v[180:183]
v_cvt_pk_bf16_f32 v157, v158, v159
v_mfma_f32_16x16x32_bf16 v[180:183], a[76:79], a[44:47], v[180:183]
ds_read_b64_tr_b16 a[96:97], v12 offset:16384
ds_read_b64_tr_b16 a[98:99], v12 offset:20480
s_waitcnt lgkmcnt(2)
v_mfma_f32_16x16x32_bf16 v[152:155], a[80:83], a[0:3], v[32:35]
v_exp_f32 v174, v174
v_mfma_f32_16x16x32_bf16 v[152:155], a[84:87], a[4:7], v[152:155]
v_cvt_pk_bf16_f32 v172, v172, v173
v_mfma_f32_16x16x32_bf16 v[152:155], a[88:91], a[8:11], v[152:155]
v_exp_f32 v175, v175
v_mfma_f32_16x16x32_bf16 v[152:155], a[92:95], a[12:15], v[152:155]
s_waitcnt vmcnt(4)
buffer_load_dwordx4 v23, s[8:11], s59 offen offset:3072 nt lds
s_add_u32 s59, s59, 16384
s_and_b32 s59, s59, 0x7ffff
ds_read_b64_tr_b16 a[100:101], v12 offset:24576
ds_read_b64_tr_b16 a[102:103], v12 offset:28672
v_mfma_f32_16x16x32_bf16 v[168:171], a[92:95], a[28:31], v[36:39]
v_exp_f32 v144, v144
v_mfma_f32_16x16x32_bf16 v[168:171], a[88:91], a[24:27], v[168:171]
v_exp_f32 v145, v145
v_mfma_f32_16x16x32_bf16 v[168:171], a[84:87], a[20:23], v[168:171]
v_cvt_pk_bf16_f32 v173, v174, v175
s_add_u32 m0, s65, 114688
v_mfma_f32_16x16x32_bf16 v[168:171], a[80:83], a[16:19], v[168:171]
ds_read_b64_tr_b16 a[104:105], v13 offset:16384
ds_read_b64_tr_b16 a[106:107], v13 offset:20480
ds_read_b64_tr_b16 a[108:109], v13 offset:24576
ds_read_b64_tr_b16 a[110:111], v13 offset:28672
v_mfma_f32_16x16x32_bf16 v[184:187], a[80:83], a[32:35], v[40:43]
v_exp_f32 v146, v146
v_mfma_f32_16x16x32_bf16 v[184:187], a[84:87], a[36:39], v[184:187]
v_cvt_pk_bf16_f32 v142, v144, v145
v_mfma_f32_16x16x32_bf16 v[184:187], a[88:91], a[40:43], v[184:187]
v_exp_f32 v147, v147
v_mfma_f32_16x16x32_bf16 v[184:187], a[92:95], a[44:47], v[184:187]
ds_read_b64_tr_b16 a[112:113], v14 offset:16384
s_waitcnt lgkmcnt(5)
v_mfma_f32_16x16x32_bf16 v[44:47], a[96:99], v[188:191], v[44:47]
v_exp_f32 v160, v160
v_mfma_f32_16x16x32_bf16 v[44:47], a[100:103], v[196:199], v[44:47]
s_waitcnt vmcnt(4)
buffer_load_dwordx4 v24, s[12:15], s60 offen nt lds
ds_read_b64_tr_b16 a[114:115], v14 offset:20480
v_mfma_f32_16x16x32_bf16 v[76:79], a[100:103], v[212:215], v[76:79]
v_exp_f32 v161, v161
v_mfma_f32_16x16x32_bf16 v[76:79], a[96:99], v[204:207], v[76:79]
ds_read_b64_tr_b16 a[116:117], v14 offset:24576
ds_read_b64_tr_b16 a[118:119], v14 offset:28672
v_mfma_f32_16x16x32_bf16 v[108:111], a[96:99], v[220:223], v[108:111]
v_cvt_pk_bf16_f32 v143, v146, v147
v_mfma_f32_16x16x32_bf16 v[108:111], a[100:103], v[228:231], v[108:111]
ds_read_b64_tr_b16 a[120:121], v15 offset:16384
s_waitcnt lgkmcnt(5)
v_mfma_f32_16x16x32_bf16 v[48:51], a[104:107], v[188:191], v[48:51]
v_exp_f32 v162, v162
v_mfma_f32_16x16x32_bf16 v[48:51], a[108:111], v[196:199], v[48:51]
ds_read_b64_tr_b16 a[122:123], v15 offset:20480
v_cvt_pk_bf16_f32 v158, v160, v161
v_mfma_f32_16x16x32_bf16 v[80:83], a[108:111], v[212:215], v[80:83]
v_exp_f32 v163, v163
v_mfma_f32_16x16x32_bf16 v[80:83], a[104:107], v[204:207], v[80:83]
ds_read_b64_tr_b16 a[124:125], v15 offset:24576
ds_read_b64_tr_b16 a[126:127], v15 offset:28672
v_mfma_f32_16x16x32_bf16 v[112:115], a[104:107], v[220:223], v[112:115]
v_exp_f32 v176, v176
v_mfma_f32_16x16x32_bf16 v[112:115], a[108:111], v[228:231], v[112:115]
s_waitcnt vmcnt(4)
buffer_load_dwordx4 v25, s[12:15], s60 offen offset:1024 nt lds
v_mfma_f32_16x16x32_bf16 a[48:51], a[60:63], v[188:191], a[48:51]
v_exp_f32 v177, v177
v_mfma_f32_16x16x32_bf16 a[48:51], a[60:63], v[196:199], a[48:51]
v_cvt_pk_bf16_f32 v159, v162, v163
s_waitcnt lgkmcnt(4)
v_mfma_f32_16x16x32_bf16 v[52:55], a[112:115], v[188:191], v[52:55]
v_exp_f32 v178, v178
v_mfma_f32_16x16x32_bf16 v[52:55], a[116:119], v[196:199], v[52:55]
ds_read_b64_tr_b16 a[96:97], v16 offset:16384
ds_read_b64_tr_b16 a[98:99], v16 offset:20480
v_mfma_f32_16x16x32_bf16 v[84:87], a[116:119], v[212:215], v[84:87]
v_cvt_pk_bf16_f32 v174, v176, v177
v_mfma_f32_16x16x32_bf16 v[84:87], a[112:115], v[204:207], v[84:87]
ds_read_b64_tr_b16 a[100:101], v16 offset:24576
ds_read_b64_tr_b16 a[102:103], v16 offset:28672
v_mfma_f32_16x16x32_bf16 v[116:119], a[112:115], v[220:223], v[116:119]
v_exp_f32 v179, v179
v_mfma_f32_16x16x32_bf16 v[116:119], a[116:119], v[228:231], v[116:119]
ds_read_b64_tr_b16 a[104:105], v17 offset:16384
s_waitcnt lgkmcnt(5)
v_mfma_f32_16x16x32_bf16 v[56:59], a[120:123], v[188:191], v[56:59]
v_exp_f32 v148, v148
v_mfma_f32_16x16x32_bf16 v[56:59], a[124:127], v[196:199], v[56:59]
ds_read_b64_tr_b16 a[106:107], v17 offset:20480
ds_read_b64_tr_b16 a[108:109], v17 offset:24576
v_mfma_f32_16x16x32_bf16 v[88:91], a[124:127], v[212:215], v[88:91]
v_exp_f32 v149, v149
v_mfma_f32_16x16x32_bf16 v[88:91], a[120:123], v[204:207], v[88:91]
s_waitcnt vmcnt(4)
buffer_load_dwordx4 v24, s[12:15], s60 offen offset:2048 nt lds
ds_read_b64_tr_b16 a[110:111], v17 offset:28672
v_mfma_f32_16x16x32_bf16 v[120:123], a[120:123], v[220:223], v[120:123]
v_cvt_pk_bf16_f32 v175, v178, v179
v_mfma_f32_16x16x32_bf16 v[120:123], a[124:127], v[228:231], v[120:123]
v_exp_f32 v150, v150
v_mfma_f32_16x16x32_bf16 a[52:55], a[60:63], v[204:207], a[52:55]
v_cvt_pk_bf16_f32 v148, v148, v149
v_mfma_f32_16x16x32_bf16 a[52:55], a[60:63], v[212:215], a[52:55]
ds_read_b64_tr_b16 a[112:113], v18 offset:16384
s_waitcnt lgkmcnt(5)
v_mfma_f32_16x16x32_bf16 v[60:63], a[96:99], v[188:191], v[60:63]
v_exp_f32 v151, v151
v_mfma_f32_16x16x32_bf16 v[60:63], a[100:103], v[196:199], v[60:63]
ds_read_b64_tr_b16 a[114:115], v18 offset:20480
ds_read_b64_tr_b16 a[116:117], v18 offset:24576
v_mfma_f32_16x16x32_bf16 v[92:95], a[100:103], v[212:215], v[92:95]
v_exp_f32 v164, v164
v_mfma_f32_16x16x32_bf16 v[92:95], a[96:99], v[204:207], v[92:95]
ds_read_b64_tr_b16 a[118:119], v18 offset:28672
v_mfma_f32_16x16x32_bf16 v[124:127], a[96:99], v[220:223], v[124:127]
v_exp_f32 v165, v165
v_mfma_f32_16x16x32_bf16 v[124:127], a[100:103], v[228:231], v[124:127]
s_waitcnt vmcnt(3)
buffer_load_dwordx4 v25, s[12:15], s60 offen offset:3072 nt lds
s_waitcnt lgkmcnt(4)
v_mfma_f32_16x16x32_bf16 v[64:67], a[104:107], v[188:191], v[64:67]
s_add_u32 s60, s60, 16384
s_and_b32 s60, s60, 0x7ffff
v_mfma_f32_16x16x32_bf16 v[64:67], a[108:111], v[196:199], v[64:67]
ds_read_b64_tr_b16 a[120:121], v19 offset:16384
ds_read_b64_tr_b16 a[122:123], v19 offset:20480
v_mfma_f32_16x16x32_bf16 v[96:99], a[108:111], v[212:215], v[96:99]
v_cvt_pk_bf16_f32 v149, v150, v151
v_mfma_f32_16x16x32_bf16 v[96:99], a[104:107], v[204:207], v[96:99]
ds_read_b64_tr_b16 a[124:125], v19 offset:24576
s_barrier
ds_read_b64_tr_b16 a[126:127], v19 offset:28672
v_mfma_f32_16x16x32_bf16 v[128:131], a[104:107], v[220:223], v[128:131]
v_exp_f32 v166, v166
v_mfma_f32_16x16x32_bf16 v[128:131], a[108:111], v[228:231], v[128:131]
v_cvt_pk_bf16_f32 v164, v164, v165
v_mfma_f32_16x16x32_bf16 a[56:59], a[60:63], v[220:223], a[56:59]
v_exp_f32 v167, v167
v_mfma_f32_16x16x32_bf16 a[56:59], a[60:63], v[228:231], a[56:59]
ds_read_b128 a[64:67], v8 offset:49152
s_waitcnt lgkmcnt(5)
v_mfma_f32_16x16x32_bf16 v[68:71], a[112:115], v[188:191], v[68:71]
v_exp_f32 v180, v180
v_mfma_f32_16x16x32_bf16 v[68:71], a[116:119], v[196:199], v[68:71]
ds_read_b128 a[68:71], v9 offset:49152
ds_read_b128 a[72:75], v10 offset:49152
v_mfma_f32_16x16x32_bf16 v[100:103], a[116:119], v[212:215], v[100:103]
v_exp_f32 v181, v181
v_mfma_f32_16x16x32_bf16 v[100:103], a[112:115], v[204:207], v[100:103]
v_cvt_pk_bf16_f32 v165, v166, v167
ds_read_b128 a[76:79], v11 offset:49152
v_mfma_f32_16x16x32_bf16 v[132:135], a[112:115], v[220:223], v[132:135]
v_exp_f32 v182, v182
v_mfma_f32_16x16x32_bf16 v[132:135], a[116:119], v[228:231], v[132:135]
v_cvt_pk_bf16_f32 v180, v180, v181
s_waitcnt lgkmcnt(4)
v_mfma_f32_16x16x32_bf16 v[72:75], a[120:123], v[188:191], v[72:75]
v_exp_f32 v183, v183
v_mfma_f32_16x16x32_bf16 v[72:75], a[124:127], v[196:199], v[72:75]
v_exp_f32 v152, v152
v_mfma_f32_16x16x32_bf16 v[104:107], a[124:127], v[212:215], v[104:107]
v_exp_f32 v153, v153
v_mfma_f32_16x16x32_bf16 v[104:107], a[120:123], v[204:207], v[104:107]
v_cvt_pk_bf16_f32 v181, v182, v183
v_mfma_f32_16x16x32_bf16 v[136:139], a[120:123], v[220:223], v[136:139]
v_exp_f32 v154, v154
v_mfma_f32_16x16x32_bf16 v[136:139], a[124:127], v[228:231], v[136:139]
v_cvt_pk_bf16_f32 v150, v152, v153
v_exp_f32 v155, v155
s_waitcnt lgkmcnt(0)
v_mfma_f32_16x16x32_bf16 v[188:191], a[64:67], a[0:3], v[32:35]
v_exp_f32 v168, v168
v_mfma_f32_16x16x32_bf16 v[188:191], a[68:71], a[4:7], v[188:191]
s_add_u32 m0, s65, 32768
v_mfma_f32_16x16x32_bf16 v[188:191], a[72:75], a[8:11], v[188:191]
v_exp_f32 v169, v169
v_mfma_f32_16x16x32_bf16 v[188:191], a[76:79], a[12:15], v[188:191]
ds_read_b128 a[80:83], v8 offset:53248
ds_read_b128 a[84:87], v9 offset:53248
ds_read_b128 a[88:91], v10 offset:53248
v_mfma_f32_16x16x32_bf16 v[204:207], a[76:79], a[28:31], v[36:39]
v_cvt_pk_bf16_f32 v151, v154, v155
v_mfma_f32_16x16x32_bf16 v[204:207], a[72:75], a[24:27], v[204:207]
v_exp_f32 v170, v170
v_mfma_f32_16x16x32_bf16 v[204:207], a[68:71], a[20:23], v[204:207]
v_cvt_pk_bf16_f32 v166, v168, v169
v_mfma_f32_16x16x32_bf16 v[204:207], a[64:67], a[16:19], v[204:207]
buffer_load_dwordx4 v20, s[8:11], s59 offen nt lds
ds_read_b128 a[92:95], v11 offset:53248
v_mfma_f32_16x16x32_bf16 v[220:223], a[64:67], a[32:35], v[40:43]
v_exp_f32 v171, v171
v_mfma_f32_16x16x32_bf16 v[220:223], a[68:71], a[36:39], v[220:223]
v_exp_f32 v184, v184
v_mfma_f32_16x16x32_bf16 v[220:223], a[72:75], a[40:43], v[220:223]
v_exp_f32 v185, v185
v_mfma_f32_16x16x32_bf16 v[220:223], a[76:79], a[44:47], v[220:223]
v_cvt_pk_bf16_f32 v167, v170, v171
s_waitcnt lgkmcnt(0)
v_mfma_f32_16x16x32_bf16 v[192:195], a[80:83], a[0:3], v[32:35]
v_exp_f32 v186, v186
v_mfma_f32_16x16x32_bf16 v[192:195], a[84:87], a[4:7], v[192:195]
v_cvt_pk_bf16_f32 v182, v184, v185
v_mfma_f32_16x16x32_bf16 v[192:195], a[88:91], a[8:11], v[192:195]
v_exp_f32 v187, v187
v_mfma_f32_16x16x32_bf16 v[192:195], a[92:95], a[12:15], v[192:195]
ds_read_b128 a[64:67], v8 offset:57344
s_waitcnt vmcnt(4)
buffer_load_dwordx4 v21, s[8:11], s59 offen offset:1024 nt lds
ds_read_b128 a[68:71], v9 offset:57344
ds_read_b128 a[72:75], v10 offset:57344
v_mfma_f32_16x16x32_bf16 v[208:211], a[92:95], a[28:31], v[36:39]
v_cvt_pk_bf16_f32 v183, v186, v187
v_mfma_f32_16x16x32_bf16 v[208:211], a[88:91], a[24:27], v[208:211]
v_exp_f32 v188, v188
v_mfma_f32_16x16x32_bf16 v[208:211], a[84:87], a[20:23], v[208:211]
v_exp_f32 v189, v189
v_mfma_f32_16x16x32_bf16 v[208:211], a[80:83], a[16:19], v[208:211]
ds_read_b128 a[76:79], v11 offset:57344
v_mfma_f32_16x16x32_bf16 v[224:227], a[80:83], a[32:35], v[40:43]
v_exp_f32 v190, v190
v_mfma_f32_16x16x32_bf16 v[224:227], a[84:87], a[36:39], v[224:227]
v_cvt_pk_bf16_f32 v188, v188, v189
v_mfma_f32_16x16x32_bf16 v[224:227], a[88:91], a[40:43], v[224:227]
v_exp_f32 v191, v191
v_mfma_f32_16x16x32_bf16 v[224:227], a[92:95], a[44:47], v[224:227]
s_waitcnt lgkmcnt(0)
v_mfma_f32_16x16x32_bf16 v[196:199], a[64:67], a[0:3], v[32:35]
v_exp_f32 v204, v204
v_mfma_f32_16x16x32_bf16 v[196:199], a[68:71], a[4:7], v[196:199]
v_exp_f32 v205, v205
v_mfma_f32_16x16x32_bf16 v[196:199], a[72:75], a[8:11], v[196:199]
v_cvt_pk_bf16_f32 v189, v190, v191
v_mfma_f32_16x16x32_bf16 v[196:199], a[76:79], a[12:15], v[196:199]
s_waitcnt vmcnt(4)
buffer_load_dwordx4 v22, s[8:11], s59 offen offset:2048 nt lds
ds_read_b128 a[80:83], v8 offset:61440
ds_read_b128 a[84:87], v9 offset:61440
ds_read_b128 a[88:91], v10 offset:61440
v_mfma_f32_16x16x32_bf16 v[212:215], a[76:79], a[28:31], v[36:39]
v_exp_f32 v206, v206
v_mfma_f32_16x16x32_bf16 v[212:215], a[72:75], a[24:27], v[212:215]
v_cvt_pk_bf16_f32 v204, v204, v205
v_mfma_f32_16x16x32_bf16 v[212:215], a[68:71], a[20:23], v[212:215]
v_exp_f32 v207, v207
v_mfma_f32_16x16x32_bf16 v[212:215], a[64:67], a[16:19], v[212:215]
ds_read_b128 a[92:95], v11 offset:61440
v_mfma_f32_16x16x32_bf16 v[228:231], a[64:67], a[32:35], v[40:43]
v_exp_f32 v220, v220
v_mfma_f32_16x16x32_bf16 v[228:231], a[68:71], a[36:39], v[228:231]
v_exp_f32 v221, v221
v_mfma_f32_16x16x32_bf16 v[228:231], a[72:75], a[40:43], v[228:231]
v_cvt_pk_bf16_f32 v205, v206, v207
v_mfma_f32_16x16x32_bf16 v[228:231], a[76:79], a[44:47], v[228:231]
ds_read_b64_tr_b16 a[96:97], v12 offset:32768
ds_read_b64_tr_b16 a[98:99], v12 offset:36864
s_waitcnt lgkmcnt(2)
v_mfma_f32_16x16x32_bf16 v[200:203], a[80:83], a[0:3], v[32:35]
v_exp_f32 v222, v222
v_mfma_f32_16x16x32_bf16 v[200:203], a[84:87], a[4:7], v[200:203]
v_cvt_pk_bf16_f32 v220, v220, v221
v_mfma_f32_16x16x32_bf16 v[200:203], a[88:91], a[8:11], v[200:203]
v_exp_f32 v223, v223
v_mfma_f32_16x16x32_bf16 v[200:203], a[92:95], a[12:15], v[200:203]
s_waitcnt vmcnt(4)
buffer_load_dwordx4 v23, s[8:11], s59 offen offset:3072 nt lds
s_add_u32 s59, s59, 16384
s_and_b32 s59, s59, 0x7ffff
ds_read_b64_tr_b16 a[100:101], v12 offset:40960
ds_read_b64_tr_b16 a[102:103], v12 offset:45056
v_mfma_f32_16x16x32_bf16 v[216:219], a[92:95], a[28:31], v[36:39]
v_exp_f32 v192, v192
v_mfma_f32_16x16x32_bf16 v[216:219], a[88:91], a[24:27], v[216:219]
v_exp_f32 v193, v193
v_mfma_f32_16x16x32_bf16 v[216:219], a[84:87], a[20:23], v[216:219]
v_cvt_pk_bf16_f32 v221, v222, v223
s_add_u32 m0, s65, 65536
v_mfma_f32_16x16x32_bf16 v[216:219], a[80:83], a[16:19], v[216:219]
ds_read_b64_tr_b16 a[104:105], v13 offset:32768
ds_read_b64_tr_b16 a[106:107], v13 offset:36864
ds_read_b64_tr_b16 a[108:109], v13 offset:40960
ds_read_b64_tr_b16 a[110:111], v13 offset:45056
v_mfma_f32_16x16x32_bf16 v[232:235], a[80:83], a[32:35], v[40:43]
v_exp_f32 v194, v194
v_mfma_f32_16x16x32_bf16 v[232:235], a[84:87], a[36:39], v[232:235]
v_cvt_pk_bf16_f32 v190, v192, v193
v_mfma_f32_16x16x32_bf16 v[232:235], a[88:91], a[40:43], v[232:235]
v_exp_f32 v195, v195
v_mfma_f32_16x16x32_bf16 v[232:235], a[92:95], a[44:47], v[232:235]
ds_read_b64_tr_b16 a[112:113], v14 offset:32768
s_waitcnt lgkmcnt(5)
v_mfma_f32_16x16x32_bf16 v[44:47], a[96:99], v[140:143], v[44:47]
v_exp_f32 v208, v208
v_mfma_f32_16x16x32_bf16 v[44:47], a[100:103], v[148:151], v[44:47]
s_waitcnt vmcnt(4)
buffer_load_dwordx4 v24, s[12:15], s60 offen nt lds
ds_read_b64_tr_b16 a[114:115], v14 offset:36864
v_mfma_f32_16x16x32_bf16 v[76:79], a[100:103], v[164:167], v[76:79]
v_exp_f32 v209, v209
v_mfma_f32_16x16x32_bf16 v[76:79], a[96:99], v[156:159], v[76:79]
ds_read_b64_tr_b16 a[116:117], v14 offset:40960
ds_read_b64_tr_b16 a[118:119], v14 offset:45056
v_mfma_f32_16x16x32_bf16 v[108:111], a[96:99], v[172:175], v[108:111]
v_cvt_pk_bf16_f32 v191, v194, v195
v_mfma_f32_16x16x32_bf16 v[108:111], a[100:103], v[180:183], v[108:111]
ds_read_b64_tr_b16 a[120:121], v15 offset:32768
s_waitcnt lgkmcnt(5)
v_mfma_f32_16x16x32_bf16 v[48:51], a[104:107], v[140:143], v[48:51]
v_exp_f32 v210, v210
v_mfma_f32_16x16x32_bf16 v[48:51], a[108:111], v[148:151], v[48:51]
ds_read_b64_tr_b16 a[122:123], v15 offset:36864
v_cvt_pk_bf16_f32 v206, v208, v209
v_mfma_f32_16x16x32_bf16 v[80:83], a[108:111], v[164:167], v[80:83]
v_exp_f32 v211, v211
v_mfma_f32_16x16x32_bf16 v[80:83], a[104:107], v[156:159], v[80:83]
ds_read_b64_tr_b16 a[124:125], v15 offset:40960
ds_read_b64_tr_b16 a[126:127], v15 offset:45056
v_mfma_f32_16x16x32_bf16 v[112:115], a[104:107], v[172:175], v[112:115]
v_exp_f32 v224, v224
v_mfma_f32_16x16x32_bf16 v[112:115], a[108:111], v[180:183], v[112:115]
s_waitcnt vmcnt(4)
buffer_load_dwordx4 v25, s[12:15], s60 offen offset:1024 nt lds
v_mfma_f32_16x16x32_bf16 a[48:51], a[60:63], v[140:143], a[48:51]
v_exp_f32 v225, v225
v_mfma_f32_16x16x32_bf16 a[48:51], a[60:63], v[148:151], a[48:51]
v_cvt_pk_bf16_f32 v207, v210, v211
s_waitcnt lgkmcnt(4)
v_mfma_f32_16x16x32_bf16 v[52:55], a[112:115], v[140:143], v[52:55]
v_exp_f32 v226, v226
v_mfma_f32_16x16x32_bf16 v[52:55], a[116:119], v[148:151], v[52:55]
ds_read_b64_tr_b16 a[96:97], v16 offset:32768
ds_read_b64_tr_b16 a[98:99], v16 offset:36864
v_mfma_f32_16x16x32_bf16 v[84:87], a[116:119], v[164:167], v[84:87]
v_cvt_pk_bf16_f32 v222, v224, v225
v_mfma_f32_16x16x32_bf16 v[84:87], a[112:115], v[156:159], v[84:87]
ds_read_b64_tr_b16 a[100:101], v16 offset:40960
ds_read_b64_tr_b16 a[102:103], v16 offset:45056
v_mfma_f32_16x16x32_bf16 v[116:119], a[112:115], v[172:175], v[116:119]
v_exp_f32 v227, v227
v_mfma_f32_16x16x32_bf16 v[116:119], a[116:119], v[180:183], v[116:119]
ds_read_b64_tr_b16 a[104:105], v17 offset:32768
s_waitcnt lgkmcnt(5)
v_mfma_f32_16x16x32_bf16 v[56:59], a[120:123], v[140:143], v[56:59]
v_exp_f32 v196, v196
v_mfma_f32_16x16x32_bf16 v[56:59], a[124:127], v[148:151], v[56:59]
ds_read_b64_tr_b16 a[106:107], v17 offset:36864
ds_read_b64_tr_b16 a[108:109], v17 offset:40960
v_mfma_f32_16x16x32_bf16 v[88:91], a[124:127], v[164:167], v[88:91]
v_exp_f32 v197, v197
v_mfma_f32_16x16x32_bf16 v[88:91], a[120:123], v[156:159], v[88:91]
s_waitcnt vmcnt(4)
buffer_load_dwordx4 v24, s[12:15], s60 offen offset:2048 nt lds
ds_read_b64_tr_b16 a[110:111], v17 offset:45056
v_mfma_f32_16x16x32_bf16 v[120:123], a[120:123], v[172:175], v[120:123]
v_cvt_pk_bf16_f32 v223, v226, v227
v_mfma_f32_16x16x32_bf16 v[120:123], a[124:127], v[180:183], v[120:123]
v_exp_f32 v198, v198
v_mfma_f32_16x16x32_bf16 a[52:55], a[60:63], v[156:159], a[52:55]
v_cvt_pk_bf16_f32 v196, v196, v197
v_mfma_f32_16x16x32_bf16 a[52:55], a[60:63], v[164:167], a[52:55]
ds_read_b64_tr_b16 a[112:113], v18 offset:32768
s_waitcnt lgkmcnt(5)
v_mfma_f32_16x16x32_bf16 v[60:63], a[96:99], v[140:143], v[60:63]
v_exp_f32 v199, v199
v_mfma_f32_16x16x32_bf16 v[60:63], a[100:103], v[148:151], v[60:63]
ds_read_b64_tr_b16 a[114:115], v18 offset:36864
ds_read_b64_tr_b16 a[116:117], v18 offset:40960
v_mfma_f32_16x16x32_bf16 v[92:95], a[100:103], v[164:167], v[92:95]
v_exp_f32 v212, v212
v_mfma_f32_16x16x32_bf16 v[92:95], a[96:99], v[156:159], v[92:95]
ds_read_b64_tr_b16 a[118:119], v18 offset:45056
v_mfma_f32_16x16x32_bf16 v[124:127], a[96:99], v[172:175], v[124:127]
v_exp_f32 v213, v213
v_mfma_f32_16x16x32_bf16 v[124:127], a[100:103], v[180:183], v[124:127]
s_waitcnt vmcnt(3)
buffer_load_dwordx4 v25, s[12:15], s60 offen offset:3072 nt lds
s_waitcnt lgkmcnt(4)
v_mfma_f32_16x16x32_bf16 v[64:67], a[104:107], v[140:143], v[64:67]
s_add_u32 s60, s60, 16384
s_and_b32 s60, s60, 0x7ffff
v_mfma_f32_16x16x32_bf16 v[64:67], a[108:111], v[148:151], v[64:67]
ds_read_b64_tr_b16 a[120:121], v19 offset:32768
ds_read_b64_tr_b16 a[122:123], v19 offset:36864
v_mfma_f32_16x16x32_bf16 v[96:99], a[108:111], v[164:167], v[96:99]
v_cvt_pk_bf16_f32 v197, v198, v199
v_mfma_f32_16x16x32_bf16 v[96:99], a[104:107], v[156:159], v[96:99]
ds_read_b64_tr_b16 a[124:125], v19 offset:40960
s_barrier
ds_read_b64_tr_b16 a[126:127], v19 offset:45056
v_mfma_f32_16x16x32_bf16 v[128:131], a[104:107], v[172:175], v[128:131]
v_exp_f32 v214, v214
v_mfma_f32_16x16x32_bf16 v[128:131], a[108:111], v[180:183], v[128:131]
v_cvt_pk_bf16_f32 v212, v212, v213
v_mfma_f32_16x16x32_bf16 a[56:59], a[60:63], v[172:175], a[56:59]
v_exp_f32 v215, v215
v_mfma_f32_16x16x32_bf16 a[56:59], a[60:63], v[180:183], a[56:59]
ds_read_b128 a[64:67], v8 offset:0
s_waitcnt lgkmcnt(5)
v_mfma_f32_16x16x32_bf16 v[68:71], a[112:115], v[140:143], v[68:71]
v_exp_f32 v228, v228
v_mfma_f32_16x16x32_bf16 v[68:71], a[116:119], v[148:151], v[68:71]
ds_read_b128 a[68:71], v9 offset:0
ds_read_b128 a[72:75], v10 offset:0
v_mfma_f32_16x16x32_bf16 v[100:103], a[116:119], v[164:167], v[100:103]
v_exp_f32 v229, v229
v_mfma_f32_16x16x32_bf16 v[100:103], a[112:115], v[156:159], v[100:103]
v_cvt_pk_bf16_f32 v213, v214, v215
ds_read_b128 a[76:79], v11 offset:0
v_mfma_f32_16x16x32_bf16 v[132:135], a[112:115], v[172:175], v[132:135]
v_exp_f32 v230, v230
v_mfma_f32_16x16x32_bf16 v[132:135], a[116:119], v[180:183], v[132:135]
v_cvt_pk_bf16_f32 v228, v228, v229
s_waitcnt lgkmcnt(4)
v_mfma_f32_16x16x32_bf16 v[72:75], a[120:123], v[140:143], v[72:75]
v_exp_f32 v231, v231
v_mfma_f32_16x16x32_bf16 v[72:75], a[124:127], v[148:151], v[72:75]
v_exp_f32 v200, v200
v_mfma_f32_16x16x32_bf16 v[104:107], a[124:127], v[164:167], v[104:107]
v_exp_f32 v201, v201
v_mfma_f32_16x16x32_bf16 v[104:107], a[120:123], v[156:159], v[104:107]
v_cvt_pk_bf16_f32 v229, v230, v231
v_mfma_f32_16x16x32_bf16 v[136:139], a[120:123], v[172:175], v[136:139]
v_exp_f32 v202, v202
v_mfma_f32_16x16x32_bf16 v[136:139], a[124:127], v[180:183], v[136:139]
v_cvt_pk_bf16_f32 v198, v200, v201
v_exp_f32 v203, v203
s_waitcnt lgkmcnt(0)
v_mfma_f32_16x16x32_bf16 v[140:143], a[64:67], a[0:3], v[32:35]
v_exp_f32 v216, v216
v_mfma_f32_16x16x32_bf16 v[140:143], a[68:71], a[4:7], v[140:143]
s_add_u32 m0, s65, 49152
v_mfma_f32_16x16x32_bf16 v[140:143], a[72:75], a[8:11], v[140:143]
v_exp_f32 v217, v217
v_mfma_f32_16x16x32_bf16 v[140:143], a[76:79], a[12:15], v[140:143]
ds_read_b128 a[80:83], v8 offset:4096
ds_read_b128 a[84:87], v9 offset:4096
ds_read_b128 a[88:91], v10 offset:4096
v_mfma_f32_16x16x32_bf16 v[156:159], a[76:79], a[28:31], v[36:39]
v_cvt_pk_bf16_f32 v199, v202, v203
v_mfma_f32_16x16x32_bf16 v[156:159], a[72:75], a[24:27], v[156:159]
v_exp_f32 v218, v218
v_mfma_f32_16x16x32_bf16 v[156:159], a[68:71], a[20:23], v[156:159]
v_cvt_pk_bf16_f32 v214, v216, v217
v_mfma_f32_16x16x32_bf16 v[156:159], a[64:67], a[16:19], v[156:159]
buffer_load_dwordx4 v20, s[8:11], s59 offen nt lds
ds_read_b128 a[92:95], v11 offset:4096
v_mfma_f32_16x16x32_bf16 v[172:175], a[64:67], a[32:35], v[40:43]
v_exp_f32 v219, v219
v_mfma_f32_16x16x32_bf16 v[172:175], a[68:71], a[36:39], v[172:175]
v_exp_f32 v232, v232
v_mfma_f32_16x16x32_bf16 v[172:175], a[72:75], a[40:43], v[172:175]
v_exp_f32 v233, v233
v_mfma_f32_16x16x32_bf16 v[172:175], a[76:79], a[44:47], v[172:175]
v_cvt_pk_bf16_f32 v215, v218, v219
s_waitcnt lgkmcnt(0)
v_mfma_f32_16x16x32_bf16 v[144:147], a[80:83], a[0:3], v[32:35]
v_exp_f32 v234, v234
v_mfma_f32_16x16x32_bf16 v[144:147], a[84:87], a[4:7], v[144:147]
v_cvt_pk_bf16_f32 v230, v232, v233
v_mfma_f32_16x16x32_bf16 v[144:147], a[88:91], a[8:11], v[144:147]
v_exp_f32 v235, v235
v_mfma_f32_16x16x32_bf16 v[144:147], a[92:95], a[12:15], v[144:147]
ds_read_b128 a[64:67], v8 offset:8192
s_waitcnt vmcnt(4)
buffer_load_dwordx4 v21, s[8:11], s59 offen offset:1024 nt lds
ds_read_b128 a[68:71], v9 offset:8192
ds_read_b128 a[72:75], v10 offset:8192
v_mfma_f32_16x16x32_bf16 v[160:163], a[92:95], a[28:31], v[36:39]
v_cvt_pk_bf16_f32 v231, v234, v235
v_mfma_f32_16x16x32_bf16 v[160:163], a[88:91], a[24:27], v[160:163]
v_exp_f32 v140, v140
v_mfma_f32_16x16x32_bf16 v[160:163], a[84:87], a[20:23], v[160:163]
v_exp_f32 v141, v141
v_mfma_f32_16x16x32_bf16 v[160:163], a[80:83], a[16:19], v[160:163]
ds_read_b128 a[76:79], v11 offset:8192
v_mfma_f32_16x16x32_bf16 v[176:179], a[80:83], a[32:35], v[40:43]
v_exp_f32 v142, v142
v_mfma_f32_16x16x32_bf16 v[176:179], a[84:87], a[36:39], v[176:179]
v_cvt_pk_bf16_f32 v140, v140, v141
v_mfma_f32_16x16x32_bf16 v[176:179], a[88:91], a[40:43], v[176:179]
v_exp_f32 v143, v143
v_mfma_f32_16x16x32_bf16 v[176:179], a[92:95], a[44:47], v[176:179]
s_waitcnt lgkmcnt(0)
v_mfma_f32_16x16x32_bf16 v[148:151], a[64:67], a[0:3], v[32:35]
v_exp_f32 v156, v156
v_mfma_f32_16x16x32_bf16 v[148:151], a[68:71], a[4:7], v[148:151]
v_exp_f32 v157, v157
v_mfma_f32_16x16x32_bf16 v[148:151], a[72:75], a[8:11], v[148:151]
v_cvt_pk_bf16_f32 v141, v142, v143
v_mfma_f32_16x16x32_bf16 v[148:151], a[76:79], a[12:15], v[148:151]
s_waitcnt vmcnt(4)
buffer_load_dwordx4 v22, s[8:11], s59 offen offset:2048 nt lds
ds_read_b128 a[80:83], v8 offset:12288
ds_read_b128 a[84:87], v9 offset:12288
ds_read_b128 a[88:91], v10 offset:12288
v_mfma_f32_16x16x32_bf16 v[164:167], a[76:79], a[28:31], v[36:39]
v_exp_f32 v158, v158
v_mfma_f32_16x16x32_bf16 v[164:167], a[72:75], a[24:27], v[164:167]
v_cvt_pk_bf16_f32 v156, v156, v157
v_mfma_f32_16x16x32_bf16 v[164:167], a[68:71], a[20:23], v[164:167]
v_exp_f32 v159, v159
v_mfma_f32_16x16x32_bf16 v[164:167], a[64:67], a[16:19], v[164:167]
ds_read_b128 a[92:95], v11 offset:12288
v_mfma_f32_16x16x32_bf16 v[180:183], a[64:67], a[32:35], v[40:43]
v_exp_f32 v172, v172
v_mfma_f32_16x16x32_bf16 v[180:183], a[68:71], a[36:39], v[180:183]
v_exp_f32 v173, v173
v_mfma_f32_16x16x32_bf16 v[180:183], a[72:75], a[40:43], v[180:183]
v_cvt_pk_bf16_f32 v157, v158, v159
v_mfma_f32_16x16x32_bf16 v[180:183], a[76:79], a[44:47], v[180:183]
ds_read_b64_tr_b16 a[96:97], v12 offset:49152
ds_read_b64_tr_b16 a[98:99], v12 offset:53248
s_waitcnt lgkmcnt(2)
v_mfma_f32_16x16x32_bf16 v[152:155], a[80:83], a[0:3], v[32:35]
v_exp_f32 v174, v174
v_mfma_f32_16x16x32_bf16 v[152:155], a[84:87], a[4:7], v[152:155]
v_cvt_pk_bf16_f32 v172, v172, v173
v_mfma_f32_16x16x32_bf16 v[152:155], a[88:91], a[8:11], v[152:155]
v_exp_f32 v175, v175
v_mfma_f32_16x16x32_bf16 v[152:155], a[92:95], a[12:15], v[152:155]
s_waitcnt vmcnt(4)
buffer_load_dwordx4 v23, s[8:11], s59 offen offset:3072 nt lds
s_add_u32 s59, s59, 16384
s_and_b32 s59, s59, 0x7ffff
ds_read_b64_tr_b16 a[100:101], v12 offset:57344
ds_read_b64_tr_b16 a[102:103], v12 offset:61440
v_mfma_f32_16x16x32_bf16 v[168:171], a[92:95], a[28:31], v[36:39]
v_exp_f32 v144, v144
v_mfma_f32_16x16x32_bf16 v[168:171], a[88:91], a[24:27], v[168:171]
v_exp_f32 v145, v145
v_mfma_f32_16x16x32_bf16 v[168:171], a[84:87], a[20:23], v[168:171]
v_cvt_pk_bf16_f32 v173, v174, v175
s_add_u32 m0, s65, 81920
v_mfma_f32_16x16x32_bf16 v[168:171], a[80:83], a[16:19], v[168:171]
ds_read_b64_tr_b16 a[104:105], v13 offset:49152
ds_read_b64_tr_b16 a[106:107], v13 offset:53248
ds_read_b64_tr_b16 a[108:109], v13 offset:57344
ds_read_b64_tr_b16 a[110:111], v13 offset:61440
v_mfma_f32_16x16x32_bf16 v[184:187], a[80:83], a[32:35], v[40:43]
v_exp_f32 v146, v146
v_mfma_f32_16x16x32_bf16 v[184:187], a[84:87], a[36:39], v[184:187]
v_cvt_pk_bf16_f32 v142, v144, v145
v_mfma_f32_16x16x32_bf16 v[184:187], a[88:91], a[40:43], v[184:187]
v_exp_f32 v147, v147
v_mfma_f32_16x16x32_bf16 v[184:187], a[92:95], a[44:47], v[184:187]
ds_read_b64_tr_b16 a[112:113], v14 offset:49152
s_waitcnt lgkmcnt(5)
v_mfma_f32_16x16x32_bf16 v[44:47], a[96:99], v[188:191], v[44:47]
v_exp_f32 v160, v160
v_mfma_f32_16x16x32_bf16 v[44:47], a[100:103], v[196:199], v[44:47]
s_waitcnt vmcnt(4)
buffer_load_dwordx4 v24, s[12:15], s60 offen nt lds
ds_read_b64_tr_b16 a[114:115], v14 offset:53248
v_mfma_f32_16x16x32_bf16 v[76:79], a[100:103], v[212:215], v[76:79]
v_exp_f32 v161, v161
v_mfma_f32_16x16x32_bf16 v[76:79], a[96:99], v[204:207], v[76:79]
ds_read_b64_tr_b16 a[116:117], v14 offset:57344
ds_read_b64_tr_b16 a[118:119], v14 offset:61440
v_mfma_f32_16x16x32_bf16 v[108:111], a[96:99], v[220:223], v[108:111]
v_cvt_pk_bf16_f32 v143, v146, v147
v_mfma_f32_16x16x32_bf16 v[108:111], a[100:103], v[228:231], v[108:111]
ds_read_b64_tr_b16 a[120:121], v15 offset:49152
s_waitcnt lgkmcnt(5)
v_mfma_f32_16x16x32_bf16 v[48:51], a[104:107], v[188:191], v[48:51]
v_exp_f32 v162, v162
v_mfma_f32_16x16x32_bf16 v[48:51], a[108:111], v[196:199], v[48:51]
ds_read_b64_tr_b16 a[122:123], v15 offset:53248
v_cvt_pk_bf16_f32 v158, v160, v161
v_mfma_f32_16x16x32_bf16 v[80:83], a[108:111], v[212:215], v[80:83]
v_exp_f32 v163, v163
v_mfma_f32_16x16x32_bf16 v[80:83], a[104:107], v[204:207], v[80:83]
ds_read_b64_tr_b16 a[124:125], v15 offset:57344
ds_read_b64_tr_b16 a[126:127], v15 offset:61440
v_mfma_f32_16x16x32_bf16 v[112:115], a[104:107], v[220:223], v[112:115]
v_exp_f32 v176, v176
v_mfma_f32_16x16x32_bf16 v[112:115], a[108:111], v[228:231], v[112:115]
s_waitcnt vmcnt(4)
buffer_load_dwordx4 v25, s[12:15], s60 offen offset:1024 nt lds
v_mfma_f32_16x16x32_bf16 a[48:51], a[60:63], v[188:191], a[48:51]
v_exp_f32 v177, v177
v_mfma_f32_16x16x32_bf16 a[48:51], a[60:63], v[196:199], a[48:51]
v_cvt_pk_bf16_f32 v159, v162, v163
s_waitcnt lgkmcnt(4)
v_mfma_f32_16x16x32_bf16 v[52:55], a[112:115], v[188:191], v[52:55]
v_exp_f32 v178, v178
v_mfma_f32_16x16x32_bf16 v[52:55], a[116:119], v[196:199], v[52:55]
ds_read_b64_tr_b16 a[96:97], v16 offset:49152
ds_read_b64_tr_b16 a[98:99], v16 offset:53248
v_mfma_f32_16x16x32_bf16 v[84:87], a[116:119], v[212:215], v[84:87]
v_cvt_pk_bf16_f32 v174, v176, v177
v_mfma_f32_16x16x32_bf16 v[84:87], a[112:115], v[204:207], v[84:87]
ds_read_b64_tr_b16 a[100:101], v16 offset:57344
ds_read_b64_tr_b16 a[102:103], v16 offset:61440
v_mfma_f32_16x16x32_bf16 v[116:119], a[112:115], v[220:223], v[116:119]
v_exp_f32 v179, v179
v_mfma_f32_16x16x32_bf16 v[116:119], a[116:119], v[228:231], v[116:119]
ds_read_b64_tr_b16 a[104:105], v17 offset:49152
s_waitcnt lgkmcnt(5)
v_mfma_f32_16x16x32_bf16 v[56:59], a[120:123], v[188:191], v[56:59]
v_exp_f32 v148, v148
v_mfma_f32_16x16x32_bf16 v[56:59], a[124:127], v[196:199], v[56:59]
ds_read_b64_tr_b16 a[106:107], v17 offset:53248
ds_read_b64_tr_b16 a[108:109], v17 offset:57344
v_mfma_f32_16x16x32_bf16 v[88:91], a[124:127], v[212:215], v[88:91]
v_exp_f32 v149, v149
v_mfma_f32_16x16x32_bf16 v[88:91], a[120:123], v[204:207], v[88:91]
s_waitcnt vmcnt(4)
buffer_load_dwordx4 v24, s[12:15], s60 offen offset:2048 nt lds
ds_read_b64_tr_b16 a[110:111], v17 offset:61440
v_mfma_f32_16x16x32_bf16 v[120:123], a[120:123], v[220:223], v[120:123]
v_cvt_pk_bf16_f32 v175, v178, v179
v_mfma_f32_16x16x32_bf16 v[120:123], a[124:127], v[228:231], v[120:123]
v_exp_f32 v150, v150
v_mfma_f32_16x16x32_bf16 a[52:55], a[60:63], v[204:207], a[52:55]
v_cvt_pk_bf16_f32 v148, v148, v149
v_mfma_f32_16x16x32_bf16 a[52:55], a[60:63], v[212:215], a[52:55]
ds_read_b64_tr_b16 a[112:113], v18 offset:49152
s_waitcnt lgkmcnt(5)
v_mfma_f32_16x16x32_bf16 v[60:63], a[96:99], v[188:191], v[60:63]
v_exp_f32 v151, v151
v_mfma_f32_16x16x32_bf16 v[60:63], a[100:103], v[196:199], v[60:63]
ds_read_b64_tr_b16 a[114:115], v18 offset:53248
ds_read_b64_tr_b16 a[116:117], v18 offset:57344
v_mfma_f32_16x16x32_bf16 v[92:95], a[100:103], v[212:215], v[92:95]
v_exp_f32 v164, v164
v_mfma_f32_16x16x32_bf16 v[92:95], a[96:99], v[204:207], v[92:95]
ds_read_b64_tr_b16 a[118:119], v18 offset:61440
v_mfma_f32_16x16x32_bf16 v[124:127], a[96:99], v[220:223], v[124:127]
v_exp_f32 v165, v165
v_mfma_f32_16x16x32_bf16 v[124:127], a[100:103], v[228:231], v[124:127]
s_waitcnt vmcnt(3)
buffer_load_dwordx4 v25, s[12:15], s60 offen offset:3072 nt lds
s_waitcnt lgkmcnt(4)
v_mfma_f32_16x16x32_bf16 v[64:67], a[104:107], v[188:191], v[64:67]
s_add_u32 s60, s60, 16384
s_and_b32 s60, s60, 0x7ffff
v_mfma_f32_16x16x32_bf16 v[64:67], a[108:111], v[196:199], v[64:67]
ds_read_b64_tr_b16 a[120:121], v19 offset:49152
ds_read_b64_tr_b16 a[122:123], v19 offset:53248
v_mfma_f32_16x16x32_bf16 v[96:99], a[108:111], v[212:215], v[96:99]
v_cvt_pk_bf16_f32 v149, v150, v151
v_mfma_f32_16x16x32_bf16 v[96:99], a[104:107], v[204:207], v[96:99]
ds_read_b64_tr_b16 a[124:125], v19 offset:57344
s_barrier
ds_read_b64_tr_b16 a[126:127], v19 offset:61440
v_mfma_f32_16x16x32_bf16 v[128:131], a[104:107], v[220:223], v[128:131]
v_exp_f32 v166, v166
v_mfma_f32_16x16x32_bf16 v[128:131], a[108:111], v[228:231], v[128:131]
v_cvt_pk_bf16_f32 v164, v164, v165
v_mfma_f32_16x16x32_bf16 a[56:59], a[60:63], v[220:223], a[56:59]
v_exp_f32 v167, v167
v_mfma_f32_16x16x32_bf16 a[56:59], a[60:63], v[228:231], a[56:59]
ds_read_b128 a[64:67], v8 offset:16384
s_waitcnt lgkmcnt(5)
v_mfma_f32_16x16x32_bf16 v[68:71], a[112:115], v[188:191], v[68:71]
v_exp_f32 v180, v180
v_mfma_f32_16x16x32_bf16 v[68:71], a[116:119], v[196:199], v[68:71]
ds_read_b128 a[68:71], v9 offset:16384
ds_read_b128 a[72:75], v10 offset:16384
v_mfma_f32_16x16x32_bf16 v[100:103], a[116:119], v[212:215], v[100:103]
v_exp_f32 v181, v181
v_mfma_f32_16x16x32_bf16 v[100:103], a[112:115], v[204:207], v[100:103]
v_cvt_pk_bf16_f32 v165, v166, v167
ds_read_b128 a[76:79], v11 offset:16384
v_mfma_f32_16x16x32_bf16 v[132:135], a[112:115], v[220:223], v[132:135]
v_exp_f32 v182, v182
v_mfma_f32_16x16x32_bf16 v[132:135], a[116:119], v[228:231], v[132:135]
v_cvt_pk_bf16_f32 v180, v180, v181
s_waitcnt lgkmcnt(4)
v_mfma_f32_16x16x32_bf16 v[72:75], a[120:123], v[188:191], v[72:75]
v_exp_f32 v183, v183
v_mfma_f32_16x16x32_bf16 v[72:75], a[124:127], v[196:199], v[72:75]
v_exp_f32 v152, v152
v_mfma_f32_16x16x32_bf16 v[104:107], a[124:127], v[212:215], v[104:107]
v_exp_f32 v153, v153
v_mfma_f32_16x16x32_bf16 v[104:107], a[120:123], v[204:207], v[104:107]
v_cvt_pk_bf16_f32 v181, v182, v183
v_mfma_f32_16x16x32_bf16 v[136:139], a[120:123], v[220:223], v[136:139]
v_exp_f32 v154, v154
v_mfma_f32_16x16x32_bf16 v[136:139], a[124:127], v[228:231], v[136:139]
v_cvt_pk_bf16_f32 v150, v152, v153
v_exp_f32 v155, v155
s_waitcnt lgkmcnt(0)
v_mfma_f32_16x16x32_bf16 v[188:191], a[64:67], a[0:3], v[32:35]
v_exp_f32 v168, v168
v_mfma_f32_16x16x32_bf16 v[188:191], a[68:71], a[4:7], v[188:191]
s_add_u32 m0, s65, 0
v_mfma_f32_16x16x32_bf16 v[188:191], a[72:75], a[8:11], v[188:191]
v_exp_f32 v169, v169
v_mfma_f32_16x16x32_bf16 v[188:191], a[76:79], a[12:15], v[188:191]
ds_read_b128 a[80:83], v8 offset:20480
ds_read_b128 a[84:87], v9 offset:20480
ds_read_b128 a[88:91], v10 offset:20480
v_mfma_f32_16x16x32_bf16 v[204:207], a[76:79], a[28:31], v[36:39]
v_cvt_pk_bf16_f32 v151, v154, v155
v_mfma_f32_16x16x32_bf16 v[204:207], a[72:75], a[24:27], v[204:207]
v_exp_f32 v170, v170
v_mfma_f32_16x16x32_bf16 v[204:207], a[68:71], a[20:23], v[204:207]
v_cvt_pk_bf16_f32 v166, v168, v169
v_mfma_f32_16x16x32_bf16 v[204:207], a[64:67], a[16:19], v[204:207]
buffer_load_dwordx4 v20, s[8:11], s59 offen nt lds
ds_read_b128 a[92:95], v11 offset:20480
v_mfma_f32_16x16x32_bf16 v[220:223], a[64:67], a[32:35], v[40:43]
v_exp_f32 v171, v171
v_mfma_f32_16x16x32_bf16 v[220:223], a[68:71], a[36:39], v[220:223]
v_exp_f32 v184, v184
v_mfma_f32_16x16x32_bf16 v[220:223], a[72:75], a[40:43], v[220:223]
v_exp_f32 v185, v185
v_mfma_f32_16x16x32_bf16 v[220:223], a[76:79], a[44:47], v[220:223]
v_cvt_pk_bf16_f32 v167, v170, v171
s_waitcnt lgkmcnt(0)
v_mfma_f32_16x16x32_bf16 v[192:195], a[80:83], a[0:3], v[32:35]
v_exp_f32 v186, v186
v_mfma_f32_16x16x32_bf16 v[192:195], a[84:87], a[4:7], v[192:195]
v_cvt_pk_bf16_f32 v182, v184, v185
v_mfma_f32_16x16x32_bf16 v[192:195], a[88:91], a[8:11], v[192:195]
v_exp_f32 v187, v187
v_mfma_f32_16x16x32_bf16 v[192:195], a[92:95], a[12:15], v[192:195]
ds_read_b128 a[64:67], v8 offset:24576
s_waitcnt vmcnt(4)
buffer_load_dwordx4 v21, s[8:11], s59 offen offset:1024 nt lds
ds_read_b128 a[68:71], v9 offset:24576
ds_read_b128 a[72:75], v10 offset:24576
v_mfma_f32_16x16x32_bf16 v[208:211], a[92:95], a[28:31], v[36:39]
v_cvt_pk_bf16_f32 v183, v186, v187
v_mfma_f32_16x16x32_bf16 v[208:211], a[88:91], a[24:27], v[208:211]
v_exp_f32 v188, v188
v_mfma_f32_16x16x32_bf16 v[208:211], a[84:87], a[20:23], v[208:211]
v_exp_f32 v189, v189
v_mfma_f32_16x16x32_bf16 v[208:211], a[80:83], a[16:19], v[208:211]
ds_read_b128 a[76:79], v11 offset:24576
v_mfma_f32_16x16x32_bf16 v[224:227], a[80:83], a[32:35], v[40:43]
v_exp_f32 v190, v190
v_mfma_f32_16x16x32_bf16 v[224:227], a[84:87], a[36:39], v[224:227]
v_cvt_pk_bf16_f32 v188, v188, v189
v_mfma_f32_16x16x32_bf16 v[224:227], a[88:91], a[40:43], v[224:227]
v_exp_f32 v191, v191
v_mfma_f32_16x16x32_bf16 v[224:227], a[92:95], a[44:47], v[224:227]
s_waitcnt lgkmcnt(0)
v_mfma_f32_16x16x32_bf16 v[196:199], a[64:67], a[0:3], v[32:35]
v_exp_f32 v204, v204
v_mfma_f32_16x16x32_bf16 v[196:199], a[68:71], a[4:7], v[196:199]
v_exp_f32 v205, v205
v_mfma_f32_16x16x32_bf16 v[196:199], a[72:75], a[8:11], v[196:199]
v_cvt_pk_bf16_f32 v189, v190, v191
v_mfma_f32_16x16x32_bf16 v[196:199], a[76:79], a[12:15], v[196:199]
s_waitcnt vmcnt(4)
buffer_load_dwordx4 v22, s[8:11], s59 offen offset:2048 nt lds
ds_read_b128 a[80:83], v8 offset:28672
ds_read_b128 a[84:87], v9 offset:28672
ds_read_b128 a[88:91], v10 offset:28672
v_mfma_f32_16x16x32_bf16 v[212:215], a[76:79], a[28:31], v[36:39]
v_exp_f32 v206, v206
v_mfma_f32_16x16x32_bf16 v[212:215], a[72:75], a[24:27], v[212:215]
v_cvt_pk_bf16_f32 v204, v204, v205
v_mfma_f32_16x16x32_bf16 v[212:215], a[68:71], a[20:23], v[212:215]
v_exp_f32 v207, v207
v_mfma_f32_16x16x32_bf16 v[212:215], a[64:67], a[16:19], v[212:215]
ds_read_b128 a[92:95], v11 offset:28672
v_mfma_f32_16x16x32_bf16 v[228:231], a[64:67], a[32:35], v[40:43]
v_exp_f32 v220, v220
v_mfma_f32_16x16x32_bf16 v[228:231], a[68:71], a[36:39], v[228:231]
v_exp_f32 v221, v221
v_mfma_f32_16x16x32_bf16 v[228:231], a[72:75], a[40:43], v[228:231]
v_cvt_pk_bf16_f32 v205, v206, v207
v_mfma_f32_16x16x32_bf16 v[228:231], a[76:79], a[44:47], v[228:231]
ds_read_b64_tr_b16 a[96:97], v12 offset:0
ds_read_b64_tr_b16 a[98:99], v12 offset:4096
s_waitcnt lgkmcnt(2)
v_mfma_f32_16x16x32_bf16 v[200:203], a[80:83], a[0:3], v[32:35]
v_exp_f32 v222, v222
v_mfma_f32_16x16x32_bf16 v[200:203], a[84:87], a[4:7], v[200:203]
v_cvt_pk_bf16_f32 v220, v220, v221
v_mfma_f32_16x16x32_bf16 v[200:203], a[88:91], a[8:11], v[200:203]
v_exp_f32 v223, v223
v_mfma_f32_16x16x32_bf16 v[200:203], a[92:95], a[12:15], v[200:203]
s_waitcnt vmcnt(4)
buffer_load_dwordx4 v23, s[8:11], s59 offen offset:3072 nt lds
s_add_u32 s59, s59, 16384
s_and_b32 s59, s59, 0x7ffff
ds_read_b64_tr_b16 a[100:101], v12 offset:8192
ds_read_b64_tr_b16 a[102:103], v12 offset:12288
v_mfma_f32_16x16x32_bf16 v[216:219], a[92:95], a[28:31], v[36:39]
v_exp_f32 v192, v192
v_mfma_f32_16x16x32_bf16 v[216:219], a[88:91], a[24:27], v[216:219]
v_exp_f32 v193, v193
v_mfma_f32_16x16x32_bf16 v[216:219], a[84:87], a[20:23], v[216:219]
v_cvt_pk_bf16_f32 v221, v222, v223
s_add_u32 m0, s65, 98304
v_mfma_f32_16x16x32_bf16 v[216:219], a[80:83], a[16:19], v[216:219]
ds_read_b64_tr_b16 a[104:105], v13 offset:0
ds_read_b64_tr_b16 a[106:107], v13 offset:4096
ds_read_b64_tr_b16 a[108:109], v13 offset:8192
ds_read_b64_tr_b16 a[110:111], v13 offset:12288
v_mfma_f32_16x16x32_bf16 v[232:235], a[80:83], a[32:35], v[40:43]
v_exp_f32 v194, v194
v_mfma_f32_16x16x32_bf16 v[232:235], a[84:87], a[36:39], v[232:235]
v_cvt_pk_bf16_f32 v190, v192, v193
v_mfma_f32_16x16x32_bf16 v[232:235], a[88:91], a[40:43], v[232:235]
v_exp_f32 v195, v195
v_mfma_f32_16x16x32_bf16 v[232:235], a[92:95], a[44:47], v[232:235]
ds_read_b64_tr_b16 a[112:113], v14 offset:0
s_waitcnt lgkmcnt(5)
v_mfma_f32_16x16x32_bf16 v[44:47], a[96:99], v[140:143], v[44:47]
v_exp_f32 v208, v208
v_mfma_f32_16x16x32_bf16 v[44:47], a[100:103], v[148:151], v[44:47]
s_waitcnt vmcnt(4)
buffer_load_dwordx4 v24, s[12:15], s60 offen nt lds
ds_read_b64_tr_b16 a[114:115], v14 offset:4096
v_mfma_f32_16x16x32_bf16 v[76:79], a[100:103], v[164:167], v[76:79]
v_exp_f32 v209, v209
v_mfma_f32_16x16x32_bf16 v[76:79], a[96:99], v[156:159], v[76:79]
ds_read_b64_tr_b16 a[116:117], v14 offset:8192
ds_read_b64_tr_b16 a[118:119], v14 offset:12288
v_mfma_f32_16x16x32_bf16 v[108:111], a[96:99], v[172:175], v[108:111]
v_cvt_pk_bf16_f32 v191, v194, v195
v_mfma_f32_16x16x32_bf16 v[108:111], a[100:103], v[180:183], v[108:111]
ds_read_b64_tr_b16 a[120:121], v15 offset:0
s_waitcnt lgkmcnt(5)
v_mfma_f32_16x16x32_bf16 v[48:51], a[104:107], v[140:143], v[48:51]
v_exp_f32 v210, v210
v_mfma_f32_16x16x32_bf16 v[48:51], a[108:111], v[148:151], v[48:51]
ds_read_b64_tr_b16 a[122:123], v15 offset:4096
v_cvt_pk_bf16_f32 v206, v208, v209
v_mfma_f32_16x16x32_bf16 v[80:83], a[108:111], v[164:167], v[80:83]
v_exp_f32 v211, v211
v_mfma_f32_16x16x32_bf16 v[80:83], a[104:107], v[156:159], v[80:83]
ds_read_b64_tr_b16 a[124:125], v15 offset:8192
ds_read_b64_tr_b16 a[126:127], v15 offset:12288
v_mfma_f32_16x16x32_bf16 v[112:115], a[104:107], v[172:175], v[112:115]
v_exp_f32 v224, v224
v_mfma_f32_16x16x32_bf16 v[112:115], a[108:111], v[180:183], v[112:115]
s_waitcnt vmcnt(4)
buffer_load_dwordx4 v25, s[12:15], s60 offen offset:1024 nt lds
v_mfma_f32_16x16x32_bf16 a[48:51], a[60:63], v[140:143], a[48:51]
v_exp_f32 v225, v225
v_mfma_f32_16x16x32_bf16 a[48:51], a[60:63], v[148:151], a[48:51]
v_cvt_pk_bf16_f32 v207, v210, v211
s_waitcnt lgkmcnt(4)
v_mfma_f32_16x16x32_bf16 v[52:55], a[112:115], v[140:143], v[52:55]
v_exp_f32 v226, v226
v_mfma_f32_16x16x32_bf16 v[52:55], a[116:119], v[148:151], v[52:55]
ds_read_b64_tr_b16 a[96:97], v16 offset:0
ds_read_b64_tr_b16 a[98:99], v16 offset:4096
v_mfma_f32_16x16x32_bf16 v[84:87], a[116:119], v[164:167], v[84:87]
v_cvt_pk_bf16_f32 v222, v224, v225
v_mfma_f32_16x16x32_bf16 v[84:87], a[112:115], v[156:159], v[84:87]
ds_read_b64_tr_b16 a[100:101], v16 offset:8192
ds_read_b64_tr_b16 a[102:103], v16 offset:12288
v_mfma_f32_16x16x32_bf16 v[116:119], a[112:115], v[172:175], v[116:119]
v_exp_f32 v227, v227
v_mfma_f32_16x16x32_bf16 v[116:119], a[116:119], v[180:183], v[116:119]
ds_read_b64_tr_b16 a[104:105], v17 offset:0
s_waitcnt lgkmcnt(5)
v_mfma_f32_16x16x32_bf16 v[56:59], a[120:123], v[140:143], v[56:59]
v_exp_f32 v196, v196
v_mfma_f32_16x16x32_bf16 v[56:59], a[124:127], v[148:151], v[56:59]
ds_read_b64_tr_b16 a[106:107], v17 offset:4096
ds_read_b64_tr_b16 a[108:109], v17 offset:8192
v_mfma_f32_16x16x32_bf16 v[88:91], a[124:127], v[164:167], v[88:91]
v_exp_f32 v197, v197
v_mfma_f32_16x16x32_bf16 v[88:91], a[120:123], v[156:159], v[88:91]
s_waitcnt vmcnt(4)
buffer_load_dwordx4 v24, s[12:15], s60 offen offset:2048 nt lds
ds_read_b64_tr_b16 a[110:111], v17 offset:12288
v_mfma_f32_16x16x32_bf16 v[120:123], a[120:123], v[172:175], v[120:123]
v_cvt_pk_bf16_f32 v223, v226, v227
v_mfma_f32_16x16x32_bf16 v[120:123], a[124:127], v[180:183], v[120:123]
v_exp_f32 v198, v198
v_mfma_f32_16x16x32_bf16 a[52:55], a[60:63], v[156:159], a[52:55]
v_cvt_pk_bf16_f32 v196, v196, v197
v_mfma_f32_16x16x32_bf16 a[52:55], a[60:63], v[164:167], a[52:55]
ds_read_b64_tr_b16 a[112:113], v18 offset:0
s_waitcnt lgkmcnt(5)
v_mfma_f32_16x16x32_bf16 v[60:63], a[96:99], v[140:143], v[60:63]
v_exp_f32 v199, v199
v_mfma_f32_16x16x32_bf16 v[60:63], a[100:103], v[148:151], v[60:63]
ds_read_b64_tr_b16 a[114:115], v18 offset:4096
ds_read_b64_tr_b16 a[116:117], v18 offset:8192
v_mfma_f32_16x16x32_bf16 v[92:95], a[100:103], v[164:167], v[92:95]
v_exp_f32 v212, v212
v_mfma_f32_16x16x32_bf16 v[92:95], a[96:99], v[156:159], v[92:95]
ds_read_b64_tr_b16 a[118:119], v18 offset:12288
v_mfma_f32_16x16x32_bf16 v[124:127], a[96:99], v[172:175], v[124:127]
v_exp_f32 v213, v213
v_mfma_f32_16x16x32_bf16 v[124:127], a[100:103], v[180:183], v[124:127]
s_waitcnt vmcnt(3)
buffer_load_dwordx4 v25, s[12:15], s60 offen offset:3072 nt lds
s_waitcnt lgkmcnt(4)
v_mfma_f32_16x16x32_bf16 v[64:67], a[104:107], v[140:143], v[64:67]
s_add_u32 s60, s60, 16384
s_and_b32 s60, s60, 0x7ffff
v_mfma_f32_16x16x32_bf16 v[64:67], a[108:111], v[148:151], v[64:67]
ds_read_b64_tr_b16 a[120:121], v19 offset:0
ds_read_b64_tr_b16 a[122:123], v19 offset:4096
v_mfma_f32_16x16x32_bf16 v[96:99], a[108:111], v[164:167], v[96:99]
v_cvt_pk_bf16_f32 v197, v198, v199
v_mfma_f32_16x16x32_bf16 v[96:99], a[104:107], v[156:159], v[96:99]
ds_read_b64_tr_b16 a[124:125], v19 offset:8192
s_barrier
ds_read_b64_tr_b16 a[126:127], v19 offset:12288
v_mfma_f32_16x16x32_bf16 v[128:131], a[104:107], v[172:175], v[128:131]
v_exp_f32 v214, v214
v_mfma_f32_16x16x32_bf16 v[128:131], a[108:111], v[180:183], v[128:131]
v_cvt_pk_bf16_f32 v212, v212, v213
v_mfma_f32_16x16x32_bf16 a[56:59], a[60:63], v[172:175], a[56:59]
v_exp_f32 v215, v215
v_mfma_f32_16x16x32_bf16 a[56:59], a[60:63], v[180:183], a[56:59]
ds_read_b128 a[64:67], v8 offset:32768
s_waitcnt lgkmcnt(5)
v_mfma_f32_16x16x32_bf16 v[68:71], a[112:115], v[140:143], v[68:71]
v_exp_f32 v228, v228
v_mfma_f32_16x16x32_bf16 v[68:71], a[116:119], v[148:151], v[68:71]
ds_read_b128 a[68:71], v9 offset:32768
ds_read_b128 a[72:75], v10 offset:32768
v_mfma_f32_16x16x32_bf16 v[100:103], a[116:119], v[164:167], v[100:103]
v_exp_f32 v229, v229
v_mfma_f32_16x16x32_bf16 v[100:103], a[112:115], v[156:159], v[100:103]
v_cvt_pk_bf16_f32 v213, v214, v215
ds_read_b128 a[76:79], v11 offset:32768
v_mfma_f32_16x16x32_bf16 v[132:135], a[112:115], v[172:175], v[132:135]
v_exp_f32 v230, v230
v_mfma_f32_16x16x32_bf16 v[132:135], a[116:119], v[180:183], v[132:135]
v_cvt_pk_bf16_f32 v228, v228, v229
s_waitcnt lgkmcnt(4)
v_mfma_f32_16x16x32_bf16 v[72:75], a[120:123], v[140:143], v[72:75]
v_exp_f32 v231, v231
v_mfma_f32_16x16x32_bf16 v[72:75], a[124:127], v[148:151], v[72:75]
v_exp_f32 v200, v200
v_mfma_f32_16x16x32_bf16 v[104:107], a[124:127], v[164:167], v[104:107]
v_exp_f32 v201, v201
v_mfma_f32_16x16x32_bf16 v[104:107], a[120:123], v[156:159], v[104:107]
v_cvt_pk_bf16_f32 v229, v230, v231
v_mfma_f32_16x16x32_bf16 v[136:139], a[120:123], v[172:175], v[136:139]
v_exp_f32 v202, v202
v_mfma_f32_16x16x32_bf16 v[136:139], a[124:127], v[180:183], v[136:139]
v_cvt_pk_bf16_f32 v198, v200, v201
v_exp_f32 v203, v203
s_waitcnt lgkmcnt(0)
v_mfma_f32_16x16x32_bf16 v[140:143], a[64:67], a[0:3], v[32:35]
v_exp_f32 v216, v216
v_mfma_f32_16x16x32_bf16 v[140:143], a[68:71], a[4:7], v[140:143]
s_add_u32 m0, s65, 16384
v_mfma_f32_16x16x32_bf16 v[140:143], a[72:75], a[8:11], v[140:143]
v_exp_f32 v217, v217
v_mfma_f32_16x16x32_bf16 v[140:143], a[76:79], a[12:15], v[140:143]
ds_read_b128 a[80:83], v8 offset:36864
ds_read_b128 a[84:87], v9 offset:36864
ds_read_b128 a[88:91], v10 offset:36864
v_mfma_f32_16x16x32_bf16 v[156:159], a[76:79], a[28:31], v[36:39]
v_cvt_pk_bf16_f32 v199, v202, v203
v_mfma_f32_16x16x32_bf16 v[156:159], a[72:75], a[24:27], v[156:159]
v_exp_f32 v218, v218
v_mfma_f32_16x16x32_bf16 v[156:159], a[68:71], a[20:23], v[156:159]
v_cvt_pk_bf16_f32 v214, v216, v217
v_mfma_f32_16x16x32_bf16 v[156:159], a[64:67], a[16:19], v[156:159]
buffer_load_dwordx4 v20, s[8:11], s59 offen nt lds
ds_read_b128 a[92:95], v11 offset:36864
v_mfma_f32_16x16x32_bf16 v[172:175], a[64:67], a[32:35], v[40:43]
v_exp_f32 v219, v219
v_mfma_f32_16x16x32_bf16 v[172:175], a[68:71], a[36:39], v[172:175]
v_exp_f32 v232, v232
v_mfma_f32_16x16x32_bf16 v[172:175], a[72:75], a[40:43], v[172:175]
v_exp_f32 v233, v233
v_mfma_f32_16x16x32_bf16 v[172:175], a[76:79], a[44:47], v[172:175]
v_cvt_pk_bf16_f32 v215, v218, v219
s_waitcnt lgkmcnt(0)
v_mfma_f32_16x16x32_bf16 v[144:147], a[80:83], a[0:3], v[32:35]
v_exp_f32 v234, v234
v_mfma_f32_16x16x32_bf16 v[144:147], a[84:87], a[4:7], v[144:147]
v_cvt_pk_bf16_f32 v230, v232, v233
v_mfma_f32_16x16x32_bf16 v[144:147], a[88:91], a[8:11], v[144:147]
v_exp_f32 v235, v235
v_mfma_f32_16x16x32_bf16 v[144:147], a[92:95], a[12:15], v[144:147]
ds_read_b128 a[64:67], v8 offset:40960
s_waitcnt vmcnt(4)
buffer_load_dwordx4 v21, s[8:11], s59 offen offset:1024 nt lds
ds_read_b128 a[68:71], v9 offset:40960
ds_read_b128 a[72:75], v10 offset:40960
v_mfma_f32_16x16x32_bf16 v[160:163], a[92:95], a[28:31], v[36:39]
v_cvt_pk_bf16_f32 v231, v234, v235
v_mfma_f32_16x16x32_bf16 v[160:163], a[88:91], a[24:27], v[160:163]
v_exp_f32 v140, v140
v_mfma_f32_16x16x32_bf16 v[160:163], a[84:87], a[20:23], v[160:163]
v_exp_f32 v141, v141
v_mfma_f32_16x16x32_bf16 v[160:163], a[80:83], a[16:19], v[160:163]
ds_read_b128 a[76:79], v11 offset:40960
v_mfma_f32_16x16x32_bf16 v[176:179], a[80:83], a[32:35], v[40:43]
v_exp_f32 v142, v142
v_mfma_f32_16x16x32_bf16 v[176:179], a[84:87], a[36:39], v[176:179]
v_cvt_pk_bf16_f32 v140, v140, v141
v_mfma_f32_16x16x32_bf16 v[176:179], a[88:91], a[40:43], v[176:179]
v_exp_f32 v143, v143
v_mfma_f32_16x16x32_bf16 v[176:179], a[92:95], a[44:47], v[176:179]
s_waitcnt lgkmcnt(0)
v_mfma_f32_16x16x32_bf16 v[148:151], a[64:67], a[0:3], v[32:35]
v_exp_f32 v156, v156
v_mfma_f32_16x16x32_bf16 v[148:151], a[68:71], a[4:7], v[148:151]
v_exp_f32 v157, v157
v_mfma_f32_16x16x32_bf16 v[148:151], a[72:75], a[8:11], v[148:151]
v_cvt_pk_bf16_f32 v141, v142, v143
v_mfma_f32_16x16x32_bf16 v[148:151], a[76:79], a[12:15], v[148:151]
s_waitcnt vmcnt(4)
buffer_load_dwordx4 v22, s[8:11], s59 offen offset:2048 nt lds
ds_read_b128 a[80:83], v8 offset:45056
ds_read_b128 a[84:87], v9 offset:45056
ds_read_b128 a[88:91], v10 offset:45056
v_mfma_f32_16x16x32_bf16 v[164:167], a[76:79], a[28:31], v[36:39]
v_exp_f32 v158, v158
v_mfma_f32_16x16x32_bf16 v[164:167], a[72:75], a[24:27], v[164:167]
v_cvt_pk_bf16_f32 v156, v156, v157
v_mfma_f32_16x16x32_bf16 v[164:167], a[68:71], a[20:23], v[164:167]
v_exp_f32 v159, v159
v_mfma_f32_16x16x32_bf16 v[164:167], a[64:67], a[16:19], v[164:167]
ds_read_b128 a[92:95], v11 offset:45056
v_mfma_f32_16x16x32_bf16 v[180:183], a[64:67], a[32:35], v[40:43]
v_exp_f32 v172, v172
v_mfma_f32_16x16x32_bf16 v[180:183], a[68:71], a[36:39], v[180:183]
v_exp_f32 v173, v173
v_mfma_f32_16x16x32_bf16 v[180:183], a[72:75], a[40:43], v[180:183]
v_cvt_pk_bf16_f32 v157, v158, v159
v_mfma_f32_16x16x32_bf16 v[180:183], a[76:79], a[44:47], v[180:183]
ds_read_b64_tr_b16 a[96:97], v12 offset:16384
ds_read_b64_tr_b16 a[98:99], v12 offset:20480
s_waitcnt lgkmcnt(2)
v_mfma_f32_16x16x32_bf16 v[152:155], a[80:83], a[0:3], v[32:35]
v_exp_f32 v174, v174
v_mfma_f32_16x16x32_bf16 v[152:155], a[84:87], a[4:7], v[152:155]
v_cvt_pk_bf16_f32 v172, v172, v173
v_mfma_f32_16x16x32_bf16 v[152:155], a[88:91], a[8:11], v[152:155]
v_exp_f32 v175, v175
v_mfma_f32_16x16x32_bf16 v[152:155], a[92:95], a[12:15], v[152:155]
s_waitcnt vmcnt(4)
buffer_load_dwordx4 v23, s[8:11], s59 offen offset:3072 nt lds
s_add_u32 s59, s59, 16384
s_and_b32 s59, s59, 0x7ffff
ds_read_b64_tr_b16 a[100:101], v12 offset:24576
ds_read_b64_tr_b16 a[102:103], v12 offset:28672
v_mfma_f32_16x16x32_bf16 v[168:171], a[92:95], a[28:31], v[36:39]
v_exp_f32 v144, v144
v_mfma_f32_16x16x32_bf16 v[168:171], a[88:91], a[24:27], v[168:171]
v_exp_f32 v145, v145
v_mfma_f32_16x16x32_bf16 v[168:171], a[84:87], a[20:23], v[168:171]
v_cvt_pk_bf16_f32 v173, v174, v175
s_add_u32 m0, s65, 114688
v_mfma_f32_16x16x32_bf16 v[168:171], a[80:83], a[16:19], v[168:171]
ds_read_b64_tr_b16 a[104:105], v13 offset:16384
ds_read_b64_tr_b16 a[106:107], v13 offset:20480
ds_read_b64_tr_b16 a[108:109], v13 offset:24576
ds_read_b64_tr_b16 a[110:111], v13 offset:28672
v_mfma_f32_16x16x32_bf16 v[184:187], a[80:83], a[32:35], v[40:43]
v_exp_f32 v146, v146
v_mfma_f32_16x16x32_bf16 v[184:187], a[84:87], a[36:39], v[184:187]
v_cvt_pk_bf16_f32 v142, v144, v145
v_mfma_f32_16x16x32_bf16 v[184:187], a[88:91], a[40:43], v[184:187]
v_exp_f32 v147, v147
v_mfma_f32_16x16x32_bf16 v[184:187], a[92:95], a[44:47], v[184:187]
ds_read_b64_tr_b16 a[112:113], v14 offset:16384
s_waitcnt lgkmcnt(5)
v_mfma_f32_16x16x32_bf16 v[44:47], a[96:99], v[188:191], v[44:47]
v_exp_f32 v160, v160
v_mfma_f32_16x16x32_bf16 v[44:47], a[100:103], v[196:199], v[44:47]
s_waitcnt vmcnt(4)
buffer_load_dwordx4 v24, s[12:15], s60 offen nt lds
ds_read_b64_tr_b16 a[114:115], v14 offset:20480
v_mfma_f32_16x16x32_bf16 v[76:79], a[100:103], v[212:215], v[76:79]
v_exp_f32 v161, v161
v_mfma_f32_16x16x32_bf16 v[76:79], a[96:99], v[204:207], v[76:79]
ds_read_b64_tr_b16 a[116:117], v14 offset:24576
ds_read_b64_tr_b16 a[118:119], v14 offset:28672
v_mfma_f32_16x16x32_bf16 v[108:111], a[96:99], v[220:223], v[108:111]
v_cvt_pk_bf16_f32 v143, v146, v147
v_mfma_f32_16x16x32_bf16 v[108:111], a[100:103], v[228:231], v[108:111]
ds_read_b64_tr_b16 a[120:121], v15 offset:16384
s_waitcnt lgkmcnt(5)
v_mfma_f32_16x16x32_bf16 v[48:51], a[104:107], v[188:191], v[48:51]
v_exp_f32 v162, v162
v_mfma_f32_16x16x32_bf16 v[48:51], a[108:111], v[196:199], v[48:51]
ds_read_b64_tr_b16 a[122:123], v15 offset:20480
v_cvt_pk_bf16_f32 v158, v160, v161
v_mfma_f32_16x16x32_bf16 v[80:83], a[108:111], v[212:215], v[80:83]
v_exp_f32 v163, v163
v_mfma_f32_16x16x32_bf16 v[80:83], a[104:107], v[204:207], v[80:83]
ds_read_b64_tr_b16 a[124:125], v15 offset:24576
ds_read_b64_tr_b16 a[126:127], v15 offset:28672
v_mfma_f32_16x16x32_bf16 v[112:115], a[104:107], v[220:223], v[112:115]
v_exp_f32 v176, v176
v_mfma_f32_16x16x32_bf16 v[112:115], a[108:111], v[228:231], v[112:115]
s_waitcnt vmcnt(4)
buffer_load_dwordx4 v25, s[12:15], s60 offen offset:1024 nt lds
v_mfma_f32_16x16x32_bf16 a[48:51], a[60:63], v[188:191], a[48:51]
v_exp_f32 v177, v177
v_mfma_f32_16x16x32_bf16 a[48:51], a[60:63], v[196:199], a[48:51]
v_cvt_pk_bf16_f32 v159, v162, v163
s_waitcnt lgkmcnt(4)
v_mfma_f32_16x16x32_bf16 v[52:55], a[112:115], v[188:191], v[52:55]
v_exp_f32 v178, v178
v_mfma_f32_16x16x32_bf16 v[52:55], a[116:119], v[196:199], v[52:55]
ds_read_b64_tr_b16 a[96:97], v16 offset:16384
ds_read_b64_tr_b16 a[98:99], v16 offset:20480
v_mfma_f32_16x16x32_bf16 v[84:87], a[116:119], v[212:215], v[84:87]
v_cvt_pk_bf16_f32 v174, v176, v177
v_mfma_f32_16x16x32_bf16 v[84:87], a[112:115], v[204:207], v[84:87]
ds_read_b64_tr_b16 a[100:101], v16 offset:24576
ds_read_b64_tr_b16 a[102:103], v16 offset:28672
v_mfma_f32_16x16x32_bf16 v[116:119], a[112:115], v[220:223], v[116:119]
v_exp_f32 v179, v179
v_mfma_f32_16x16x32_bf16 v[116:119], a[116:119], v[228:231], v[116:119]
ds_read_b64_tr_b16 a[104:105], v17 offset:16384
s_waitcnt lgkmcnt(5)
v_mfma_f32_16x16x32_bf16 v[56:59], a[120:123], v[188:191], v[56:59]
v_exp_f32 v148, v148
v_mfma_f32_16x16x32_bf16 v[56:59], a[124:127], v[196:199], v[56:59]
ds_read_b64_tr_b16 a[106:107], v17 offset:20480
ds_read_b64_tr_b16 a[108:109], v17 offset:24576
v_mfma_f32_16x16x32_bf16 v[88:91], a[124:127], v[212:215], v[88:91]
v_exp_f32 v149, v149
v_mfma_f32_16x16x32_bf16 v[88:91], a[120:123], v[204:207], v[88:91]
s_waitcnt vmcnt(4)
buffer_load_dwordx4 v24, s[12:15], s60 offen offset:2048 nt lds
ds_read_b64_tr_b16 a[110:111], v17 offset:28672
v_mfma_f32_16x16x32_bf16 v[120:123], a[120:123], v[220:223], v[120:123]
v_cvt_pk_bf16_f32 v175, v178, v179
v_mfma_f32_16x16x32_bf16 v[120:123], a[124:127], v[228:231], v[120:123]
v_exp_f32 v150, v150
v_mfma_f32_16x16x32_bf16 a[52:55], a[60:63], v[204:207], a[52:55]
v_cvt_pk_bf16_f32 v148, v148, v149
v_mfma_f32_16x16x32_bf16 a[52:55], a[60:63], v[212:215], a[52:55]
ds_read_b64_tr_b16 a[112:113], v18 offset:16384
s_waitcnt lgkmcnt(5)
v_mfma_f32_16x16x32_bf16 v[60:63], a[96:99], v[188:191], v[60:63]
v_exp_f32 v151, v151
v_mfma_f32_16x16x32_bf16 v[60:63], a[100:103], v[196:199], v[60:63]
ds_read_b64_tr_b16 a[114:115], v18 offset:20480
ds_read_b64_tr_b16 a[116:117], v18 offset:24576
v_mfma_f32_16x16x32_bf16 v[92:95], a[100:103], v[212:215], v[92:95]
v_exp_f32 v164, v164
v_mfma_f32_16x16x32_bf16 v[92:95], a[96:99], v[204:207], v[92:95]
ds_read_b64_tr_b16 a[118:119], v18 offset:28672
v_mfma_f32_16x16x32_bf16 v[124:127], a[96:99], v[220:223], v[124:127]
v_exp_f32 v165, v165
v_mfma_f32_16x16x32_bf16 v[124:127], a[100:103], v[228:231], v[124:127]
s_waitcnt vmcnt(3)
buffer_load_dwordx4 v25, s[12:15], s60 offen offset:3072 nt lds
s_waitcnt lgkmcnt(4)
v_mfma_f32_16x16x32_bf16 v[64:67], a[104:107], v[188:191], v[64:67]
s_add_u32 s60, s60, 16384
s_and_b32 s60, s60, 0x7ffff
v_mfma_f32_16x16x32_bf16 v[64:67], a[108:111], v[196:199], v[64:67]
ds_read_b64_tr_b16 a[120:121], v19 offset:16384
ds_read_b64_tr_b16 a[122:123], v19 offset:20480
v_mfma_f32_16x16x32_bf16 v[96:99], a[108:111], v[212:215], v[96:99]
v_cvt_pk_bf16_f32 v149, v150, v151
v_mfma_f32_16x16x32_bf16 v[96:99], a[104:107], v[204:207], v[96:99]
ds_read_b64_tr_b16 a[124:125], v19 offset:24576
s_barrier
ds_read_b64_tr_b16 a[126:127], v19 offset:28672
v_mfma_f32_16x16x32_bf16 v[128:131], a[104:107], v[220:223], v[128:131]
v_exp_f32 v166, v166
v_mfma_f32_16x16x32_bf16 v[128:131], a[108:111], v[228:231], v[128:131]
v_cvt_pk_bf16_f32 v164, v164, v165
v_mfma_f32_16x16x32_bf16 a[56:59], a[60:63], v[220:223], a[56:59]
v_exp_f32 v167, v167
v_mfma_f32_16x16x32_bf16 a[56:59], a[60:63], v[228:231], a[56:59]
ds_read_b128 a[64:67], v8 offset:49152
s_waitcnt lgkmcnt(5)
v_mfma_f32_16x16x32_bf16 v[68:71], a[112:115], v[188:191], v[68:71]
v_exp_f32 v180, v180
v_mfma_f32_16x16x32_bf16 v[68:71], a[116:119], v[196:199], v[68:71]
ds_read_b128 a[68:71], v9 offset:49152
ds_read_b128 a[72:75], v10 offset:49152
v_mfma_f32_16x16x32_bf16 v[100:103], a[116:119], v[212:215], v[100:103]
v_exp_f32 v181, v181
v_mfma_f32_16x16x32_bf16 v[100:103], a[112:115], v[204:207], v[100:103]
v_cvt_pk_bf16_f32 v165, v166, v167
ds_read_b128 a[76:79], v11 offset:49152
v_mfma_f32_16x16x32_bf16 v[132:135], a[112:115], v[220:223], v[132:135]
v_exp_f32 v182, v182
v_mfma_f32_16x16x32_bf16 v[132:135], a[116:119], v[228:231], v[132:135]
v_cvt_pk_bf16_f32 v180, v180, v181
s_waitcnt lgkmcnt(4)
v_mfma_f32_16x16x32_bf16 v[72:75], a[120:123], v[188:191], v[72:75]
v_exp_f32 v183, v183
v_mfma_f32_16x16x32_bf16 v[72:75], a[124:127], v[196:199], v[72:75]
v_exp_f32 v152, v152
v_mfma_f32_16x16x32_bf16 v[104:107], a[124:127], v[212:215], v[104:107]
v_exp_f32 v153, v153
v_mfma_f32_16x16x32_bf16 v[104:107], a[120:123], v[204:207], v[104:107]
v_cvt_pk_bf16_f32 v181, v182, v183
v_mfma_f32_16x16x32_bf16 v[136:139], a[120:123], v[220:223], v[136:139]
v_exp_f32 v154, v154
v_mfma_f32_16x16x32_bf16 v[136:139], a[124:127], v[228:231], v[136:139]
v_cvt_pk_bf16_f32 v150, v152, v153
v_exp_f32 v155, v155
s_waitcnt lgkmcnt(0)
v_mfma_f32_16x16x32_bf16 v[188:191], a[64:67], a[0:3], v[32:35]
v_exp_f32 v168, v168
v_mfma_f32_16x16x32_bf16 v[188:191], a[68:71], a[4:7], v[188:191]
s_add_u32 m0, s65, 32768
v_mfma_f32_16x16x32_bf16 v[188:191], a[72:75], a[8:11], v[188:191]
v_exp_f32 v169, v169
v_mfma_f32_16x16x32_bf16 v[188:191], a[76:79], a[12:15], v[188:191]
ds_read_b128 a[80:83], v8 offset:53248
ds_read_b128 a[84:87], v9 offset:53248
ds_read_b128 a[88:91], v10 offset:53248
v_mfma_f32_16x16x32_bf16 v[204:207], a[76:79], a[28:31], v[36:39]
v_cvt_pk_bf16_f32 v151, v154, v155
v_mfma_f32_16x16x32_bf16 v[204:207], a[72:75], a[24:27], v[204:207]
v_exp_f32 v170, v170
v_mfma_f32_16x16x32_bf16 v[204:207], a[68:71], a[20:23], v[204:207]
v_cvt_pk_bf16_f32 v166, v168, v169
v_mfma_f32_16x16x32_bf16 v[204:207], a[64:67], a[16:19], v[204:207]
buffer_load_dwordx4 v20, s[8:11], s59 offen nt lds
ds_read_b128 a[92:95], v11 offset:53248
v_mfma_f32_16x16x32_bf16 v[220:223], a[64:67], a[32:35], v[40:43]
v_exp_f32 v171, v171
v_mfma_f32_16x16x32_bf16 v[220:223], a[68:71], a[36:39], v[220:223]
v_exp_f32 v184, v184
v_mfma_f32_16x16x32_bf16 v[220:223], a[72:75], a[40:43], v[220:223]
v_exp_f32 v185, v185
v_mfma_f32_16x16x32_bf16 v[220:223], a[76:79], a[44:47], v[220:223]
v_cvt_pk_bf16_f32 v167, v170, v171
s_waitcnt lgkmcnt(0)
v_mfma_f32_16x16x32_bf16 v[192:195], a[80:83], a[0:3], v[32:35]
v_exp_f32 v186, v186
v_mfma_f32_16x16x32_bf16 v[192:195], a[84:87], a[4:7], v[192:195]
v_cvt_pk_bf16_f32 v182, v184, v185
v_mfma_f32_16x16x32_bf16 v[192:195], a[88:91], a[8:11], v[192:195]
v_exp_f32 v187, v187
v_mfma_f32_16x16x32_bf16 v[192:195], a[92:95], a[12:15], v[192:195]
ds_read_b128 a[64:67], v8 offset:57344
s_waitcnt vmcnt(4)
buffer_load_dwordx4 v21, s[8:11], s59 offen offset:1024 nt lds
ds_read_b128 a[68:71], v9 offset:57344
ds_read_b128 a[72:75], v10 offset:57344
v_mfma_f32_16x16x32_bf16 v[208:211], a[92:95], a[28:31], v[36:39]
v_cvt_pk_bf16_f32 v183, v186, v187
v_mfma_f32_16x16x32_bf16 v[208:211], a[88:91], a[24:27], v[208:211]
v_exp_f32 v188, v188
v_mfma_f32_16x16x32_bf16 v[208:211], a[84:87], a[20:23], v[208:211]
v_exp_f32 v189, v189
v_mfma_f32_16x16x32_bf16 v[208:211], a[80:83], a[16:19], v[208:211]
ds_read_b128 a[76:79], v11 offset:57344
v_mfma_f32_16x16x32_bf16 v[224:227], a[80:83], a[32:35], v[40:43]
v_exp_f32 v190, v190
v_mfma_f32_16x16x32_bf16 v[224:227], a[84:87], a[36:39], v[224:227]
v_cvt_pk_bf16_f32 v188, v188, v189
v_mfma_f32_16x16x32_bf16 v[224:227], a[88:91], a[40:43], v[224:227]
v_exp_f32 v191, v191
v_mfma_f32_16x16x32_bf16 v[224:227], a[92:95], a[44:47], v[224:227]
s_waitcnt lgkmcnt(0)
v_mfma_f32_16x16x32_bf16 v[196:199], a[64:67], a[0:3], v[32:35]
v_exp_f32 v204, v204
v_mfma_f32_16x16x32_bf16 v[196:199], a[68:71], a[4:7], v[196:199]
v_exp_f32 v205, v205
v_mfma_f32_16x16x32_bf16 v[196:199], a[72:75], a[8:11], v[196:199]
v_cvt_pk_bf16_f32 v189, v190, v191
v_mfma_f32_16x16x32_bf16 v[196:199], a[76:79], a[12:15], v[196:199]
s_waitcnt vmcnt(4)
buffer_load_dwordx4 v22, s[8:11], s59 offen offset:2048 nt lds
ds_read_b128 a[80:83], v8 offset:61440
ds_read_b128 a[84:87], v9 offset:61440
ds_read_b128 a[88:91], v10 offset:61440
v_mfma_f32_16x16x32_bf16 v[212:215], a[76:79], a[28:31], v[36:39]
v_exp_f32 v206, v206
v_mfma_f32_16x16x32_bf16 v[212:215], a[72:75], a[24:27], v[212:215]
v_cvt_pk_bf16_f32 v204, v204, v205
v_mfma_f32_16x16x32_bf16 v[212:215], a[68:71], a[20:23], v[212:215]
v_exp_f32 v207, v207
v_mfma_f32_16x16x32_bf16 v[212:215], a[64:67], a[16:19], v[212:215]
ds_read_b128 a[92:95], v11 offset:61440
v_mfma_f32_16x16x32_bf16 v[228:231], a[64:67], a[32:35], v[40:43]
v_exp_f32 v220, v220
v_mfma_f32_16x16x32_bf16 v[228:231], a[68:71], a[36:39], v[228:231]
v_exp_f32 v221, v221
v_mfma_f32_16x16x32_bf16 v[228:231], a[72:75], a[40:43], v[228:231]
v_cvt_pk_bf16_f32 v205, v206, v207
v_mfma_f32_16x16x32_bf16 v[228:231], a[76:79], a[44:47], v[228:231]
ds_read_b64_tr_b16 a[96:97], v12 offset:32768
ds_read_b64_tr_b16 a[98:99], v12 offset:36864
s_waitcnt lgkmcnt(2)
v_mfma_f32_16x16x32_bf16 v[200:203], a[80:83], a[0:3], v[32:35]
v_exp_f32 v222, v222
v_mfma_f32_16x16x32_bf16 v[200:203], a[84:87], a[4:7], v[200:203]
v_cvt_pk_bf16_f32 v220, v220, v221
v_mfma_f32_16x16x32_bf16 v[200:203], a[88:91], a[8:11], v[200:203]
v_exp_f32 v223, v223
v_mfma_f32_16x16x32_bf16 v[200:203], a[92:95], a[12:15], v[200:203]
s_waitcnt vmcnt(4)
buffer_load_dwordx4 v23, s[8:11], s59 offen offset:3072 nt lds
s_add_u32 s59, s59, 16384
s_and_b32 s59, s59, 0x7ffff
ds_read_b64_tr_b16 a[100:101], v12 offset:40960
ds_read_b64_tr_b16 a[102:103], v12 offset:45056
v_mfma_f32_16x16x32_bf16 v[216:219], a[92:95], a[28:31], v[36:39]
v_exp_f32 v192, v192
v_mfma_f32_16x16x32_bf16 v[216:219], a[88:91], a[24:27], v[216:219]
v_exp_f32 v193, v193
v_mfma_f32_16x16x32_bf16 v[216:219], a[84:87], a[20:23], v[216:219]
v_cvt_pk_bf16_f32 v221, v222, v223
s_add_u32 m0, s65, 65536
v_mfma_f32_16x16x32_bf16 v[216:219], a[80:83], a[16:19], v[216:219]
ds_read_b64_tr_b16 a[104:105], v13 offset:32768
ds_read_b64_tr_b16 a[106:107], v13 offset:36864
ds_read_b64_tr_b16 a[108:109], v13 offset:40960
ds_read_b64_tr_b16 a[110:111], v13 offset:45056
v_mfma_f32_16x16x32_bf16 v[232:235], a[80:83], a[32:35], v[40:43]
v_exp_f32 v194, v194
v_mfma_f32_16x16x32_bf16 v[232:235], a[84:87], a[36:39], v[232:235]
v_cvt_pk_bf16_f32 v190, v192, v193
v_mfma_f32_16x16x32_bf16 v[232:235], a[88:91], a[40:43], v[232:235]
v_exp_f32 v195, v195
v_mfma_f32_16x16x32_bf16 v[232:235], a[92:95], a[44:47], v[232:235]
ds_read_b64_tr_b16 a[112:113], v14 offset:32768
s_waitcnt lgkmcnt(5)
v_mfma_f32_16x16x32_bf16 v[44:47], a[96:99], v[140:143], v[44:47]
v_exp_f32 v208, v208
v_mfma_f32_16x16x32_bf16 v[44:47], a[100:103], v[148:151], v[44:47]
s_waitcnt vmcnt(4)
buffer_load_dwordx4 v24, s[12:15], s60 offen nt lds
ds_read_b64_tr_b16 a[114:115], v14 offset:36864
v_mfma_f32_16x16x32_bf16 v[76:79], a[100:103], v[164:167], v[76:79]
v_exp_f32 v209, v209
v_mfma_f32_16x16x32_bf16 v[76:79], a[96:99], v[156:159], v[76:79]
ds_read_b64_tr_b16 a[116:117], v14 offset:40960
ds_read_b64_tr_b16 a[118:119], v14 offset:45056
v_mfma_f32_16x16x32_bf16 v[108:111], a[96:99], v[172:175], v[108:111]
v_cvt_pk_bf16_f32 v191, v194, v195
v_mfma_f32_16x16x32_bf16 v[108:111], a[100:103], v[180:183], v[108:111]
ds_read_b64_tr_b16 a[120:121], v15 offset:32768
s_waitcnt lgkmcnt(5)
v_mfma_f32_16x16x32_bf16 v[48:51], a[104:107], v[140:143], v[48:51]
v_exp_f32 v210, v210
v_mfma_f32_16x16x32_bf16 v[48:51], a[108:111], v[148:151], v[48:51]
ds_read_b64_tr_b16 a[122:123], v15 offset:36864
v_cvt_pk_bf16_f32 v206, v208, v209
v_mfma_f32_16x16x32_bf16 v[80:83], a[108:111], v[164:167], v[80:83]
v_exp_f32 v211, v211
v_mfma_f32_16x16x32_bf16 v[80:83], a[104:107], v[156:159], v[80:83]
ds_read_b64_tr_b16 a[124:125], v15 offset:40960
ds_read_b64_tr_b16 a[126:127], v15 offset:45056
v_mfma_f32_16x16x32_bf16 v[112:115], a[104:107], v[172:175], v[112:115]
v_exp_f32 v224, v224
v_mfma_f32_16x16x32_bf16 v[112:115], a[108:111], v[180:183], v[112:115]
s_waitcnt vmcnt(4)
buffer_load_dwordx4 v25, s[12:15], s60 offen offset:1024 nt lds
v_mfma_f32_16x16x32_bf16 a[48:51], a[60:63], v[140:143], a[48:51]
v_exp_f32 v225, v225
v_mfma_f32_16x16x32_bf16 a[48:51], a[60:63], v[148:151], a[48:51]
v_cvt_pk_bf16_f32 v207, v210, v211
s_waitcnt lgkmcnt(4)
v_mfma_f32_16x16x32_bf16 v[52:55], a[112:115], v[140:143], v[52:55]
v_exp_f32 v226, v226
v_mfma_f32_16x16x32_bf16 v[52:55], a[116:119], v[148:151], v[52:55]
ds_read_b64_tr_b16 a[96:97], v16 offset:32768
ds_read_b64_tr_b16 a[98:99], v16 offset:36864
v_mfma_f32_16x16x32_bf16 v[84:87], a[116:119], v[164:167], v[84:87]
v_cvt_pk_bf16_f32 v222, v224, v225
v_mfma_f32_16x16x32_bf16 v[84:87], a[112:115], v[156:159], v[84:87]
ds_read_b64_tr_b16 a[100:101], v16 offset:40960
ds_read_b64_tr_b16 a[102:103], v16 offset:45056
v_mfma_f32_16x16x32_bf16 v[116:119], a[112:115], v[172:175], v[116:119]
v_exp_f32 v227, v227
v_mfma_f32_16x16x32_bf16 v[116:119], a[116:119], v[180:183], v[116:119]
ds_read_b64_tr_b16 a[104:105], v17 offset:32768
s_waitcnt lgkmcnt(5)
v_mfma_f32_16x16x32_bf16 v[56:59], a[120:123], v[140:143], v[56:59]
v_exp_f32 v196, v196
v_mfma_f32_16x16x32_bf16 v[56:59], a[124:127], v[148:151], v[56:59]
ds_read_b64_tr_b16 a[106:107], v17 offset:36864
ds_read_b64_tr_b16 a[108:109], v17 offset:40960
v_mfma_f32_16x16x32_bf16 v[88:91], a[124:127], v[164:167], v[88:91]
v_exp_f32 v197, v197
v_mfma_f32_16x16x32_bf16 v[88:91], a[120:123], v[156:159], v[88:91]
s_waitcnt vmcnt(4)
buffer_load_dwordx4 v24, s[12:15], s60 offen offset:2048 nt lds
ds_read_b64_tr_b16 a[110:111], v17 offset:45056
v_mfma_f32_16x16x32_bf16 v[120:123], a[120:123], v[172:175], v[120:123]
v_cvt_pk_bf16_f32 v223, v226, v227
v_mfma_f32_16x16x32_bf16 v[120:123], a[124:127], v[180:183], v[120:123]
v_exp_f32 v198, v198
v_mfma_f32_16x16x32_bf16 a[52:55], a[60:63], v[156:159], a[52:55]
v_cvt_pk_bf16_f32 v196, v196, v197
v_mfma_f32_16x16x32_bf16 a[52:55], a[60:63], v[164:167], a[52:55]
ds_read_b64_tr_b16 a[112:113], v18 offset:32768
s_waitcnt lgkmcnt(5)
v_mfma_f32_16x16x32_bf16 v[60:63], a[96:99], v[140:143], v[60:63]
v_exp_f32 v199, v199
v_mfma_f32_16x16x32_bf16 v[60:63], a[100:103], v[148:151], v[60:63]
ds_read_b64_tr_b16 a[114:115], v18 offset:36864
ds_read_b64_tr_b16 a[116:117], v18 offset:40960
v_mfma_f32_16x16x32_bf16 v[92:95], a[100:103], v[164:167], v[92:95]
v_exp_f32 v212, v212
v_mfma_f32_16x16x32_bf16 v[92:95], a[96:99], v[156:159], v[92:95]
ds_read_b64_tr_b16 a[118:119], v18 offset:45056
v_mfma_f32_16x16x32_bf16 v[124:127], a[96:99], v[172:175], v[124:127]
v_exp_f32 v213, v213
v_mfma_f32_16x16x32_bf16 v[124:127], a[100:103], v[180:183], v[124:127]
s_waitcnt vmcnt(3)
buffer_load_dwordx4 v25, s[12:15], s60 offen offset:3072 nt lds
s_waitcnt lgkmcnt(4)
v_mfma_f32_16x16x32_bf16 v[64:67], a[104:107], v[140:143], v[64:67]
s_add_u32 s60, s60, 16384
s_and_b32 s60, s60, 0x7ffff
v_mfma_f32_16x16x32_bf16 v[64:67], a[108:111], v[148:151], v[64:67]
ds_read_b64_tr_b16 a[120:121], v19 offset:32768
ds_read_b64_tr_b16 a[122:123], v19 offset:36864
v_mfma_f32_16x16x32_bf16 v[96:99], a[108:111], v[164:167], v[96:99]
v_cvt_pk_bf16_f32 v197, v198, v199
v_mfma_f32_16x16x32_bf16 v[96:99], a[104:107], v[156:159], v[96:99]
ds_read_b64_tr_b16 a[124:125], v19 offset:40960
s_barrier
ds_read_b64_tr_b16 a[126:127], v19 offset:45056
v_mfma_f32_16x16x32_bf16 v[128:131], a[104:107], v[172:175], v[128:131]
v_exp_f32 v214, v214
v_mfma_f32_16x16x32_bf16 v[128:131], a[108:111], v[180:183], v[128:131]
v_cvt_pk_bf16_f32 v212, v212, v213
v_mfma_f32_16x16x32_bf16 a[56:59], a[60:63], v[172:175], a[56:59]
v_exp_f32 v215, v215
v_mfma_f32_16x16x32_bf16 a[56:59], a[60:63], v[180:183], a[56:59]
ds_read_b128 a[64:67], v8 offset:0
s_waitcnt lgkmcnt(5)
v_mfma_f32_16x16x32_bf16 v[68:71], a[112:115], v[140:143], v[68:71]
v_exp_f32 v228, v228
v_mfma_f32_16x16x32_bf16 v[68:71], a[116:119], v[148:151], v[68:71]
ds_read_b128 a[68:71], v9 offset:0
ds_read_b128 a[72:75], v10 offset:0
v_mfma_f32_16x16x32_bf16 v[100:103], a[116:119], v[164:167], v[100:103]
v_exp_f32 v229, v229
v_mfma_f32_16x16x32_bf16 v[100:103], a[112:115], v[156:159], v[100:103]
v_cvt_pk_bf16_f32 v213, v214, v215
ds_read_b128 a[76:79], v11 offset:0
v_mfma_f32_16x16x32_bf16 v[132:135], a[112:115], v[172:175], v[132:135]
v_exp_f32 v230, v230
v_mfma_f32_16x16x32_bf16 v[132:135], a[116:119], v[180:183], v[132:135]
v_cvt_pk_bf16_f32 v228, v228, v229
s_waitcnt lgkmcnt(4)
v_mfma_f32_16x16x32_bf16 v[72:75], a[120:123], v[140:143], v[72:75]
v_exp_f32 v231, v231
v_mfma_f32_16x16x32_bf16 v[72:75], a[124:127], v[148:151], v[72:75]
v_exp_f32 v200, v200
v_mfma_f32_16x16x32_bf16 v[104:107], a[124:127], v[164:167], v[104:107]
v_exp_f32 v201, v201
v_mfma_f32_16x16x32_bf16 v[104:107], a[120:123], v[156:159], v[104:107]
v_cvt_pk_bf16_f32 v229, v230, v231
v_mfma_f32_16x16x32_bf16 v[136:139], a[120:123], v[172:175], v[136:139]
v_exp_f32 v202, v202
v_mfma_f32_16x16x32_bf16 v[136:139], a[124:127], v[180:183], v[136:139]
v_cvt_pk_bf16_f32 v198, v200, v201
v_exp_f32 v203, v203
s_waitcnt lgkmcnt(0)
v_mfma_f32_16x16x32_bf16 v[140:143], a[64:67], a[0:3], v[32:35]
v_exp_f32 v216, v216
v_mfma_f32_16x16x32_bf16 v[140:143], a[68:71], a[4:7], v[140:143]
s_add_u32 m0, s65, 49152
v_mfma_f32_16x16x32_bf16 v[140:143], a[72:75], a[8:11], v[140:143]
v_exp_f32 v217, v217
v_mfma_f32_16x16x32_bf16 v[140:143], a[76:79], a[12:15], v[140:143]
ds_read_b128 a[80:83], v8 offset:4096
ds_read_b128 a[84:87], v9 offset:4096
ds_read_b128 a[88:91], v10 offset:4096
v_mfma_f32_16x16x32_bf16 v[156:159], a[76:79], a[28:31], v[36:39]
v_cvt_pk_bf16_f32 v199, v202, v203
v_mfma_f32_16x16x32_bf16 v[156:159], a[72:75], a[24:27], v[156:159]
v_exp_f32 v218, v218
v_mfma_f32_16x16x32_bf16 v[156:159], a[68:71], a[20:23], v[156:159]
v_cvt_pk_bf16_f32 v214, v216, v217
v_mfma_f32_16x16x32_bf16 v[156:159], a[64:67], a[16:19], v[156:159]
buffer_load_dwordx4 v20, s[8:11], s59 offen nt lds
ds_read_b128 a[92:95], v11 offset:4096
v_mfma_f32_16x16x32_bf16 v[172:175], a[64:67], a[32:35], v[40:43]
v_exp_f32 v219, v219
v_mfma_f32_16x16x32_bf16 v[172:175], a[68:71], a[36:39], v[172:175]
v_exp_f32 v232, v232
v_mfma_f32_16x16x32_bf16 v[172:175], a[72:75], a[40:43], v[172:175]
v_exp_f32 v233, v233
v_mfma_f32_16x16x32_bf16 v[172:175], a[76:79], a[44:47], v[172:175]
v_cvt_pk_bf16_f32 v215, v218, v219
s_waitcnt lgkmcnt(0)
v_mfma_f32_16x16x32_bf16 v[144:147], a[80:83], a[0:3], v[32:35]
v_exp_f32 v234, v234
v_mfma_f32_16x16x32_bf16 v[144:147], a[84:87], a[4:7], v[144:147]
v_cvt_pk_bf16_f32 v230, v232, v233
v_mfma_f32_16x16x32_bf16 v[144:147], a[88:91], a[8:11], v[144:147]
v_exp_f32 v235, v235
v_mfma_f32_16x16x32_bf16 v[144:147], a[92:95], a[12:15], v[144:147]
ds_read_b128 a[64:67], v8 offset:8192
s_waitcnt vmcnt(4)
buffer_load_dwordx4 v21, s[8:11], s59 offen offset:1024 nt lds
ds_read_b128 a[68:71], v9 offset:8192
ds_read_b128 a[72:75], v10 offset:8192
v_mfma_f32_16x16x32_bf16 v[160:163], a[92:95], a[28:31], v[36:39]
v_cvt_pk_bf16_f32 v231, v234, v235
v_mfma_f32_16x16x32_bf16 v[160:163], a[88:91], a[24:27], v[160:163]
v_exp_f32 v140, v140
v_mfma_f32_16x16x32_bf16 v[160:163], a[84:87], a[20:23], v[160:163]
v_exp_f32 v141, v141
v_mfma_f32_16x16x32_bf16 v[160:163], a[80:83], a[16:19], v[160:163]
ds_read_b128 a[76:79], v11 offset:8192
v_mfma_f32_16x16x32_bf16 v[176:179], a[80:83], a[32:35], v[40:43]
v_exp_f32 v142, v142
v_mfma_f32_16x16x32_bf16 v[176:179], a[84:87], a[36:39], v[176:179]
v_cvt_pk_bf16_f32 v140, v140, v141
v_mfma_f32_16x16x32_bf16 v[176:179], a[88:91], a[40:43], v[176:179]
v_exp_f32 v143, v143
v_mfma_f32_16x16x32_bf16 v[176:179], a[92:95], a[44:47], v[176:179]
s_waitcnt lgkmcnt(0)
v_mfma_f32_16x16x32_bf16 v[148:151], a[64:67], a[0:3], v[32:35]
v_exp_f32 v156, v156
v_mfma_f32_16x16x32_bf16 v[148:151], a[68:71], a[4:7], v[148:151]
v_exp_f32 v157, v157
v_mfma_f32_16x16x32_bf16 v[148:151], a[72:75], a[8:11], v[148:151]
v_cvt_pk_bf16_f32 v141, v142, v143
v_mfma_f32_16x16x32_bf16 v[148:151], a[76:79], a[12:15], v[148:151]
s_waitcnt vmcnt(4)
buffer_load_dwordx4 v22, s[8:11], s59 offen offset:2048 nt lds
ds_read_b128 a[80:83], v8 offset:12288
ds_read_b128 a[84:87], v9 offset:12288
ds_read_b128 a[88:91], v10 offset:12288
v_mfma_f32_16x16x32_bf16 v[164:167], a[76:79], a[28:31], v[36:39]
v_exp_f32 v158, v158
v_mfma_f32_16x16x32_bf16 v[164:167], a[72:75], a[24:27], v[164:167]
v_cvt_pk_bf16_f32 v156, v156, v157
v_mfma_f32_16x16x32_bf16 v[164:167], a[68:71], a[20:23], v[164:167]
v_exp_f32 v159, v159
v_mfma_f32_16x16x32_bf16 v[164:167], a[64:67], a[16:19], v[164:167]
ds_read_b128 a[92:95], v11 offset:12288
v_mfma_f32_16x16x32_bf16 v[180:183], a[64:67], a[32:35], v[40:43]
v_exp_f32 v172, v172
v_mfma_f32_16x16x32_bf16 v[180:183], a[68:71], a[36:39], v[180:183]
v_exp_f32 v173, v173
v_mfma_f32_16x16x32_bf16 v[180:183], a[72:75], a[40:43], v[180:183]
v_cvt_pk_bf16_f32 v157, v158, v159
v_mfma_f32_16x16x32_bf16 v[180:183], a[76:79], a[44:47], v[180:183]
ds_read_b64_tr_b16 a[96:97], v12 offset:49152
ds_read_b64_tr_b16 a[98:99], v12 offset:53248
s_waitcnt lgkmcnt(2)
v_mfma_f32_16x16x32_bf16 v[152:155], a[80:83], a[0:3], v[32:35]
v_exp_f32 v174, v174
v_mfma_f32_16x16x32_bf16 v[152:155], a[84:87], a[4:7], v[152:155]
v_cvt_pk_bf16_f32 v172, v172, v173
v_mfma_f32_16x16x32_bf16 v[152:155], a[88:91], a[8:11], v[152:155]
v_exp_f32 v175, v175
v_mfma_f32_16x16x32_bf16 v[152:155], a[92:95], a[12:15], v[152:155]
s_waitcnt vmcnt(4)
buffer_load_dwordx4 v23, s[8:11], s59 offen offset:3072 nt lds
s_add_u32 s59, s59, 16384
s_and_b32 s59, s59, 0x7ffff
ds_read_b64_tr_b16 a[100:101], v12 offset:57344
ds_read_b64_tr_b16 a[102:103], v12 offset:61440
v_mfma_f32_16x16x32_bf16 v[168:171], a[92:95], a[28:31], v[36:39]
v_exp_f32 v144, v144
v_mfma_f32_16x16x32_bf16 v[168:171], a[88:91], a[24:27], v[168:171]
v_exp_f32 v145, v145
v_mfma_f32_16x16x32_bf16 v[168:171], a[84:87], a[20:23], v[168:171]
v_cvt_pk_bf16_f32 v173, v174, v175
s_add_u32 m0, s65, 81920
v_mfma_f32_16x16x32_bf16 v[168:171], a[80:83], a[16:19], v[168:171]
ds_read_b64_tr_b16 a[104:105], v13 offset:49152
ds_read_b64_tr_b16 a[106:107], v13 offset:53248
ds_read_b64_tr_b16 a[108:109], v13 offset:57344
ds_read_b64_tr_b16 a[110:111], v13 offset:61440
v_mfma_f32_16x16x32_bf16 v[184:187], a[80:83], a[32:35], v[40:43]
v_exp_f32 v146, v146
v_mfma_f32_16x16x32_bf16 v[184:187], a[84:87], a[36:39], v[184:187]
v_cvt_pk_bf16_f32 v142, v144, v145
v_mfma_f32_16x16x32_bf16 v[184:187], a[88:91], a[40:43], v[184:187]
v_exp_f32 v147, v147
v_mfma_f32_16x16x32_bf16 v[184:187], a[92:95], a[44:47], v[184:187]
ds_read_b64_tr_b16 a[112:113], v14 offset:49152
s_waitcnt lgkmcnt(5)
v_mfma_f32_16x16x32_bf16 v[44:47], a[96:99], v[188:191], v[44:47]
v_exp_f32 v160, v160
v_mfma_f32_16x16x32_bf16 v[44:47], a[100:103], v[196:199], v[44:47]
s_waitcnt vmcnt(4)
buffer_load_dwordx4 v24, s[12:15], s60 offen nt lds
ds_read_b64_tr_b16 a[114:115], v14 offset:53248
v_mfma_f32_16x16x32_bf16 v[76:79], a[100:103], v[212:215], v[76:79]
v_exp_f32 v161, v161
v_mfma_f32_16x16x32_bf16 v[76:79], a[96:99], v[204:207], v[76:79]
ds_read_b64_tr_b16 a[116:117], v14 offset:57344
ds_read_b64_tr_b16 a[118:119], v14 offset:61440
v_mfma_f32_16x16x32_bf16 v[108:111], a[96:99], v[220:223], v[108:111]
v_cvt_pk_bf16_f32 v143, v146, v147
v_mfma_f32_16x16x32_bf16 v[108:111], a[100:103], v[228:231], v[108:111]
ds_read_b64_tr_b16 a[120:121], v15 offset:49152
s_waitcnt lgkmcnt(5)
v_mfma_f32_16x16x32_bf16 v[48:51], a[104:107], v[188:191], v[48:51]
v_exp_f32 v162, v162
v_mfma_f32_16x16x32_bf16 v[48:51], a[108:111], v[196:199], v[48:51]
ds_read_b64_tr_b16 a[122:123], v15 offset:53248
v_cvt_pk_bf16_f32 v158, v160, v161
v_mfma_f32_16x16x32_bf16 v[80:83], a[108:111], v[212:215], v[80:83]
v_exp_f32 v163, v163
v_mfma_f32_16x16x32_bf16 v[80:83], a[104:107], v[204:207], v[80:83]
ds_read_b64_tr_b16 a[124:125], v15 offset:57344
ds_read_b64_tr_b16 a[126:127], v15 offset:61440
v_mfma_f32_16x16x32_bf16 v[112:115], a[104:107], v[220:223], v[112:115]
v_exp_f32 v176, v176
v_mfma_f32_16x16x32_bf16 v[112:115], a[108:111], v[228:231], v[112:115]
s_waitcnt vmcnt(4)
buffer_load_dwordx4 v25, s[12:15], s60 offen offset:1024 nt lds
v_mfma_f32_16x16x32_bf16 a[48:51], a[60:63], v[188:191], a[48:51]
v_exp_f32 v177, v177
v_mfma_f32_16x16x32_bf16 a[48:51], a[60:63], v[196:199], a[48:51]
v_cvt_pk_bf16_f32 v159, v162, v163
s_waitcnt lgkmcnt(4)
v_mfma_f32_16x16x32_bf16 v[52:55], a[112:115], v[188:191], v[52:55]
v_exp_f32 v178, v178
v_mfma_f32_16x16x32_bf16 v[52:55], a[116:119], v[196:199], v[52:55]
ds_read_b64_tr_b16 a[96:97], v16 offset:49152
ds_read_b64_tr_b16 a[98:99], v16 offset:53248
v_mfma_f32_16x16x32_bf16 v[84:87], a[116:119], v[212:215], v[84:87]
v_cvt_pk_bf16_f32 v174, v176, v177
v_mfma_f32_16x16x32_bf16 v[84:87], a[112:115], v[204:207], v[84:87]
ds_read_b64_tr_b16 a[100:101], v16 offset:57344
ds_read_b64_tr_b16 a[102:103], v16 offset:61440
v_mfma_f32_16x16x32_bf16 v[116:119], a[112:115], v[220:223], v[116:119]
v_exp_f32 v179, v179
v_mfma_f32_16x16x32_bf16 v[116:119], a[116:119], v[228:231], v[116:119]
ds_read_b64_tr_b16 a[104:105], v17 offset:49152
s_waitcnt lgkmcnt(5)
v_mfma_f32_16x16x32_bf16 v[56:59], a[120:123], v[188:191], v[56:59]
v_exp_f32 v148, v148
v_mfma_f32_16x16x32_bf16 v[56:59], a[124:127], v[196:199], v[56:59]
ds_read_b64_tr_b16 a[106:107], v17 offset:53248
ds_read_b64_tr_b16 a[108:109], v17 offset:57344
v_mfma_f32_16x16x32_bf16 v[88:91], a[124:127], v[212:215], v[88:91]
v_exp_f32 v149, v149
v_mfma_f32_16x16x32_bf16 v[88:91], a[120:123], v[204:207], v[88:91]
s_waitcnt vmcnt(4)
buffer_load_dwordx4 v24, s[12:15], s60 offen offset:2048 nt lds
ds_read_b64_tr_b16 a[110:111], v17 offset:61440
v_mfma_f32_16x16x32_bf16 v[120:123], a[120:123], v[220:223], v[120:123]
v_cvt_pk_bf16_f32 v175, v178, v179
v_mfma_f32_16x16x32_bf16 v[120:123], a[124:127], v[228:231], v[120:123]
v_exp_f32 v150, v150
v_mfma_f32_16x16x32_bf16 a[52:55], a[60:63], v[204:207], a[52:55]
v_cvt_pk_bf16_f32 v148, v148, v149
v_mfma_f32_16x16x32_bf16 a[52:55], a[60:63], v[212:215], a[52:55]
ds_read_b64_tr_b16 a[112:113], v18 offset:49152
s_waitcnt lgkmcnt(5)
v_mfma_f32_16x16x32_bf16 v[60:63], a[96:99], v[188:191], v[60:63]
v_exp_f32 v151, v151
v_mfma_f32_16x16x32_bf16 v[60:63], a[100:103], v[196:199], v[60:63]
ds_read_b64_tr_b16 a[114:115], v18 offset:53248
ds_read_b64_tr_b16 a[116:117], v18 offset:57344
v_mfma_f32_16x16x32_bf16 v[92:95], a[100:103], v[212:215], v[92:95]
v_exp_f32 v164, v164
v_mfma_f32_16x16x32_bf16 v[92:95], a[96:99], v[204:207], v[92:95]
ds_read_b64_tr_b16 a[118:119], v18 offset:61440
v_mfma_f32_16x16x32_bf16 v[124:127], a[96:99], v[220:223], v[124:127]
v_exp_f32 v165, v165
v_mfma_f32_16x16x32_bf16 v[124:127], a[100:103], v[228:231], v[124:127]
s_waitcnt vmcnt(3)
buffer_load_dwordx4 v25, s[12:15], s60 offen offset:3072 nt lds
s_waitcnt lgkmcnt(4)
v_mfma_f32_16x16x32_bf16 v[64:67], a[104:107], v[188:191], v[64:67]
s_add_u32 s60, s60, 16384
s_and_b32 s60, s60, 0x7ffff
v_mfma_f32_16x16x32_bf16 v[64:67], a[108:111], v[196:199], v[64:67]
ds_read_b64_tr_b16 a[120:121], v19 offset:49152
ds_read_b64_tr_b16 a[122:123], v19 offset:53248
v_mfma_f32_16x16x32_bf16 v[96:99], a[108:111], v[212:215], v[96:99]
v_cvt_pk_bf16_f32 v149, v150, v151
v_mfma_f32_16x16x32_bf16 v[96:99], a[104:107], v[204:207], v[96:99]
ds_read_b64_tr_b16 a[124:125], v19 offset:57344
s_barrier
ds_read_b64_tr_b16 a[126:127], v19 offset:61440
v_mfma_f32_16x16x32_bf16 v[128:131], a[104:107], v[220:223], v[128:131]
v_exp_f32 v166, v166
v_mfma_f32_16x16x32_bf16 v[128:131], a[108:111], v[228:231], v[128:131]
v_cvt_pk_bf16_f32 v164, v164, v165
v_mfma_f32_16x16x32_bf16 a[56:59], a[60:63], v[220:223], a[56:59]
v_exp_f32 v167, v167
v_mfma_f32_16x16x32_bf16 a[56:59], a[60:63], v[228:231], a[56:59]
ds_read_b128 a[64:67], v8 offset:16384
s_waitcnt lgkmcnt(5)
v_mfma_f32_16x16x32_bf16 v[68:71], a[112:115], v[188:191], v[68:71]
v_exp_f32 v180, v180
v_mfma_f32_16x16x32_bf16 v[68:71], a[116:119], v[196:199], v[68:71]
ds_read_b128 a[68:71], v9 offset:16384
ds_read_b128 a[72:75], v10 offset:16384
v_mfma_f32_16x16x32_bf16 v[100:103], a[116:119], v[212:215], v[100:103]
v_exp_f32 v181, v181
v_mfma_f32_16x16x32_bf16 v[100:103], a[112:115], v[204:207], v[100:103]
v_cvt_pk_bf16_f32 v165, v166, v167
ds_read_b128 a[76:79], v11 offset:16384
v_mfma_f32_16x16x32_bf16 v[132:135], a[112:115], v[220:223], v[132:135]
v_exp_f32 v182, v182
v_mfma_f32_16x16x32_bf16 v[132:135], a[116:119], v[228:231], v[132:135]
v_cvt_pk_bf16_f32 v180, v180, v181
s_waitcnt lgkmcnt(4)
v_mfma_f32_16x16x32_bf16 v[72:75], a[120:123], v[188:191], v[72:75]
v_exp_f32 v183, v183
v_mfma_f32_16x16x32_bf16 v[72:75], a[124:127], v[196:199], v[72:75]
v_exp_f32 v152, v152
v_mfma_f32_16x16x32_bf16 v[104:107], a[124:127], v[212:215], v[104:107]
v_exp_f32 v153, v153
v_mfma_f32_16x16x32_bf16 v[104:107], a[120:123], v[204:207], v[104:107]
v_cvt_pk_bf16_f32 v181, v182, v183
v_mfma_f32_16x16x32_bf16 v[136:139], a[120:123], v[220:223], v[136:139]
v_exp_f32 v154, v154
v_mfma_f32_16x16x32_bf16 v[136:139], a[124:127], v[228:231], v[136:139]
v_cvt_pk_bf16_f32 v150, v152, v153
v_exp_f32 v155, v155
s_waitcnt lgkmcnt(0)
v_mfma_f32_16x16x32_bf16 v[188:191], a[64:67], a[0:3], v[32:35]
v_exp_f32 v168, v168
v_mfma_f32_16x16x32_bf16 v[188:191], a[68:71], a[4:7], v[188:191]
s_add_u32 m0, s65, 0
v_mfma_f32_16x16x32_bf16 v[188:191], a[72:75], a[8:11], v[188:191]
v_exp_f32 v169, v169
v_mfma_f32_16x16x32_bf16 v[188:191], a[76:79], a[12:15], v[188:191]
ds_read_b128 a[80:83], v8 offset:20480
ds_read_b128 a[84:87], v9 offset:20480
ds_read_b128 a[88:91], v10 offset:20480
v_mfma_f32_16x16x32_bf16 v[204:207], a[76:79], a[28:31], v[36:39]
v_cvt_pk_bf16_f32 v151, v154, v155
v_mfma_f32_16x16x32_bf16 v[204:207], a[72:75], a[24:27], v[204:207]
v_exp_f32 v170, v170
v_mfma_f32_16x16x32_bf16 v[204:207], a[68:71], a[20:23], v[204:207]
v_cvt_pk_bf16_f32 v166, v168, v169
v_mfma_f32_16x16x32_bf16 v[204:207], a[64:67], a[16:19], v[204:207]
buffer_load_dwordx4 v20, s[8:11], s59 offen nt lds
ds_read_b128 a[92:95], v11 offset:20480
v_mfma_f32_16x16x32_bf16 v[220:223], a[64:67], a[32:35], v[40:43]
v_exp_f32 v171, v171
v_mfma_f32_16x16x32_bf16 v[220:223], a[68:71], a[36:39], v[220:223]
v_exp_f32 v184, v184
v_mfma_f32_16x16x32_bf16 v[220:223], a[72:75], a[40:43], v[220:223]
v_exp_f32 v185, v185
v_mfma_f32_16x16x32_bf16 v[220:223], a[76:79], a[44:47], v[220:223]
v_cvt_pk_bf16_f32 v167, v170, v171
s_waitcnt lgkmcnt(0)
v_mfma_f32_16x16x32_bf16 v[192:195], a[80:83], a[0:3], v[32:35]
v_exp_f32 v186, v186
v_mfma_f32_16x16x32_bf16 v[192:195], a[84:87], a[4:7], v[192:195]
v_cvt_pk_bf16_f32 v182, v184, v185
v_mfma_f32_16x16x32_bf16 v[192:195], a[88:91], a[8:11], v[192:195]
v_exp_f32 v187, v187
v_mfma_f32_16x16x32_bf16 v[192:195], a[92:95], a[12:15], v[192:195]
ds_read_b128 a[64:67], v8 offset:24576
s_waitcnt vmcnt(4)
buffer_load_dwordx4 v21, s[8:11], s59 offen offset:1024 nt lds
ds_read_b128 a[68:71], v9 offset:24576
ds_read_b128 a[72:75], v10 offset:24576
v_mfma_f32_16x16x32_bf16 v[208:211], a[92:95], a[28:31], v[36:39]
v_cvt_pk_bf16_f32 v183, v186, v187
v_mfma_f32_16x16x32_bf16 v[208:211], a[88:91], a[24:27], v[208:211]
v_exp_f32 v188, v188
v_mfma_f32_16x16x32_bf16 v[208:211], a[84:87], a[20:23], v[208:211]
v_exp_f32 v189, v189
v_mfma_f32_16x16x32_bf16 v[208:211], a[80:83], a[16:19], v[208:211]
ds_read_b128 a[76:79], v11 offset:24576
v_mfma_f32_16x16x32_bf16 v[224:227], a[80:83], a[32:35], v[40:43]
v_exp_f32 v190, v190
v_mfma_f32_16x16x32_bf16 v[224:227], a[84:87], a[36:39], v[224:227]
v_cvt_pk_bf16_f32 v188, v188, v189
v_mfma_f32_16x16x32_bf16 v[224:227], a[88:91], a[40:43], v[224:227]
v_exp_f32 v191, v191
v_mfma_f32_16x16x32_bf16 v[224:227], a[92:95], a[44:47], v[224:227]
s_waitcnt lgkmcnt(0)
v_mfma_f32_16x16x32_bf16 v[196:199], a[64:67], a[0:3], v[32:35]
v_exp_f32 v204, v204
v_mfma_f32_16x16x32_bf16 v[196:199], a[68:71], a[4:7], v[196:199]
v_exp_f32 v205, v205
v_mfma_f32_16x16x32_bf16 v[196:199], a[72:75], a[8:11], v[196:199]
v_cvt_pk_bf16_f32 v189, v190, v191
v_mfma_f32_16x16x32_bf16 v[196:199], a[76:79], a[12:15], v[196:199]
s_waitcnt vmcnt(4)
buffer_load_dwordx4 v22, s[8:11], s59 offen offset:2048 nt lds
ds_read_b128 a[80:83], v8 offset:28672
ds_read_b128 a[84:87], v9 offset:28672
ds_read_b128 a[88:91], v10 offset:28672
v_mfma_f32_16x16x32_bf16 v[212:215], a[76:79], a[28:31], v[36:39]
v_exp_f32 v206, v206
v_mfma_f32_16x16x32_bf16 v[212:215], a[72:75], a[24:27], v[212:215]
v_cvt_pk_bf16_f32 v204, v204, v205
v_mfma_f32_16x16x32_bf16 v[212:215], a[68:71], a[20:23], v[212:215]
v_exp_f32 v207, v207
v_mfma_f32_16x16x32_bf16 v[212:215], a[64:67], a[16:19], v[212:215]
ds_read_b128 a[92:95], v11 offset:28672
v_mfma_f32_16x16x32_bf16 v[228:231], a[64:67], a[32:35], v[40:43]
v_exp_f32 v220, v220
v_mfma_f32_16x16x32_bf16 v[228:231], a[68:71], a[36:39], v[228:231]
v_exp_f32 v221, v221
v_mfma_f32_16x16x32_bf16 v[228:231], a[72:75], a[40:43], v[228:231]
v_cvt_pk_bf16_f32 v205, v206, v207
v_mfma_f32_16x16x32_bf16 v[228:231], a[76:79], a[44:47], v[228:231]
ds_read_b64_tr_b16 a[96:97], v12 offset:0
ds_read_b64_tr_b16 a[98:99], v12 offset:4096
s_waitcnt lgkmcnt(2)
v_mfma_f32_16x16x32_bf16 v[200:203], a[80:83], a[0:3], v[32:35]
v_exp_f32 v222, v222
v_mfma_f32_16x16x32_bf16 v[200:203], a[84:87], a[4:7], v[200:203]
v_cvt_pk_bf16_f32 v220, v220, v221
v_mfma_f32_16x16x32_bf16 v[200:203], a[88:91], a[8:11], v[200:203]
v_exp_f32 v223, v223
v_mfma_f32_16x16x32_bf16 v[200:203], a[92:95], a[12:15], v[200:203]
s_waitcnt vmcnt(4)
buffer_load_dwordx4 v23, s[8:11], s59 offen offset:3072 nt lds
s_add_u32 s59, s59, 16384
s_and_b32 s59, s59, 0x7ffff
ds_read_b64_tr_b16 a[100:101], v12 offset:8192
ds_read_b64_tr_b16 a[102:103], v12 offset:12288
v_mfma_f32_16x16x32_bf16 v[216:219], a[92:95], a[28:31], v[36:39]
v_exp_f32 v192, v192
v_mfma_f32_16x16x32_bf16 v[216:219], a[88:91], a[24:27], v[216:219]
v_exp_f32 v193, v193
v_mfma_f32_16x16x32_bf16 v[216:219], a[84:87], a[20:23], v[216:219]
v_cvt_pk_bf16_f32 v221, v222, v223
s_add_u32 m0, s65, 98304
v_mfma_f32_16x16x32_bf16 v[216:219], a[80:83], a[16:19], v[216:219]
ds_read_b64_tr_b16 a[104:105], v13 offset:0
ds_read_b64_tr_b16 a[106:107], v13 offset:4096
ds_read_b64_tr_b16 a[108:109], v13 offset:8192
ds_read_b64_tr_b16 a[110:111], v13 offset:12288
v_mfma_f32_16x16x32_bf16 v[232:235], a[80:83], a[32:35], v[40:43]
v_exp_f32 v194, v194
v_mfma_f32_16x16x32_bf16 v[232:235], a[84:87], a[36:39], v[232:235]
v_cvt_pk_bf16_f32 v190, v192, v193
v_mfma_f32_16x16x32_bf16 v[232:235], a[88:91], a[40:43], v[232:235]
v_exp_f32 v195, v195
v_mfma_f32_16x16x32_bf16 v[232:235], a[92:95], a[44:47], v[232:235]
ds_read_b64_tr_b16 a[112:113], v14 offset:0
s_waitcnt lgkmcnt(5)
v_mfma_f32_16x16x32_bf16 v[44:47], a[96:99], v[140:143], v[44:47]
v_exp_f32 v208, v208
v_mfma_f32_16x16x32_bf16 v[44:47], a[100:103], v[148:151], v[44:47]
s_waitcnt vmcnt(4)
buffer_load_dwordx4 v24, s[12:15], s60 offen nt lds
ds_read_b64_tr_b16 a[114:115], v14 offset:4096
v_mfma_f32_16x16x32_bf16 v[76:79], a[100:103], v[164:167], v[76:79]
v_exp_f32 v209, v209
v_mfma_f32_16x16x32_bf16 v[76:79], a[96:99], v[156:159], v[76:79]
ds_read_b64_tr_b16 a[116:117], v14 offset:8192
ds_read_b64_tr_b16 a[118:119], v14 offset:12288
v_mfma_f32_16x16x32_bf16 v[108:111], a[96:99], v[172:175], v[108:111]
v_cvt_pk_bf16_f32 v191, v194, v195
v_mfma_f32_16x16x32_bf16 v[108:111], a[100:103], v[180:183], v[108:111]
ds_read_b64_tr_b16 a[120:121], v15 offset:0
s_waitcnt lgkmcnt(5)
v_mfma_f32_16x16x32_bf16 v[48:51], a[104:107], v[140:143], v[48:51]
v_exp_f32 v210, v210
v_mfma_f32_16x16x32_bf16 v[48:51], a[108:111], v[148:151], v[48:51]
ds_read_b64_tr_b16 a[122:123], v15 offset:4096
v_cvt_pk_bf16_f32 v206, v208, v209
v_mfma_f32_16x16x32_bf16 v[80:83], a[108:111], v[164:167], v[80:83]
v_exp_f32 v211, v211
v_mfma_f32_16x16x32_bf16 v[80:83], a[104:107], v[156:159], v[80:83]
ds_read_b64_tr_b16 a[124:125], v15 offset:8192
ds_read_b64_tr_b16 a[126:127], v15 offset:12288
v_mfma_f32_16x16x32_bf16 v[112:115], a[104:107], v[172:175], v[112:115]
v_exp_f32 v224, v224
v_mfma_f32_16x16x32_bf16 v[112:115], a[108:111], v[180:183], v[112:115]
s_waitcnt vmcnt(4)
buffer_load_dwordx4 v25, s[12:15], s60 offen offset:1024 nt lds
v_mfma_f32_16x16x32_bf16 a[48:51], a[60:63], v[140:143], a[48:51]
v_exp_f32 v225, v225
v_mfma_f32_16x16x32_bf16 a[48:51], a[60:63], v[148:151], a[48:51]
v_cvt_pk_bf16_f32 v207, v210, v211
s_waitcnt lgkmcnt(4)
v_mfma_f32_16x16x32_bf16 v[52:55], a[112:115], v[140:143], v[52:55]
v_exp_f32 v226, v226
v_mfma_f32_16x16x32_bf16 v[52:55], a[116:119], v[148:151], v[52:55]
ds_read_b64_tr_b16 a[96:97], v16 offset:0
ds_read_b64_tr_b16 a[98:99], v16 offset:4096
v_mfma_f32_16x16x32_bf16 v[84:87], a[116:119], v[164:167], v[84:87]
v_cvt_pk_bf16_f32 v222, v224, v225
v_mfma_f32_16x16x32_bf16 v[84:87], a[112:115], v[156:159], v[84:87]
ds_read_b64_tr_b16 a[100:101], v16 offset:8192
ds_read_b64_tr_b16 a[102:103], v16 offset:12288
v_mfma_f32_16x16x32_bf16 v[116:119], a[112:115], v[172:175], v[116:119]
v_exp_f32 v227, v227
v_mfma_f32_16x16x32_bf16 v[116:119], a[116:119], v[180:183], v[116:119]
ds_read_b64_tr_b16 a[104:105], v17 offset:0
s_waitcnt lgkmcnt(5)
v_mfma_f32_16x16x32_bf16 v[56:59], a[120:123], v[140:143], v[56:59]
v_exp_f32 v196, v196
v_mfma_f32_16x16x32_bf16 v[56:59], a[124:127], v[148:151], v[56:59]
ds_read_b64_tr_b16 a[106:107], v17 offset:4096
ds_read_b64_tr_b16 a[108:109], v17 offset:8192
v_mfma_f32_16x16x32_bf16 v[88:91], a[124:127], v[164:167], v[88:91]
v_exp_f32 v197, v197
v_mfma_f32_16x16x32_bf16 v[88:91], a[120:123], v[156:159], v[88:91]
s_waitcnt vmcnt(4)
buffer_load_dwordx4 v24, s[12:15], s60 offen offset:2048 nt lds
ds_read_b64_tr_b16 a[110:111], v17 offset:12288
v_mfma_f32_16x16x32_bf16 v[120:123], a[120:123], v[172:175], v[120:123]
v_cvt_pk_bf16_f32 v223, v226, v227
v_mfma_f32_16x16x32_bf16 v[120:123], a[124:127], v[180:183], v[120:123]
v_exp_f32 v198, v198
v_mfma_f32_16x16x32_bf16 a[52:55], a[60:63], v[156:159], a[52:55]
v_cvt_pk_bf16_f32 v196, v196, v197
v_mfma_f32_16x16x32_bf16 a[52:55], a[60:63], v[164:167], a[52:55]
ds_read_b64_tr_b16 a[112:113], v18 offset:0
s_waitcnt lgkmcnt(5)
v_mfma_f32_16x16x32_bf16 v[60:63], a[96:99], v[140:143], v[60:63]
v_exp_f32 v199, v199
v_mfma_f32_16x16x32_bf16 v[60:63], a[100:103], v[148:151], v[60:63]
ds_read_b64_tr_b16 a[114:115], v18 offset:4096
ds_read_b64_tr_b16 a[116:117], v18 offset:8192
v_mfma_f32_16x16x32_bf16 v[92:95], a[100:103], v[164:167], v[92:95]
v_exp_f32 v212, v212
v_mfma_f32_16x16x32_bf16 v[92:95], a[96:99], v[156:159], v[92:95]
ds_read_b64_tr_b16 a[118:119], v18 offset:12288
v_mfma_f32_16x16x32_bf16 v[124:127], a[96:99], v[172:175], v[124:127]
v_exp_f32 v213, v213
v_mfma_f32_16x16x32_bf16 v[124:127], a[100:103], v[180:183], v[124:127]
s_waitcnt vmcnt(3)
buffer_load_dwordx4 v25, s[12:15], s60 offen offset:3072 nt lds
s_waitcnt lgkmcnt(4)
v_mfma_f32_16x16x32_bf16 v[64:67], a[104:107], v[140:143], v[64:67]
s_add_u32 s60, s60, 16384
s_and_b32 s60, s60, 0x7ffff
v_mfma_f32_16x16x32_bf16 v[64:67], a[108:111], v[148:151], v[64:67]
ds_read_b64_tr_b16 a[120:121], v19 offset:0
ds_read_b64_tr_b16 a[122:123], v19 offset:4096
v_mfma_f32_16x16x32_bf16 v[96:99], a[108:111], v[164:167], v[96:99]
v_cvt_pk_bf16_f32 v197, v198, v199
v_mfma_f32_16x16x32_bf16 v[96:99], a[104:107], v[156:159], v[96:99]
ds_read_b64_tr_b16 a[124:125], v19 offset:8192
s_barrier
ds_read_b64_tr_b16 a[126:127], v19 offset:12288
v_mfma_f32_16x16x32_bf16 v[128:131], a[104:107], v[172:175], v[128:131]
v_exp_f32 v214, v214
v_mfma_f32_16x16x32_bf16 v[128:131], a[108:111], v[180:183], v[128:131]
v_cvt_pk_bf16_f32 v212, v212, v213
v_mfma_f32_16x16x32_bf16 a[56:59], a[60:63], v[172:175], a[56:59]
v_exp_f32 v215, v215
v_mfma_f32_16x16x32_bf16 a[56:59], a[60:63], v[180:183], a[56:59]
ds_read_b128 a[64:67], v8 offset:32768
s_waitcnt lgkmcnt(5)
v_mfma_f32_16x16x32_bf16 v[68:71], a[112:115], v[140:143], v[68:71]
v_exp_f32 v228, v228
v_mfma_f32_16x16x32_bf16 v[68:71], a[116:119], v[148:151], v[68:71]
ds_read_b128 a[68:71], v9 offset:32768
ds_read_b128 a[72:75], v10 offset:32768
v_mfma_f32_16x16x32_bf16 v[100:103], a[116:119], v[164:167], v[100:103]
v_exp_f32 v229, v229
v_mfma_f32_16x16x32_bf16 v[100:103], a[112:115], v[156:159], v[100:103]
v_cvt_pk_bf16_f32 v213, v214, v215
ds_read_b128 a[76:79], v11 offset:32768
v_mfma_f32_16x16x32_bf16 v[132:135], a[112:115], v[172:175], v[132:135]
v_exp_f32 v230, v230
v_mfma_f32_16x16x32_bf16 v[132:135], a[116:119], v[180:183], v[132:135]
v_cvt_pk_bf16_f32 v228, v228, v229
s_waitcnt lgkmcnt(4)
v_mfma_f32_16x16x32_bf16 v[72:75], a[120:123], v[140:143], v[72:75]
v_exp_f32 v231, v231
v_mfma_f32_16x16x32_bf16 v[72:75], a[124:127], v[148:151], v[72:75]
v_exp_f32 v200, v200
v_mfma_f32_16x16x32_bf16 v[104:107], a[124:127], v[164:167], v[104:107]
v_exp_f32 v201, v201
v_mfma_f32_16x16x32_bf16 v[104:107], a[120:123], v[156:159], v[104:107]
v_cvt_pk_bf16_f32 v229, v230, v231
v_mfma_f32_16x16x32_bf16 v[136:139], a[120:123], v[172:175], v[136:139]
v_exp_f32 v202, v202
v_mfma_f32_16x16x32_bf16 v[136:139], a[124:127], v[180:183], v[136:139]
v_cvt_pk_bf16_f32 v198, v200, v201
v_exp_f32 v203, v203
s_waitcnt lgkmcnt(0)
v_mfma_f32_16x16x32_bf16 v[140:143], a[64:67], a[0:3], v[32:35]
v_exp_f32 v216, v216
v_mfma_f32_16x16x32_bf16 v[140:143], a[68:71], a[4:7], v[140:143]
s_add_u32 m0, s65, 16384
v_mfma_f32_16x16x32_bf16 v[140:143], a[72:75], a[8:11], v[140:143]
v_exp_f32 v217, v217
v_mfma_f32_16x16x32_bf16 v[140:143], a[76:79], a[12:15], v[140:143]
ds_read_b128 a[80:83], v8 offset:36864
ds_read_b128 a[84:87], v9 offset:36864
ds_read_b128 a[88:91], v10 offset:36864
v_mfma_f32_16x16x32_bf16 v[156:159], a[76:79], a[28:31], v[36:39]
v_cvt_pk_bf16_f32 v199, v202, v203
v_mfma_f32_16x16x32_bf16 v[156:159], a[72:75], a[24:27], v[156:159]
v_exp_f32 v218, v218
v_mfma_f32_16x16x32_bf16 v[156:159], a[68:71], a[20:23], v[156:159]
v_cvt_pk_bf16_f32 v214, v216, v217
v_mfma_f32_16x16x32_bf16 v[156:159], a[64:67], a[16:19], v[156:159]
buffer_load_dwordx4 v20, s[8:11], s59 offen nt lds
ds_read_b128 a[92:95], v11 offset:36864
v_mfma_f32_16x16x32_bf16 v[172:175], a[64:67], a[32:35], v[40:43]
v_exp_f32 v219, v219
v_mfma_f32_16x16x32_bf16 v[172:175], a[68:71], a[36:39], v[172:175]
v_exp_f32 v232, v232
v_mfma_f32_16x16x32_bf16 v[172:175], a[72:75], a[40:43], v[172:175]
v_exp_f32 v233, v233
v_mfma_f32_16x16x32_bf16 v[172:175], a[76:79], a[44:47], v[172:175]
v_cvt_pk_bf16_f32 v215, v218, v219
s_waitcnt lgkmcnt(0)
v_mfma_f32_16x16x32_bf16 v[144:147], a[80:83], a[0:3], v[32:35]
v_exp_f32 v234, v234
v_mfma_f32_16x16x32_bf16 v[144:147], a[84:87], a[4:7], v[144:147]
v_cvt_pk_bf16_f32 v230, v232, v233
v_mfma_f32_16x16x32_bf16 v[144:147], a[88:91], a[8:11], v[144:147]
v_exp_f32 v235, v235
v_mfma_f32_16x16x32_bf16 v[144:147], a[92:95], a[12:15], v[144:147]
ds_read_b128 a[64:67], v8 offset:40960
s_waitcnt vmcnt(4)
buffer_load_dwordx4 v21, s[8:11], s59 offen offset:1024 nt lds
ds_read_b128 a[68:71], v9 offset:40960
ds_read_b128 a[72:75], v10 offset:40960
v_mfma_f32_16x16x32_bf16 v[160:163], a[92:95], a[28:31], v[36:39]
v_cvt_pk_bf16_f32 v231, v234, v235
v_mfma_f32_16x16x32_bf16 v[160:163], a[88:91], a[24:27], v[160:163]
v_exp_f32 v140, v140
v_mfma_f32_16x16x32_bf16 v[160:163], a[84:87], a[20:23], v[160:163]
v_exp_f32 v141, v141
v_mfma_f32_16x16x32_bf16 v[160:163], a[80:83], a[16:19], v[160:163]
ds_read_b128 a[76:79], v11 offset:40960
v_mfma_f32_16x16x32_bf16 v[176:179], a[80:83], a[32:35], v[40:43]
v_exp_f32 v142, v142
v_mfma_f32_16x16x32_bf16 v[176:179], a[84:87], a[36:39], v[176:179]
v_cvt_pk_bf16_f32 v140, v140, v141
v_mfma_f32_16x16x32_bf16 v[176:179], a[88:91], a[40:43], v[176:179]
v_exp_f32 v143, v143
v_mfma_f32_16x16x32_bf16 v[176:179], a[92:95], a[44:47], v[176:179]
s_waitcnt lgkmcnt(0)
v_mfma_f32_16x16x32_bf16 v[148:151], a[64:67], a[0:3], v[32:35]
v_exp_f32 v156, v156
v_mfma_f32_16x16x32_bf16 v[148:151], a[68:71], a[4:7], v[148:151]
v_exp_f32 v157, v157
v_mfma_f32_16x16x32_bf16 v[148:151], a[72:75], a[8:11], v[148:151]
v_cvt_pk_bf16_f32 v141, v142, v143
v_mfma_f32_16x16x32_bf16 v[148:151], a[76:79], a[12:15], v[148:151]
s_waitcnt vmcnt(4)
buffer_load_dwordx4 v22, s[8:11], s59 offen offset:2048 nt lds
ds_read_b128 a[80:83], v8 offset:45056
ds_read_b128 a[84:87], v9 offset:45056
ds_read_b128 a[88:91], v10 offset:45056
v_mfma_f32_16x16x32_bf16 v[164:167], a[76:79], a[28:31], v[36:39]
v_exp_f32 v158, v158
v_mfma_f32_16x16x32_bf16 v[164:167], a[72:75], a[24:27], v[164:167]
v_cvt_pk_bf16_f32 v156, v156, v157
v_mfma_f32_16x16x32_bf16 v[164:167], a[68:71], a[20:23], v[164:167]
v_exp_f32 v159, v159
v_mfma_f32_16x16x32_bf16 v[164:167], a[64:67], a[16:19], v[164:167]
ds_read_b128 a[92:95], v11 offset:45056
v_mfma_f32_16x16x32_bf16 v[180:183], a[64:67], a[32:35], v[40:43]
v_exp_f32 v172, v172
v_mfma_f32_16x16x32_bf16 v[180:183], a[68:71], a[36:39], v[180:183]
v_exp_f32 v173, v173
v_mfma_f32_16x16x32_bf16 v[180:183], a[72:75], a[40:43], v[180:183]
v_cvt_pk_bf16_f32 v157, v158, v159
v_mfma_f32_16x16x32_bf16 v[180:183], a[76:79], a[44:47], v[180:183]
ds_read_b64_tr_b16 a[96:97], v12 offset:16384
ds_read_b64_tr_b16 a[98:99], v12 offset:20480
s_waitcnt lgkmcnt(2)
v_mfma_f32_16x16x32_bf16 v[152:155], a[80:83], a[0:3], v[32:35]
v_exp_f32 v174, v174
v_mfma_f32_16x16x32_bf16 v[152:155], a[84:87], a[4:7], v[152:155]
v_cvt_pk_bf16_f32 v172, v172, v173
v_mfma_f32_16x16x32_bf16 v[152:155], a[88:91], a[8:11], v[152:155]
v_exp_f32 v175, v175
v_mfma_f32_16x16x32_bf16 v[152:155], a[92:95], a[12:15], v[152:155]
s_waitcnt vmcnt(4)
buffer_load_dwordx4 v23, s[8:11], s59 offen offset:3072 nt lds
s_add_u32 s59, s59, 16384
s_and_b32 s59, s59, 0x7ffff
ds_read_b64_tr_b16 a[100:101], v12 offset:24576
ds_read_b64_tr_b16 a[102:103], v12 offset:28672
v_mfma_f32_16x16x32_bf16 v[168:171], a[92:95], a[28:31], v[36:39]
v_exp_f32 v144, v144
v_mfma_f32_16x16x32_bf16 v[168:171], a[88:91], a[24:27], v[168:171]
v_exp_f32 v145, v145
v_mfma_f32_16x16x32_bf16 v[168:171], a[84:87], a[20:23], v[168:171]
v_cvt_pk_bf16_f32 v173, v174, v175
s_add_u32 m0, s65, 114688
v_mfma_f32_16x16x32_bf16 v[168:171], a[80:83], a[16:19], v[168:171]
ds_read_b64_tr_b16 a[104:105], v13 offset:16384
ds_read_b64_tr_b16 a[106:107], v13 offset:20480
ds_read_b64_tr_b16 a[108:109], v13 offset:24576
ds_read_b64_tr_b16 a[110:111], v13 offset:28672
v_mfma_f32_16x16x32_bf16 v[184:187], a[80:83], a[32:35], v[40:43]
v_exp_f32 v146, v146
v_mfma_f32_16x16x32_bf16 v[184:187], a[84:87], a[36:39], v[184:187]
v_cvt_pk_bf16_f32 v142, v144, v145
v_mfma_f32_16x16x32_bf16 v[184:187], a[88:91], a[40:43], v[184:187]
v_exp_f32 v147, v147
v_mfma_f32_16x16x32_bf16 v[184:187], a[92:95], a[44:47], v[184:187]
ds_read_b64_tr_b16 a[112:113], v14 offset:16384
s_waitcnt lgkmcnt(5)
v_mfma_f32_16x16x32_bf16 v[44:47], a[96:99], v[188:191], v[44:47]
v_exp_f32 v160, v160
v_mfma_f32_16x16x32_bf16 v[44:47], a[100:103], v[196:199], v[44:47]
s_waitcnt vmcnt(4)
buffer_load_dwordx4 v24, s[12:15], s60 offen nt lds
ds_read_b64_tr_b16 a[114:115], v14 offset:20480
v_mfma_f32_16x16x32_bf16 v[76:79], a[100:103], v[212:215], v[76:79]
v_exp_f32 v161, v161
v_mfma_f32_16x16x32_bf16 v[76:79], a[96:99], v[204:207], v[76:79]
ds_read_b64_tr_b16 a[116:117], v14 offset:24576
ds_read_b64_tr_b16 a[118:119], v14 offset:28672
v_mfma_f32_16x16x32_bf16 v[108:111], a[96:99], v[220:223], v[108:111]
v_cvt_pk_bf16_f32 v143, v146, v147
v_mfma_f32_16x16x32_bf16 v[108:111], a[100:103], v[228:231], v[108:111]
ds_read_b64_tr_b16 a[120:121], v15 offset:16384
s_waitcnt lgkmcnt(5)
v_mfma_f32_16x16x32_bf16 v[48:51], a[104:107], v[188:191], v[48:51]
v_exp_f32 v162, v162
v_mfma_f32_16x16x32_bf16 v[48:51], a[108:111], v[196:199], v[48:51]
ds_read_b64_tr_b16 a[122:123], v15 offset:20480
v_cvt_pk_bf16_f32 v158, v160, v161
v_mfma_f32_16x16x32_bf16 v[80:83], a[108:111], v[212:215], v[80:83]
v_exp_f32 v163, v163
v_mfma_f32_16x16x32_bf16 v[80:83], a[104:107], v[204:207], v[80:83]
ds_read_b64_tr_b16 a[124:125], v15 offset:24576
ds_read_b64_tr_b16 a[126:127], v15 offset:28672
v_mfma_f32_16x16x32_bf16 v[112:115], a[104:107], v[220:223], v[112:115]
v_exp_f32 v176, v176
v_mfma_f32_16x16x32_bf16 v[112:115], a[108:111], v[228:231], v[112:115]
s_waitcnt vmcnt(4)
buffer_load_dwordx4 v25, s[12:15], s60 offen offset:1024 nt lds
v_mfma_f32_16x16x32_bf16 a[48:51], a[60:63], v[188:191], a[48:51]
v_exp_f32 v177, v177
v_mfma_f32_16x16x32_bf16 a[48:51], a[60:63], v[196:199], a[48:51]
v_cvt_pk_bf16_f32 v159, v162, v163
s_waitcnt lgkmcnt(4)
v_mfma_f32_16x16x32_bf16 v[52:55], a[112:115], v[188:191], v[52:55]
v_exp_f32 v178, v178
v_mfma_f32_16x16x32_bf16 v[52:55], a[116:119], v[196:199], v[52:55]
ds_read_b64_tr_b16 a[96:97], v16 offset:16384
ds_read_b64_tr_b16 a[98:99], v16 offset:20480
v_mfma_f32_16x16x32_bf16 v[84:87], a[116:119], v[212:215], v[84:87]
v_cvt_pk_bf16_f32 v174, v176, v177
v_mfma_f32_16x16x32_bf16 v[84:87], a[112:115], v[204:207], v[84:87]
ds_read_b64_tr_b16 a[100:101], v16 offset:24576
ds_read_b64_tr_b16 a[102:103], v16 offset:28672
v_mfma_f32_16x16x32_bf16 v[116:119], a[112:115], v[220:223], v[116:119]
v_exp_f32 v179, v179
v_mfma_f32_16x16x32_bf16 v[116:119], a[116:119], v[228:231], v[116:119]
ds_read_b64_tr_b16 a[104:105], v17 offset:16384
s_waitcnt lgkmcnt(5)
v_mfma_f32_16x16x32_bf16 v[56:59], a[120:123], v[188:191], v[56:59]
v_exp_f32 v148, v148
v_mfma_f32_16x16x32_bf16 v[56:59], a[124:127], v[196:199], v[56:59]
ds_read_b64_tr_b16 a[106:107], v17 offset:20480
ds_read_b64_tr_b16 a[108:109], v17 offset:24576
v_mfma_f32_16x16x32_bf16 v[88:91], a[124:127], v[212:215], v[88:91]
v_exp_f32 v149, v149
v_mfma_f32_16x16x32_bf16 v[88:91], a[120:123], v[204:207], v[88:91]
s_waitcnt vmcnt(4)
buffer_load_dwordx4 v24, s[12:15], s60 offen offset:2048 nt lds
ds_read_b64_tr_b16 a[110:111], v17 offset:28672
v_mfma_f32_16x16x32_bf16 v[120:123], a[120:123], v[220:223], v[120:123]
v_cvt_pk_bf16_f32 v175, v178, v179
v_mfma_f32_16x16x32_bf16 v[120:123], a[124:127], v[228:231], v[120:123]
v_exp_f32 v150, v150
v_mfma_f32_16x16x32_bf16 a[52:55], a[60:63], v[204:207], a[52:55]
v_cvt_pk_bf16_f32 v148, v148, v149
v_mfma_f32_16x16x32_bf16 a[52:55], a[60:63], v[212:215], a[52:55]
ds_read_b64_tr_b16 a[112:113], v18 offset:16384
s_waitcnt lgkmcnt(5)
v_mfma_f32_16x16x32_bf16 v[60:63], a[96:99], v[188:191], v[60:63]
v_exp_f32 v151, v151
v_mfma_f32_16x16x32_bf16 v[60:63], a[100:103], v[196:199], v[60:63]
ds_read_b64_tr_b16 a[114:115], v18 offset:20480
ds_read_b64_tr_b16 a[116:117], v18 offset:24576
v_mfma_f32_16x16x32_bf16 v[92:95], a[100:103], v[212:215], v[92:95]
v_exp_f32 v164, v164
v_mfma_f32_16x16x32_bf16 v[92:95], a[96:99], v[204:207], v[92:95]
ds_read_b64_tr_b16 a[118:119], v18 offset:28672
v_mfma_f32_16x16x32_bf16 v[124:127], a[96:99], v[220:223], v[124:127]
v_exp_f32 v165, v165
v_mfma_f32_16x16x32_bf16 v[124:127], a[100:103], v[228:231], v[124:127]
s_waitcnt vmcnt(3)
buffer_load_dwordx4 v25, s[12:15], s60 offen offset:3072 nt lds
s_waitcnt lgkmcnt(4)
v_mfma_f32_16x16x32_bf16 v[64:67], a[104:107], v[188:191], v[64:67]
s_add_u32 s60, s60, 16384
s_and_b32 s60, s60, 0x7ffff
v_mfma_f32_16x16x32_bf16 v[64:67], a[108:111], v[196:199], v[64:67]
ds_read_b64_tr_b16 a[120:121], v19 offset:16384
ds_read_b64_tr_b16 a[122:123], v19 offset:20480
v_mfma_f32_16x16x32_bf16 v[96:99], a[108:111], v[212:215], v[96:99]
v_cvt_pk_bf16_f32 v149, v150, v151
v_mfma_f32_16x16x32_bf16 v[96:99], a[104:107], v[204:207], v[96:99]
ds_read_b64_tr_b16 a[124:125], v19 offset:24576
s_barrier
ds_read_b64_tr_b16 a[126:127], v19 offset:28672
v_mfma_f32_16x16x32_bf16 v[128:131], a[104:107], v[220:223], v[128:131]
v_exp_f32 v166, v166
v_mfma_f32_16x16x32_bf16 v[128:131], a[108:111], v[228:231], v[128:131]
v_cvt_pk_bf16_f32 v164, v164, v165
v_mfma_f32_16x16x32_bf16 a[56:59], a[60:63], v[220:223], a[56:59]
v_exp_f32 v167, v167
v_mfma_f32_16x16x32_bf16 a[56:59], a[60:63], v[228:231], a[56:59]
ds_read_b128 a[64:67], v8 offset:49152
s_waitcnt lgkmcnt(5)
v_mfma_f32_16x16x32_bf16 v[68:71], a[112:115], v[188:191], v[68:71]
v_exp_f32 v180, v180
v_mfma_f32_16x16x32_bf16 v[68:71], a[116:119], v[196:199], v[68:71]
ds_read_b128 a[68:71], v9 offset:49152
ds_read_b128 a[72:75], v10 offset:49152
v_mfma_f32_16x16x32_bf16 v[100:103], a[116:119], v[212:215], v[100:103]
v_exp_f32 v181, v181
v_mfma_f32_16x16x32_bf16 v[100:103], a[112:115], v[204:207], v[100:103]
v_cvt_pk_bf16_f32 v165, v166, v167
ds_read_b128 a[76:79], v11 offset:49152
v_mfma_f32_16x16x32_bf16 v[132:135], a[112:115], v[220:223], v[132:135]
v_exp_f32 v182, v182
v_mfma_f32_16x16x32_bf16 v[132:135], a[116:119], v[228:231], v[132:135]
v_cvt_pk_bf16_f32 v180, v180, v181
s_waitcnt lgkmcnt(4)
v_mfma_f32_16x16x32_bf16 v[72:75], a[120:123], v[188:191], v[72:75]
v_exp_f32 v183, v183
v_mfma_f32_16x16x32_bf16 v[72:75], a[124:127], v[196:199], v[72:75]
v_exp_f32 v152, v152
v_mfma_f32_16x16x32_bf16 v[104:107], a[124:127], v[212:215], v[104:107]
v_exp_f32 v153, v153
v_mfma_f32_16x16x32_bf16 v[104:107], a[120:123], v[204:207], v[104:107]
v_cvt_pk_bf16_f32 v181, v182, v183
v_mfma_f32_16x16x32_bf16 v[136:139], a[120:123], v[220:223], v[136:139]
v_exp_f32 v154, v154
v_mfma_f32_16x16x32_bf16 v[136:139], a[124:127], v[228:231], v[136:139]
v_cvt_pk_bf16_f32 v150, v152, v153
v_exp_f32 v155, v155
s_waitcnt lgkmcnt(0)
v_mfma_f32_16x16x32_bf16 v[188:191], a[64:67], a[0:3], v[32:35]
v_exp_f32 v168, v168
v_mfma_f32_16x16x32_bf16 v[188:191], a[68:71], a[4:7], v[188:191]
s_add_u32 m0, s65, 32768
v_mfma_f32_16x16x32_bf16 v[188:191], a[72:75], a[8:11], v[188:191]
v_exp_f32 v169, v169
v_mfma_f32_16x16x32_bf16 v[188:191], a[76:79], a[12:15], v[188:191]
ds_read_b128 a[80:83], v8 offset:53248
ds_read_b128 a[84:87], v9 offset:53248
ds_read_b128 a[88:91], v10 offset:53248
v_mfma_f32_16x16x32_bf16 v[204:207], a[76:79], a[28:31], v[36:39]
v_cvt_pk_bf16_f32 v151, v154, v155
v_mfma_f32_16x16x32_bf16 v[204:207], a[72:75], a[24:27], v[204:207]
v_exp_f32 v170, v170
v_mfma_f32_16x16x32_bf16 v[204:207], a[68:71], a[20:23], v[204:207]
v_cvt_pk_bf16_f32 v166, v168, v169
v_mfma_f32_16x16x32_bf16 v[204:207], a[64:67], a[16:19], v[204:207]
buffer_load_dwordx4 v20, s[8:11], s59 offen nt lds
ds_read_b128 a[92:95], v11 offset:53248
v_mfma_f32_16x16x32_bf16 v[220:223], a[64:67], a[32:35], v[40:43]
v_exp_f32 v171, v171
v_mfma_f32_16x16x32_bf16 v[220:223], a[68:71], a[36:39], v[220:223]
v_exp_f32 v184, v184
v_mfma_f32_16x16x32_bf16 v[220:223], a[72:75], a[40:43], v[220:223]
v_exp_f32 v185, v185
v_mfma_f32_16x16x32_bf16 v[220:223], a[76:79], a[44:47], v[220:223]
v_cvt_pk_bf16_f32 v167, v170, v171
s_waitcnt lgkmcnt(0)
v_mfma_f32_16x16x32_bf16 v[192:195], a[80:83], a[0:3], v[32:35]
v_exp_f32 v186, v186
v_mfma_f32_16x16x32_bf16 v[192:195], a[84:87], a[4:7], v[192:195]
v_cvt_pk_bf16_f32 v182, v184, v185
v_mfma_f32_16x16x32_bf16 v[192:195], a[88:91], a[8:11], v[192:195]
v_exp_f32 v187, v187
v_mfma_f32_16x16x32_bf16 v[192:195], a[92:95], a[12:15], v[192:195]
ds_read_b128 a[64:67], v8 offset:57344
s_waitcnt vmcnt(4)
buffer_load_dwordx4 v21, s[8:11], s59 offen offset:1024 nt lds
ds_read_b128 a[68:71], v9 offset:57344
ds_read_b128 a[72:75], v10 offset:57344
v_mfma_f32_16x16x32_bf16 v[208:211], a[92:95], a[28:31], v[36:39]
v_cvt_pk_bf16_f32 v183, v186, v187
v_mfma_f32_16x16x32_bf16 v[208:211], a[88:91], a[24:27], v[208:211]
v_exp_f32 v188, v188
v_mfma_f32_16x16x32_bf16 v[208:211], a[84:87], a[20:23], v[208:211]
v_exp_f32 v189, v189
v_mfma_f32_16x16x32_bf16 v[208:211], a[80:83], a[16:19], v[208:211]
ds_read_b128 a[76:79], v11 offset:57344
v_mfma_f32_16x16x32_bf16 v[224:227], a[80:83], a[32:35], v[40:43]
v_exp_f32 v190, v190
v_mfma_f32_16x16x32_bf16 v[224:227], a[84:87], a[36:39], v[224:227]
v_cvt_pk_bf16_f32 v188, v188, v189
v_mfma_f32_16x16x32_bf16 v[224:227], a[88:91], a[40:43], v[224:227]
v_exp_f32 v191, v191
v_mfma_f32_16x16x32_bf16 v[224:227], a[92:95], a[44:47], v[224:227]
s_waitcnt lgkmcnt(0)
v_mfma_f32_16x16x32_bf16 v[196:199], a[64:67], a[0:3], v[32:35]
v_exp_f32 v204, v204
v_mfma_f32_16x16x32_bf16 v[196:199], a[68:71], a[4:7], v[196:199]
v_exp_f32 v205, v205
v_mfma_f32_16x16x32_bf16 v[196:199], a[72:75], a[8:11], v[196:199]
v_cvt_pk_bf16_f32 v189, v190, v191
v_mfma_f32_16x16x32_bf16 v[196:199], a[76:79], a[12:15], v[196:199]
s_waitcnt vmcnt(4)
buffer_load_dwordx4 v22, s[8:11], s59 offen offset:2048 nt lds
ds_read_b128 a[80:83], v8 offset:61440
ds_read_b128 a[84:87], v9 offset:61440
ds_read_b128 a[88:91], v10 offset:61440
v_mfma_f32_16x16x32_bf16 v[212:215], a[76:79], a[28:31], v[36:39]
v_exp_f32 v206, v206
v_mfma_f32_16x16x32_bf16 v[212:215], a[72:75], a[24:27], v[212:215]
v_cvt_pk_bf16_f32 v204, v204, v205
v_mfma_f32_16x16x32_bf16 v[212:215], a[68:71], a[20:23], v[212:215]
v_exp_f32 v207, v207
v_mfma_f32_16x16x32_bf16 v[212:215], a[64:67], a[16:19], v[212:215]
ds_read_b128 a[92:95], v11 offset:61440
v_mfma_f32_16x16x32_bf16 v[228:231], a[64:67], a[32:35], v[40:43]
v_exp_f32 v220, v220
v_mfma_f32_16x16x32_bf16 v[228:231], a[68:71], a[36:39], v[228:231]
v_exp_f32 v221, v221
v_mfma_f32_16x16x32_bf16 v[228:231], a[72:75], a[40:43], v[228:231]
v_cvt_pk_bf16_f32 v205, v206, v207
v_mfma_f32_16x16x32_bf16 v[228:231], a[76:79], a[44:47], v[228:231]
ds_read_b64_tr_b16 a[96:97], v12 offset:32768
ds_read_b64_tr_b16 a[98:99], v12 offset:36864
s_waitcnt lgkmcnt(2)
v_mfma_f32_16x16x32_bf16 v[200:203], a[80:83], a[0:3], v[32:35]
v_exp_f32 v222, v222
v_mfma_f32_16x16x32_bf16 v[200:203], a[84:87], a[4:7], v[200:203]
v_cvt_pk_bf16_f32 v220, v220, v221
v_mfma_f32_16x16x32_bf16 v[200:203], a[88:91], a[8:11], v[200:203]
v_exp_f32 v223, v223
v_mfma_f32_16x16x32_bf16 v[200:203], a[92:95], a[12:15], v[200:203]
s_waitcnt vmcnt(4)
buffer_load_dwordx4 v23, s[8:11], s59 offen offset:3072 nt lds
s_add_u32 s59, s59, 16384
s_and_b32 s59, s59, 0x7ffff
ds_read_b64_tr_b16 a[100:101], v12 offset:40960
ds_read_b64_tr_b16 a[102:103], v12 offset:45056
v_mfma_f32_16x16x32_bf16 v[216:219], a[92:95], a[28:31], v[36:39]
v_exp_f32 v192, v192
v_mfma_f32_16x16x32_bf16 v[216:219], a[88:91], a[24:27], v[216:219]
v_exp_f32 v193, v193
v_mfma_f32_16x16x32_bf16 v[216:219], a[84:87], a[20:23], v[216:219]
v_cvt_pk_bf16_f32 v221, v222, v223
s_add_u32 m0, s65, 65536
v_mfma_f32_16x16x32_bf16 v[216:219], a[80:83], a[16:19], v[216:219]
ds_read_b64_tr_b16 a[104:105], v13 offset:32768
ds_read_b64_tr_b16 a[106:107], v13 offset:36864
ds_read_b64_tr_b16 a[108:109], v13 offset:40960
ds_read_b64_tr_b16 a[110:111], v13 offset:45056
v_mfma_f32_16x16x32_bf16 v[232:235], a[80:83], a[32:35], v[40:43]
v_exp_f32 v194, v194
v_mfma_f32_16x16x32_bf16 v[232:235], a[84:87], a[36:39], v[232:235]
v_cvt_pk_bf16_f32 v190, v192, v193
v_mfma_f32_16x16x32_bf16 v[232:235], a[88:91], a[40:43], v[232:235]
v_exp_f32 v195, v195
v_mfma_f32_16x16x32_bf16 v[232:235], a[92:95], a[44:47], v[232:235]
ds_read_b64_tr_b16 a[112:113], v14 offset:32768
s_waitcnt lgkmcnt(5)
v_mfma_f32_16x16x32_bf16 v[44:47], a[96:99], v[140:143], v[44:47]
v_exp_f32 v208, v208
v_mfma_f32_16x16x32_bf16 v[44:47], a[100:103], v[148:151], v[44:47]
s_waitcnt vmcnt(4)
buffer_load_dwordx4 v24, s[12:15], s60 offen nt lds
ds_read_b64_tr_b16 a[114:115], v14 offset:36864
v_mfma_f32_16x16x32_bf16 v[76:79], a[100:103], v[164:167], v[76:79]
v_exp_f32 v209, v209
v_mfma_f32_16x16x32_bf16 v[76:79], a[96:99], v[156:159], v[76:79]
ds_read_b64_tr_b16 a[116:117], v14 offset:40960
ds_read_b64_tr_b16 a[118:119], v14 offset:45056
v_mfma_f32_16x16x32_bf16 v[108:111], a[96:99], v[172:175], v[108:111]
v_cvt_pk_bf16_f32 v191, v194, v195
v_mfma_f32_16x16x32_bf16 v[108:111], a[100:103], v[180:183], v[108:111]
ds_read_b64_tr_b16 a[120:121], v15 offset:32768
s_waitcnt lgkmcnt(5)
v_mfma_f32_16x16x32_bf16 v[48:51], a[104:107], v[140:143], v[48:51]
v_exp_f32 v210, v210
v_mfma_f32_16x16x32_bf16 v[48:51], a[108:111], v[148:151], v[48:51]
ds_read_b64_tr_b16 a[122:123], v15 offset:36864
v_cvt_pk_bf16_f32 v206, v208, v209
v_mfma_f32_16x16x32_bf16 v[80:83], a[108:111], v[164:167], v[80:83]
v_exp_f32 v211, v211
v_mfma_f32_16x16x32_bf16 v[80:83], a[104:107], v[156:159], v[80:83]
ds_read_b64_tr_b16 a[124:125], v15 offset:40960
ds_read_b64_tr_b16 a[126:127], v15 offset:45056
v_mfma_f32_16x16x32_bf16 v[112:115], a[104:107], v[172:175], v[112:115]
v_exp_f32 v224, v224
v_mfma_f32_16x16x32_bf16 v[112:115], a[108:111], v[180:183], v[112:115]
s_waitcnt vmcnt(4)
buffer_load_dwordx4 v25, s[12:15], s60 offen offset:1024 nt lds
v_mfma_f32_16x16x32_bf16 a[48:51], a[60:63], v[140:143], a[48:51]
v_exp_f32 v225, v225
v_mfma_f32_16x16x32_bf16 a[48:51], a[60:63], v[148:151], a[48:51]
v_cvt_pk_bf16_f32 v207, v210, v211
s_waitcnt lgkmcnt(4)
v_mfma_f32_16x16x32_bf16 v[52:55], a[112:115], v[140:143], v[52:55]
v_exp_f32 v226, v226
v_mfma_f32_16x16x32_bf16 v[52:55], a[116:119], v[148:151], v[52:55]
ds_read_b64_tr_b16 a[96:97], v16 offset:32768
ds_read_b64_tr_b16 a[98:99], v16 offset:36864
v_mfma_f32_16x16x32_bf16 v[84:87], a[116:119], v[164:167], v[84:87]
v_cvt_pk_bf16_f32 v222, v224, v225
v_mfma_f32_16x16x32_bf16 v[84:87], a[112:115], v[156:159], v[84:87]
ds_read_b64_tr_b16 a[100:101], v16 offset:40960
ds_read_b64_tr_b16 a[102:103], v16 offset:45056
v_mfma_f32_16x16x32_bf16 v[116:119], a[112:115], v[172:175], v[116:119]
v_exp_f32 v227, v227
v_mfma_f32_16x16x32_bf16 v[116:119], a[116:119], v[180:183], v[116:119]
ds_read_b64_tr_b16 a[104:105], v17 offset:32768
s_waitcnt lgkmcnt(5)
v_mfma_f32_16x16x32_bf16 v[56:59], a[120:123], v[140:143], v[56:59]
v_exp_f32 v196, v196
v_mfma_f32_16x16x32_bf16 v[56:59], a[124:127], v[148:151], v[56:59]
ds_read_b64_tr_b16 a[106:107], v17 offset:36864
ds_read_b64_tr_b16 a[108:109], v17 offset:40960
v_mfma_f32_16x16x32_bf16 v[88:91], a[124:127], v[164:167], v[88:91]
v_exp_f32 v197, v197
v_mfma_f32_16x16x32_bf16 v[88:91], a[120:123], v[156:159], v[88:91]
s_waitcnt vmcnt(4)
buffer_load_dwordx4 v24, s[12:15], s60 offen offset:2048 nt lds
ds_read_b64_tr_b16 a[110:111], v17 offset:45056
v_mfma_f32_16x16x32_bf16 v[120:123], a[120:123], v[172:175], v[120:123]
v_cvt_pk_bf16_f32 v223, v226, v227
v_mfma_f32_16x16x32_bf16 v[120:123], a[124:127], v[180:183], v[120:123]
v_exp_f32 v198, v198
v_mfma_f32_16x16x32_bf16 a[52:55], a[60:63], v[156:159], a[52:55]
v_cvt_pk_bf16_f32 v196, v196, v197
v_mfma_f32_16x16x32_bf16 a[52:55], a[60:63], v[164:167], a[52:55]
ds_read_b64_tr_b16 a[112:113], v18 offset:32768
s_waitcnt lgkmcnt(5)
v_mfma_f32_16x16x32_bf16 v[60:63], a[96:99], v[140:143], v[60:63]
v_exp_f32 v199, v199
v_mfma_f32_16x16x32_bf16 v[60:63], a[100:103], v[148:151], v[60:63]
ds_read_b64_tr_b16 a[114:115], v18 offset:36864
ds_read_b64_tr_b16 a[116:117], v18 offset:40960
v_mfma_f32_16x16x32_bf16 v[92:95], a[100:103], v[164:167], v[92:95]
v_exp_f32 v212, v212
v_mfma_f32_16x16x32_bf16 v[92:95], a[96:99], v[156:159], v[92:95]
ds_read_b64_tr_b16 a[118:119], v18 offset:45056
v_mfma_f32_16x16x32_bf16 v[124:127], a[96:99], v[172:175], v[124:127]
v_exp_f32 v213, v213
v_mfma_f32_16x16x32_bf16 v[124:127], a[100:103], v[180:183], v[124:127]
s_waitcnt vmcnt(3)
buffer_load_dwordx4 v25, s[12:15], s60 offen offset:3072 nt lds
s_waitcnt lgkmcnt(4)
v_mfma_f32_16x16x32_bf16 v[64:67], a[104:107], v[140:143], v[64:67]
s_add_u32 s60, s60, 16384
s_and_b32 s60, s60, 0x7ffff
v_mfma_f32_16x16x32_bf16 v[64:67], a[108:111], v[148:151], v[64:67]
ds_read_b64_tr_b16 a[120:121], v19 offset:32768
ds_read_b64_tr_b16 a[122:123], v19 offset:36864
v_mfma_f32_16x16x32_bf16 v[96:99], a[108:111], v[164:167], v[96:99]
v_cvt_pk_bf16_f32 v197, v198, v199
v_mfma_f32_16x16x32_bf16 v[96:99], a[104:107], v[156:159], v[96:99]
ds_read_b64_tr_b16 a[124:125], v19 offset:40960
s_barrier
ds_read_b64_tr_b16 a[126:127], v19 offset:45056
v_mfma_f32_16x16x32_bf16 v[128:131], a[104:107], v[172:175], v[128:131]
v_exp_f32 v214, v214
v_mfma_f32_16x16x32_bf16 v[128:131], a[108:111], v[180:183], v[128:131]
v_cvt_pk_bf16_f32 v212, v212, v213
v_mfma_f32_16x16x32_bf16 a[56:59], a[60:63], v[172:175], a[56:59]
v_exp_f32 v215, v215
v_mfma_f32_16x16x32_bf16 a[56:59], a[60:63], v[180:183], a[56:59]
ds_read_b128 a[64:67], v8 offset:0
s_waitcnt lgkmcnt(5)
v_mfma_f32_16x16x32_bf16 v[68:71], a[112:115], v[140:143], v[68:71]
v_exp_f32 v228, v228
v_mfma_f32_16x16x32_bf16 v[68:71], a[116:119], v[148:151], v[68:71]
ds_read_b128 a[68:71], v9 offset:0
ds_read_b128 a[72:75], v10 offset:0
v_mfma_f32_16x16x32_bf16 v[100:103], a[116:119], v[164:167], v[100:103]
v_exp_f32 v229, v229
v_mfma_f32_16x16x32_bf16 v[100:103], a[112:115], v[156:159], v[100:103]
v_cvt_pk_bf16_f32 v213, v214, v215
ds_read_b128 a[76:79], v11 offset:0
v_mfma_f32_16x16x32_bf16 v[132:135], a[112:115], v[172:175], v[132:135]
v_exp_f32 v230, v230
v_mfma_f32_16x16x32_bf16 v[132:135], a[116:119], v[180:183], v[132:135]
v_cvt_pk_bf16_f32 v228, v228, v229
s_waitcnt lgkmcnt(4)
v_mfma_f32_16x16x32_bf16 v[72:75], a[120:123], v[140:143], v[72:75]
v_exp_f32 v231, v231
v_mfma_f32_16x16x32_bf16 v[72:75], a[124:127], v[148:151], v[72:75]
v_exp_f32 v200, v200
v_mfma_f32_16x16x32_bf16 v[104:107], a[124:127], v[164:167], v[104:107]
v_exp_f32 v201, v201
v_mfma_f32_16x16x32_bf16 v[104:107], a[120:123], v[156:159], v[104:107]
v_cvt_pk_bf16_f32 v229, v230, v231
v_mfma_f32_16x16x32_bf16 v[136:139], a[120:123], v[172:175], v[136:139]
v_exp_f32 v202, v202
v_mfma_f32_16x16x32_bf16 v[136:139], a[124:127], v[180:183], v[136:139]
v_cvt_pk_bf16_f32 v198, v200, v201
v_exp_f32 v203, v203
s_waitcnt lgkmcnt(0)
v_mfma_f32_16x16x32_bf16 v[140:143], a[64:67], a[0:3], v[32:35]
v_exp_f32 v216, v216
v_mfma_f32_16x16x32_bf16 v[140:143], a[68:71], a[4:7], v[140:143]
s_add_u32 m0, s65, 49152
v_mfma_f32_16x16x32_bf16 v[140:143], a[72:75], a[8:11], v[140:143]
v_exp_f32 v217, v217
v_mfma_f32_16x16x32_bf16 v[140:143], a[76:79], a[12:15], v[140:143]
ds_read_b128 a[80:83], v8 offset:4096
ds_read_b128 a[84:87], v9 offset:4096
ds_read_b128 a[88:91], v10 offset:4096
v_mfma_f32_16x16x32_bf16 v[156:159], a[76:79], a[28:31], v[36:39]
v_cvt_pk_bf16_f32 v199, v202, v203
v_mfma_f32_16x16x32_bf16 v[156:159], a[72:75], a[24:27], v[156:159]
v_exp_f32 v218, v218
v_mfma_f32_16x16x32_bf16 v[156:159], a[68:71], a[20:23], v[156:159]
v_cvt_pk_bf16_f32 v214, v216, v217
v_mfma_f32_16x16x32_bf16 v[156:159], a[64:67], a[16:19], v[156:159]
buffer_load_dwordx4 v20, s[8:11], s59 offen nt lds
ds_read_b128 a[92:95], v11 offset:4096
v_mfma_f32_16x16x32_bf16 v[172:175], a[64:67], a[32:35], v[40:43]
v_exp_f32 v219, v219
v_mfma_f32_16x16x32_bf16 v[172:175], a[68:71], a[36:39], v[172:175]
v_exp_f32 v232, v232
v_mfma_f32_16x16x32_bf16 v[172:175], a[72:75], a[40:43], v[172:175]
v_exp_f32 v233, v233
v_mfma_f32_16x16x32_bf16 v[172:175], a[76:79], a[44:47], v[172:175]
v_cvt_pk_bf16_f32 v215, v218, v219
s_waitcnt lgkmcnt(0)
v_mfma_f32_16x16x32_bf16 v[144:147], a[80:83], a[0:3], v[32:35]
v_exp_f32 v234, v234
v_mfma_f32_16x16x32_bf16 v[144:147], a[84:87], a[4:7], v[144:147]
v_cvt_pk_bf16_f32 v230, v232, v233
v_mfma_f32_16x16x32_bf16 v[144:147], a[88:91], a[8:11], v[144:147]
v_exp_f32 v235, v235
v_mfma_f32_16x16x32_bf16 v[144:147], a[92:95], a[12:15], v[144:147]
ds_read_b128 a[64:67], v8 offset:8192
s_waitcnt vmcnt(4)
buffer_load_dwordx4 v21, s[8:11], s59 offen offset:1024 nt lds
ds_read_b128 a[68:71], v9 offset:8192
ds_read_b128 a[72:75], v10 offset:8192
v_mfma_f32_16x16x32_bf16 v[160:163], a[92:95], a[28:31], v[36:39]
v_cvt_pk_bf16_f32 v231, v234, v235
v_mfma_f32_16x16x32_bf16 v[160:163], a[88:91], a[24:27], v[160:163]
v_exp_f32 v140, v140
v_mfma_f32_16x16x32_bf16 v[160:163], a[84:87], a[20:23], v[160:163]
v_exp_f32 v141, v141
v_mfma_f32_16x16x32_bf16 v[160:163], a[80:83], a[16:19], v[160:163]
ds_read_b128 a[76:79], v11 offset:8192
v_mfma_f32_16x16x32_bf16 v[176:179], a[80:83], a[32:35], v[40:43]
v_exp_f32 v142, v142
v_mfma_f32_16x16x32_bf16 v[176:179], a[84:87], a[36:39], v[176:179]
v_cvt_pk_bf16_f32 v140, v140, v141
v_mfma_f32_16x16x32_bf16 v[176:179], a[88:91], a[40:43], v[176:179]
v_exp_f32 v143, v143
v_mfma_f32_16x16x32_bf16 v[176:179], a[92:95], a[44:47], v[176:179]
s_waitcnt lgkmcnt(0)
v_mfma_f32_16x16x32_bf16 v[148:151], a[64:67], a[0:3], v[32:35]
v_exp_f32 v156, v156
v_mfma_f32_16x16x32_bf16 v[148:151], a[68:71], a[4:7], v[148:151]
v_exp_f32 v157, v157
v_mfma_f32_16x16x32_bf16 v[148:151], a[72:75], a[8:11], v[148:151]
v_cvt_pk_bf16_f32 v141, v142, v143
v_mfma_f32_16x16x32_bf16 v[148:151], a[76:79], a[12:15], v[148:151]
s_waitcnt vmcnt(4)
buffer_load_dwordx4 v22, s[8:11], s59 offen offset:2048 nt lds
ds_read_b128 a[80:83], v8 offset:12288
ds_read_b128 a[84:87], v9 offset:12288
ds_read_b128 a[88:91], v10 offset:12288
v_mfma_f32_16x16x32_bf16 v[164:167], a[76:79], a[28:31], v[36:39]
v_exp_f32 v158, v158
v_mfma_f32_16x16x32_bf16 v[164:167], a[72:75], a[24:27], v[164:167]
v_cvt_pk_bf16_f32 v156, v156, v157
v_mfma_f32_16x16x32_bf16 v[164:167], a[68:71], a[20:23], v[164:167]
v_exp_f32 v159, v159
v_mfma_f32_16x16x32_bf16 v[164:167], a[64:67], a[16:19], v[164:167]
ds_read_b128 a[92:95], v11 offset:12288
v_mfma_f32_16x16x32_bf16 v[180:183], a[64:67], a[32:35], v[40:43]
v_exp_f32 v172, v172
v_mfma_f32_16x16x32_bf16 v[180:183], a[68:71], a[36:39], v[180:183]
v_exp_f32 v173, v173
v_mfma_f32_16x16x32_bf16 v[180:183], a[72:75], a[40:43], v[180:183]
v_cvt_pk_bf16_f32 v157, v158, v159
v_mfma_f32_16x16x32_bf16 v[180:183], a[76:79], a[44:47], v[180:183]
ds_read_b64_tr_b16 a[96:97], v12 offset:49152
ds_read_b64_tr_b16 a[98:99], v12 offset:53248
s_waitcnt lgkmcnt(2)
v_mfma_f32_16x16x32_bf16 v[152:155], a[80:83], a[0:3], v[32:35]
v_exp_f32 v174, v174
v_mfma_f32_16x16x32_bf16 v[152:155], a[84:87], a[4:7], v[152:155]
v_cvt_pk_bf16_f32 v172, v172, v173
v_mfma_f32_16x16x32_bf16 v[152:155], a[88:91], a[8:11], v[152:155]
v_exp_f32 v175, v175
v_mfma_f32_16x16x32_bf16 v[152:155], a[92:95], a[12:15], v[152:155]
s_waitcnt vmcnt(4)
buffer_load_dwordx4 v23, s[8:11], s59 offen offset:3072 nt lds
s_add_u32 s59, s59, 16384
s_and_b32 s59, s59, 0x7ffff
ds_read_b64_tr_b16 a[100:101], v12 offset:57344
ds_read_b64_tr_b16 a[102:103], v12 offset:61440
v_mfma_f32_16x16x32_bf16 v[168:171], a[92:95], a[28:31], v[36:39]
v_exp_f32 v144, v144
v_mfma_f32_16x16x32_bf16 v[168:171], a[88:91], a[24:27], v[168:171]
v_exp_f32 v145, v145
v_mfma_f32_16x16x32_bf16 v[168:171], a[84:87], a[20:23], v[168:171]
v_cvt_pk_bf16_f32 v173, v174, v175
s_add_u32 m0, s65, 81920
v_mfma_f32_16x16x32_bf16 v[168:171], a[80:83], a[16:19], v[168:171]
ds_read_b64_tr_b16 a[104:105], v13 offset:49152
ds_read_b64_tr_b16 a[106:107], v13 offset:53248
ds_read_b64_tr_b16 a[108:109], v13 offset:57344
ds_read_b64_tr_b16 a[110:111], v13 offset:61440
v_mfma_f32_16x16x32_bf16 v[184:187], a[80:83], a[32:35], v[40:43]
v_exp_f32 v146, v146
v_mfma_f32_16x16x32_bf16 v[184:187], a[84:87], a[36:39], v[184:187]
v_cvt_pk_bf16_f32 v142, v144, v145
v_mfma_f32_16x16x32_bf16 v[184:187], a[88:91], a[40:43], v[184:187]
v_exp_f32 v147, v147
v_mfma_f32_16x16x32_bf16 v[184:187], a[92:95], a[44:47], v[184:187]
ds_read_b64_tr_b16 a[112:113], v14 offset:49152
s_waitcnt lgkmcnt(5)
v_mfma_f32_16x16x32_bf16 v[44:47], a[96:99], v[188:191], v[44:47]
v_exp_f32 v160, v160
v_mfma_f32_16x16x32_bf16 v[44:47], a[100:103], v[196:199], v[44:47]
s_waitcnt vmcnt(4)
buffer_load_dwordx4 v24, s[12:15], s60 offen nt lds
ds_read_b64_tr_b16 a[114:115], v14 offset:53248
v_mfma_f32_16x16x32_bf16 v[76:79], a[100:103], v[212:215], v[76:79]
v_exp_f32 v161, v161
v_mfma_f32_16x16x32_bf16 v[76:79], a[96:99], v[204:207], v[76:79]
ds_read_b64_tr_b16 a[116:117], v14 offset:57344
ds_read_b64_tr_b16 a[118:119], v14 offset:61440
v_mfma_f32_16x16x32_bf16 v[108:111], a[96:99], v[220:223], v[108:111]
v_cvt_pk_bf16_f32 v143, v146, v147
v_mfma_f32_16x16x32_bf16 v[108:111], a[100:103], v[228:231], v[108:111]
ds_read_b64_tr_b16 a[120:121], v15 offset:49152
s_waitcnt lgkmcnt(5)
v_mfma_f32_16x16x32_bf16 v[48:51], a[104:107], v[188:191], v[48:51]
v_exp_f32 v162, v162
v_mfma_f32_16x16x32_bf16 v[48:51], a[108:111], v[196:199], v[48:51]
ds_read_b64_tr_b16 a[122:123], v15 offset:53248
v_cvt_pk_bf16_f32 v158, v160, v161
v_mfma_f32_16x16x32_bf16 v[80:83], a[108:111], v[212:215], v[80:83]
v_exp_f32 v163, v163
v_mfma_f32_16x16x32_bf16 v[80:83], a[104:107], v[204:207], v[80:83]
ds_read_b64_tr_b16 a[124:125], v15 offset:57344
ds_read_b64_tr_b16 a[126:127], v15 offset:61440
v_mfma_f32_16x16x32_bf16 v[112:115], a[104:107], v[220:223], v[112:115]
v_exp_f32 v176, v176
v_mfma_f32_16x16x32_bf16 v[112:115], a[108:111], v[228:231], v[112:115]
s_waitcnt vmcnt(4)
buffer_load_dwordx4 v25, s[12:15], s60 offen offset:1024 nt lds
v_mfma_f32_16x16x32_bf16 a[48:51], a[60:63], v[188:191], a[48:51]
v_exp_f32 v177, v177
v_mfma_f32_16x16x32_bf16 a[48:51], a[60:63], v[196:199], a[48:51]
v_cvt_pk_bf16_f32 v159, v162, v163
s_waitcnt lgkmcnt(4)
v_mfma_f32_16x16x32_bf16 v[52:55], a[112:115], v[188:191], v[52:55]
v_exp_f32 v178, v178
v_mfma_f32_16x16x32_bf16 v[52:55], a[116:119], v[196:199], v[52:55]
ds_read_b64_tr_b16 a[96:97], v16 offset:49152
ds_read_b64_tr_b16 a[98:99], v16 offset:53248
v_mfma_f32_16x16x32_bf16 v[84:87], a[116:119], v[212:215], v[84:87]
v_cvt_pk_bf16_f32 v174, v176, v177
v_mfma_f32_16x16x32_bf16 v[84:87], a[112:115], v[204:207], v[84:87]
ds_read_b64_tr_b16 a[100:101], v16 offset:57344
ds_read_b64_tr_b16 a[102:103], v16 offset:61440
v_mfma_f32_16x16x32_bf16 v[116:119], a[112:115], v[220:223], v[116:119]
v_exp_f32 v179, v179
v_mfma_f32_16x16x32_bf16 v[116:119], a[116:119], v[228:231], v[116:119]
ds_read_b64_tr_b16 a[104:105], v17 offset:49152
s_waitcnt lgkmcnt(5)
v_mfma_f32_16x16x32_bf16 v[56:59], a[120:123], v[188:191], v[56:59]
v_exp_f32 v148, v148
v_mfma_f32_16x16x32_bf16 v[56:59], a[124:127], v[196:199], v[56:59]
ds_read_b64_tr_b16 a[106:107], v17 offset:53248
ds_read_b64_tr_b16 a[108:109], v17 offset:57344
v_mfma_f32_16x16x32_bf16 v[88:91], a[124:127], v[212:215], v[88:91]
v_exp_f32 v149, v149
v_mfma_f32_16x16x32_bf16 v[88:91], a[120:123], v[204:207], v[88:91]
s_waitcnt vmcnt(4)
buffer_load_dwordx4 v24, s[12:15], s60 offen offset:2048 nt lds
ds_read_b64_tr_b16 a[110:111], v17 offset:61440
v_mfma_f32_16x16x32_bf16 v[120:123], a[120:123], v[220:223], v[120:123]
v_cvt_pk_bf16_f32 v175, v178, v179
v_mfma_f32_16x16x32_bf16 v[120:123], a[124:127], v[228:231], v[120:123]
v_exp_f32 v150, v150
v_mfma_f32_16x16x32_bf16 a[52:55], a[60:63], v[204:207], a[52:55]
v_cvt_pk_bf16_f32 v148, v148, v149
v_mfma_f32_16x16x32_bf16 a[52:55], a[60:63], v[212:215], a[52:55]
ds_read_b64_tr_b16 a[112:113], v18 offset:49152
s_waitcnt lgkmcnt(5)
v_mfma_f32_16x16x32_bf16 v[60:63], a[96:99], v[188:191], v[60:63]
v_exp_f32 v151, v151
v_mfma_f32_16x16x32_bf16 v[60:63], a[100:103], v[196:199], v[60:63]
ds_read_b64_tr_b16 a[114:115], v18 offset:53248
ds_read_b64_tr_b16 a[116:117], v18 offset:57344
v_mfma_f32_16x16x32_bf16 v[92:95], a[100:103], v[212:215], v[92:95]
v_exp_f32 v164, v164
v_mfma_f32_16x16x32_bf16 v[92:95], a[96:99], v[204:207], v[92:95]
ds_read_b64_tr_b16 a[118:119], v18 offset:61440
v_mfma_f32_16x16x32_bf16 v[124:127], a[96:99], v[220:223], v[124:127]
v_exp_f32 v165, v165
v_mfma_f32_16x16x32_bf16 v[124:127], a[100:103], v[228:231], v[124:127]
s_waitcnt vmcnt(3)
buffer_load_dwordx4 v25, s[12:15], s60 offen offset:3072 nt lds
s_waitcnt lgkmcnt(4)
v_mfma_f32_16x16x32_bf16 v[64:67], a[104:107], v[188:191], v[64:67]
s_add_u32 s60, s60, 16384
s_and_b32 s60, s60, 0x7ffff
v_mfma_f32_16x16x32_bf16 v[64:67], a[108:111], v[196:199], v[64:67]
ds_read_b64_tr_b16 a[120:121], v19 offset:49152
ds_read_b64_tr_b16 a[122:123], v19 offset:53248
v_mfma_f32_16x16x32_bf16 v[96:99], a[108:111], v[212:215], v[96:99]
v_cvt_pk_bf16_f32 v149, v150, v151
v_mfma_f32_16x16x32_bf16 v[96:99], a[104:107], v[204:207], v[96:99]
ds_read_b64_tr_b16 a[124:125], v19 offset:57344
s_barrier
ds_read_b64_tr_b16 a[126:127], v19 offset:61440
v_mfma_f32_16x16x32_bf16 v[128:131], a[104:107], v[220:223], v[128:131]
v_exp_f32 v166, v166
v_mfma_f32_16x16x32_bf16 v[128:131], a[108:111], v[228:231], v[128:131]
v_cvt_pk_bf16_f32 v164, v164, v165
v_mfma_f32_16x16x32_bf16 a[56:59], a[60:63], v[220:223], a[56:59]
v_exp_f32 v167, v167
v_mfma_f32_16x16x32_bf16 a[56:59], a[60:63], v[228:231], a[56:59]
ds_read_b128 a[64:67], v8 offset:16384
s_waitcnt lgkmcnt(5)
v_mfma_f32_16x16x32_bf16 v[68:71], a[112:115], v[188:191], v[68:71]
v_exp_f32 v180, v180
v_mfma_f32_16x16x32_bf16 v[68:71], a[116:119], v[196:199], v[68:71]
ds_read_b128 a[68:71], v9 offset:16384
ds_read_b128 a[72:75], v10 offset:16384
v_mfma_f32_16x16x32_bf16 v[100:103], a[116:119], v[212:215], v[100:103]
v_exp_f32 v181, v181
v_mfma_f32_16x16x32_bf16 v[100:103], a[112:115], v[204:207], v[100:103]
v_cvt_pk_bf16_f32 v165, v166, v167
ds_read_b128 a[76:79], v11 offset:16384
v_mfma_f32_16x16x32_bf16 v[132:135], a[112:115], v[220:223], v[132:135]
v_exp_f32 v182, v182
v_mfma_f32_16x16x32_bf16 v[132:135], a[116:119], v[228:231], v[132:135]
v_cvt_pk_bf16_f32 v180, v180, v181
s_waitcnt lgkmcnt(4)
v_mfma_f32_16x16x32_bf16 v[72:75], a[120:123], v[188:191], v[72:75]
v_exp_f32 v183, v183
v_mfma_f32_16x16x32_bf16 v[72:75], a[124:127], v[196:199], v[72:75]
v_exp_f32 v152, v152
v_mfma_f32_16x16x32_bf16 v[104:107], a[124:127], v[212:215], v[104:107]
v_exp_f32 v153, v153
v_mfma_f32_16x16x32_bf16 v[104:107], a[120:123], v[204:207], v[104:107]
v_cvt_pk_bf16_f32 v181, v182, v183
v_mfma_f32_16x16x32_bf16 v[136:139], a[120:123], v[220:223], v[136:139]
v_exp_f32 v154, v154
v_mfma_f32_16x16x32_bf16 v[136:139], a[124:127], v[228:231], v[136:139]
v_cvt_pk_bf16_f32 v150, v152, v153
v_exp_f32 v155, v155
s_waitcnt lgkmcnt(0)
v_mfma_f32_16x16x32_bf16 v[188:191], a[64:67], a[0:3], v[32:35]
v_exp_f32 v168, v168
v_mfma_f32_16x16x32_bf16 v[188:191], a[68:71], a[4:7], v[188:191]
s_add_u32 m0, s65, 0
v_mfma_f32_16x16x32_bf16 v[188:191], a[72:75], a[8:11], v[188:191]
v_exp_f32 v169, v169
v_mfma_f32_16x16x32_bf16 v[188:191], a[76:79], a[12:15], v[188:191]
ds_read_b128 a[80:83], v8 offset:20480
ds_read_b128 a[84:87], v9 offset:20480
ds_read_b128 a[88:91], v10 offset:20480
v_mfma_f32_16x16x32_bf16 v[204:207], a[76:79], a[28:31], v[36:39]
v_cvt_pk_bf16_f32 v151, v154, v155
v_mfma_f32_16x16x32_bf16 v[204:207], a[72:75], a[24:27], v[204:207]
v_exp_f32 v170, v170
v_mfma_f32_16x16x32_bf16 v[204:207], a[68:71], a[20:23], v[204:207]
v_cvt_pk_bf16_f32 v166, v168, v169
v_mfma_f32_16x16x32_bf16 v[204:207], a[64:67], a[16:19], v[204:207]
buffer_load_dwordx4 v20, s[8:11], s59 offen nt lds
ds_read_b128 a[92:95], v11 offset:20480
v_mfma_f32_16x16x32_bf16 v[220:223], a[64:67], a[32:35], v[40:43]
v_exp_f32 v171, v171
v_mfma_f32_16x16x32_bf16 v[220:223], a[68:71], a[36:39], v[220:223]
v_exp_f32 v184, v184
v_mfma_f32_16x16x32_bf16 v[220:223], a[72:75], a[40:43], v[220:223]
v_exp_f32 v185, v185
v_mfma_f32_16x16x32_bf16 v[220:223], a[76:79], a[44:47], v[220:223]
v_cvt_pk_bf16_f32 v167, v170, v171
s_waitcnt lgkmcnt(0)
v_mfma_f32_16x16x32_bf16 v[192:195], a[80:83], a[0:3], v[32:35]
v_exp_f32 v186, v186
v_mfma_f32_16x16x32_bf16 v[192:195], a[84:87], a[4:7], v[192:195]
v_cvt_pk_bf16_f32 v182, v184, v185
v_mfma_f32_16x16x32_bf16 v[192:195], a[88:91], a[8:11], v[192:195]
v_exp_f32 v187, v187
v_mfma_f32_16x16x32_bf16 v[192:195], a[92:95], a[12:15], v[192:195]
ds_read_b128 a[64:67], v8 offset:24576
s_waitcnt vmcnt(4)
buffer_load_dwordx4 v21, s[8:11], s59 offen offset:1024 nt lds
ds_read_b128 a[68:71], v9 offset:24576
ds_read_b128 a[72:75], v10 offset:24576
v_mfma_f32_16x16x32_bf16 v[208:211], a[92:95], a[28:31], v[36:39]
v_cvt_pk_bf16_f32 v183, v186, v187
v_mfma_f32_16x16x32_bf16 v[208:211], a[88:91], a[24:27], v[208:211]
v_exp_f32 v188, v188
v_mfma_f32_16x16x32_bf16 v[208:211], a[84:87], a[20:23], v[208:211]
v_exp_f32 v189, v189
v_mfma_f32_16x16x32_bf16 v[208:211], a[80:83], a[16:19], v[208:211]
ds_read_b128 a[76:79], v11 offset:24576
v_mfma_f32_16x16x32_bf16 v[224:227], a[80:83], a[32:35], v[40:43]
v_exp_f32 v190, v190
v_mfma_f32_16x16x32_bf16 v[224:227], a[84:87], a[36:39], v[224:227]
v_cvt_pk_bf16_f32 v188, v188, v189
v_mfma_f32_16x16x32_bf16 v[224:227], a[88:91], a[40:43], v[224:227]
v_exp_f32 v191, v191
v_mfma_f32_16x16x32_bf16 v[224:227], a[92:95], a[44:47], v[224:227]
s_waitcnt lgkmcnt(0)
v_mfma_f32_16x16x32_bf16 v[196:199], a[64:67], a[0:3], v[32:35]
v_exp_f32 v204, v204
v_mfma_f32_16x16x32_bf16 v[196:199], a[68:71], a[4:7], v[196:199]
v_exp_f32 v205, v205
v_mfma_f32_16x16x32_bf16 v[196:199], a[72:75], a[8:11], v[196:199]
v_cvt_pk_bf16_f32 v189, v190, v191
v_mfma_f32_16x16x32_bf16 v[196:199], a[76:79], a[12:15], v[196:199]
s_waitcnt vmcnt(4)
buffer_load_dwordx4 v22, s[8:11], s59 offen offset:2048 nt lds
ds_read_b128 a[80:83], v8 offset:28672
ds_read_b128 a[84:87], v9 offset:28672
ds_read_b128 a[88:91], v10 offset:28672
v_mfma_f32_16x16x32_bf16 v[212:215], a[76:79], a[28:31], v[36:39]
v_exp_f32 v206, v206
v_mfma_f32_16x16x32_bf16 v[212:215], a[72:75], a[24:27], v[212:215]
v_cvt_pk_bf16_f32 v204, v204, v205
v_mfma_f32_16x16x32_bf16 v[212:215], a[68:71], a[20:23], v[212:215]
v_exp_f32 v207, v207
v_mfma_f32_16x16x32_bf16 v[212:215], a[64:67], a[16:19], v[212:215]
ds_read_b128 a[92:95], v11 offset:28672
v_mfma_f32_16x16x32_bf16 v[228:231], a[64:67], a[32:35], v[40:43]
v_exp_f32 v220, v220
v_mfma_f32_16x16x32_bf16 v[228:231], a[68:71], a[36:39], v[228:231]
v_exp_f32 v221, v221
v_mfma_f32_16x16x32_bf16 v[228:231], a[72:75], a[40:43], v[228:231]
v_cvt_pk_bf16_f32 v205, v206, v207
v_mfma_f32_16x16x32_bf16 v[228:231], a[76:79], a[44:47], v[228:231]
ds_read_b64_tr_b16 a[96:97], v12 offset:0
ds_read_b64_tr_b16 a[98:99], v12 offset:4096
s_waitcnt lgkmcnt(2)
v_mfma_f32_16x16x32_bf16 v[200:203], a[80:83], a[0:3], v[32:35]
v_exp_f32 v222, v222
v_mfma_f32_16x16x32_bf16 v[200:203], a[84:87], a[4:7], v[200:203]
v_cvt_pk_bf16_f32 v220, v220, v221
v_mfma_f32_16x16x32_bf16 v[200:203], a[88:91], a[8:11], v[200:203]
v_exp_f32 v223, v223
v_mfma_f32_16x16x32_bf16 v[200:203], a[92:95], a[12:15], v[200:203]
s_waitcnt vmcnt(4)
buffer_load_dwordx4 v23, s[8:11], s59 offen offset:3072 nt lds
s_add_u32 s59, s59, 16384
s_and_b32 s59, s59, 0x7ffff
ds_read_b64_tr_b16 a[100:101], v12 offset:8192
ds_read_b64_tr_b16 a[102:103], v12 offset:12288
v_mfma_f32_16x16x32_bf16 v[216:219], a[92:95], a[28:31], v[36:39]
v_exp_f32 v192, v192
v_mfma_f32_16x16x32_bf16 v[216:219], a[88:91], a[24:27], v[216:219]
v_exp_f32 v193, v193
v_mfma_f32_16x16x32_bf16 v[216:219], a[84:87], a[20:23], v[216:219]
v_cvt_pk_bf16_f32 v221, v222, v223
s_add_u32 m0, s65, 98304
v_mfma_f32_16x16x32_bf16 v[216:219], a[80:83], a[16:19], v[216:219]
ds_read_b64_tr_b16 a[104:105], v13 offset:0
ds_read_b64_tr_b16 a[106:107], v13 offset:4096
ds_read_b64_tr_b16 a[108:109], v13 offset:8192
ds_read_b64_tr_b16 a[110:111], v13 offset:12288
v_mfma_f32_16x16x32_bf16 v[232:235], a[80:83], a[32:35], v[40:43]
v_exp_f32 v194, v194
v_mfma_f32_16x16x32_bf16 v[232:235], a[84:87], a[36:39], v[232:235]
v_cvt_pk_bf16_f32 v190, v192, v193
v_mfma_f32_16x16x32_bf16 v[232:235], a[88:91], a[40:43], v[232:235]
v_exp_f32 v195, v195
v_mfma_f32_16x16x32_bf16 v[232:235], a[92:95], a[44:47], v[232:235]
ds_read_b64_tr_b16 a[112:113], v14 offset:0
s_waitcnt lgkmcnt(5)
v_mfma_f32_16x16x32_bf16 v[44:47], a[96:99], v[140:143], v[44:47]
v_exp_f32 v208, v208
v_mfma_f32_16x16x32_bf16 v[44:47], a[100:103], v[148:151], v[44:47]
s_waitcnt vmcnt(4)
buffer_load_dwordx4 v24, s[12:15], s60 offen nt lds
ds_read_b64_tr_b16 a[114:115], v14 offset:4096
v_mfma_f32_16x16x32_bf16 v[76:79], a[100:103], v[164:167], v[76:79]
v_exp_f32 v209, v209
v_mfma_f32_16x16x32_bf16 v[76:79], a[96:99], v[156:159], v[76:79]
ds_read_b64_tr_b16 a[116:117], v14 offset:8192
ds_read_b64_tr_b16 a[118:119], v14 offset:12288
v_mfma_f32_16x16x32_bf16 v[108:111], a[96:99], v[172:175], v[108:111]
v_cvt_pk_bf16_f32 v191, v194, v195
v_mfma_f32_16x16x32_bf16 v[108:111], a[100:103], v[180:183], v[108:111]
ds_read_b64_tr_b16 a[120:121], v15 offset:0
s_waitcnt lgkmcnt(5)
v_mfma_f32_16x16x32_bf16 v[48:51], a[104:107], v[140:143], v[48:51]
v_exp_f32 v210, v210
v_mfma_f32_16x16x32_bf16 v[48:51], a[108:111], v[148:151], v[48:51]
ds_read_b64_tr_b16 a[122:123], v15 offset:4096
v_cvt_pk_bf16_f32 v206, v208, v209
v_mfma_f32_16x16x32_bf16 v[80:83], a[108:111], v[164:167], v[80:83]
v_exp_f32 v211, v211
v_mfma_f32_16x16x32_bf16 v[80:83], a[104:107], v[156:159], v[80:83]
ds_read_b64_tr_b16 a[124:125], v15 offset:8192
ds_read_b64_tr_b16 a[126:127], v15 offset:12288
v_mfma_f32_16x16x32_bf16 v[112:115], a[104:107], v[172:175], v[112:115]
v_exp_f32 v224, v224
v_mfma_f32_16x16x32_bf16 v[112:115], a[108:111], v[180:183], v[112:115]
s_waitcnt vmcnt(4)
buffer_load_dwordx4 v25, s[12:15], s60 offen offset:1024 nt lds
v_mfma_f32_16x16x32_bf16 a[48:51], a[60:63], v[140:143], a[48:51]
v_exp_f32 v225, v225
v_mfma_f32_16x16x32_bf16 a[48:51], a[60:63], v[148:151], a[48:51]
v_cvt_pk_bf16_f32 v207, v210, v211
s_waitcnt lgkmcnt(4)
v_mfma_f32_16x16x32_bf16 v[52:55], a[112:115], v[140:143], v[52:55]
v_exp_f32 v226, v226
v_mfma_f32_16x16x32_bf16 v[52:55], a[116:119], v[148:151], v[52:55]
ds_read_b64_tr_b16 a[96:97], v16 offset:0
ds_read_b64_tr_b16 a[98:99], v16 offset:4096
v_mfma_f32_16x16x32_bf16 v[84:87], a[116:119], v[164:167], v[84:87]
v_cvt_pk_bf16_f32 v222, v224, v225
v_mfma_f32_16x16x32_bf16 v[84:87], a[112:115], v[156:159], v[84:87]
ds_read_b64_tr_b16 a[100:101], v16 offset:8192
ds_read_b64_tr_b16 a[102:103], v16 offset:12288
v_mfma_f32_16x16x32_bf16 v[116:119], a[112:115], v[172:175], v[116:119]
v_exp_f32 v227, v227
v_mfma_f32_16x16x32_bf16 v[116:119], a[116:119], v[180:183], v[116:119]
ds_read_b64_tr_b16 a[104:105], v17 offset:0
s_waitcnt lgkmcnt(5)
v_mfma_f32_16x16x32_bf16 v[56:59], a[120:123], v[140:143], v[56:59]
v_exp_f32 v196, v196
v_mfma_f32_16x16x32_bf16 v[56:59], a[124:127], v[148:151], v[56:59]
ds_read_b64_tr_b16 a[106:107], v17 offset:4096
ds_read_b64_tr_b16 a[108:109], v17 offset:8192
v_mfma_f32_16x16x32_bf16 v[88:91], a[124:127], v[164:167], v[88:91]
v_exp_f32 v197, v197
v_mfma_f32_16x16x32_bf16 v[88:91], a[120:123], v[156:159], v[88:91]
s_waitcnt vmcnt(4)
buffer_load_dwordx4 v24, s[12:15], s60 offen offset:2048 nt lds
ds_read_b64_tr_b16 a[110:111], v17 offset:12288
v_mfma_f32_16x16x32_bf16 v[120:123], a[120:123], v[172:175], v[120:123]
v_cvt_pk_bf16_f32 v223, v226, v227
v_mfma_f32_16x16x32_bf16 v[120:123], a[124:127], v[180:183], v[120:123]
v_exp_f32 v198, v198
v_mfma_f32_16x16x32_bf16 a[52:55], a[60:63], v[156:159], a[52:55]
v_cvt_pk_bf16_f32 v196, v196, v197
v_mfma_f32_16x16x32_bf16 a[52:55], a[60:63], v[164:167], a[52:55]
ds_read_b64_tr_b16 a[112:113], v18 offset:0
s_waitcnt lgkmcnt(5)
v_mfma_f32_16x16x32_bf16 v[60:63], a[96:99], v[140:143], v[60:63]
v_exp_f32 v199, v199
v_mfma_f32_16x16x32_bf16 v[60:63], a[100:103], v[148:151], v[60:63]
ds_read_b64_tr_b16 a[114:115], v18 offset:4096
ds_read_b64_tr_b16 a[116:117], v18 offset:8192
v_mfma_f32_16x16x32_bf16 v[92:95], a[100:103], v[164:167], v[92:95]
v_exp_f32 v212, v212
v_mfma_f32_16x16x32_bf16 v[92:95], a[96:99], v[156:159], v[92:95]
ds_read_b64_tr_b16 a[118:119], v18 offset:12288
v_mfma_f32_16x16x32_bf16 v[124:127], a[96:99], v[172:175], v[124:127]
v_exp_f32 v213, v213
v_mfma_f32_16x16x32_bf16 v[124:127], a[100:103], v[180:183], v[124:127]
s_waitcnt vmcnt(3)
buffer_load_dwordx4 v25, s[12:15], s60 offen offset:3072 nt lds
s_waitcnt lgkmcnt(4)
v_mfma_f32_16x16x32_bf16 v[64:67], a[104:107], v[140:143], v[64:67]
s_add_u32 s60, s60, 16384
s_and_b32 s60, s60, 0x7ffff
v_mfma_f32_16x16x32_bf16 v[64:67], a[108:111], v[148:151], v[64:67]
ds_read_b64_tr_b16 a[120:121], v19 offset:0
ds_read_b64_tr_b16 a[122:123], v19 offset:4096
v_mfma_f32_16x16x32_bf16 v[96:99], a[108:111], v[164:167], v[96:99]
v_cvt_pk_bf16_f32 v197, v198, v199
v_mfma_f32_16x16x32_bf16 v[96:99], a[104:107], v[156:159], v[96:99]
ds_read_b64_tr_b16 a[124:125], v19 offset:8192
s_barrier
ds_read_b64_tr_b16 a[126:127], v19 offset:12288
v_mfma_f32_16x16x32_bf16 v[128:131], a[104:107], v[172:175], v[128:131]
v_exp_f32 v214, v214
v_mfma_f32_16x16x32_bf16 v[128:131], a[108:111], v[180:183], v[128:131]
v_cvt_pk_bf16_f32 v212, v212, v213
v_mfma_f32_16x16x32_bf16 a[56:59], a[60:63], v[172:175], a[56:59]
v_exp_f32 v215, v215
v_mfma_f32_16x16x32_bf16 a[56:59], a[60:63], v[180:183], a[56:59]
ds_read_b128 a[64:67], v8 offset:32768
s_waitcnt lgkmcnt(5)
v_mfma_f32_16x16x32_bf16 v[68:71], a[112:115], v[140:143], v[68:71]
v_exp_f32 v228, v228
v_mfma_f32_16x16x32_bf16 v[68:71], a[116:119], v[148:151], v[68:71]
ds_read_b128 a[68:71], v9 offset:32768
ds_read_b128 a[72:75], v10 offset:32768
v_mfma_f32_16x16x32_bf16 v[100:103], a[116:119], v[164:167], v[100:103]
v_exp_f32 v229, v229
v_mfma_f32_16x16x32_bf16 v[100:103], a[112:115], v[156:159], v[100:103]
v_cvt_pk_bf16_f32 v213, v214, v215
ds_read_b128 a[76:79], v11 offset:32768
v_mfma_f32_16x16x32_bf16 v[132:135], a[112:115], v[172:175], v[132:135]
v_exp_f32 v230, v230
v_mfma_f32_16x16x32_bf16 v[132:135], a[116:119], v[180:183], v[132:135]
v_cvt_pk_bf16_f32 v228, v228, v229
s_waitcnt lgkmcnt(4)
v_mfma_f32_16x16x32_bf16 v[72:75], a[120:123], v[140:143], v[72:75]
v_exp_f32 v231, v231
v_mfma_f32_16x16x32_bf16 v[72:75], a[124:127], v[148:151], v[72:75]
v_exp_f32 v200, v200
v_mfma_f32_16x16x32_bf16 v[104:107], a[124:127], v[164:167], v[104:107]
v_exp_f32 v201, v201
v_mfma_f32_16x16x32_bf16 v[104:107], a[120:123], v[156:159], v[104:107]
v_cvt_pk_bf16_f32 v229, v230, v231
v_mfma_f32_16x16x32_bf16 v[136:139], a[120:123], v[172:175], v[136:139]
v_exp_f32 v202, v202
v_mfma_f32_16x16x32_bf16 v[136:139], a[124:127], v[180:183], v[136:139]
v_cvt_pk_bf16_f32 v198, v200, v201
v_exp_f32 v203, v203
s_waitcnt lgkmcnt(0)
v_mfma_f32_16x16x32_bf16 v[140:143], a[64:67], a[0:3], v[32:35]
v_exp_f32 v216, v216
v_mfma_f32_16x16x32_bf16 v[140:143], a[68:71], a[4:7], v[140:143]
s_add_u32 m0, s65, 16384
v_mfma_f32_16x16x32_bf16 v[140:143], a[72:75], a[8:11], v[140:143]
v_exp_f32 v217, v217
v_mfma_f32_16x16x32_bf16 v[140:143], a[76:79], a[12:15], v[140:143]
ds_read_b128 a[80:83], v8 offset:36864
ds_read_b128 a[84:87], v9 offset:36864
ds_read_b128 a[88:91], v10 offset:36864
v_mfma_f32_16x16x32_bf16 v[156:159], a[76:79], a[28:31], v[36:39]
v_cvt_pk_bf16_f32 v199, v202, v203
v_mfma_f32_16x16x32_bf16 v[156:159], a[72:75], a[24:27], v[156:159]
v_exp_f32 v218, v218
v_mfma_f32_16x16x32_bf16 v[156:159], a[68:71], a[20:23], v[156:159]
v_cvt_pk_bf16_f32 v214, v216, v217
v_mfma_f32_16x16x32_bf16 v[156:159], a[64:67], a[16:19], v[156:159]
buffer_load_dwordx4 v20, s[8:11], s59 offen nt lds
ds_read_b128 a[92:95], v11 offset:36864
v_mfma_f32_16x16x32_bf16 v[172:175], a[64:67], a[32:35], v[40:43]
v_exp_f32 v219, v219
v_mfma_f32_16x16x32_bf16 v[172:175], a[68:71], a[36:39], v[172:175]
v_exp_f32 v232, v232
v_mfma_f32_16x16x32_bf16 v[172:175], a[72:75], a[40:43], v[172:175]
v_exp_f32 v233, v233
v_mfma_f32_16x16x32_bf16 v[172:175], a[76:79], a[44:47], v[172:175]
v_cvt_pk_bf16_f32 v215, v218, v219
s_waitcnt lgkmcnt(0)
v_mfma_f32_16x16x32_bf16 v[144:147], a[80:83], a[0:3], v[32:35]
v_exp_f32 v234, v234
v_mfma_f32_16x16x32_bf16 v[144:147], a[84:87], a[4:7], v[144:147]
v_cvt_pk_bf16_f32 v230, v232, v233
v_mfma_f32_16x16x32_bf16 v[144:147], a[88:91], a[8:11], v[144:147]
v_exp_f32 v235, v235
v_mfma_f32_16x16x32_bf16 v[144:147], a[92:95], a[12:15], v[144:147]
ds_read_b128 a[64:67], v8 offset:40960
s_waitcnt vmcnt(4)
buffer_load_dwordx4 v21, s[8:11], s59 offen offset:1024 nt lds
ds_read_b128 a[68:71], v9 offset:40960
ds_read_b128 a[72:75], v10 offset:40960
v_mfma_f32_16x16x32_bf16 v[160:163], a[92:95], a[28:31], v[36:39]
v_cvt_pk_bf16_f32 v231, v234, v235
v_mfma_f32_16x16x32_bf16 v[160:163], a[88:91], a[24:27], v[160:163]
v_exp_f32 v140, v140
v_mfma_f32_16x16x32_bf16 v[160:163], a[84:87], a[20:23], v[160:163]
v_exp_f32 v141, v141
v_mfma_f32_16x16x32_bf16 v[160:163], a[80:83], a[16:19], v[160:163]
ds_read_b128 a[76:79], v11 offset:40960
v_mfma_f32_16x16x32_bf16 v[176:179], a[80:83], a[32:35], v[40:43]
v_exp_f32 v142, v142
v_mfma_f32_16x16x32_bf16 v[176:179], a[84:87], a[36:39], v[176:179]
v_cvt_pk_bf16_f32 v140, v140, v141
v_mfma_f32_16x16x32_bf16 v[176:179], a[88:91], a[40:43], v[176:179]
v_exp_f32 v143, v143
v_mfma_f32_16x16x32_bf16 v[176:179], a[92:95], a[44:47], v[176:179]
s_waitcnt lgkmcnt(0)
v_mfma_f32_16x16x32_bf16 v[148:151], a[64:67], a[0:3], v[32:35]
v_exp_f32 v156, v156
v_mfma_f32_16x16x32_bf16 v[148:151], a[68:71], a[4:7], v[148:151]
v_exp_f32 v157, v157
v_mfma_f32_16x16x32_bf16 v[148:151], a[72:75], a[8:11], v[148:151]
v_cvt_pk_bf16_f32 v141, v142, v143
v_mfma_f32_16x16x32_bf16 v[148:151], a[76:79], a[12:15], v[148:151]
s_waitcnt vmcnt(4)
buffer_load_dwordx4 v22, s[8:11], s59 offen offset:2048 nt lds
ds_read_b128 a[80:83], v8 offset:45056
ds_read_b128 a[84:87], v9 offset:45056
ds_read_b128 a[88:91], v10 offset:45056
v_mfma_f32_16x16x32_bf16 v[164:167], a[76:79], a[28:31], v[36:39]
v_exp_f32 v158, v158
v_mfma_f32_16x16x32_bf16 v[164:167], a[72:75], a[24:27], v[164:167]
v_cvt_pk_bf16_f32 v156, v156, v157
v_mfma_f32_16x16x32_bf16 v[164:167], a[68:71], a[20:23], v[164:167]
v_exp_f32 v159, v159
v_mfma_f32_16x16x32_bf16 v[164:167], a[64:67], a[16:19], v[164:167]
ds_read_b128 a[92:95], v11 offset:45056
v_mfma_f32_16x16x32_bf16 v[180:183], a[64:67], a[32:35], v[40:43]
v_exp_f32 v172, v172
v_mfma_f32_16x16x32_bf16 v[180:183], a[68:71], a[36:39], v[180:183]
v_exp_f32 v173, v173
v_mfma_f32_16x16x32_bf16 v[180:183], a[72:75], a[40:43], v[180:183]
v_cvt_pk_bf16_f32 v157, v158, v159
v_mfma_f32_16x16x32_bf16 v[180:183], a[76:79], a[44:47], v[180:183]
ds_read_b64_tr_b16 a[96:97], v12 offset:16384
ds_read_b64_tr_b16 a[98:99], v12 offset:20480
s_waitcnt lgkmcnt(2)
v_mfma_f32_16x16x32_bf16 v[152:155], a[80:83], a[0:3], v[32:35]
v_exp_f32 v174, v174
v_mfma_f32_16x16x32_bf16 v[152:155], a[84:87], a[4:7], v[152:155]
v_cvt_pk_bf16_f32 v172, v172, v173
v_mfma_f32_16x16x32_bf16 v[152:155], a[88:91], a[8:11], v[152:155]
v_exp_f32 v175, v175
v_mfma_f32_16x16x32_bf16 v[152:155], a[92:95], a[12:15], v[152:155]
s_waitcnt vmcnt(4)
buffer_load_dwordx4 v23, s[8:11], s59 offen offset:3072 nt lds
s_add_u32 s59, s59, 16384
s_and_b32 s59, s59, 0x7ffff
ds_read_b64_tr_b16 a[100:101], v12 offset:24576
ds_read_b64_tr_b16 a[102:103], v12 offset:28672
v_mfma_f32_16x16x32_bf16 v[168:171], a[92:95], a[28:31], v[36:39]
v_exp_f32 v144, v144
v_mfma_f32_16x16x32_bf16 v[168:171], a[88:91], a[24:27], v[168:171]
v_exp_f32 v145, v145
v_mfma_f32_16x16x32_bf16 v[168:171], a[84:87], a[20:23], v[168:171]
v_cvt_pk_bf16_f32 v173, v174, v175
s_add_u32 m0, s65, 114688
v_mfma_f32_16x16x32_bf16 v[168:171], a[80:83], a[16:19], v[168:171]
ds_read_b64_tr_b16 a[104:105], v13 offset:16384
ds_read_b64_tr_b16 a[106:107], v13 offset:20480
ds_read_b64_tr_b16 a[108:109], v13 offset:24576
ds_read_b64_tr_b16 a[110:111], v13 offset:28672
v_mfma_f32_16x16x32_bf16 v[184:187], a[80:83], a[32:35], v[40:43]
v_exp_f32 v146, v146
v_mfma_f32_16x16x32_bf16 v[184:187], a[84:87], a[36:39], v[184:187]
v_cvt_pk_bf16_f32 v142, v144, v145
v_mfma_f32_16x16x32_bf16 v[184:187], a[88:91], a[40:43], v[184:187]
v_exp_f32 v147, v147
v_mfma_f32_16x16x32_bf16 v[184:187], a[92:95], a[44:47], v[184:187]
ds_read_b64_tr_b16 a[112:113], v14 offset:16384
s_waitcnt lgkmcnt(5)
v_mfma_f32_16x16x32_bf16 v[44:47], a[96:99], v[188:191], v[44:47]
v_exp_f32 v160, v160
v_mfma_f32_16x16x32_bf16 v[44:47], a[100:103], v[196:199], v[44:47]
s_waitcnt vmcnt(4)
buffer_load_dwordx4 v24, s[12:15], s60 offen nt lds
ds_read_b64_tr_b16 a[114:115], v14 offset:20480
v_mfma_f32_16x16x32_bf16 v[76:79], a[100:103], v[212:215], v[76:79]
v_exp_f32 v161, v161
v_mfma_f32_16x16x32_bf16 v[76:79], a[96:99], v[204:207], v[76:79]
ds_read_b64_tr_b16 a[116:117], v14 offset:24576
ds_read_b64_tr_b16 a[118:119], v14 offset:28672
v_mfma_f32_16x16x32_bf16 v[108:111], a[96:99], v[220:223], v[108:111]
v_cvt_pk_bf16_f32 v143, v146, v147
v_mfma_f32_16x16x32_bf16 v[108:111], a[100:103], v[228:231], v[108:111]
ds_read_b64_tr_b16 a[120:121], v15 offset:16384
s_waitcnt lgkmcnt(5)
v_mfma_f32_16x16x32_bf16 v[48:51], a[104:107], v[188:191], v[48:51]
v_exp_f32 v162, v162
v_mfma_f32_16x16x32_bf16 v[48:51], a[108:111], v[196:199], v[48:51]
ds_read_b64_tr_b16 a[122:123], v15 offset:20480
v_cvt_pk_bf16_f32 v158, v160, v161
v_mfma_f32_16x16x32_bf16 v[80:83], a[108:111], v[212:215], v[80:83]
v_exp_f32 v163, v163
v_mfma_f32_16x16x32_bf16 v[80:83], a[104:107], v[204:207], v[80:83]
ds_read_b64_tr_b16 a[124:125], v15 offset:24576
ds_read_b64_tr_b16 a[126:127], v15 offset:28672
v_mfma_f32_16x16x32_bf16 v[112:115], a[104:107], v[220:223], v[112:115]
v_exp_f32 v176, v176
v_mfma_f32_16x16x32_bf16 v[112:115], a[108:111], v[228:231], v[112:115]
s_waitcnt vmcnt(4)
buffer_load_dwordx4 v25, s[12:15], s60 offen offset:1024 nt lds
v_mfma_f32_16x16x32_bf16 a[48:51], a[60:63], v[188:191], a[48:51]
v_exp_f32 v177, v177
v_mfma_f32_16x16x32_bf16 a[48:51], a[60:63], v[196:199], a[48:51]
v_cvt_pk_bf16_f32 v159, v162, v163
s_waitcnt lgkmcnt(4)
v_mfma_f32_16x16x32_bf16 v[52:55], a[112:115], v[188:191], v[52:55]
v_exp_f32 v178, v178
v_mfma_f32_16x16x32_bf16 v[52:55], a[116:119], v[196:199], v[52:55]
ds_read_b64_tr_b16 a[96:97], v16 offset:16384
ds_read_b64_tr_b16 a[98:99], v16 offset:20480
v_mfma_f32_16x16x32_bf16 v[84:87], a[116:119], v[212:215], v[84:87]
v_cvt_pk_bf16_f32 v174, v176, v177
v_mfma_f32_16x16x32_bf16 v[84:87], a[112:115], v[204:207], v[84:87]
ds_read_b64_tr_b16 a[100:101], v16 offset:24576
ds_read_b64_tr_b16 a[102:103], v16 offset:28672
v_mfma_f32_16x16x32_bf16 v[116:119], a[112:115], v[220:223], v[116:119]
v_exp_f32 v179, v179
v_mfma_f32_16x16x32_bf16 v[116:119], a[116:119], v[228:231], v[116:119]
ds_read_b64_tr_b16 a[104:105], v17 offset:16384
s_waitcnt lgkmcnt(5)
v_mfma_f32_16x16x32_bf16 v[56:59], a[120:123], v[188:191], v[56:59]
v_exp_f32 v148, v148
v_mfma_f32_16x16x32_bf16 v[56:59], a[124:127], v[196:199], v[56:59]
ds_read_b64_tr_b16 a[106:107], v17 offset:20480
ds_read_b64_tr_b16 a[108:109], v17 offset:24576
v_mfma_f32_16x16x32_bf16 v[88:91], a[124:127], v[212:215], v[88:91]
v_exp_f32 v149, v149
v_mfma_f32_16x16x32_bf16 v[88:91], a[120:123], v[204:207], v[88:91]
s_waitcnt vmcnt(4)
buffer_load_dwordx4 v24, s[12:15], s60 offen offset:2048 nt lds
ds_read_b64_tr_b16 a[110:111], v17 offset:28672
v_mfma_f32_16x16x32_bf16 v[120:123], a[120:123], v[220:223], v[120:123]
v_cvt_pk_bf16_f32 v175, v178, v179
v_mfma_f32_16x16x32_bf16 v[120:123], a[124:127], v[228:231], v[120:123]
v_exp_f32 v150, v150
v_mfma_f32_16x16x32_bf16 a[52:55], a[60:63], v[204:207], a[52:55]
v_cvt_pk_bf16_f32 v148, v148, v149
v_mfma_f32_16x16x32_bf16 a[52:55], a[60:63], v[212:215], a[52:55]
ds_read_b64_tr_b16 a[112:113], v18 offset:16384
s_waitcnt lgkmcnt(5)
v_mfma_f32_16x16x32_bf16 v[60:63], a[96:99], v[188:191], v[60:63]
v_exp_f32 v151, v151
v_mfma_f32_16x16x32_bf16 v[60:63], a[100:103], v[196:199], v[60:63]
ds_read_b64_tr_b16 a[114:115], v18 offset:20480
ds_read_b64_tr_b16 a[116:117], v18 offset:24576
v_mfma_f32_16x16x32_bf16 v[92:95], a[100:103], v[212:215], v[92:95]
v_exp_f32 v164, v164
v_mfma_f32_16x16x32_bf16 v[92:95], a[96:99], v[204:207], v[92:95]
ds_read_b64_tr_b16 a[118:119], v18 offset:28672
v_mfma_f32_16x16x32_bf16 v[124:127], a[96:99], v[220:223], v[124:127]
v_exp_f32 v165, v165
v_mfma_f32_16x16x32_bf16 v[124:127], a[100:103], v[228:231], v[124:127]
s_waitcnt vmcnt(3)
buffer_load_dwordx4 v25, s[12:15], s60 offen offset:3072 nt lds
s_waitcnt lgkmcnt(4)
v_mfma_f32_16x16x32_bf16 v[64:67], a[104:107], v[188:191], v[64:67]
s_add_u32 s60, s60, 16384
s_and_b32 s60, s60, 0x7ffff
v_mfma_f32_16x16x32_bf16 v[64:67], a[108:111], v[196:199], v[64:67]
ds_read_b64_tr_b16 a[120:121], v19 offset:16384
ds_read_b64_tr_b16 a[122:123], v19 offset:20480
v_mfma_f32_16x16x32_bf16 v[96:99], a[108:111], v[212:215], v[96:99]
v_cvt_pk_bf16_f32 v149, v150, v151
v_mfma_f32_16x16x32_bf16 v[96:99], a[104:107], v[204:207], v[96:99]
ds_read_b64_tr_b16 a[124:125], v19 offset:24576
s_barrier
ds_read_b64_tr_b16 a[126:127], v19 offset:28672
v_mfma_f32_16x16x32_bf16 v[128:131], a[104:107], v[220:223], v[128:131]
v_exp_f32 v166, v166
v_mfma_f32_16x16x32_bf16 v[128:131], a[108:111], v[228:231], v[128:131]
v_cvt_pk_bf16_f32 v164, v164, v165
v_mfma_f32_16x16x32_bf16 a[56:59], a[60:63], v[220:223], a[56:59]
v_exp_f32 v167, v167
v_mfma_f32_16x16x32_bf16 a[56:59], a[60:63], v[228:231], a[56:59]
ds_read_b128 a[64:67], v8 offset:49152
s_waitcnt lgkmcnt(5)
v_mfma_f32_16x16x32_bf16 v[68:71], a[112:115], v[188:191], v[68:71]
v_exp_f32 v180, v180
v_mfma_f32_16x16x32_bf16 v[68:71], a[116:119], v[196:199], v[68:71]
ds_read_b128 a[68:71], v9 offset:49152
ds_read_b128 a[72:75], v10 offset:49152
v_mfma_f32_16x16x32_bf16 v[100:103], a[116:119], v[212:215], v[100:103]
v_exp_f32 v181, v181
v_mfma_f32_16x16x32_bf16 v[100:103], a[112:115], v[204:207], v[100:103]
v_cvt_pk_bf16_f32 v165, v166, v167
ds_read_b128 a[76:79], v11 offset:49152
v_mfma_f32_16x16x32_bf16 v[132:135], a[112:115], v[220:223], v[132:135]
v_exp_f32 v182, v182
v_mfma_f32_16x16x32_bf16 v[132:135], a[116:119], v[228:231], v[132:135]
v_cvt_pk_bf16_f32 v180, v180, v181
s_waitcnt lgkmcnt(4)
v_mfma_f32_16x16x32_bf16 v[72:75], a[120:123], v[188:191], v[72:75]
v_exp_f32 v183, v183
v_mfma_f32_16x16x32_bf16 v[72:75], a[124:127], v[196:199], v[72:75]
v_exp_f32 v152, v152
v_mfma_f32_16x16x32_bf16 v[104:107], a[124:127], v[212:215], v[104:107]
v_exp_f32 v153, v153
v_mfma_f32_16x16x32_bf16 v[104:107], a[120:123], v[204:207], v[104:107]
v_cvt_pk_bf16_f32 v181, v182, v183
v_mfma_f32_16x16x32_bf16 v[136:139], a[120:123], v[220:223], v[136:139]
v_exp_f32 v154, v154
v_mfma_f32_16x16x32_bf16 v[136:139], a[124:127], v[228:231], v[136:139]
v_cvt_pk_bf16_f32 v150, v152, v153
v_exp_f32 v155, v155
s_waitcnt lgkmcnt(0)
v_mfma_f32_16x16x32_bf16 v[188:191], a[64:67], a[0:3], v[32:35]
v_exp_f32 v168, v168
v_mfma_f32_16x16x32_bf16 v[188:191], a[68:71], a[4:7], v[188:191]
s_add_u32 m0, s65, 32768
v_mfma_f32_16x16x32_bf16 v[188:191], a[72:75], a[8:11], v[188:191]
v_exp_f32 v169, v169
v_mfma_f32_16x16x32_bf16 v[188:191], a[76:79], a[12:15], v[188:191]
ds_read_b128 a[80:83], v8 offset:53248
ds_read_b128 a[84:87], v9 offset:53248
ds_read_b128 a[88:91], v10 offset:53248
v_mfma_f32_16x16x32_bf16 v[204:207], a[76:79], a[28:31], v[36:39]
v_cvt_pk_bf16_f32 v151, v154, v155
v_mfma_f32_16x16x32_bf16 v[204:207], a[72:75], a[24:27], v[204:207]
v_exp_f32 v170, v170
v_mfma_f32_16x16x32_bf16 v[204:207], a[68:71], a[20:23], v[204:207]
v_cvt_pk_bf16_f32 v166, v168, v169
v_mfma_f32_16x16x32_bf16 v[204:207], a[64:67], a[16:19], v[204:207]
buffer_load_dwordx4 v20, s[8:11], s59 offen nt lds
ds_read_b128 a[92:95], v11 offset:53248
v_mfma_f32_16x16x32_bf16 v[220:223], a[64:67], a[32:35], v[40:43]
v_exp_f32 v171, v171
v_mfma_f32_16x16x32_bf16 v[220:223], a[68:71], a[36:39], v[220:223]
v_exp_f32 v184, v184
v_mfma_f32_16x16x32_bf16 v[220:223], a[72:75], a[40:43], v[220:223]
v_exp_f32 v185, v185
v_mfma_f32_16x16x32_bf16 v[220:223], a[76:79], a[44:47], v[220:223]
v_cvt_pk_bf16_f32 v167, v170, v171
s_waitcnt lgkmcnt(0)
v_mfma_f32_16x16x32_bf16 v[192:195], a[80:83], a[0:3], v[32:35]
v_exp_f32 v186, v186
v_mfma_f32_16x16x32_bf16 v[192:195], a[84:87], a[4:7], v[192:195]
v_cvt_pk_bf16_f32 v182, v184, v185
v_mfma_f32_16x16x32_bf16 v[192:195], a[88:91], a[8:11], v[192:195]
v_exp_f32 v187, v187
v_mfma_f32_16x16x32_bf16 v[192:195], a[92:95], a[12:15], v[192:195]
ds_read_b128 a[64:67], v8 offset:57344
s_waitcnt vmcnt(4)
buffer_load_dwordx4 v21, s[8:11], s59 offen offset:1024 nt lds
ds_read_b128 a[68:71], v9 offset:57344
ds_read_b128 a[72:75], v10 offset:57344
v_mfma_f32_16x16x32_bf16 v[208:211], a[92:95], a[28:31], v[36:39]
v_cvt_pk_bf16_f32 v183, v186, v187
v_mfma_f32_16x16x32_bf16 v[208:211], a[88:91], a[24:27], v[208:211]
v_exp_f32 v188, v188
v_mfma_f32_16x16x32_bf16 v[208:211], a[84:87], a[20:23], v[208:211]
v_exp_f32 v189, v189
v_mfma_f32_16x16x32_bf16 v[208:211], a[80:83], a[16:19], v[208:211]
ds_read_b128 a[76:79], v11 offset:57344
v_mfma_f32_16x16x32_bf16 v[224:227], a[80:83], a[32:35], v[40:43]
v_exp_f32 v190, v190
v_mfma_f32_16x16x32_bf16 v[224:227], a[84:87], a[36:39], v[224:227]
v_cvt_pk_bf16_f32 v188, v188, v189
v_mfma_f32_16x16x32_bf16 v[224:227], a[88:91], a[40:43], v[224:227]
v_exp_f32 v191, v191
v_mfma_f32_16x16x32_bf16 v[224:227], a[92:95], a[44:47], v[224:227]
s_waitcnt lgkmcnt(0)
v_mfma_f32_16x16x32_bf16 v[196:199], a[64:67], a[0:3], v[32:35]
v_exp_f32 v204, v204
v_mfma_f32_16x16x32_bf16 v[196:199], a[68:71], a[4:7], v[196:199]
v_exp_f32 v205, v205
v_mfma_f32_16x16x32_bf16 v[196:199], a[72:75], a[8:11], v[196:199]
v_cvt_pk_bf16_f32 v189, v190, v191
v_mfma_f32_16x16x32_bf16 v[196:199], a[76:79], a[12:15], v[196:199]
s_waitcnt vmcnt(4)
buffer_load_dwordx4 v22, s[8:11], s59 offen offset:2048 nt lds
ds_read_b128 a[80:83], v8 offset:61440
ds_read_b128 a[84:87], v9 offset:61440
ds_read_b128 a[88:91], v10 offset:61440
v_mfma_f32_16x16x32_bf16 v[212:215], a[76:79], a[28:31], v[36:39]
v_exp_f32 v206, v206
v_mfma_f32_16x16x32_bf16 v[212:215], a[72:75], a[24:27], v[212:215]
v_cvt_pk_bf16_f32 v204, v204, v205
v_mfma_f32_16x16x32_bf16 v[212:215], a[68:71], a[20:23], v[212:215]
v_exp_f32 v207, v207
v_mfma_f32_16x16x32_bf16 v[212:215], a[64:67], a[16:19], v[212:215]
ds_read_b128 a[92:95], v11 offset:61440
v_mfma_f32_16x16x32_bf16 v[228:231], a[64:67], a[32:35], v[40:43]
v_exp_f32 v220, v220
v_mfma_f32_16x16x32_bf16 v[228:231], a[68:71], a[36:39], v[228:231]
v_exp_f32 v221, v221
v_mfma_f32_16x16x32_bf16 v[228:231], a[72:75], a[40:43], v[228:231]
v_cvt_pk_bf16_f32 v205, v206, v207
v_mfma_f32_16x16x32_bf16 v[228:231], a[76:79], a[44:47], v[228:231]
ds_read_b64_tr_b16 a[96:97], v12 offset:32768
ds_read_b64_tr_b16 a[98:99], v12 offset:36864
s_waitcnt lgkmcnt(2)
v_mfma_f32_16x16x32_bf16 v[200:203], a[80:83], a[0:3], v[32:35]
v_exp_f32 v222, v222
v_mfma_f32_16x16x32_bf16 v[200:203], a[84:87], a[4:7], v[200:203]
v_cvt_pk_bf16_f32 v220, v220, v221
v_mfma_f32_16x16x32_bf16 v[200:203], a[88:91], a[8:11], v[200:203]
v_exp_f32 v223, v223
v_mfma_f32_16x16x32_bf16 v[200:203], a[92:95], a[12:15], v[200:203]
s_waitcnt vmcnt(4)
buffer_load_dwordx4 v23, s[8:11], s59 offen offset:3072 nt lds
s_add_u32 s59, s59, 16384
s_and_b32 s59, s59, 0x7ffff
ds_read_b64_tr_b16 a[100:101], v12 offset:40960
ds_read_b64_tr_b16 a[102:103], v12 offset:45056
v_mfma_f32_16x16x32_bf16 v[216:219], a[92:95], a[28:31], v[36:39]
v_exp_f32 v192, v192
v_mfma_f32_16x16x32_bf16 v[216:219], a[88:91], a[24:27], v[216:219]
v_exp_f32 v193, v193
v_mfma_f32_16x16x32_bf16 v[216:219], a[84:87], a[20:23], v[216:219]
v_cvt_pk_bf16_f32 v221, v222, v223
s_add_u32 m0, s65, 65536
v_mfma_f32_16x16x32_bf16 v[216:219], a[80:83], a[16:19], v[216:219]
ds_read_b64_tr_b16 a[104:105], v13 offset:32768
ds_read_b64_tr_b16 a[106:107], v13 offset:36864
ds_read_b64_tr_b16 a[108:109], v13 offset:40960
ds_read_b64_tr_b16 a[110:111], v13 offset:45056
v_mfma_f32_16x16x32_bf16 v[232:235], a[80:83], a[32:35], v[40:43]
v_exp_f32 v194, v194
v_mfma_f32_16x16x32_bf16 v[232:235], a[84:87], a[36:39], v[232:235]
v_cvt_pk_bf16_f32 v190, v192, v193
v_mfma_f32_16x16x32_bf16 v[232:235], a[88:91], a[40:43], v[232:235]
v_exp_f32 v195, v195
v_mfma_f32_16x16x32_bf16 v[232:235], a[92:95], a[44:47], v[232:235]
ds_read_b64_tr_b16 a[112:113], v14 offset:32768
s_waitcnt lgkmcnt(5)
v_mfma_f32_16x16x32_bf16 v[44:47], a[96:99], v[140:143], v[44:47]
v_exp_f32 v208, v208
v_mfma_f32_16x16x32_bf16 v[44:47], a[100:103], v[148:151], v[44:47]
s_waitcnt vmcnt(4)
buffer_load_dwordx4 v24, s[12:15], s60 offen nt lds
ds_read_b64_tr_b16 a[114:115], v14 offset:36864
v_mfma_f32_16x16x32_bf16 v[76:79], a[100:103], v[164:167], v[76:79]
v_exp_f32 v209, v209
v_mfma_f32_16x16x32_bf16 v[76:79], a[96:99], v[156:159], v[76:79]
ds_read_b64_tr_b16 a[116:117], v14 offset:40960
ds_read_b64_tr_b16 a[118:119], v14 offset:45056
v_mfma_f32_16x16x32_bf16 v[108:111], a[96:99], v[172:175], v[108:111]
v_cvt_pk_bf16_f32 v191, v194, v195
v_mfma_f32_16x16x32_bf16 v[108:111], a[100:103], v[180:183], v[108:111]
ds_read_b64_tr_b16 a[120:121], v15 offset:32768
s_waitcnt lgkmcnt(5)
v_mfma_f32_16x16x32_bf16 v[48:51], a[104:107], v[140:143], v[48:51]
v_exp_f32 v210, v210
v_mfma_f32_16x16x32_bf16 v[48:51], a[108:111], v[148:151], v[48:51]
ds_read_b64_tr_b16 a[122:123], v15 offset:36864
v_cvt_pk_bf16_f32 v206, v208, v209
v_mfma_f32_16x16x32_bf16 v[80:83], a[108:111], v[164:167], v[80:83]
v_exp_f32 v211, v211
v_mfma_f32_16x16x32_bf16 v[80:83], a[104:107], v[156:159], v[80:83]
ds_read_b64_tr_b16 a[124:125], v15 offset:40960
ds_read_b64_tr_b16 a[126:127], v15 offset:45056
v_mfma_f32_16x16x32_bf16 v[112:115], a[104:107], v[172:175], v[112:115]
v_exp_f32 v224, v224
v_mfma_f32_16x16x32_bf16 v[112:115], a[108:111], v[180:183], v[112:115]
s_waitcnt vmcnt(4)
buffer_load_dwordx4 v25, s[12:15], s60 offen offset:1024 nt lds
v_mfma_f32_16x16x32_bf16 a[48:51], a[60:63], v[140:143], a[48:51]
v_exp_f32 v225, v225
v_mfma_f32_16x16x32_bf16 a[48:51], a[60:63], v[148:151], a[48:51]
v_cvt_pk_bf16_f32 v207, v210, v211
s_waitcnt lgkmcnt(4)
v_mfma_f32_16x16x32_bf16 v[52:55], a[112:115], v[140:143], v[52:55]
v_exp_f32 v226, v226
v_mfma_f32_16x16x32_bf16 v[52:55], a[116:119], v[148:151], v[52:55]
ds_read_b64_tr_b16 a[96:97], v16 offset:32768
ds_read_b64_tr_b16 a[98:99], v16 offset:36864
v_mfma_f32_16x16x32_bf16 v[84:87], a[116:119], v[164:167], v[84:87]
v_cvt_pk_bf16_f32 v222, v224, v225
v_mfma_f32_16x16x32_bf16 v[84:87], a[112:115], v[156:159], v[84:87]
ds_read_b64_tr_b16 a[100:101], v16 offset:40960
ds_read_b64_tr_b16 a[102:103], v16 offset:45056
v_mfma_f32_16x16x32_bf16 v[116:119], a[112:115], v[172:175], v[116:119]
v_exp_f32 v227, v227
v_mfma_f32_16x16x32_bf16 v[116:119], a[116:119], v[180:183], v[116:119]
ds_read_b64_tr_b16 a[104:105], v17 offset:32768
s_waitcnt lgkmcnt(5)
v_mfma_f32_16x16x32_bf16 v[56:59], a[120:123], v[140:143], v[56:59]
v_exp_f32 v196, v196
v_mfma_f32_16x16x32_bf16 v[56:59], a[124:127], v[148:151], v[56:59]
ds_read_b64_tr_b16 a[106:107], v17 offset:36864
ds_read_b64_tr_b16 a[108:109], v17 offset:40960
v_mfma_f32_16x16x32_bf16 v[88:91], a[124:127], v[164:167], v[88:91]
v_exp_f32 v197, v197
v_mfma_f32_16x16x32_bf16 v[88:91], a[120:123], v[156:159], v[88:91]
s_waitcnt vmcnt(4)
buffer_load_dwordx4 v24, s[12:15], s60 offen offset:2048 nt lds
ds_read_b64_tr_b16 a[110:111], v17 offset:45056
v_mfma_f32_16x16x32_bf16 v[120:123], a[120:123], v[172:175], v[120:123]
v_cvt_pk_bf16_f32 v223, v226, v227
v_mfma_f32_16x16x32_bf16 v[120:123], a[124:127], v[180:183], v[120:123]
v_exp_f32 v198, v198
v_mfma_f32_16x16x32_bf16 a[52:55], a[60:63], v[156:159], a[52:55]
v_cvt_pk_bf16_f32 v196, v196, v197
v_mfma_f32_16x16x32_bf16 a[52:55], a[60:63], v[164:167], a[52:55]
ds_read_b64_tr_b16 a[112:113], v18 offset:32768
s_waitcnt lgkmcnt(5)
v_mfma_f32_16x16x32_bf16 v[60:63], a[96:99], v[140:143], v[60:63]
v_exp_f32 v199, v199
v_mfma_f32_16x16x32_bf16 v[60:63], a[100:103], v[148:151], v[60:63]
ds_read_b64_tr_b16 a[114:115], v18 offset:36864
ds_read_b64_tr_b16 a[116:117], v18 offset:40960
v_mfma_f32_16x16x32_bf16 v[92:95], a[100:103], v[164:167], v[92:95]
v_exp_f32 v212, v212
v_mfma_f32_16x16x32_bf16 v[92:95], a[96:99], v[156:159], v[92:95]
ds_read_b64_tr_b16 a[118:119], v18 offset:45056
v_mfma_f32_16x16x32_bf16 v[124:127], a[96:99], v[172:175], v[124:127]
v_exp_f32 v213, v213
v_mfma_f32_16x16x32_bf16 v[124:127], a[100:103], v[180:183], v[124:127]
s_waitcnt vmcnt(3)
buffer_load_dwordx4 v25, s[12:15], s60 offen offset:3072 nt lds
s_waitcnt lgkmcnt(4)
v_mfma_f32_16x16x32_bf16 v[64:67], a[104:107], v[140:143], v[64:67]
s_add_u32 s60, s60, 16384
s_and_b32 s60, s60, 0x7ffff
v_mfma_f32_16x16x32_bf16 v[64:67], a[108:111], v[148:151], v[64:67]
ds_read_b64_tr_b16 a[120:121], v19 offset:32768
ds_read_b64_tr_b16 a[122:123], v19 offset:36864
v_mfma_f32_16x16x32_bf16 v[96:99], a[108:111], v[164:167], v[96:99]
v_cvt_pk_bf16_f32 v197, v198, v199
v_mfma_f32_16x16x32_bf16 v[96:99], a[104:107], v[156:159], v[96:99]
ds_read_b64_tr_b16 a[124:125], v19 offset:40960
s_barrier
ds_read_b64_tr_b16 a[126:127], v19 offset:45056
v_mfma_f32_16x16x32_bf16 v[128:131], a[104:107], v[172:175], v[128:131]
v_exp_f32 v214, v214
v_mfma_f32_16x16x32_bf16 v[128:131], a[108:111], v[180:183], v[128:131]
v_cvt_pk_bf16_f32 v212, v212, v213
v_mfma_f32_16x16x32_bf16 a[56:59], a[60:63], v[172:175], a[56:59]
v_exp_f32 v215, v215
v_mfma_f32_16x16x32_bf16 a[56:59], a[60:63], v[180:183], a[56:59]
ds_read_b128 a[64:67], v8 offset:0
s_waitcnt lgkmcnt(5)
v_mfma_f32_16x16x32_bf16 v[68:71], a[112:115], v[140:143], v[68:71]
v_exp_f32 v228, v228
v_mfma_f32_16x16x32_bf16 v[68:71], a[116:119], v[148:151], v[68:71]
ds_read_b128 a[68:71], v9 offset:0
ds_read_b128 a[72:75], v10 offset:0
v_mfma_f32_16x16x32_bf16 v[100:103], a[116:119], v[164:167], v[100:103]
v_exp_f32 v229, v229
v_mfma_f32_16x16x32_bf16 v[100:103], a[112:115], v[156:159], v[100:103]
v_cvt_pk_bf16_f32 v213, v214, v215
ds_read_b128 a[76:79], v11 offset:0
v_mfma_f32_16x16x32_bf16 v[132:135], a[112:115], v[172:175], v[132:135]
v_exp_f32 v230, v230
v_mfma_f32_16x16x32_bf16 v[132:135], a[116:119], v[180:183], v[132:135]
v_cvt_pk_bf16_f32 v228, v228, v229
s_waitcnt lgkmcnt(4)
v_mfma_f32_16x16x32_bf16 v[72:75], a[120:123], v[140:143], v[72:75]
v_exp_f32 v231, v231
v_mfma_f32_16x16x32_bf16 v[72:75], a[124:127], v[148:151], v[72:75]
v_exp_f32 v200, v200
v_mfma_f32_16x16x32_bf16 v[104:107], a[124:127], v[164:167], v[104:107]
v_exp_f32 v201, v201
v_mfma_f32_16x16x32_bf16 v[104:107], a[120:123], v[156:159], v[104:107]
v_cvt_pk_bf16_f32 v229, v230, v231
v_mfma_f32_16x16x32_bf16 v[136:139], a[120:123], v[172:175], v[136:139]
v_exp_f32 v202, v202
v_mfma_f32_16x16x32_bf16 v[136:139], a[124:127], v[180:183], v[136:139]
v_cvt_pk_bf16_f32 v198, v200, v201
v_exp_f32 v203, v203
s_waitcnt lgkmcnt(0)
v_mfma_f32_16x16x32_bf16 v[140:143], a[64:67], a[0:3], v[32:35]
v_exp_f32 v216, v216
v_mfma_f32_16x16x32_bf16 v[140:143], a[68:71], a[4:7], v[140:143]
s_add_u32 m0, s65, 49152
v_mfma_f32_16x16x32_bf16 v[140:143], a[72:75], a[8:11], v[140:143]
v_exp_f32 v217, v217
v_mfma_f32_16x16x32_bf16 v[140:143], a[76:79], a[12:15], v[140:143]
ds_read_b128 a[80:83], v8 offset:4096
ds_read_b128 a[84:87], v9 offset:4096
ds_read_b128 a[88:91], v10 offset:4096
v_mfma_f32_16x16x32_bf16 v[156:159], a[76:79], a[28:31], v[36:39]
v_cvt_pk_bf16_f32 v199, v202, v203
v_mfma_f32_16x16x32_bf16 v[156:159], a[72:75], a[24:27], v[156:159]
v_exp_f32 v218, v218
v_mfma_f32_16x16x32_bf16 v[156:159], a[68:71], a[20:23], v[156:159]
v_cvt_pk_bf16_f32 v214, v216, v217
v_mfma_f32_16x16x32_bf16 v[156:159], a[64:67], a[16:19], v[156:159]
buffer_load_dwordx4 v20, s[8:11], s59 offen nt lds
ds_read_b128 a[92:95], v11 offset:4096
v_mfma_f32_16x16x32_bf16 v[172:175], a[64:67], a[32:35], v[40:43]
v_exp_f32 v219, v219
v_mfma_f32_16x16x32_bf16 v[172:175], a[68:71], a[36:39], v[172:175]
v_exp_f32 v232, v232
v_mfma_f32_16x16x32_bf16 v[172:175], a[72:75], a[40:43], v[172:175]
v_exp_f32 v233, v233
v_mfma_f32_16x16x32_bf16 v[172:175], a[76:79], a[44:47], v[172:175]
v_cvt_pk_bf16_f32 v215, v218, v219
s_waitcnt lgkmcnt(0)
v_mfma_f32_16x16x32_bf16 v[144:147], a[80:83], a[0:3], v[32:35]
v_exp_f32 v234, v234
v_mfma_f32_16x16x32_bf16 v[144:147], a[84:87], a[4:7], v[144:147]
v_cvt_pk_bf16_f32 v230, v232, v233
v_mfma_f32_16x16x32_bf16 v[144:147], a[88:91], a[8:11], v[144:147]
v_exp_f32 v235, v235
v_mfma_f32_16x16x32_bf16 v[144:147], a[92:95], a[12:15], v[144:147]
ds_read_b128 a[64:67], v8 offset:8192
s_waitcnt vmcnt(4)
buffer_load_dwordx4 v21, s[8:11], s59 offen offset:1024 nt lds
ds_read_b128 a[68:71], v9 offset:8192
ds_read_b128 a[72:75], v10 offset:8192
v_mfma_f32_16x16x32_bf16 v[160:163], a[92:95], a[28:31], v[36:39]
v_cvt_pk_bf16_f32 v231, v234, v235
v_mfma_f32_16x16x32_bf16 v[160:163], a[88:91], a[24:27], v[160:163]
v_exp_f32 v140, v140
v_mfma_f32_16x16x32_bf16 v[160:163], a[84:87], a[20:23], v[160:163]
v_exp_f32 v141, v141
v_mfma_f32_16x16x32_bf16 v[160:163], a[80:83], a[16:19], v[160:163]
ds_read_b128 a[76:79], v11 offset:8192
v_mfma_f32_16x16x32_bf16 v[176:179], a[80:83], a[32:35], v[40:43]
v_exp_f32 v142, v142
v_mfma_f32_16x16x32_bf16 v[176:179], a[84:87], a[36:39], v[176:179]
v_cvt_pk_bf16_f32 v140, v140, v141
v_mfma_f32_16x16x32_bf16 v[176:179], a[88:91], a[40:43], v[176:179]
v_exp_f32 v143, v143
v_mfma_f32_16x16x32_bf16 v[176:179], a[92:95], a[44:47], v[176:179]
s_waitcnt lgkmcnt(0)
v_mfma_f32_16x16x32_bf16 v[148:151], a[64:67], a[0:3], v[32:35]
v_exp_f32 v156, v156
v_mfma_f32_16x16x32_bf16 v[148:151], a[68:71], a[4:7], v[148:151]
v_exp_f32 v157, v157
v_mfma_f32_16x16x32_bf16 v[148:151], a[72:75], a[8:11], v[148:151]
v_cvt_pk_bf16_f32 v141, v142, v143
v_mfma_f32_16x16x32_bf16 v[148:151], a[76:79], a[12:15], v[148:151]
s_waitcnt vmcnt(4)
buffer_load_dwordx4 v22, s[8:11], s59 offen offset:2048 nt lds
ds_read_b128 a[80:83], v8 offset:12288
ds_read_b128 a[84:87], v9 offset:12288
ds_read_b128 a[88:91], v10 offset:12288
v_mfma_f32_16x16x32_bf16 v[164:167], a[76:79], a[28:31], v[36:39]
v_exp_f32 v158, v158
v_mfma_f32_16x16x32_bf16 v[164:167], a[72:75], a[24:27], v[164:167]
v_cvt_pk_bf16_f32 v156, v156, v157
v_mfma_f32_16x16x32_bf16 v[164:167], a[68:71], a[20:23], v[164:167]
v_exp_f32 v159, v159
v_mfma_f32_16x16x32_bf16 v[164:167], a[64:67], a[16:19], v[164:167]
ds_read_b128 a[92:95], v11 offset:12288
v_mfma_f32_16x16x32_bf16 v[180:183], a[64:67], a[32:35], v[40:43]
v_exp_f32 v172, v172
v_mfma_f32_16x16x32_bf16 v[180:183], a[68:71], a[36:39], v[180:183]
v_exp_f32 v173, v173
v_mfma_f32_16x16x32_bf16 v[180:183], a[72:75], a[40:43], v[180:183]
v_cvt_pk_bf16_f32 v157, v158, v159
v_mfma_f32_16x16x32_bf16 v[180:183], a[76:79], a[44:47], v[180:183]
ds_read_b64_tr_b16 a[96:97], v12 offset:49152
ds_read_b64_tr_b16 a[98:99], v12 offset:53248
s_waitcnt lgkmcnt(2)
v_mfma_f32_16x16x32_bf16 v[152:155], a[80:83], a[0:3], v[32:35]
v_exp_f32 v174, v174
v_mfma_f32_16x16x32_bf16 v[152:155], a[84:87], a[4:7], v[152:155]
v_cvt_pk_bf16_f32 v172, v172, v173
v_mfma_f32_16x16x32_bf16 v[152:155], a[88:91], a[8:11], v[152:155]
v_exp_f32 v175, v175
v_mfma_f32_16x16x32_bf16 v[152:155], a[92:95], a[12:15], v[152:155]
s_waitcnt vmcnt(4)
buffer_load_dwordx4 v23, s[8:11], s59 offen offset:3072 nt lds
s_add_u32 s59, s59, 16384
s_and_b32 s59, s59, 0x7ffff
ds_read_b64_tr_b16 a[100:101], v12 offset:57344
ds_read_b64_tr_b16 a[102:103], v12 offset:61440
v_mfma_f32_16x16x32_bf16 v[168:171], a[92:95], a[28:31], v[36:39]
v_exp_f32 v144, v144
v_mfma_f32_16x16x32_bf16 v[168:171], a[88:91], a[24:27], v[168:171]
v_exp_f32 v145, v145
v_mfma_f32_16x16x32_bf16 v[168:171], a[84:87], a[20:23], v[168:171]
v_cvt_pk_bf16_f32 v173, v174, v175
s_add_u32 m0, s65, 81920
v_mfma_f32_16x16x32_bf16 v[168:171], a[80:83], a[16:19], v[168:171]
ds_read_b64_tr_b16 a[104:105], v13 offset:49152
ds_read_b64_tr_b16 a[106:107], v13 offset:53248
ds_read_b64_tr_b16 a[108:109], v13 offset:57344
ds_read_b64_tr_b16 a[110:111], v13 offset:61440
v_mfma_f32_16x16x32_bf16 v[184:187], a[80:83], a[32:35], v[40:43]
v_exp_f32 v146, v146
v_mfma_f32_16x16x32_bf16 v[184:187], a[84:87], a[36:39], v[184:187]
v_cvt_pk_bf16_f32 v142, v144, v145
v_mfma_f32_16x16x32_bf16 v[184:187], a[88:91], a[40:43], v[184:187]
v_exp_f32 v147, v147
v_mfma_f32_16x16x32_bf16 v[184:187], a[92:95], a[44:47], v[184:187]
ds_read_b64_tr_b16 a[112:113], v14 offset:49152
s_waitcnt lgkmcnt(5)
v_mfma_f32_16x16x32_bf16 v[44:47], a[96:99], v[188:191], v[44:47]
v_exp_f32 v160, v160
v_mfma_f32_16x16x32_bf16 v[44:47], a[100:103], v[196:199], v[44:47]
s_waitcnt vmcnt(4)
buffer_load_dwordx4 v24, s[12:15], s60 offen nt lds
ds_read_b64_tr_b16 a[114:115], v14 offset:53248
v_mfma_f32_16x16x32_bf16 v[76:79], a[100:103], v[212:215], v[76:79]
v_exp_f32 v161, v161
v_mfma_f32_16x16x32_bf16 v[76:79], a[96:99], v[204:207], v[76:79]
ds_read_b64_tr_b16 a[116:117], v14 offset:57344
ds_read_b64_tr_b16 a[118:119], v14 offset:61440
v_mfma_f32_16x16x32_bf16 v[108:111], a[96:99], v[220:223], v[108:111]
v_cvt_pk_bf16_f32 v143, v146, v147
v_mfma_f32_16x16x32_bf16 v[108:111], a[100:103], v[228:231], v[108:111]
ds_read_b64_tr_b16 a[120:121], v15 offset:49152
s_waitcnt lgkmcnt(5)
v_mfma_f32_16x16x32_bf16 v[48:51], a[104:107], v[188:191], v[48:51]
v_exp_f32 v162, v162
v_mfma_f32_16x16x32_bf16 v[48:51], a[108:111], v[196:199], v[48:51]
ds_read_b64_tr_b16 a[122:123], v15 offset:53248
v_cvt_pk_bf16_f32 v158, v160, v161
v_mfma_f32_16x16x32_bf16 v[80:83], a[108:111], v[212:215], v[80:83]
v_exp_f32 v163, v163
v_mfma_f32_16x16x32_bf16 v[80:83], a[104:107], v[204:207], v[80:83]
ds_read_b64_tr_b16 a[124:125], v15 offset:57344
ds_read_b64_tr_b16 a[126:127], v15 offset:61440
v_mfma_f32_16x16x32_bf16 v[112:115], a[104:107], v[220:223], v[112:115]
v_exp_f32 v176, v176
v_mfma_f32_16x16x32_bf16 v[112:115], a[108:111], v[228:231], v[112:115]
s_waitcnt vmcnt(4)
buffer_load_dwordx4 v25, s[12:15], s60 offen offset:1024 nt lds
v_mfma_f32_16x16x32_bf16 a[48:51], a[60:63], v[188:191], a[48:51]
v_exp_f32 v177, v177
v_mfma_f32_16x16x32_bf16 a[48:51], a[60:63], v[196:199], a[48:51]
v_cvt_pk_bf16_f32 v159, v162, v163
s_waitcnt lgkmcnt(4)
v_mfma_f32_16x16x32_bf16 v[52:55], a[112:115], v[188:191], v[52:55]
v_exp_f32 v178, v178
v_mfma_f32_16x16x32_bf16 v[52:55], a[116:119], v[196:199], v[52:55]
ds_read_b64_tr_b16 a[96:97], v16 offset:49152
ds_read_b64_tr_b16 a[98:99], v16 offset:53248
v_mfma_f32_16x16x32_bf16 v[84:87], a[116:119], v[212:215], v[84:87]
v_cvt_pk_bf16_f32 v174, v176, v177
v_mfma_f32_16x16x32_bf16 v[84:87], a[112:115], v[204:207], v[84:87]
ds_read_b64_tr_b16 a[100:101], v16 offset:57344
ds_read_b64_tr_b16 a[102:103], v16 offset:61440
v_mfma_f32_16x16x32_bf16 v[116:119], a[112:115], v[220:223], v[116:119]
v_exp_f32 v179, v179
v_mfma_f32_16x16x32_bf16 v[116:119], a[116:119], v[228:231], v[116:119]
ds_read_b64_tr_b16 a[104:105], v17 offset:49152
s_waitcnt lgkmcnt(5)
v_mfma_f32_16x16x32_bf16 v[56:59], a[120:123], v[188:191], v[56:59]
v_exp_f32 v148, v148
v_mfma_f32_16x16x32_bf16 v[56:59], a[124:127], v[196:199], v[56:59]
ds_read_b64_tr_b16 a[106:107], v17 offset:53248
ds_read_b64_tr_b16 a[108:109], v17 offset:57344
v_mfma_f32_16x16x32_bf16 v[88:91], a[124:127], v[212:215], v[88:91]
v_exp_f32 v149, v149
v_mfma_f32_16x16x32_bf16 v[88:91], a[120:123], v[204:207], v[88:91]
s_waitcnt vmcnt(4)
buffer_load_dwordx4 v24, s[12:15], s60 offen offset:2048 nt lds
ds_read_b64_tr_b16 a[110:111], v17 offset:61440
v_mfma_f32_16x16x32_bf16 v[120:123], a[120:123], v[220:223], v[120:123]
v_cvt_pk_bf16_f32 v175, v178, v179
v_mfma_f32_16x16x32_bf16 v[120:123], a[124:127], v[228:231], v[120:123]
v_exp_f32 v150, v150
v_mfma_f32_16x16x32_bf16 a[52:55], a[60:63], v[204:207], a[52:55]
v_cvt_pk_bf16_f32 v148, v148, v149
v_mfma_f32_16x16x32_bf16 a[52:55], a[60:63], v[212:215], a[52:55]
ds_read_b64_tr_b16 a[112:113], v18 offset:49152
s_waitcnt lgkmcnt(5)
v_mfma_f32_16x16x32_bf16 v[60:63], a[96:99], v[188:191], v[60:63]
v_exp_f32 v151, v151
v_mfma_f32_16x16x32_bf16 v[60:63], a[100:103], v[196:199], v[60:63]
ds_read_b64_tr_b16 a[114:115], v18 offset:53248
ds_read_b64_tr_b16 a[116:117], v18 offset:57344
v_mfma_f32_16x16x32_bf16 v[92:95], a[100:103], v[212:215], v[92:95]
v_exp_f32 v164, v164
v_mfma_f32_16x16x32_bf16 v[92:95], a[96:99], v[204:207], v[92:95]
ds_read_b64_tr_b16 a[118:119], v18 offset:61440
v_mfma_f32_16x16x32_bf16 v[124:127], a[96:99], v[220:223], v[124:127]
v_exp_f32 v165, v165
v_mfma_f32_16x16x32_bf16 v[124:127], a[100:103], v[228:231], v[124:127]
s_waitcnt vmcnt(3)
buffer_load_dwordx4 v25, s[12:15], s60 offen offset:3072 nt lds
s_waitcnt lgkmcnt(4)
v_mfma_f32_16x16x32_bf16 v[64:67], a[104:107], v[188:191], v[64:67]
s_add_u32 s60, s60, 16384
s_and_b32 s60, s60, 0x7ffff
v_mfma_f32_16x16x32_bf16 v[64:67], a[108:111], v[196:199], v[64:67]
ds_read_b64_tr_b16 a[120:121], v19 offset:49152
ds_read_b64_tr_b16 a[122:123], v19 offset:53248
v_mfma_f32_16x16x32_bf16 v[96:99], a[108:111], v[212:215], v[96:99]
v_cvt_pk_bf16_f32 v149, v150, v151
v_mfma_f32_16x16x32_bf16 v[96:99], a[104:107], v[204:207], v[96:99]
ds_read_b64_tr_b16 a[124:125], v19 offset:57344
s_barrier
ds_read_b64_tr_b16 a[126:127], v19 offset:61440
v_mfma_f32_16x16x32_bf16 v[128:131], a[104:107], v[220:223], v[128:131]
v_exp_f32 v166, v166
v_mfma_f32_16x16x32_bf16 v[128:131], a[108:111], v[228:231], v[128:131]
v_cvt_pk_bf16_f32 v164, v164, v165
v_mfma_f32_16x16x32_bf16 a[56:59], a[60:63], v[220:223], a[56:59]
v_exp_f32 v167, v167
v_mfma_f32_16x16x32_bf16 a[56:59], a[60:63], v[228:231], a[56:59]
ds_read_b128 a[64:67], v8 offset:16384
s_waitcnt lgkmcnt(5)
v_mfma_f32_16x16x32_bf16 v[68:71], a[112:115], v[188:191], v[68:71]
v_exp_f32 v180, v180
v_mfma_f32_16x16x32_bf16 v[68:71], a[116:119], v[196:199], v[68:71]
ds_read_b128 a[68:71], v9 offset:16384
ds_read_b128 a[72:75], v10 offset:16384
v_mfma_f32_16x16x32_bf16 v[100:103], a[116:119], v[212:215], v[100:103]
v_exp_f32 v181, v181
v_mfma_f32_16x16x32_bf16 v[100:103], a[112:115], v[204:207], v[100:103]
v_cvt_pk_bf16_f32 v165, v166, v167
ds_read_b128 a[76:79], v11 offset:16384
v_mfma_f32_16x16x32_bf16 v[132:135], a[112:115], v[220:223], v[132:135]
v_exp_f32 v182, v182
v_mfma_f32_16x16x32_bf16 v[132:135], a[116:119], v[228:231], v[132:135]
v_cvt_pk_bf16_f32 v180, v180, v181
s_waitcnt lgkmcnt(4)
v_mfma_f32_16x16x32_bf16 v[72:75], a[120:123], v[188:191], v[72:75]
v_exp_f32 v183, v183
v_mfma_f32_16x16x32_bf16 v[72:75], a[124:127], v[196:199], v[72:75]
v_exp_f32 v152, v152
v_mfma_f32_16x16x32_bf16 v[104:107], a[124:127], v[212:215], v[104:107]
v_exp_f32 v153, v153
v_mfma_f32_16x16x32_bf16 v[104:107], a[120:123], v[204:207], v[104:107]
v_cvt_pk_bf16_f32 v181, v182, v183
v_mfma_f32_16x16x32_bf16 v[136:139], a[120:123], v[220:223], v[136:139]
v_exp_f32 v154, v154
v_mfma_f32_16x16x32_bf16 v[136:139], a[124:127], v[228:231], v[136:139]
v_cvt_pk_bf16_f32 v150, v152, v153
v_exp_f32 v155, v155
s_waitcnt lgkmcnt(0)
v_mfma_f32_16x16x32_bf16 v[188:191], a[64:67], a[0:3], v[32:35]
v_exp_f32 v168, v168
v_mfma_f32_16x16x32_bf16 v[188:191], a[68:71], a[4:7], v[188:191]
s_add_u32 m0, s65, 98304
v_mfma_f32_16x16x32_bf16 v[188:191], a[72:75], a[8:11], v[188:191]
v_exp_f32 v169, v169
v_mfma_f32_16x16x32_bf16 v[188:191], a[76:79], a[12:15], v[188:191]
ds_read_b128 a[80:83], v8 offset:20480
ds_read_b128 a[84:87], v9 offset:20480
ds_read_b128 a[88:91], v10 offset:20480
v_mfma_f32_16x16x32_bf16 v[204:207], a[76:79], a[28:31], v[36:39]
v_cvt_pk_bf16_f32 v151, v154, v155
v_mfma_f32_16x16x32_bf16 v[204:207], a[72:75], a[24:27], v[204:207]
v_exp_f32 v170, v170
v_mfma_f32_16x16x32_bf16 v[204:207], a[68:71], a[20:23], v[204:207]
v_cvt_pk_bf16_f32 v166, v168, v169
v_mfma_f32_16x16x32_bf16 v[204:207], a[64:67], a[16:19], v[204:207]
buffer_load_dwordx4 v24, s[12:15], s60 offen nt lds
ds_read_b128 a[92:95], v11 offset:20480
v_mfma_f32_16x16x32_bf16 v[220:223], a[64:67], a[32:35], v[40:43]
v_exp_f32 v171, v171
v_mfma_f32_16x16x32_bf16 v[220:223], a[68:71], a[36:39], v[220:223]
v_exp_f32 v184, v184
v_mfma_f32_16x16x32_bf16 v[220:223], a[72:75], a[40:43], v[220:223]
v_exp_f32 v185, v185
v_mfma_f32_16x16x32_bf16 v[220:223], a[76:79], a[44:47], v[220:223]
v_cvt_pk_bf16_f32 v167, v170, v171
s_waitcnt lgkmcnt(0)
v_mfma_f32_16x16x32_bf16 v[192:195], a[80:83], a[0:3], v[32:35]
v_exp_f32 v186, v186
v_mfma_f32_16x16x32_bf16 v[192:195], a[84:87], a[4:7], v[192:195]
v_cvt_pk_bf16_f32 v182, v184, v185
v_mfma_f32_16x16x32_bf16 v[192:195], a[88:91], a[8:11], v[192:195]
v_exp_f32 v187, v187
v_mfma_f32_16x16x32_bf16 v[192:195], a[92:95], a[12:15], v[192:195]
s_waitcnt vmcnt(4)
buffer_load_dwordx4 v25, s[12:15], s60 offen offset:1024 nt lds
ds_read_b128 a[64:67], v8 offset:24576
ds_read_b128 a[68:71], v9 offset:24576
ds_read_b128 a[72:75], v10 offset:24576
v_mfma_f32_16x16x32_bf16 v[208:211], a[92:95], a[28:31], v[36:39]
v_cvt_pk_bf16_f32 v183, v186, v187
v_mfma_f32_16x16x32_bf16 v[208:211], a[88:91], a[24:27], v[208:211]
v_exp_f32 v188, v188
v_mfma_f32_16x16x32_bf16 v[208:211], a[84:87], a[20:23], v[208:211]
v_exp_f32 v189, v189
v_mfma_f32_16x16x32_bf16 v[208:211], a[80:83], a[16:19], v[208:211]
ds_read_b128 a[76:79], v11 offset:24576
v_mfma_f32_16x16x32_bf16 v[224:227], a[80:83], a[32:35], v[40:43]
v_exp_f32 v190, v190
v_mfma_f32_16x16x32_bf16 v[224:227], a[84:87], a[36:39], v[224:227]
v_cvt_pk_bf16_f32 v188, v188, v189
v_mfma_f32_16x16x32_bf16 v[224:227], a[88:91], a[40:43], v[224:227]
v_exp_f32 v191, v191
v_mfma_f32_16x16x32_bf16 v[224:227], a[92:95], a[44:47], v[224:227]
s_waitcnt vmcnt(4)
buffer_load_dwordx4 v24, s[12:15], s60 offen offset:2048 nt lds
s_waitcnt lgkmcnt(0)
v_mfma_f32_16x16x32_bf16 v[196:199], a[64:67], a[0:3], v[32:35]
v_exp_f32 v204, v204
v_mfma_f32_16x16x32_bf16 v[196:199], a[68:71], a[4:7], v[196:199]
v_exp_f32 v205, v205
v_mfma_f32_16x16x32_bf16 v[196:199], a[72:75], a[8:11], v[196:199]
v_cvt_pk_bf16_f32 v189, v190, v191
v_mfma_f32_16x16x32_bf16 v[196:199], a[76:79], a[12:15], v[196:199]
ds_read_b128 a[80:83], v8 offset:28672
ds_read_b128 a[84:87], v9 offset:28672
ds_read_b128 a[88:91], v10 offset:28672
v_mfma_f32_16x16x32_bf16 v[212:215], a[76:79], a[28:31], v[36:39]
v_exp_f32 v206, v206
v_mfma_f32_16x16x32_bf16 v[212:215], a[72:75], a[24:27], v[212:215]
v_cvt_pk_bf16_f32 v204, v204, v205
v_mfma_f32_16x16x32_bf16 v[212:215], a[68:71], a[20:23], v[212:215]
v_exp_f32 v207, v207
v_mfma_f32_16x16x32_bf16 v[212:215], a[64:67], a[16:19], v[212:215]
s_waitcnt vmcnt(4)
buffer_load_dwordx4 v25, s[12:15], s60 offen offset:3072 nt lds
s_add_u32 s60, s60, 16384
s_and_b32 s60, s60, 0x7ffff
ds_read_b128 a[92:95], v11 offset:28672
v_mfma_f32_16x16x32_bf16 v[228:231], a[64:67], a[32:35], v[40:43]
v_exp_f32 v220, v220
v_mfma_f32_16x16x32_bf16 v[228:231], a[68:71], a[36:39], v[228:231]
v_exp_f32 v221, v221
v_mfma_f32_16x16x32_bf16 v[228:231], a[72:75], a[40:43], v[228:231]
v_cvt_pk_bf16_f32 v205, v206, v207
s_add_u32 m0, s65, 131072
v_mfma_f32_16x16x32_bf16 v[228:231], a[76:79], a[44:47], v[228:231]
ds_read_b64_tr_b16 a[96:97], v12 offset:0
ds_read_b64_tr_b16 a[98:99], v12 offset:4096
s_waitcnt lgkmcnt(2)
v_mfma_f32_16x16x32_bf16 v[200:203], a[80:83], a[0:3], v[32:35]
v_exp_f32 v222, v222
v_mfma_f32_16x16x32_bf16 v[200:203], a[84:87], a[4:7], v[200:203]
v_cvt_pk_bf16_f32 v220, v220, v221
v_mfma_f32_16x16x32_bf16 v[200:203], a[88:91], a[8:11], v[200:203]
v_exp_f32 v223, v223
v_mfma_f32_16x16x32_bf16 v[200:203], a[92:95], a[12:15], v[200:203]
buffer_load_dwordx4 v28, s[24:27], s75 offen lds
ds_read_b64_tr_b16 a[100:101], v12 offset:8192
ds_read_b64_tr_b16 a[102:103], v12 offset:12288
v_mfma_f32_16x16x32_bf16 v[216:219], a[92:95], a[28:31], v[36:39]
v_exp_f32 v192, v192
v_mfma_f32_16x16x32_bf16 v[216:219], a[88:91], a[24:27], v[216:219]
v_exp_f32 v193, v193
v_mfma_f32_16x16x32_bf16 v[216:219], a[84:87], a[20:23], v[216:219]
v_cvt_pk_bf16_f32 v221, v222, v223
v_mfma_f32_16x16x32_bf16 v[216:219], a[80:83], a[16:19], v[216:219]
buffer_load_dwordx4 v29, s[24:27], s75 offen offset:1024 lds
ds_read_b64_tr_b16 a[104:105], v13 offset:0
ds_read_b64_tr_b16 a[106:107], v13 offset:4096
ds_read_b64_tr_b16 a[108:109], v13 offset:8192
ds_read_b64_tr_b16 a[110:111], v13 offset:12288
v_mfma_f32_16x16x32_bf16 v[232:235], a[80:83], a[32:35], v[40:43]
v_exp_f32 v194, v194
v_mfma_f32_16x16x32_bf16 v[232:235], a[84:87], a[36:39], v[232:235]
v_cvt_pk_bf16_f32 v190, v192, v193
v_mfma_f32_16x16x32_bf16 v[232:235], a[88:91], a[40:43], v[232:235]
v_exp_f32 v195, v195
v_mfma_f32_16x16x32_bf16 v[232:235], a[92:95], a[44:47], v[232:235]
ds_read_b64_tr_b16 a[112:113], v14 offset:0
s_waitcnt lgkmcnt(5)
v_mfma_f32_16x16x32_bf16 v[44:47], a[96:99], v[140:143], v[44:47]
v_exp_f32 v208, v208
v_mfma_f32_16x16x32_bf16 v[44:47], a[100:103], v[148:151], v[44:47]
buffer_load_dwordx4 v30, s[24:27], s75 offen offset:2048 lds
ds_read_b64_tr_b16 a[114:115], v14 offset:4096
v_mfma_f32_16x16x32_bf16 v[76:79], a[100:103], v[164:167], v[76:79]
v_exp_f32 v209, v209
v_mfma_f32_16x16x32_bf16 v[76:79], a[96:99], v[156:159], v[76:79]
ds_read_b64_tr_b16 a[116:117], v14 offset:8192
ds_read_b64_tr_b16 a[118:119], v14 offset:12288
v_mfma_f32_16x16x32_bf16 v[108:111], a[96:99], v[172:175], v[108:111]
v_cvt_pk_bf16_f32 v191, v194, v195
v_mfma_f32_16x16x32_bf16 v[108:111], a[100:103], v[180:183], v[108:111]
ds_read_b64_tr_b16 a[120:121], v15 offset:0
s_waitcnt lgkmcnt(5)
v_mfma_f32_16x16x32_bf16 v[48:51], a[104:107], v[140:143], v[48:51]
v_exp_f32 v210, v210
v_mfma_f32_16x16x32_bf16 v[48:51], a[108:111], v[148:151], v[48:51]
buffer_load_dwordx4 v31, s[24:27], s75 offen offset:3072 lds
s_add_u32 s75, s75, 32768
ds_read_b64_tr_b16 a[122:123], v15 offset:4096
v_mfma_f32_16x16x32_bf16 v[80:83], a[108:111], v[164:167], v[80:83]
v_cvt_pk_bf16_f32 v206, v208, v209
s_add_u32 m0, s65, 0
v_mfma_f32_16x16x32_bf16 v[80:83], a[104:107], v[156:159], v[80:83]
ds_read_b64_tr_b16 a[124:125], v15 offset:8192
ds_read_b64_tr_b16 a[126:127], v15 offset:12288
v_mfma_f32_16x16x32_bf16 v[112:115], a[104:107], v[172:175], v[112:115]
v_exp_f32 v211, v211
v_mfma_f32_16x16x32_bf16 v[112:115], a[108:111], v[180:183], v[112:115]
buffer_load_dwordx4 v28, s[24:27], s75 offen lds
v_mfma_f32_16x16x32_bf16 a[48:51], a[60:63], v[140:143], a[48:51]
v_exp_f32 v224, v224
v_mfma_f32_16x16x32_bf16 a[48:51], a[60:63], v[148:151], a[48:51]
ds_read_b64_tr_b16 a[96:97], v16 offset:0
s_waitcnt lgkmcnt(5)
v_mfma_f32_16x16x32_bf16 v[52:55], a[112:115], v[140:143], v[52:55]
v_exp_f32 v225, v225
v_mfma_f32_16x16x32_bf16 v[52:55], a[116:119], v[148:151], v[52:55]
ds_read_b64_tr_b16 a[98:99], v16 offset:4096
v_cvt_pk_bf16_f32 v207, v210, v211
v_mfma_f32_16x16x32_bf16 v[84:87], a[116:119], v[164:167], v[84:87]
v_exp_f32 v226, v226
v_mfma_f32_16x16x32_bf16 v[84:87], a[112:115], v[156:159], v[84:87]
ds_read_b64_tr_b16 a[100:101], v16 offset:8192
ds_read_b64_tr_b16 a[102:103], v16 offset:12288
v_mfma_f32_16x16x32_bf16 v[116:119], a[112:115], v[172:175], v[116:119]
v_cvt_pk_bf16_f32 v222, v224, v225
v_mfma_f32_16x16x32_bf16 v[116:119], a[116:119], v[180:183], v[116:119]
s_waitcnt vmcnt(9)
buffer_load_dwordx4 v29, s[24:27], s75 offen offset:1024 lds
s_waitcnt lgkmcnt(4)
v_mfma_f32_16x16x32_bf16 v[56:59], a[120:123], v[140:143], v[56:59]
v_exp_f32 v227, v227
v_mfma_f32_16x16x32_bf16 v[56:59], a[124:127], v[148:151], v[56:59]
ds_read_b64_tr_b16 a[104:105], v17 offset:0
ds_read_b64_tr_b16 a[106:107], v17 offset:4096
v_mfma_f32_16x16x32_bf16 v[88:91], a[124:127], v[164:167], v[88:91]
v_exp_f32 v196, v196
v_mfma_f32_16x16x32_bf16 v[88:91], a[120:123], v[156:159], v[88:91]
ds_read_b64_tr_b16 a[108:109], v17 offset:8192
ds_read_b64_tr_b16 a[110:111], v17 offset:12288
v_mfma_f32_16x16x32_bf16 v[120:123], a[120:123], v[172:175], v[120:123]
v_exp_f32 v197, v197
v_mfma_f32_16x16x32_bf16 v[120:123], a[124:127], v[180:183], v[120:123]
s_waitcnt vmcnt(9)
buffer_load_dwordx4 v30, s[24:27], s75 offen offset:2048 lds
v_mfma_f32_16x16x32_bf16 a[52:55], a[60:63], v[156:159], a[52:55]
v_cvt_pk_bf16_f32 v223, v226, v227
v_mfma_f32_16x16x32_bf16 a[52:55], a[60:63], v[164:167], a[52:55]
ds_read_b64_tr_b16 a[112:113], v18 offset:0
s_waitcnt lgkmcnt(5)
v_mfma_f32_16x16x32_bf16 v[60:63], a[96:99], v[140:143], v[60:63]
v_exp_f32 v198, v198
v_mfma_f32_16x16x32_bf16 v[60:63], a[100:103], v[148:151], v[60:63]
v_cvt_pk_bf16_f32 v196, v196, v197
ds_read_b64_tr_b16 a[114:115], v18 offset:4096
v_mfma_f32_16x16x32_bf16 v[92:95], a[100:103], v[164:167], v[92:95]
v_exp_f32 v199, v199
v_mfma_f32_16x16x32_bf16 v[92:95], a[96:99], v[156:159], v[92:95]
s_waitcnt vmcnt(9)
buffer_load_dwordx4 v31, s[24:27], s75 offen offset:3072 lds
s_add_u32 s75, s75, 32768
ds_read_b64_tr_b16 a[116:117], v18 offset:8192
ds_read_b64_tr_b16 a[118:119], v18 offset:12288
v_mfma_f32_16x16x32_bf16 v[124:127], a[96:99], v[172:175], v[124:127]
v_exp_f32 v212, v212
v_mfma_f32_16x16x32_bf16 v[124:127], a[100:103], v[180:183], v[124:127]
ds_read_b64_tr_b16 a[120:121], v19 offset:0
s_waitcnt lgkmcnt(5)
v_mfma_f32_16x16x32_bf16 v[64:67], a[104:107], v[140:143], v[64:67]
v_exp_f32 v213, v213
v_mfma_f32_16x16x32_bf16 v[64:67], a[108:111], v[148:151], v[64:67]
ds_read_b64_tr_b16 a[122:123], v19 offset:4096
v_cvt_pk_bf16_f32 v197, v198, v199
v_mfma_f32_16x16x32_bf16 v[96:99], a[108:111], v[164:167], v[96:99]
v_exp_f32 v214, v214
v_mfma_f32_16x16x32_bf16 v[96:99], a[104:107], v[156:159], v[96:99]
ds_read_b64_tr_b16 a[124:125], v19 offset:8192
s_barrier
ds_read_b64_tr_b16 a[126:127], v19 offset:12288
v_mfma_f32_16x16x32_bf16 v[128:131], a[104:107], v[172:175], v[128:131]
v_cvt_pk_bf16_f32 v212, v212, v213
v_mfma_f32_16x16x32_bf16 v[128:131], a[108:111], v[180:183], v[128:131]
v_exp_f32 v215, v215
v_mfma_f32_16x16x32_bf16 a[56:59], a[60:63], v[172:175], a[56:59]
v_exp_f32 v228, v228
v_mfma_f32_16x16x32_bf16 a[56:59], a[60:63], v[180:183], a[56:59]
ds_read_b128 a[64:67], v8 offset:32768
s_waitcnt lgkmcnt(5)
v_mfma_f32_16x16x32_bf16 v[68:71], a[112:115], v[140:143], v[68:71]
v_exp_f32 v229, v229
v_mfma_f32_16x16x32_bf16 v[68:71], a[116:119], v[148:151], v[68:71]
ds_read_b128 a[68:71], v9 offset:32768
v_cvt_pk_bf16_f32 v213, v214, v215
v_mfma_f32_16x16x32_bf16 v[100:103], a[116:119], v[164:167], v[100:103]
v_exp_f32 v230, v230
v_mfma_f32_16x16x32_bf16 v[100:103], a[112:115], v[156:159], v[100:103]
ds_read_b128 a[72:75], v10 offset:32768
v_cvt_pk_bf16_f32 v228, v228, v229
v_mfma_f32_16x16x32_bf16 v[132:135], a[112:115], v[172:175], v[132:135]
v_exp_f32 v231, v231
v_mfma_f32_16x16x32_bf16 v[132:135], a[116:119], v[180:183], v[132:135]
ds_read_b128 a[76:79], v11 offset:32768
s_waitcnt lgkmcnt(4)
v_mfma_f32_16x16x32_bf16 v[72:75], a[120:123], v[140:143], v[72:75]
v_exp_f32 v200, v200
v_mfma_f32_16x16x32_bf16 v[72:75], a[124:127], v[148:151], v[72:75]
v_exp_f32 v201, v201
v_mfma_f32_16x16x32_bf16 v[104:107], a[124:127], v[164:167], v[104:107]
v_cvt_pk_bf16_f32 v229, v230, v231
v_mfma_f32_16x16x32_bf16 v[104:107], a[120:123], v[156:159], v[104:107]
v_exp_f32 v202, v202
v_mfma_f32_16x16x32_bf16 v[136:139], a[120:123], v[172:175], v[136:139]
v_cvt_pk_bf16_f32 v198, v200, v201
v_mfma_f32_16x16x32_bf16 v[136:139], a[124:127], v[180:183], v[136:139]
v_exp_f32 v203, v203
s_waitcnt lgkmcnt(0)
v_mfma_f32_16x16x32_bf16 v[140:143], a[64:67], a[0:3], v[32:35]
v_exp_f32 v216, v216
v_mfma_f32_16x16x32_bf16 v[140:143], a[68:71], a[4:7], v[140:143]
s_add_u32 m0, s65, 114688
v_mfma_f32_16x16x32_bf16 v[140:143], a[72:75], a[8:11], v[140:143]
v_exp_f32 v217, v217
v_mfma_f32_16x16x32_bf16 v[140:143], a[76:79], a[12:15], v[140:143]
ds_read_b128 a[80:83], v8 offset:36864
ds_read_b128 a[84:87], v9 offset:36864
ds_read_b128 a[88:91], v10 offset:36864
v_mfma_f32_16x16x32_bf16 v[156:159], a[76:79], a[28:31], v[36:39]
v_cvt_pk_bf16_f32 v199, v202, v203
v_mfma_f32_16x16x32_bf16 v[156:159], a[72:75], a[24:27], v[156:159]
v_exp_f32 v218, v218
v_mfma_f32_16x16x32_bf16 v[156:159], a[68:71], a[20:23], v[156:159]
v_cvt_pk_bf16_f32 v214, v216, v217
v_mfma_f32_16x16x32_bf16 v[156:159], a[64:67], a[16:19], v[156:159]
buffer_load_dwordx4 v24, s[12:15], s60 offen nt lds
ds_read_b128 a[92:95], v11 offset:36864
v_mfma_f32_16x16x32_bf16 v[172:175], a[64:67], a[32:35], v[40:43]
v_exp_f32 v219, v219
v_mfma_f32_16x16x32_bf16 v[172:175], a[68:71], a[36:39], v[172:175]
v_exp_f32 v232, v232
v_mfma_f32_16x16x32_bf16 v[172:175], a[72:75], a[40:43], v[172:175]
v_exp_f32 v233, v233
v_mfma_f32_16x16x32_bf16 v[172:175], a[76:79], a[44:47], v[172:175]
buffer_load_dwordx4 v25, s[12:15], s60 offen offset:1024 nt lds
s_waitcnt lgkmcnt(0)
v_mfma_f32_16x16x32_bf16 v[144:147], a[80:83], a[0:3], v[32:35]
v_cvt_pk_bf16_f32 v215, v218, v219
v_mfma_f32_16x16x32_bf16 v[144:147], a[84:87], a[4:7], v[144:147]
v_exp_f32 v234, v234
v_mfma_f32_16x16x32_bf16 v[144:147], a[88:91], a[8:11], v[144:147]
v_cvt_pk_bf16_f32 v230, v232, v233
v_mfma_f32_16x16x32_bf16 v[144:147], a[92:95], a[12:15], v[144:147]
ds_read_b128 a[64:67], v8 offset:40960
ds_read_b128 a[68:71], v9 offset:40960
ds_read_b128 a[72:75], v10 offset:40960
v_mfma_f32_16x16x32_bf16 v[160:163], a[92:95], a[28:31], v[36:39]
v_exp_f32 v235, v235
v_mfma_f32_16x16x32_bf16 v[160:163], a[88:91], a[24:27], v[160:163]
v_cvt_pk_bf16_f32 v231, v234, v235
v_mfma_f32_16x16x32_bf16 v[160:163], a[84:87], a[20:23], v[160:163]
v_exp_f32 v140, v140
v_mfma_f32_16x16x32_bf16 v[160:163], a[80:83], a[16:19], v[160:163]
buffer_load_dwordx4 v24, s[12:15], s60 offen offset:2048 nt lds
ds_read_b128 a[76:79], v11 offset:40960
v_mfma_f32_16x16x32_bf16 v[176:179], a[80:83], a[32:35], v[40:43]
v_exp_f32 v141, v141
v_mfma_f32_16x16x32_bf16 v[176:179], a[84:87], a[36:39], v[176:179]
v_exp_f32 v142, v142
v_mfma_f32_16x16x32_bf16 v[176:179], a[88:91], a[40:43], v[176:179]
v_cvt_pk_bf16_f32 v140, v140, v141
v_mfma_f32_16x16x32_bf16 v[176:179], a[92:95], a[44:47], v[176:179]
s_waitcnt vmcnt(12)
buffer_load_dwordx4 v25, s[12:15], s60 offen offset:3072 nt lds
s_add_u32 s60, s60, 16384
s_and_b32 s60, s60, 0x7ffff
s_waitcnt lgkmcnt(0)
v_mfma_f32_16x16x32_bf16 v[148:151], a[64:67], a[0:3], v[32:35]
v_exp_f32 v143, v143
v_mfma_f32_16x16x32_bf16 v[148:151], a[68:71], a[4:7], v[148:151]
v_exp_f32 v156, v156
v_mfma_f32_16x16x32_bf16 v[148:151], a[72:75], a[8:11], v[148:151]
v_exp_f32 v157, v157
v_mfma_f32_16x16x32_bf16 v[148:151], a[76:79], a[12:15], v[148:151]
ds_read_b128 a[80:83], v8 offset:45056
s_add_u32 m0, s65, 16384
ds_read_b128 a[84:87], v9 offset:45056
ds_read_b128 a[88:91], v10 offset:45056
v_mfma_f32_16x16x32_bf16 v[164:167], a[76:79], a[28:31], v[36:39]
v_cvt_pk_bf16_f32 v141, v142, v143
v_mfma_f32_16x16x32_bf16 v[164:167], a[72:75], a[24:27], v[164:167]
v_exp_f32 v158, v158
v_mfma_f32_16x16x32_bf16 v[164:167], a[68:71], a[20:23], v[164:167]
v_cvt_pk_bf16_f32 v156, v156, v157
v_mfma_f32_16x16x32_bf16 v[164:167], a[64:67], a[16:19], v[164:167]
s_waitcnt vmcnt(9)
buffer_load_dwordx4 v28, s[24:27], s75 offen lds
ds_read_b128 a[92:95], v11 offset:45056
v_mfma_f32_16x16x32_bf16 v[180:183], a[64:67], a[32:35], v[40:43]
v_exp_f32 v159, v159
v_mfma_f32_16x16x32_bf16 v[180:183], a[68:71], a[36:39], v[180:183]
v_exp_f32 v172, v172
v_mfma_f32_16x16x32_bf16 v[180:183], a[72:75], a[40:43], v[180:183]
v_exp_f32 v173, v173
v_mfma_f32_16x16x32_bf16 v[180:183], a[76:79], a[44:47], v[180:183]
s_waitcnt vmcnt(9)
buffer_load_dwordx4 v29, s[24:27], s75 offen offset:1024 lds
ds_read_b64_tr_b16 a[96:97], v12 offset:16384
ds_read_b64_tr_b16 a[98:99], v12 offset:20480
s_waitcnt lgkmcnt(2)
v_mfma_f32_16x16x32_bf16 v[152:155], a[80:83], a[0:3], v[32:35]
v_cvt_pk_bf16_f32 v157, v158, v159
v_mfma_f32_16x16x32_bf16 v[152:155], a[84:87], a[4:7], v[152:155]
v_exp_f32 v174, v174
v_mfma_f32_16x16x32_bf16 v[152:155], a[88:91], a[8:11], v[152:155]
v_cvt_pk_bf16_f32 v172, v172, v173
v_mfma_f32_16x16x32_bf16 v[152:155], a[92:95], a[12:15], v[152:155]
s_waitcnt vmcnt(9)
buffer_load_dwordx4 v30, s[24:27], s75 offen offset:2048 lds
ds_read_b64_tr_b16 a[100:101], v12 offset:24576
ds_read_b64_tr_b16 a[102:103], v12 offset:28672
v_mfma_f32_16x16x32_bf16 v[168:171], a[92:95], a[28:31], v[36:39]
v_exp_f32 v175, v175
v_mfma_f32_16x16x32_bf16 v[168:171], a[88:91], a[24:27], v[168:171]
v_exp_f32 v144, v144
v_mfma_f32_16x16x32_bf16 v[168:171], a[84:87], a[20:23], v[168:171]
v_exp_f32 v145, v145
v_mfma_f32_16x16x32_bf16 v[168:171], a[80:83], a[16:19], v[168:171]
s_waitcnt vmcnt(9)
buffer_load_dwordx4 v31, s[24:27], s75 offen offset:3072 lds
s_add_u32 s75, s75, 32768
ds_read_b64_tr_b16 a[104:105], v13 offset:16384
ds_read_b64_tr_b16 a[106:107], v13 offset:20480
ds_read_b64_tr_b16 a[108:109], v13 offset:24576
ds_read_b64_tr_b16 a[110:111], v13 offset:28672
v_mfma_f32_16x16x32_bf16 v[184:187], a[80:83], a[32:35], v[40:43]
v_cvt_pk_bf16_f32 v173, v174, v175
v_mfma_f32_16x16x32_bf16 v[184:187], a[84:87], a[36:39], v[184:187]
v_exp_f32 v146, v146
v_mfma_f32_16x16x32_bf16 v[184:187], a[88:91], a[40:43], v[184:187]
v_cvt_pk_bf16_f32 v142, v144, v145
v_mfma_f32_16x16x32_bf16 v[184:187], a[92:95], a[44:47], v[184:187]
ds_read_b64_tr_b16 a[128:129], v244 offset:0
ds_read_b64_tr_b16 a[130:131], v244 offset:2048
ds_read_b64_tr_b16 a[132:133], v245 offset:0
s_waitcnt lgkmcnt(7)
v_mfma_f32_16x16x32_bf16 v[44:47], a[96:99], v[188:191], v[44:47]
ds_read_b64_tr_b16 a[134:135], v245 offset:2048
ds_read_b64_tr_b16 a[136:137], v246 offset:0
v_mfma_f32_16x16x32_bf16 v[44:47], a[100:103], v[196:199], v[44:47]
ds_read_b64_tr_b16 a[112:113], v14 offset:16384
ds_read_b64_tr_b16 a[114:115], v14 offset:20480
v_mfma_f32_16x16x32_bf16 v[76:79], a[100:103], v[212:215], v[76:79]
v_exp_f32 v147, v147
v_mfma_f32_16x16x32_bf16 v[76:79], a[96:99], v[204:207], v[76:79]
ds_read_b64_tr_b16 a[138:139], v246 offset:2048
ds_read_b64_tr_b16 a[140:141], v247 offset:0
ds_read_b64_tr_b16 a[116:117], v14 offset:24576
ds_read_b64_tr_b16 a[118:119], v14 offset:28672
v_mfma_f32_16x16x32_bf16 v[108:111], a[96:99], v[220:223], v[108:111]
v_exp_f32 v160, v160
v_mfma_f32_16x16x32_bf16 v[108:111], a[100:103], v[228:231], v[108:111]
s_waitcnt lgkmcnt(14)
ds_read_b64_tr_b16 a[142:143], v247 offset:2048
s_waitcnt lgkmcnt(12)
v_mfma_f32_16x16x32_bf16 v[48:51], a[104:107], v[188:191], v[48:51]
v_exp_f32 v161, v161
v_mfma_f32_16x16x32_bf16 v[48:51], a[108:111], v[196:199], v[48:51]
ds_read_b64_tr_b16 a[120:121], v15 offset:16384
ds_read_b64_tr_b16 a[122:123], v15 offset:20480
v_mfma_f32_16x16x32_bf16 v[80:83], a[108:111], v[212:215], v[80:83]
v_cvt_pk_bf16_f32 v143, v146, v147
v_mfma_f32_16x16x32_bf16 v[80:83], a[104:107], v[204:207], v[80:83]
v_exp_f32 v162, v162
s_waitcnt lgkmcnt(2)
ds_read_b64_tr_b16 a[124:125], v15 offset:24576
ds_read_b64_tr_b16 a[126:127], v15 offset:28672
v_mfma_f32_16x16x32_bf16 v[112:115], a[104:107], v[220:223], v[112:115]
v_cvt_pk_bf16_f32 v158, v160, v161
s_add_u32 m0, s65, 131072
v_mfma_f32_16x16x32_bf16 v[112:115], a[108:111], v[228:231], v[112:115]
s_waitcnt vmcnt(9)
buffer_load_dwordx4 v28, s[24:27], s75 offen lds
v_mfma_f32_16x16x32_bf16 a[48:51], a[60:63], v[188:191], a[48:51]
v_exp_f32 v163, v163
v_mfma_f32_16x16x32_bf16 a[48:51], a[60:63], v[196:199], a[48:51]
ds_read_b64_tr_b16 a[96:97], v16 offset:16384
v_mfma_f32_16x16x32_bf16 v[52:55], a[112:115], v[188:191], v[52:55]
v_exp_f32 v176, v176
v_mfma_f32_16x16x32_bf16 v[52:55], a[116:119], v[196:199], v[52:55]
v_exp_f32 v177, v177
s_waitcnt vmcnt(9)
buffer_load_dwordx4 v29, s[24:27], s75 offen offset:1024 lds
ds_read_b64_tr_b16 a[98:99], v16 offset:20480
v_mfma_f32_16x16x32_bf16 v[84:87], a[116:119], v[212:215], v[84:87]
v_cvt_pk_bf16_f32 v159, v162, v163
v_mfma_f32_16x16x32_bf16 v[84:87], a[112:115], v[204:207], v[84:87]
s_waitcnt vmcnt(9)
buffer_load_dwordx4 v30, s[24:27], s75 offen offset:2048 lds
ds_read_b64_tr_b16 a[100:101], v16 offset:24576
ds_read_b64_tr_b16 a[102:103], v16 offset:28672
v_mfma_f32_16x16x32_bf16 v[116:119], a[112:115], v[220:223], v[116:119]
v_exp_f32 v178, v178
v_mfma_f32_16x16x32_bf16 v[116:119], a[116:119], v[228:231], v[116:119]
v_cvt_pk_bf16_f32 v174, v176, v177
s_waitcnt lgkmcnt(4)
v_mfma_f32_16x16x32_bf16 v[56:59], a[120:123], v[188:191], v[56:59]
v_exp_f32 v179, v179
v_mfma_f32_16x16x32_bf16 v[56:59], a[124:127], v[196:199], v[56:59]
s_waitcnt vmcnt(9)
buffer_load_dwordx4 v31, s[24:27], s75 offen offset:3072 lds
s_add_u32 s75, s75, 32768
s_and_b32 s75, s75, 0xfffff
s_or_b32 s75, s75, s79
ds_read_b64_tr_b16 a[104:105], v17 offset:16384
ds_read_b64_tr_b16 a[106:107], v17 offset:20480
v_mfma_f32_16x16x32_bf16 v[88:91], a[124:127], v[212:215], v[88:91]
v_exp_f32 v148, v148
v_mfma_f32_16x16x32_bf16 v[88:91], a[120:123], v[204:207], v[88:91]
ds_read_b64_tr_b16 a[108:109], v17 offset:24576
ds_read_b64_tr_b16 a[110:111], v17 offset:28672
v_mfma_f32_16x16x32_bf16 v[120:123], a[120:123], v[220:223], v[120:123]
v_exp_f32 v149, v149
v_mfma_f32_16x16x32_bf16 v[120:123], a[124:127], v[228:231], v[120:123]
ds_read_b64_tr_b16 a[144:145], v236 offset:0
v_mfma_f32_16x16x32_bf16 a[52:55], a[60:63], v[204:207], a[52:55]
ds_read_b64_tr_b16 a[146:147], v236 offset:2048
v_cvt_pk_bf16_f32 v175, v178, v179
v_mfma_f32_16x16x32_bf16 a[52:55], a[60:63], v[212:215], a[52:55]
ds_read_b64_tr_b16 a[148:149], v237 offset:0
s_waitcnt lgkmcnt(7)
v_mfma_f32_16x16x32_bf16 v[60:63], a[96:99], v[188:191], v[60:63]
v_exp_f32 v150, v150
v_mfma_f32_16x16x32_bf16 v[60:63], a[100:103], v[196:199], v[60:63]
v_cvt_pk_bf16_f32 v148, v148, v149
ds_read_b64_tr_b16 a[150:151], v237 offset:2048
ds_read_b64_tr_b16 a[152:153], v238 offset:0
ds_read_b64_tr_b16 a[112:113], v18 offset:16384
ds_read_b64_tr_b16 a[114:115], v18 offset:20480
v_mfma_f32_16x16x32_bf16 v[92:95], a[100:103], v[212:215], v[92:95]
v_exp_f32 v151, v151
v_mfma_f32_16x16x32_bf16 v[92:95], a[96:99], v[204:207], v[92:95]
ds_read_b64_tr_b16 a[154:155], v238 offset:2048
ds_read_b64_tr_b16 a[156:157], v239 offset:0
ds_read_b64_tr_b16 a[116:117], v18 offset:24576
ds_read_b64_tr_b16 a[118:119], v18 offset:28672
v_mfma_f32_16x16x32_bf16 v[124:127], a[96:99], v[220:223], v[124:127]
v_exp_f32 v164, v164
v_mfma_f32_16x16x32_bf16 v[124:127], a[100:103], v[228:231], v[124:127]
s_waitcnt lgkmcnt(14)
ds_read_b64_tr_b16 a[158:159], v239 offset:2048
s_waitcnt lgkmcnt(12)
v_mfma_f32_16x16x32_bf16 v[64:67], a[104:107], v[188:191], v[64:67]
v_exp_f32 v165, v165
v_mfma_f32_16x16x32_bf16 v[64:67], a[108:111], v[196:199], v[64:67]
ds_read_b64_tr_b16 a[120:121], v19 offset:16384
ds_read_b64_tr_b16 a[122:123], v19 offset:20480
v_mfma_f32_16x16x32_bf16 v[96:99], a[108:111], v[212:215], v[96:99]
v_cvt_pk_bf16_f32 v149, v150, v151
v_mfma_f32_16x16x32_bf16 v[96:99], a[104:107], v[204:207], v[96:99]
s_waitcnt lgkmcnt(2)
ds_read_b64_tr_b16 a[124:125], v19 offset:24576
s_barrier
ds_read_b64_tr_b16 a[126:127], v19 offset:28672
v_mfma_f32_16x16x32_bf16 v[128:131], a[104:107], v[220:223], v[128:131]
v_exp_f32 v166, v166
v_mfma_f32_16x16x32_bf16 v[128:131], a[108:111], v[228:231], v[128:131]
s_add_u32 m0, s65, 0
s_waitcnt vmcnt(9)
buffer_load_dwordx4 v28, s[24:27], s75 offen lds
v_mfma_f32_16x16x32_bf16 a[56:59], a[60:63], v[220:223], a[56:59]
v_cvt_pk_bf16_f32 v164, v164, v165
v_mfma_f32_16x16x32_bf16 a[56:59], a[60:63], v[228:231], a[56:59]
ds_read_b128 a[64:67], v8 offset:49152
v_mfma_f32_16x16x32_bf16 v[68:71], a[112:115], v[188:191], v[68:71]
v_exp_f32 v167, v167
v_mfma_f32_16x16x32_bf16 v[68:71], a[116:119], v[196:199], v[68:71]
v_exp_f32 v180, v180
s_waitcnt vmcnt(9)
buffer_load_dwordx4 v29, s[24:27], s75 offen offset:1024 lds
ds_read_b128 a[68:71], v9 offset:49152
v_mfma_f32_16x16x32_bf16 v[100:103], a[116:119], v[212:215], v[100:103]
v_exp_f32 v181, v181
v_mfma_f32_16x16x32_bf16 v[100:103], a[112:115], v[204:207], v[100:103]
v_cvt_pk_bf16_f32 v165, v166, v167
s_waitcnt vmcnt(9)
buffer_load_dwordx4 v30, s[24:27], s75 offen offset:2048 lds
ds_read_b128 a[72:75], v10 offset:49152
v_mfma_f32_16x16x32_bf16 v[132:135], a[112:115], v[220:223], v[132:135]
v_exp_f32 v182, v182
v_mfma_f32_16x16x32_bf16 v[132:135], a[116:119], v[228:231], v[132:135]
ds_read_b128 a[76:79], v11 offset:49152
s_waitcnt lgkmcnt(4)
v_mfma_f32_16x16x32_bf16 v[72:75], a[120:123], v[188:191], v[72:75]
v_cvt_pk_bf16_f32 v180, v180, v181
v_mfma_f32_16x16x32_bf16 v[72:75], a[124:127], v[196:199], v[72:75]
v_exp_f32 v183, v183
s_waitcnt vmcnt(9)
buffer_load_dwordx4 v31, s[24:27], s75 offen offset:3072 lds
s_add_u32 s75, s75, 32768
v_mfma_f32_16x16x32_bf16 v[104:107], a[124:127], v[212:215], v[104:107]
v_exp_f32 v152, v152
v_mfma_f32_16x16x32_bf16 v[104:107], a[120:123], v[204:207], v[104:107]
v_exp_f32 v153, v153
v_mfma_f32_16x16x32_bf16 v[136:139], a[120:123], v[220:223], v[136:139]
v_cvt_pk_bf16_f32 v181, v182, v183
v_mfma_f32_16x16x32_bf16 v[136:139], a[124:127], v[228:231], v[136:139]
v_exp_f32 v154, v154
v_cvt_pk_bf16_f32 v150, v152, v153
v_exp_f32 v155, v155
s_waitcnt lgkmcnt(0)
v_mfma_f32_16x16x32_bf16 v[188:191], a[64:67], a[0:3], v[32:35]
v_exp_f32 v168, v168
v_mfma_f32_16x16x32_bf16 v[188:191], a[68:71], a[4:7], v[188:191]
s_add_u32 m0, s65, 32768
v_mfma_f32_16x16x32_bf16 v[188:191], a[72:75], a[8:11], v[188:191]
v_exp_f32 v169, v169
v_mfma_f32_16x16x32_bf16 v[188:191], a[76:79], a[12:15], v[188:191]
ds_read_b128 a[80:83], v8 offset:53248
ds_read_b128 a[84:87], v9 offset:53248
ds_read_b128 a[88:91], v10 offset:53248
v_mfma_f32_16x16x32_bf16 v[204:207], a[76:79], a[28:31], v[36:39]
v_cvt_pk_bf16_f32 v151, v154, v155
v_mfma_f32_16x16x32_bf16 v[204:207], a[72:75], a[24:27], v[204:207]
v_exp_f32 v170, v170
v_mfma_f32_16x16x32_bf16 v[204:207], a[68:71], a[20:23], v[204:207]
v_cvt_pk_bf16_f32 v166, v168, v169
v_mfma_f32_16x16x32_bf16 v[204:207], a[64:67], a[16:19], v[204:207]
s_waitcnt vmcnt(9)
buffer_load_dwordx4 v28, s[24:27], s75 offen lds
ds_read_b128 a[92:95], v11 offset:53248
s_waitcnt vmcnt(9)
buffer_load_dwordx4 v29, s[24:27], s75 offen offset:1024 lds
v_mfma_f32_16x16x32_bf16 v[220:223], a[64:67], a[32:35], v[40:43]
v_exp_f32 v171, v171
v_mfma_f32_16x16x32_bf16 v[220:223], a[68:71], a[36:39], v[220:223]
v_exp_f32 v184, v184
v_mfma_f32_16x16x32_bf16 v[220:223], a[72:75], a[40:43], v[220:223]
v_exp_f32 v185, v185
v_mfma_f32_16x16x32_bf16 v[220:223], a[76:79], a[44:47], v[220:223]
s_waitcnt vmcnt(9)
buffer_load_dwordx4 v30, s[24:27], s75 offen offset:2048 lds
s_waitcnt lgkmcnt(0)
v_mfma_f32_16x16x32_bf16 v[192:195], a[80:83], a[0:3], v[32:35]
v_cvt_pk_bf16_f32 v167, v170, v171
v_mfma_f32_16x16x32_bf16 v[192:195], a[84:87], a[4:7], v[192:195]
v_exp_f32 v186, v186
v_mfma_f32_16x16x32_bf16 v[192:195], a[88:91], a[8:11], v[192:195]
v_cvt_pk_bf16_f32 v182, v184, v185
v_mfma_f32_16x16x32_bf16 v[192:195], a[92:95], a[12:15], v[192:195]
s_waitcnt vmcnt(9)
buffer_load_dwordx4 v31, s[24:27], s75 offen offset:3072 lds
s_add_u32 s75, s75, 32768
ds_read_b128 a[64:67], v8 offset:57344
s_add_u32 m0, s65, 65536
ds_read_b128 a[68:71], v9 offset:57344
ds_read_b128 a[72:75], v10 offset:57344
v_mfma_f32_16x16x32_bf16 v[208:211], a[92:95], a[28:31], v[36:39]
v_exp_f32 v187, v187
v_mfma_f32_16x16x32_bf16 v[208:211], a[88:91], a[24:27], v[208:211]
v_cvt_pk_bf16_f32 v183, v186, v187
v_mfma_f32_16x16x32_bf16 v[208:211], a[84:87], a[20:23], v[208:211]
v_exp_f32 v188, v188
v_mfma_f32_16x16x32_bf16 v[208:211], a[80:83], a[16:19], v[208:211]
s_waitcnt vmcnt(9)
buffer_load_dwordx4 v28, s[24:27], s75 offen lds
ds_read_b128 a[76:79], v11 offset:57344
s_waitcnt vmcnt(9)
buffer_load_dwordx4 v29, s[24:27], s75 offen offset:1024 lds
v_mfma_f32_16x16x32_bf16 v[224:227], a[80:83], a[32:35], v[40:43]
v_exp_f32 v189, v189
v_mfma_f32_16x16x32_bf16 v[224:227], a[84:87], a[36:39], v[224:227]
v_exp_f32 v190, v190
v_mfma_f32_16x16x32_bf16 v[224:227], a[88:91], a[40:43], v[224:227]
v_cvt_pk_bf16_f32 v188, v188, v189
v_mfma_f32_16x16x32_bf16 v[224:227], a[92:95], a[44:47], v[224:227]
s_waitcnt vmcnt(9)
buffer_load_dwordx4 v30, s[24:27], s75 offen offset:2048 lds
s_waitcnt lgkmcnt(0)
v_mfma_f32_16x16x32_bf16 v[196:199], a[64:67], a[0:3], v[32:35]
v_exp_f32 v191, v191
v_mfma_f32_16x16x32_bf16 v[196:199], a[68:71], a[4:7], v[196:199]
v_exp_f32 v204, v204
v_mfma_f32_16x16x32_bf16 v[196:199], a[72:75], a[8:11], v[196:199]
v_exp_f32 v205, v205
v_mfma_f32_16x16x32_bf16 v[196:199], a[76:79], a[12:15], v[196:199]
s_waitcnt vmcnt(9)
buffer_load_dwordx4 v31, s[24:27], s75 offen offset:3072 lds
s_add_u32 s75, s75, 32768
ds_read_b128 a[80:83], v8 offset:61440
ds_read_b128 a[84:87], v9 offset:61440
ds_read_b128 a[88:91], v10 offset:61440
v_mfma_f32_16x16x32_bf16 v[212:215], a[76:79], a[28:31], v[36:39]
v_cvt_pk_bf16_f32 v189, v190, v191
v_mfma_f32_16x16x32_bf16 v[212:215], a[72:75], a[24:27], v[212:215]
v_exp_f32 v206, v206
v_mfma_f32_16x16x32_bf16 v[212:215], a[68:71], a[20:23], v[212:215]
v_cvt_pk_bf16_f32 v204, v204, v205
v_mfma_f32_16x16x32_bf16 v[212:215], a[64:67], a[16:19], v[212:215]
ds_read_b64_tr_b16 a[160:161], v236 offset:16384
ds_read_b64_tr_b16 a[162:163], v236 offset:18432
ds_read_b128 a[92:95], v11 offset:61440
ds_read_b64_tr_b16 a[164:165], v237 offset:16384
v_mfma_f32_16x16x32_bf16 v[228:231], a[64:67], a[32:35], v[40:43]
v_exp_f32 v207, v207
v_mfma_f32_16x16x32_bf16 v[228:231], a[68:71], a[36:39], v[228:231]
ds_read_b64_tr_b16 a[166:167], v237 offset:18432
ds_read_b64_tr_b16 a[168:169], v238 offset:16384
v_mfma_f32_16x16x32_bf16 v[228:231], a[72:75], a[40:43], v[228:231]
v_exp_f32 v220, v220
v_mfma_f32_16x16x32_bf16 v[228:231], a[76:79], a[44:47], v[228:231]
v_exp_f32 v221, v221
ds_read_b64_tr_b16 a[170:171], v238 offset:18432
ds_read_b64_tr_b16 a[172:173], v239 offset:16384
ds_read_b64_tr_b16 a[96:97], v12 offset:32768
ds_read_b64_tr_b16 a[98:99], v12 offset:36864
s_waitcnt lgkmcnt(7)
v_mfma_f32_16x16x32_bf16 v[200:203], a[80:83], a[0:3], v[32:35]
v_cvt_pk_bf16_f32 v205, v206, v207
ds_read_b64_tr_b16 a[174:175], v239 offset:18432
v_mfma_f32_16x16x32_bf16 v[200:203], a[84:87], a[4:7], v[200:203]
v_exp_f32 v222, v222
v_mfma_f32_16x16x32_bf16 v[200:203], a[88:91], a[8:11], v[200:203]
v_cvt_pk_bf16_f32 v220, v220, v221
v_mfma_f32_16x16x32_bf16 v[200:203], a[92:95], a[12:15], v[200:203]
ds_read_b64_tr_b16 a[100:101], v12 offset:40960
ds_read_b64_tr_b16 a[102:103], v12 offset:45056
v_mfma_f32_16x16x32_bf16 v[216:219], a[92:95], a[28:31], v[36:39]
v_exp_f32 v223, v223
v_mfma_f32_16x16x32_bf16 v[216:219], a[88:91], a[24:27], v[216:219]
v_exp_f32 v192, v192
v_mfma_f32_16x16x32_bf16 v[216:219], a[84:87], a[20:23], v[216:219]
v_exp_f32 v193, v193
v_mfma_f32_16x16x32_bf16 v[216:219], a[80:83], a[16:19], v[216:219]
s_waitcnt lgkmcnt(2)
s_add_u32 m0, s65, 16384
ds_read_b64_tr_b16 a[104:105], v13 offset:32768
s_waitcnt vmcnt(9)
buffer_load_dwordx4 v28, s[24:27], s75 offen lds
ds_read_b64_tr_b16 a[106:107], v13 offset:36864
ds_read_b64_tr_b16 a[108:109], v13 offset:40960
ds_read_b64_tr_b16 a[110:111], v13 offset:45056
v_mfma_f32_16x16x32_bf16 v[232:235], a[80:83], a[32:35], v[40:43]
v_cvt_pk_bf16_f32 v221, v222, v223
v_mfma_f32_16x16x32_bf16 v[232:235], a[84:87], a[36:39], v[232:235]
v_exp_f32 v194, v194
v_mfma_f32_16x16x32_bf16 v[232:235], a[88:91], a[40:43], v[232:235]
v_cvt_pk_bf16_f32 v190, v192, v193
v_mfma_f32_16x16x32_bf16 v[232:235], a[92:95], a[44:47], v[232:235]
s_waitcnt vmcnt(9)
buffer_load_dwordx4 v29, s[24:27], s75 offen offset:1024 lds
s_waitcnt lgkmcnt(4)
v_mfma_f32_16x16x32_bf16 v[44:47], a[96:99], v[140:143], v[44:47]
v_exp_f32 v195, v195
v_mfma_f32_16x16x32_bf16 v[44:47], a[100:103], v[148:151], v[44:47]
s_waitcnt vmcnt(9)
buffer_load_dwordx4 v30, s[24:27], s75 offen offset:2048 lds
ds_read_b64_tr_b16 a[112:113], v14 offset:32768
ds_read_b64_tr_b16 a[114:115], v14 offset:36864
v_mfma_f32_16x16x32_bf16 v[76:79], a[100:103], v[164:167], v[76:79]
v_exp_f32 v208, v208
v_mfma_f32_16x16x32_bf16 v[76:79], a[96:99], v[156:159], v[76:79]
ds_read_b64_tr_b16 a[116:117], v14 offset:40960
ds_read_b64_tr_b16 a[118:119], v14 offset:45056
v_mfma_f32_16x16x32_bf16 v[108:111], a[96:99], v[172:175], v[108:111]
v_exp_f32 v209, v209
v_mfma_f32_16x16x32_bf16 v[108:111], a[100:103], v[180:183], v[108:111]
s_waitcnt vmcnt(9)
buffer_load_dwordx4 v31, s[24:27], s75 offen offset:3072 lds
s_add_u32 s75, s75, 32768
s_and_b32 s75, s75, 0xfffff
s_or_b32 s75, s75, s79
s_waitcnt lgkmcnt(4)
v_mfma_f32_16x16x32_bf16 v[48:51], a[104:107], v[140:143], v[48:51]
ds_read_b64_tr_b16 a[176:177], v244 offset:0
v_cvt_pk_bf16_f32 v191, v194, v195
v_mfma_f32_16x16x32_bf16 v[48:51], a[108:111], v[148:151], v[48:51]
ds_read_b64_tr_b16 a[178:179], v244 offset:2048
ds_read_b64_tr_b16 a[120:121], v15 offset:32768
ds_read_b64_tr_b16 a[122:123], v15 offset:36864
v_mfma_f32_16x16x32_bf16 v[80:83], a[108:111], v[164:167], v[80:83]
v_exp_f32 v210, v210
v_mfma_f32_16x16x32_bf16 v[80:83], a[104:107], v[156:159], v[80:83]
ds_read_b64_tr_b16 a[180:181], v245 offset:0
ds_read_b64_tr_b16 a[182:183], v245 offset:2048
ds_read_b64_tr_b16 a[124:125], v15 offset:40960
ds_read_b64_tr_b16 a[126:127], v15 offset:45056
v_mfma_f32_16x16x32_bf16 v[112:115], a[104:107], v[172:175], v[112:115]
v_cvt_pk_bf16_f32 v206, v208, v209
ds_read_b64_tr_b16 a[184:185], v246 offset:0
v_mfma_f32_16x16x32_bf16 v[112:115], a[108:111], v[180:183], v[112:115]
ds_read_b64_tr_b16 a[186:187], v246 offset:2048
ds_read_b64_tr_b16 a[188:189], v247 offset:0
v_mfma_f32_16x16x32_bf16 a[48:51], a[60:63], v[140:143], a[48:51]
v_exp_f32 v211, v211
v_mfma_f32_16x16x32_bf16 a[48:51], a[60:63], v[148:151], a[48:51]
s_waitcnt lgkmcnt(14)
ds_read_b64_tr_b16 a[190:191], v247 offset:2048
s_waitcnt lgkmcnt(12)
v_mfma_f32_16x16x32_bf16 v[52:55], a[112:115], v[140:143], v[52:55]
v_exp_f32 v224, v224
v_mfma_f32_16x16x32_bf16 v[52:55], a[116:119], v[148:151], v[52:55]
v_exp_f32 v225, v225
ds_read_b64_tr_b16 a[96:97], v16 offset:32768
ds_read_b64_tr_b16 a[98:99], v16 offset:36864
v_mfma_f32_16x16x32_bf16 v[84:87], a[116:119], v[164:167], v[84:87]
v_cvt_pk_bf16_f32 v207, v210, v211
v_mfma_f32_16x16x32_bf16 v[84:87], a[112:115], v[156:159], v[84:87]
ds_read_b64_tr_b16 a[100:101], v16 offset:40960
s_waitcnt lgkmcnt(14)
ds_read_b64_tr_b16 a[102:103], v16 offset:45056
v_mfma_f32_16x16x32_bf16 v[116:119], a[112:115], v[172:175], v[116:119]
v_exp_f32 v226, v226
v_mfma_f32_16x16x32_bf16 v[116:119], a[116:119], v[180:183], v[116:119]
v_cvt_pk_bf16_f32 v222, v224, v225
s_waitcnt lgkmcnt(4)
s_add_u32 m0, s65, 131072
v_mfma_f32_16x16x32_bf16 v[56:59], a[120:123], v[140:143], v[56:59]
v_exp_f32 v227, v227
v_mfma_f32_16x16x32_bf16 v[56:59], a[124:127], v[148:151], v[56:59]
s_waitcnt vmcnt(9)
buffer_load_dwordx4 v28, s[24:27], s75 offen lds
ds_read_b64_tr_b16 a[104:105], v17 offset:32768
ds_read_b64_tr_b16 a[106:107], v17 offset:36864
v_mfma_f32_16x16x32_bf16 v[88:91], a[124:127], v[164:167], v[88:91]
v_exp_f32 v196, v196
v_mfma_f32_16x16x32_bf16 v[88:91], a[120:123], v[156:159], v[88:91]
s_waitcnt vmcnt(9)
buffer_load_dwordx4 v29, s[24:27], s75 offen offset:1024 lds
ds_read_b64_tr_b16 a[108:109], v17 offset:40960
ds_read_b64_tr_b16 a[110:111], v17 offset:45056
v_mfma_f32_16x16x32_bf16 v[120:123], a[120:123], v[172:175], v[120:123]
v_exp_f32 v197, v197
v_mfma_f32_16x16x32_bf16 v[120:123], a[124:127], v[180:183], v[120:123]
s_waitcnt vmcnt(9)
buffer_load_dwordx4 v30, s[24:27], s75 offen offset:2048 lds
v_mfma_f32_16x16x32_bf16 a[52:55], a[60:63], v[156:159], a[52:55]
v_cvt_pk_bf16_f32 v223, v226, v227
v_mfma_f32_16x16x32_bf16 a[52:55], a[60:63], v[164:167], a[52:55]
ds_read_b64_tr_b16 a[112:113], v18 offset:32768
s_waitcnt lgkmcnt(5)
v_mfma_f32_16x16x32_bf16 v[60:63], a[96:99], v[140:143], v[60:63]
v_exp_f32 v198, v198
v_mfma_f32_16x16x32_bf16 v[60:63], a[100:103], v[148:151], v[60:63]
v_cvt_pk_bf16_f32 v196, v196, v197
s_waitcnt vmcnt(9)
buffer_load_dwordx4 v31, s[24:27], s75 offen offset:3072 lds
ds_read_b64_tr_b16 a[114:115], v18 offset:36864
v_mfma_f32_16x16x32_bf16 v[92:95], a[100:103], v[164:167], v[92:95]
v_exp_f32 v199, v199
v_mfma_f32_16x16x32_bf16 v[92:95], a[96:99], v[156:159], v[92:95]
s_add_u32 s75, s75, 32768
ds_read_b64_tr_b16 a[192:193], v236 offset:0
ds_read_b64_tr_b16 a[116:117], v18 offset:40960
ds_read_b64_tr_b16 a[118:119], v18 offset:45056
v_mfma_f32_16x16x32_bf16 v[124:127], a[96:99], v[172:175], v[124:127]
v_exp_f32 v212, v212
v_mfma_f32_16x16x32_bf16 v[124:127], a[100:103], v[180:183], v[124:127]
ds_read_b64_tr_b16 a[194:195], v236 offset:2048
ds_read_b64_tr_b16 a[196:197], v237 offset:0
s_waitcnt lgkmcnt(7)
v_mfma_f32_16x16x32_bf16 v[64:67], a[104:107], v[140:143], v[64:67]
ds_read_b64_tr_b16 a[198:199], v237 offset:2048
ds_read_b64_tr_b16 a[200:201], v238 offset:0
v_mfma_f32_16x16x32_bf16 v[64:67], a[108:111], v[148:151], v[64:67]
ds_read_b64_tr_b16 a[120:121], v19 offset:32768
ds_read_b64_tr_b16 a[122:123], v19 offset:36864
v_mfma_f32_16x16x32_bf16 v[96:99], a[108:111], v[164:167], v[96:99]
v_exp_f32 v213, v213
v_mfma_f32_16x16x32_bf16 v[96:99], a[104:107], v[156:159], v[96:99]
v_cvt_pk_bf16_f32 v197, v198, v199
ds_read_b64_tr_b16 a[202:203], v238 offset:2048
ds_read_b64_tr_b16 a[204:205], v239 offset:0
ds_read_b64_tr_b16 a[124:125], v19 offset:40960
s_barrier
ds_read_b64_tr_b16 a[126:127], v19 offset:45056
v_mfma_f32_16x16x32_bf16 v[128:131], a[104:107], v[172:175], v[128:131]
v_exp_f32 v214, v214
v_mfma_f32_16x16x32_bf16 v[128:131], a[108:111], v[180:183], v[128:131]
s_waitcnt lgkmcnt(14)
ds_read_b64_tr_b16 a[206:207], v239 offset:2048
v_cvt_pk_bf16_f32 v212, v212, v213
v_mfma_f32_16x16x32_bf16 a[56:59], a[60:63], v[172:175], a[56:59]
v_exp_f32 v215, v215
v_mfma_f32_16x16x32_bf16 a[56:59], a[60:63], v[180:183], a[56:59]
s_waitcnt lgkmcnt(0)
v_mfma_f32_16x16x32_bf16 v[68:71], a[112:115], v[140:143], v[68:71]
v_exp_f32 v228, v228
v_mfma_f32_16x16x32_bf16 v[68:71], a[116:119], v[148:151], v[68:71]
ds_read_b64_tr_b16 a[96:97], v12 offset:49152
ds_read_b64_tr_b16 a[98:99], v12 offset:53248
v_mfma_f32_16x16x32_bf16 v[100:103], a[116:119], v[164:167], v[100:103]
v_exp_f32 v229, v229
v_mfma_f32_16x16x32_bf16 v[100:103], a[112:115], v[156:159], v[100:103]
v_cvt_pk_bf16_f32 v213, v214, v215
s_add_u32 m0, s65, 0
s_waitcnt vmcnt(9)
buffer_load_dwordx4 v28, s[24:27], s75 offen lds
ds_read_b64_tr_b16 a[100:101], v12 offset:57344
ds_read_b64_tr_b16 a[102:103], v12 offset:61440
v_mfma_f32_16x16x32_bf16 v[132:135], a[112:115], v[172:175], v[132:135]
v_exp_f32 v230, v230
v_mfma_f32_16x16x32_bf16 v[132:135], a[116:119], v[180:183], v[132:135]
ds_read_b64_tr_b16 a[104:105], v13 offset:49152
v_mfma_f32_16x16x32_bf16 v[72:75], a[120:123], v[140:143], v[72:75]
v_cvt_pk_bf16_f32 v228, v228, v229
v_mfma_f32_16x16x32_bf16 v[72:75], a[124:127], v[148:151], v[72:75]
v_exp_f32 v231, v231
s_waitcnt vmcnt(9)
buffer_load_dwordx4 v29, s[24:27], s75 offen offset:1024 lds
ds_read_b64_tr_b16 a[106:107], v13 offset:53248
v_mfma_f32_16x16x32_bf16 v[104:107], a[124:127], v[164:167], v[104:107]
v_exp_f32 v200, v200
v_mfma_f32_16x16x32_bf16 v[104:107], a[120:123], v[156:159], v[104:107]
s_waitcnt vmcnt(9)
buffer_load_dwordx4 v30, s[24:27], s75 offen offset:2048 lds
ds_read_b64_tr_b16 a[108:109], v13 offset:57344
ds_read_b64_tr_b16 a[110:111], v13 offset:61440
v_mfma_f32_16x16x32_bf16 v[136:139], a[120:123], v[172:175], v[136:139]
v_exp_f32 v201, v201
v_mfma_f32_16x16x32_bf16 v[136:139], a[124:127], v[180:183], v[136:139]
v_cvt_pk_bf16_f32 v229, v230, v231
v_exp_f32 v202, v202
v_cvt_pk_bf16_f32 v198, v200, v201
s_waitcnt vmcnt(9)
buffer_load_dwordx4 v31, s[24:27], s75 offen offset:3072 lds
v_exp_f32 v203, v203
s_add_u32 s75, s75, 32768
v_exp_f32 v216, v216
v_exp_f32 v217, v217
v_cvt_pk_bf16_f32 v199, v202, v203
v_exp_f32 v218, v218
v_cvt_pk_bf16_f32 v214, v216, v217
v_exp_f32 v219, v219
v_exp_f32 v232, v232
v_exp_f32 v233, v233
v_cvt_pk_bf16_f32 v215, v218, v219
v_exp_f32 v234, v234
v_cvt_pk_bf16_f32 v230, v232, v233
v_exp_f32 v235, v235
s_nop 0
v_cvt_pk_bf16_f32 v231, v234, v235
s_waitcnt lgkmcnt(4)
v_mfma_f32_16x16x32_bf16 v[44:47], a[96:99], v[188:191], v[44:47]
s_add_u32 m0, s65, 49152
ds_read_b64_tr_b16 a[112:113], v14 offset:49152
v_mfma_f32_16x16x32_bf16 v[44:47], a[100:103], v[196:199], v[44:47]
s_waitcnt vmcnt(9)
buffer_load_dwordx4 v28, s[24:27], s75 offen lds
v_mfma_f32_16x16x32_bf16 v[76:79], a[100:103], v[212:215], v[76:79]
ds_read_b64_tr_b16 a[114:115], v14 offset:53248
ds_read_b64_tr_b16 a[116:117], v14 offset:57344
v_mfma_f32_16x16x32_bf16 v[76:79], a[96:99], v[204:207], v[76:79]
s_waitcnt vmcnt(9)
buffer_load_dwordx4 v29, s[24:27], s75 offen offset:1024 lds
v_mfma_f32_16x16x32_bf16 v[108:111], a[96:99], v[220:223], v[108:111]
ds_read_b64_tr_b16 a[118:119], v14 offset:61440
ds_read_b64_tr_b16 a[120:121], v15 offset:49152
v_mfma_f32_16x16x32_bf16 v[108:111], a[100:103], v[228:231], v[108:111]
ds_read_b64_tr_b16 a[122:123], v15 offset:53248
s_waitcnt lgkmcnt(6)
v_mfma_f32_16x16x32_bf16 v[48:51], a[104:107], v[188:191], v[48:51]
ds_read_b64_tr_b16 a[124:125], v15 offset:57344
v_mfma_f32_16x16x32_bf16 v[48:51], a[108:111], v[196:199], v[48:51]
s_waitcnt vmcnt(9)
buffer_load_dwordx4 v30, s[24:27], s75 offen offset:2048 lds
v_mfma_f32_16x16x32_bf16 v[80:83], a[108:111], v[212:215], v[80:83]
ds_read_b64_tr_b16 a[126:127], v15 offset:61440
v_mfma_f32_16x16x32_bf16 v[80:83], a[104:107], v[204:207], v[80:83]
s_waitcnt vmcnt(9)
buffer_load_dwordx4 v31, s[24:27], s75 offen offset:3072 lds
v_mfma_f32_16x16x32_bf16 v[112:115], a[104:107], v[220:223], v[112:115]
s_add_u32 s75, s75, 32768
s_add_u32 m0, s65, 81920
v_mfma_f32_16x16x32_bf16 v[112:115], a[108:111], v[228:231], v[112:115]
s_waitcnt vmcnt(9)
buffer_load_dwordx4 v28, s[24:27], s75 offen lds
v_mfma_f32_16x16x32_bf16 a[48:51], a[60:63], v[188:191], a[48:51]
ds_read_b64_tr_b16 a[96:97], v16 offset:49152
v_mfma_f32_16x16x32_bf16 a[48:51], a[60:63], v[196:199], a[48:51]
s_waitcnt vmcnt(9)
buffer_load_dwordx4 v29, s[24:27], s75 offen offset:1024 lds
s_waitcnt lgkmcnt(5)
v_mfma_f32_16x16x32_bf16 v[52:55], a[112:115], v[188:191], v[52:55]
ds_read_b64_tr_b16 a[98:99], v16 offset:53248
ds_read_b64_tr_b16 a[100:101], v16 offset:57344
v_mfma_f32_16x16x32_bf16 v[52:55], a[116:119], v[196:199], v[52:55]
s_waitcnt vmcnt(9)
buffer_load_dwordx4 v30, s[24:27], s75 offen offset:2048 lds
v_mfma_f32_16x16x32_bf16 v[84:87], a[116:119], v[212:215], v[84:87]
ds_read_b64_tr_b16 a[102:103], v16 offset:61440
v_mfma_f32_16x16x32_bf16 v[84:87], a[112:115], v[204:207], v[84:87]
s_waitcnt vmcnt(9)
buffer_load_dwordx4 v31, s[24:27], s75 offen offset:3072 lds
v_mfma_f32_16x16x32_bf16 v[116:119], a[112:115], v[220:223], v[116:119]
s_add_u32 s75, s75, 32768
s_and_b32 s75, s75, 0xfffff
s_or_b32 s75, s75, s79
ds_read_b64_tr_b16 a[104:105], v17 offset:49152
v_mfma_f32_16x16x32_bf16 v[116:119], a[116:119], v[228:231], v[116:119]
ds_read_b64_tr_b16 a[208:209], v236 offset:32768
s_waitcnt lgkmcnt(6)
v_mfma_f32_16x16x32_bf16 v[56:59], a[120:123], v[188:191], v[56:59]
ds_read_b64_tr_b16 a[210:211], v236 offset:34816
ds_read_b64_tr_b16 a[212:213], v237 offset:32768
v_mfma_f32_16x16x32_bf16 v[56:59], a[124:127], v[196:199], v[56:59]
ds_read_b64_tr_b16 a[214:215], v237 offset:34816
ds_read_b64_tr_b16 a[216:217], v238 offset:32768
v_mfma_f32_16x16x32_bf16 v[88:91], a[124:127], v[212:215], v[88:91]
ds_read_b64_tr_b16 a[106:107], v17 offset:53248
ds_read_b64_tr_b16 a[218:219], v238 offset:34816
v_mfma_f32_16x16x32_bf16 v[88:91], a[120:123], v[204:207], v[88:91]
ds_read_b64_tr_b16 a[108:109], v17 offset:57344
ds_read_b64_tr_b16 a[220:221], v239 offset:32768
v_mfma_f32_16x16x32_bf16 v[120:123], a[120:123], v[220:223], v[120:123]
ds_read_b64_tr_b16 a[110:111], v17 offset:61440
s_waitcnt lgkmcnt(14)
ds_read_b64_tr_b16 a[222:223], v239 offset:34816
v_mfma_f32_16x16x32_bf16 v[120:123], a[124:127], v[228:231], v[120:123]
v_mfma_f32_16x16x32_bf16 a[52:55], a[60:63], v[204:207], a[52:55]
s_waitcnt lgkmcnt(14)
ds_read_b64_tr_b16 a[112:113], v18 offset:49152
v_mfma_f32_16x16x32_bf16 a[52:55], a[60:63], v[212:215], a[52:55]
s_waitcnt lgkmcnt(14)
ds_read_b64_tr_b16 a[114:115], v18 offset:53248
s_waitcnt lgkmcnt(14)
v_mfma_f32_16x16x32_bf16 v[60:63], a[96:99], v[188:191], v[60:63]
ds_read_b64_tr_b16 a[116:117], v18 offset:57344
v_mfma_f32_16x16x32_bf16 v[60:63], a[100:103], v[196:199], v[60:63]
s_waitcnt lgkmcnt(3)
s_add_u32 m0, s65, 32768
v_mfma_f32_16x16x32_bf16 v[92:95], a[100:103], v[212:215], v[92:95]
ds_read_b64_tr_b16 a[118:119], v18 offset:61440
v_mfma_f32_16x16x32_bf16 v[92:95], a[96:99], v[204:207], v[92:95]
s_waitcnt vmcnt(9)
buffer_load_dwordx4 v28, s[24:27], s75 offen lds
v_mfma_f32_16x16x32_bf16 v[124:127], a[96:99], v[220:223], v[124:127]
ds_read_b64_tr_b16 a[120:121], v19 offset:49152
v_mfma_f32_16x16x32_bf16 v[124:127], a[100:103], v[228:231], v[124:127]
ds_read_b64_tr_b16 a[122:123], v19 offset:53248
v_mfma_f32_16x16x32_bf16 v[64:67], a[104:107], v[188:191], v[64:67]
ds_read_b64_tr_b16 a[124:125], v19 offset:57344
v_mfma_f32_16x16x32_bf16 v[64:67], a[108:111], v[196:199], v[64:67]
s_waitcnt vmcnt(9)
buffer_load_dwordx4 v29, s[24:27], s75 offen offset:1024 lds
v_mfma_f32_16x16x32_bf16 v[96:99], a[108:111], v[212:215], v[96:99]
ds_read_b64_tr_b16 a[126:127], v19 offset:61440
v_mfma_f32_16x16x32_bf16 v[96:99], a[104:107], v[204:207], v[96:99]
s_waitcnt vmcnt(9)
buffer_load_dwordx4 v30, s[24:27], s75 offen offset:2048 lds
v_mfma_f32_16x16x32_bf16 v[128:131], a[104:107], v[220:223], v[128:131]
v_mfma_f32_16x16x32_bf16 v[128:131], a[108:111], v[228:231], v[128:131]
s_waitcnt vmcnt(9)
buffer_load_dwordx4 v31, s[24:27], s75 offen offset:3072 lds
v_mfma_f32_16x16x32_bf16 a[56:59], a[60:63], v[220:223], a[56:59]
s_add_u32 s75, s75, 32768
v_mfma_f32_16x16x32_bf16 a[56:59], a[60:63], v[228:231], a[56:59]
ds_read_b64_tr_b16 a[224:225], v240 offset:0
ds_read_b64_tr_b16 a[226:227], v240 offset:2048
ds_read_b64_tr_b16 a[228:229], v241 offset:0
ds_read_b64_tr_b16 a[230:231], v241 offset:2048
ds_read_b64_tr_b16 a[232:233], v242 offset:0
s_waitcnt lgkmcnt(9)
v_mfma_f32_16x16x32_bf16 v[68:71], a[112:115], v[188:191], v[68:71]
ds_read_b64_tr_b16 a[234:235], v242 offset:2048
ds_read_b64_tr_b16 a[236:237], v243 offset:0
v_mfma_f32_16x16x32_bf16 v[68:71], a[116:119], v[196:199], v[68:71]
ds_read_b64_tr_b16 a[238:239], v243 offset:2048
v_mfma_f32_16x16x32_bf16 v[100:103], a[116:119], v[212:215], v[100:103]
v_mfma_f32_16x16x32_bf16 v[100:103], a[112:115], v[204:207], v[100:103]
v_mfma_f32_16x16x32_bf16 v[132:135], a[112:115], v[220:223], v[132:135]
v_mfma_f32_16x16x32_bf16 v[132:135], a[116:119], v[228:231], v[132:135]
s_waitcnt lgkmcnt(0)
v_mfma_f32_16x16x32_bf16 v[72:75], a[120:123], v[188:191], v[72:75]
s_add_u32 m0, s65, 65536
v_mfma_f32_16x16x32_bf16 v[72:75], a[124:127], v[196:199], v[72:75]
s_waitcnt vmcnt(9)
buffer_load_dwordx4 v28, s[24:27], s75 offen lds
v_mfma_f32_16x16x32_bf16 v[104:107], a[124:127], v[212:215], v[104:107]
v_mfma_f32_16x16x32_bf16 v[104:107], a[120:123], v[204:207], v[104:107]
s_waitcnt vmcnt(9)
buffer_load_dwordx4 v29, s[24:27], s75 offen offset:1024 lds
v_mfma_f32_16x16x32_bf16 v[136:139], a[120:123], v[220:223], v[136:139]
v_mfma_f32_16x16x32_bf16 v[136:139], a[124:127], v[228:231], v[136:139]
s_waitcnt vmcnt(9)
buffer_load_dwordx4 v30, s[24:27], s75 offen offset:2048 lds
s_waitcnt vmcnt(9)
buffer_load_dwordx4 v31, s[24:27], s75 offen offset:3072 lds
s_add_u32 s75, s75, 32768
s_nop 4
v_accvgpr_read_b32 v2, a48
v_accvgpr_read_b32 v4, a52
v_accvgpr_read_b32 v6, a56
v_max3_f32 v1, v2, v4, v6
v_rcp_f32 v2, v2
v_rcp_f32 v4, v4
v_rcp_f32 v6, v6
v_cmp_nge_f32 vcc, 0x53800000, v1
v_mov_b32 v5, 163776
s_nop 0
s_cbranch_vccz L_lok
v_mov_b32 v1, 1
ds_write_b32 v5, v1
s_waitcnt lgkmcnt(0)
L_lok:
s_mov_b32 s76, 0
v_pk_mul_f32 v[44:45], v[44:45], v[2:3] op_sel_hi:[1,0]
v_pk_mul_f32 v[46:47], v[46:47], v[2:3] op_sel_hi:[1,0]
v_cvt_pk_bf16_f32 v140, v44, v45
v_cvt_pk_bf16_f32 v141, v46, v47
v_pk_mul_f32 v[48:49], v[48:49], v[2:3] op_sel_hi:[1,0]
v_pk_mul_f32 v[50:51], v[50:51], v[2:3] op_sel_hi:[1,0]
v_cvt_pk_bf16_f32 v142, v48, v49
v_cvt_pk_bf16_f32 v143, v50, v51
buffer_store_dwordx4 v[140:143], v26, s[28:31], s76 offen sc1
v_pk_mul_f32 v[76:77], v[76:77], v[4:5] op_sel_hi:[1,0]
v_pk_mul_f32 v[78:79], v[78:79], v[4:5] op_sel_hi:[1,0]
v_cvt_pk_bf16_f32 v144, v76, v77
v_cvt_pk_bf16_f32 v145, v78, v79
v_pk_mul_f32 v[80:81], v[80:81], v[4:5] op_sel_hi:[1,0]
v_pk_mul_f32 v[82:83], v[82:83], v[4:5] op_sel_hi:[1,0]
v_cvt_pk_bf16_f32 v146, v80, v81
v_cvt_pk_bf16_f32 v147, v82, v83
buffer_store_dwordx4 v[144:147], v26, s[28:31], s76 offen offset:1024 sc1
v_pk_mul_f32 v[108:109], v[108:109], v[6:7] op_sel_hi:[1,0]
v_pk_mul_f32 v[110:111], v[110:111], v[6:7] op_sel_hi:[1,0]
v_cvt_pk_bf16_f32 v148, v108, v109
v_cvt_pk_bf16_f32 v149, v110, v111
v_pk_mul_f32 v[112:113], v[112:113], v[6:7] op_sel_hi:[1,0]
v_pk_mul_f32 v[114:115], v[114:115], v[6:7] op_sel_hi:[1,0]
v_cvt_pk_bf16_f32 v150, v112, v113
v_cvt_pk_bf16_f32 v151, v114, v115
buffer_store_dwordx4 v[148:151], v26, s[28:31], s76 offen offset:2048 sc1
s_mov_b32 s76, 3072
v_pk_mul_f32 v[52:53], v[52:53], v[2:3] op_sel_hi:[1,0]
v_pk_mul_f32 v[54:55], v[54:55], v[2:3] op_sel_hi:[1,0]
v_cvt_pk_bf16_f32 v152, v52, v53
v_cvt_pk_bf16_f32 v153, v54, v55
v_pk_mul_f32 v[56:57], v[56:57], v[2:3] op_sel_hi:[1,0]
v_pk_mul_f32 v[58:59], v[58:59], v[2:3] op_sel_hi:[1,0]
v_cvt_pk_bf16_f32 v154, v56, v57
v_cvt_pk_bf16_f32 v155, v58, v59
buffer_store_dwordx4 v[152:155], v26, s[28:31], s76 offen sc1
v_pk_mul_f32 v[84:85], v[84:85], v[4:5] op_sel_hi:[1,0]
v_pk_mul_f32 v[86:87], v[86:87], v[4:5] op_sel_hi:[1,0]
v_cvt_pk_bf16_f32 v156, v84, v85
v_cvt_pk_bf16_f32 v157, v86, v87
v_pk_mul_f32 v[88:89], v[88:89], v[4:5] op_sel_hi:[1,0]
v_pk_mul_f32 v[90:91], v[90:91], v[4:5] op_sel_hi:[1,0]
v_cvt_pk_bf16_f32 v158, v88, v89
v_cvt_pk_bf16_f32 v159, v90, v91
buffer_store_dwordx4 v[156:159], v26, s[28:31], s76 offen offset:1024 sc1
v_pk_mul_f32 v[116:117], v[116:117], v[6:7] op_sel_hi:[1,0]
v_pk_mul_f32 v[118:119], v[118:119], v[6:7] op_sel_hi:[1,0]
v_cvt_pk_bf16_f32 v160, v116, v117
v_cvt_pk_bf16_f32 v161, v118, v119
v_pk_mul_f32 v[120:121], v[120:121], v[6:7] op_sel_hi:[1,0]
v_pk_mul_f32 v[122:123], v[122:123], v[6:7] op_sel_hi:[1,0]
v_cvt_pk_bf16_f32 v162, v120, v121
v_cvt_pk_bf16_f32 v163, v122, v123
buffer_store_dwordx4 v[160:163], v26, s[28:31], s76 offen offset:2048 sc1
s_mov_b32 s76, 6144
v_pk_mul_f32 v[60:61], v[60:61], v[2:3] op_sel_hi:[1,0]
v_pk_mul_f32 v[62:63], v[62:63], v[2:3] op_sel_hi:[1,0]
v_cvt_pk_bf16_f32 v164, v60, v61
v_cvt_pk_bf16_f32 v165, v62, v63
v_pk_mul_f32 v[64:65], v[64:65], v[2:3] op_sel_hi:[1,0]
v_pk_mul_f32 v[66:67], v[66:67], v[2:3] op_sel_hi:[1,0]
v_cvt_pk_bf16_f32 v166, v64, v65
v_cvt_pk_bf16_f32 v167, v66, v67
buffer_store_dwordx4 v[164:167], v26, s[28:31], s76 offen sc1
v_pk_mul_f32 v[92:93], v[92:93], v[4:5] op_sel_hi:[1,0]
v_pk_mul_f32 v[94:95], v[94:95], v[4:5] op_sel_hi:[1,0]
v_cvt_pk_bf16_f32 v168, v92, v93
v_cvt_pk_bf16_f32 v169, v94, v95
v_pk_mul_f32 v[96:97], v[96:97], v[4:5] op_sel_hi:[1,0]
v_pk_mul_f32 v[98:99], v[98:99], v[4:5] op_sel_hi:[1,0]
v_cvt_pk_bf16_f32 v170, v96, v97
v_cvt_pk_bf16_f32 v171, v98, v99
buffer_store_dwordx4 v[168:171], v26, s[28:31], s76 offen offset:1024 sc1
v_pk_mul_f32 v[124:125], v[124:125], v[6:7] op_sel_hi:[1,0]
v_pk_mul_f32 v[126:127], v[126:127], v[6:7] op_sel_hi:[1,0]
v_cvt_pk_bf16_f32 v172, v124, v125
v_cvt_pk_bf16_f32 v173, v126, v127
v_pk_mul_f32 v[128:129], v[128:129], v[6:7] op_sel_hi:[1,0]
v_pk_mul_f32 v[130:131], v[130:131], v[6:7] op_sel_hi:[1,0]
v_cvt_pk_bf16_f32 v174, v128, v129
v_cvt_pk_bf16_f32 v175, v130, v131
buffer_store_dwordx4 v[172:175], v26, s[28:31], s76 offen offset:2048 sc1
s_mov_b32 s76, 9216
v_pk_mul_f32 v[68:69], v[68:69], v[2:3] op_sel_hi:[1,0]
v_pk_mul_f32 v[70:71], v[70:71], v[2:3] op_sel_hi:[1,0]
v_cvt_pk_bf16_f32 v176, v68, v69
v_cvt_pk_bf16_f32 v177, v70, v71
v_pk_mul_f32 v[72:73], v[72:73], v[2:3] op_sel_hi:[1,0]
v_pk_mul_f32 v[74:75], v[74:75], v[2:3] op_sel_hi:[1,0]
v_cvt_pk_bf16_f32 v178, v72, v73
v_cvt_pk_bf16_f32 v179, v74, v75
buffer_store_dwordx4 v[176:179], v26, s[28:31], s76 offen sc1
v_pk_mul_f32 v[100:101], v[100:101], v[4:5] op_sel_hi:[1,0]
v_pk_mul_f32 v[102:103], v[102:103], v[4:5] op_sel_hi:[1,0]
v_cvt_pk_bf16_f32 v180, v100, v101
v_cvt_pk_bf16_f32 v181, v102, v103
v_pk_mul_f32 v[104:105], v[104:105], v[4:5] op_sel_hi:[1,0]
v_pk_mul_f32 v[106:107], v[106:107], v[4:5] op_sel_hi:[1,0]
v_cvt_pk_bf16_f32 v182, v104, v105
v_cvt_pk_bf16_f32 v183, v106, v107
buffer_store_dwordx4 v[180:183], v26, s[28:31], s76 offen offset:1024 sc1
v_pk_mul_f32 v[132:133], v[132:133], v[6:7] op_sel_hi:[1,0]
v_pk_mul_f32 v[134:135], v[134:135], v[6:7] op_sel_hi:[1,0]
v_cvt_pk_bf16_f32 v184, v132, v133
v_cvt_pk_bf16_f32 v185, v134, v135
v_pk_mul_f32 v[136:137], v[136:137], v[6:7] op_sel_hi:[1,0]
v_pk_mul_f32 v[138:139], v[138:139], v[6:7] op_sel_hi:[1,0]
v_cvt_pk_bf16_f32 v186, v136, v137
v_cvt_pk_bf16_f32 v187, v138, v139
buffer_store_dwordx4 v[184:187], v26, s[28:31], s76 offen offset:2048 sc1
ds_read_b64_tr_b16 a[240:241], v236 offset:16384
ds_read_b64_tr_b16 a[242:243], v236 offset:18432
ds_read_b64_tr_b16 a[244:245], v237 offset:16384
ds_read_b64_tr_b16 a[246:247], v237 offset:18432
ds_read_b64_tr_b16 a[248:249], v238 offset:16384
ds_read_b64_tr_b16 a[250:251], v238 offset:18432
ds_read_b64_tr_b16 a[252:253], v239 offset:16384
ds_read_b64_tr_b16 a[254:255], v239 offset:18432
s_waitcnt lgkmcnt(0)
s_add_u32 m0, s65, 16384
s_nop 0
s_waitcnt vmcnt(9)
buffer_load_dwordx4 v28, s[24:27], s75 offen lds
s_waitcnt vmcnt(9)
buffer_load_dwordx4 v29, s[24:27], s75 offen offset:1024 lds
s_waitcnt vmcnt(9)
buffer_load_dwordx4 v30, s[24:27], s75 offen offset:2048 lds
s_waitcnt vmcnt(9)
buffer_load_dwordx4 v31, s[24:27], s75 offen offset:3072 lds
s_add_u32 s75, s75, 32768
s_barrier
ds_read_b32 v4, v5
s_waitcnt lgkmcnt(0)
v_readfirstlane_b32 s6, v4
s_nop 1
s_cmp_gt_u32 s6, s74
s_cbranch_scc1 L_fallback
s_add_u32 m0, s65, 98304
s_nop 0
buffer_load_dwordx4 v28, s[24:27], s75 offen lds
buffer_load_dwordx4 v29, s[24:27], s75 offen offset:1024 lds
buffer_load_dwordx4 v30, s[24:27], s75 offen offset:2048 lds
buffer_load_dwordx4 v31, s[24:27], s75 offen offset:3072 lds
s_add_u32 s75, s75, 32768
s_and_b32 s75, s75, 0xfffff
s_or_b32 s75, s75, s79
s_add_u32 m0, s65, 114688
s_nop 0
buffer_load_dwordx4 v28, s[24:27], s75 offen lds
buffer_load_dwordx4 v29, s[24:27], s75 offen offset:1024 lds
buffer_load_dwordx4 v30, s[24:27], s75 offen offset:2048 lds
buffer_load_dwordx4 v31, s[24:27], s75 offen offset:3072 lds
s_add_u32 s75, s75, 32768
v_lshrrev_b32 v1, 4, v27
v_and_b32 v2, 15, v27
ds_read_b64_tr_b16 a[0:1], v244 offset:0
ds_read_b64_tr_b16 a[2:3], v244 offset:2048
ds_read_b64_tr_b16 a[4:5], v245 offset:0
ds_read_b64_tr_b16 a[6:7], v245 offset:2048
ds_read_b64_tr_b16 a[8:9], v246 offset:0
ds_read_b64_tr_b16 a[10:11], v246 offset:2048
ds_read_b64_tr_b16 a[12:13], v247 offset:0
ds_read_b64_tr_b16 a[14:15], v247 offset:2048
s_mov_b32 s6, 200000
L_nonce_chk:
s_cmp_lg_u32 s68, 0
s_cbranch_scc1 L_nonce_ok
s_sub_u32 s6, s6, 1
s_cmp_eq_u32 s6, 0
s_cbranch_scc1 L_nonce_ok
v_mov_b32 v3, 0
global_load_dwordx2 v[6:7], v3, s[52:53] sc1
s_waitcnt vmcnt(0)
v_readfirstlane_b32 s68, v6
v_readfirstlane_b32 s69, v7
s_nop 1
s_branch L_nonce_chk
L_nonce_ok:
v_xor_b32 v3, v1, v2
v_lshlrev_b32 v3, 4, v3
v_lshl_add_u32 v3, v2, 8, v3
v_add_u32 v3, s65, v3
v_xor_b32 v32, 0, v3
v_xor_b32 v33, 64, v3
v_xor_b32 v34, 128, v3
v_xor_b32 v35, 192, v3
s_mul_i32 s6, s56, 12
v_add_u32 v3, s6, v1
v_and_b32 v4, 15, v3
v_lshrrev_b32 v5, 4, v3
v_xor_b32 v6, v4, v2
v_lshlrev_b32 v6, 4, v6
v_lshl_add_u32 v6, v4, 8, v6
v_lshl_add_u32 v36, v5, 14, v6
v_lshlrev_b32 v6, 3, v2
v_lshl_add_u32 v39, v3, 10, v6
v_add_u32 v3, s6, v1
v_add_u32 v3, 4, v3
v_and_b32 v4, 15, v3
v_lshrrev_b32 v5, 4, v3
v_xor_b32 v6, v4, v2
v_lshlrev_b32 v6, 4, v6
v_lshl_add_u32 v6, v4, 8, v6
v_lshl_add_u32 v37, v5, 14, v6
v_lshlrev_b32 v6, 3, v2
v_lshl_add_u32 v40, v3, 10, v6
v_add_u32 v3, s6, v1
v_add_u32 v3, 8, v3
v_and_b32 v4, 15, v3
v_lshrrev_b32 v5, 4, v3
v_xor_b32 v6, v4, v2
v_lshlrev_b32 v6, 4, v6
v_lshl_add_u32 v6, v4, 8, v6
v_lshl_add_u32 v38, v5, 14, v6
v_lshlrev_b32 v6, 3, v2
v_lshl_add_u32 v41, v3, 10, v6
v_mov_b32 v4, s68
v_mov_b32 v5, s69
v_mov_b32 v3, 0
v_and_b32 v1, 7, v27
v_lshlrev_b32 v1, 3, v1
s_mul_i32 s76, s78, 12288
ds_read_b64_tr_b16 a[16:17], v236 offset:0
ds_read_b64_tr_b16 a[18:19], v236 offset:2048
ds_read_b64_tr_b16 a[20:21], v237 offset:0
ds_read_b64_tr_b16 a[22:23], v237 offset:2048
ds_read_b64_tr_b16 a[24:25], v238 offset:0
ds_read_b64_tr_b16 a[26:27], v238 offset:2048
ds_read_b64_tr_b16 a[28:29], v239 offset:0
s_waitcnt lgkmcnt(14)
ds_read_b64_tr_b16 a[30:31], v239 offset:2048
s_waitcnt lgkmcnt(8)
s_waitcnt vmcnt(12)
s_mov_b64 exec, 1
global_store_dwordx2 v3, v[4:5], s[70:71] sc1
s_mov_b64 exec, -1
s_add_u32 m0, s65, 131072
s_nop 0
buffer_load_dwordx4 v28, s[24:27], s75 offen lds
buffer_load_dwordx4 v29, s[24:27], s75 offen offset:1024 lds
buffer_load_dwordx4 v30, s[24:27], s75 offen offset:2048 lds
buffer_load_dwordx4 v31, s[24:27], s75 offen offset:3072 lds
s_add_u32 s75, s75, 32768
ds_read_b64_tr_b16 a[32:33], v236 offset:49152
ds_read_b64_tr_b16 a[34:35], v236 offset:51200
ds_read_b64_tr_b16 a[36:37], v237 offset:49152
ds_read_b64_tr_b16 a[38:39], v237 offset:51200
ds_read_b64_tr_b16 a[40:41], v238 offset:49152
ds_read_b64_tr_b16 a[42:43], v238 offset:51200
ds_read_b64_tr_b16 a[44:45], v239 offset:49152
s_waitcnt lgkmcnt(14)
ds_read_b64_tr_b16 a[46:47], v239 offset:51200
s_waitcnt lgkmcnt(8)
s_add_u32 m0, s65, 0
s_nop 0
buffer_load_dwordx4 v28, s[24:27], s75 offen lds
buffer_load_dwordx4 v29, s[24:27], s75 offen offset:1024 lds
buffer_load_dwordx4 v30, s[24:27], s75 offen offset:2048 lds
buffer_load_dwordx4 v31, s[24:27], s75 offen offset:3072 lds
s_add_u32 s75, s75, 32768
ds_read_b64_tr_b16 a[48:49], v240 offset:16384
ds_read_b64_tr_b16 a[50:51], v240 offset:18432
ds_read_b64_tr_b16 a[52:53], v241 offset:16384
ds_read_b64_tr_b16 a[54:55], v241 offset:18432
ds_read_b64_tr_b16 a[56:57], v242 offset:16384
ds_read_b64_tr_b16 a[58:59], v242 offset:18432
ds_read_b64_tr_b16 a[60:61], v243 offset:16384
s_waitcnt lgkmcnt(14)
ds_read_b64_tr_b16 a[62:63], v243 offset:18432
s_waitcnt lgkmcnt(8)
s_add_u32 m0, s65, 49152
s_nop 0
buffer_load_dwordx4 v28, s[24:27], s75 offen lds
buffer_load_dwordx4 v29, s[24:27], s75 offen offset:1024 lds
buffer_load_dwordx4 v30, s[24:27], s75 offen offset:2048 lds
buffer_load_dwordx4 v31, s[24:27], s75 offen offset:3072 lds
s_add_u32 s75, s75, 32768
s_and_b32 s75, s75, 0xfffff
s_or_b32 s75, s75, s79
ds_read_b64_tr_b16 a[64:65], v236 offset:32768
ds_read_b64_tr_b16 a[66:67], v236 offset:34816
ds_read_b64_tr_b16 a[68:69], v237 offset:32768
ds_read_b64_tr_b16 a[70:71], v237 offset:34816
ds_read_b64_tr_b16 a[72:73], v238 offset:32768
ds_read_b64_tr_b16 a[74:75], v238 offset:34816
ds_read_b64_tr_b16 a[76:77], v239 offset:32768
s_waitcnt lgkmcnt(14)
ds_read_b64_tr_b16 a[78:79], v239 offset:34816
s_waitcnt lgkmcnt(8)
s_add_u32 m0, s65, 81920
s_nop 0
buffer_load_dwordx4 v28, s[24:27], s75 offen lds
buffer_load_dwordx4 v29, s[24:27], s75 offen offset:1024 lds
buffer_load_dwordx4 v30, s[24:27], s75 offen offset:2048 lds
buffer_load_dwordx4 v31, s[24:27], s75 offen offset:3072 lds
s_add_u32 s75, s75, 32768
ds_read_b64_tr_b16 a[80:81], v240 offset:0
ds_read_b64_tr_b16 a[82:83], v240 offset:2048
ds_read_b64_tr_b16 a[84:85], v241 offset:0
ds_read_b64_tr_b16 a[86:87], v241 offset:2048
ds_read_b64_tr_b16 a[88:89], v242 offset:0
ds_read_b64_tr_b16 a[90:91], v242 offset:2048
ds_read_b64_tr_b16 a[92:93], v243 offset:0
s_waitcnt lgkmcnt(14)
ds_read_b64_tr_b16 a[94:95], v243 offset:2048
s_waitcnt lgkmcnt(8)
s_add_u32 m0, s65, 32768
s_nop 0
buffer_load_dwordx4 v28, s[24:27], s75 offen lds
buffer_load_dwordx4 v29, s[24:27], s75 offen offset:1024 lds
buffer_load_dwordx4 v30, s[24:27], s75 offen offset:2048 lds
buffer_load_dwordx4 v31, s[24:27], s75 offen offset:3072 lds
s_add_u32 s75, s75, 32768
s_waitcnt vmcnt(29)
ds_read_b64_tr_b16 a[96:97], v236 offset:16384
ds_read_b64_tr_b16 a[98:99], v236 offset:18432
ds_read_b64_tr_b16 a[100:101], v237 offset:16384
ds_read_b64_tr_b16 a[102:103], v237 offset:18432
ds_read_b64_tr_b16 a[104:105], v238 offset:16384
ds_read_b64_tr_b16 a[106:107], v238 offset:18432
ds_read_b64_tr_b16 a[108:109], v239 offset:16384
s_waitcnt lgkmcnt(14)
ds_read_b64_tr_b16 a[110:111], v239 offset:18432
s_waitcnt lgkmcnt(8)
s_add_u32 m0, s65, 65536
s_nop 0
buffer_load_dwordx4 v28, s[24:27], s75 offen lds
buffer_load_dwordx4 v29, s[24:27], s75 offen offset:1024 lds
buffer_load_dwordx4 v30, s[24:27], s75 offen offset:2048 lds
buffer_load_dwordx4 v31, s[24:27], s75 offen offset:3072 lds
s_add_u32 s75, s75, 32768
s_waitcnt vmcnt(29)
ds_read_b64_tr_b16 a[112:113], v240 offset:32768
ds_read_b64_tr_b16 a[114:115], v240 offset:34816
ds_read_b64_tr_b16 a[116:117], v241 offset:32768
ds_read_b64_tr_b16 a[118:119], v241 offset:34816
ds_read_b64_tr_b16 a[120:121], v242 offset:32768
ds_read_b64_tr_b16 a[122:123], v242 offset:34816
ds_read_b64_tr_b16 a[124:125], v243 offset:32768
s_waitcnt lgkmcnt(14)
ds_read_b64_tr_b16 a[126:127], v243 offset:34816
s_waitcnt lgkmcnt(8)
s_add_u32 m0, s65, 16384
s_nop 0
buffer_load_dwordx4 v28, s[24:27], s75 offen lds
buffer_load_dwordx4 v29, s[24:27], s75 offen offset:1024 lds
buffer_load_dwordx4 v30, s[24:27], s75 offen offset:2048 lds
buffer_load_dwordx4 v31, s[24:27], s75 offen offset:3072 lds
s_add_u32 s75, s75, 32768
s_and_b32 s75, s75, 0xfffff
s_or_b32 s75, s75, s79
s_waitcnt vmcnt(29)
ds_read_b64_tr_b16 v[188:189], v240 offset:49152
ds_read_b64_tr_b16 v[190:191], v240 offset:51200
ds_read_b64_tr_b16 v[192:193], v241 offset:49152
ds_read_b64_tr_b16 v[194:195], v241 offset:51200
ds_read_b64_tr_b16 v[196:197], v242 offset:49152
ds_read_b64_tr_b16 v[198:199], v242 offset:51200
ds_read_b64_tr_b16 v[200:201], v243 offset:49152
s_waitcnt lgkmcnt(14)
ds_read_b64_tr_b16 v[202:203], v243 offset:51200
s_waitcnt lgkmcnt(8)
s_add_u32 m0, s65, 98304
s_nop 0
buffer_load_dwordx4 v28, s[24:27], s75 offen lds
buffer_load_dwordx4 v29, s[24:27], s75 offen offset:1024 lds
buffer_load_dwordx4 v30, s[24:27], s75 offen offset:2048 lds
buffer_load_dwordx4 v31, s[24:27], s75 offen offset:3072 lds
s_add_u32 s75, s75, 32768
s_waitcnt vmcnt(28)
ds_read_b64_tr_b16 v[204:205], v244 offset:0
ds_read_b64_tr_b16 v[206:207], v244 offset:2048
ds_read_b64_tr_b16 v[208:209], v245 offset:0
ds_read_b64_tr_b16 v[210:211], v245 offset:2048
ds_read_b64_tr_b16 v[212:213], v246 offset:0
ds_read_b64_tr_b16 v[214:215], v246 offset:2048
ds_read_b64_tr_b16 v[216:217], v247 offset:0
s_waitcnt lgkmcnt(14)
ds_read_b64_tr_b16 v[218:219], v247 offset:2048
s_waitcnt lgkmcnt(8)
s_add_u32 m0, s65, 114688
s_nop 0
buffer_load_dwordx4 v28, s[24:27], s75 offen lds
buffer_load_dwordx4 v29, s[24:27], s75 offen offset:1024 lds
buffer_load_dwordx4 v30, s[24:27], s75 offen offset:2048 lds
buffer_load_dwordx4 v31, s[24:27], s75 offen offset:3072 lds
s_add_u32 s75, s75, 32768
s_waitcnt vmcnt(28)
ds_read_b64_tr_b16 v[220:221], v236 offset:0
ds_read_b64_tr_b16 v[222:223], v236 offset:2048
ds_read_b64_tr_b16 v[224:225], v237 offset:0
ds_read_b64_tr_b16 v[226:227], v237 offset:2048
ds_read_b64_tr_b16 v[228:229], v238 offset:0
ds_read_b64_tr_b16 v[230:231], v238 offset:2048
ds_read_b64_tr_b16 v[232:233], v239 offset:0
s_waitcnt lgkmcnt(14)
ds_read_b64_tr_b16 v[234:235], v239 offset:2048
s_waitcnt lgkmcnt(8)
s_add_u32 m0, s65, 131072
s_nop 0
buffer_load_dwordx4 v28, s[24:27], s75 offen lds
buffer_load_dwordx4 v29, s[24:27], s75 offen offset:1024 lds
buffer_load_dwordx4 v30, s[24:27], s75 offen offset:2048 lds
buffer_load_dwordx4 v31, s[24:27], s75 offen offset:3072 lds
s_add_u32 s75, s75, 32768
s_waitcnt vmcnt(28)
ds_read_b64_tr_b16 v[8:9], v236 offset:49152
ds_read_b64_tr_b16 v[10:11], v236 offset:51200
ds_read_b64_tr_b16 v[12:13], v237 offset:49152
ds_read_b64_tr_b16 v[14:15], v237 offset:51200
ds_read_b64_tr_b16 v[16:17], v238 offset:49152
ds_read_b64_tr_b16 v[18:19], v238 offset:51200
ds_read_b64_tr_b16 v[20:21], v239 offset:49152
s_waitcnt lgkmcnt(14)
ds_read_b64_tr_b16 v[22:23], v239 offset:51200
s_waitcnt lgkmcnt(8)
s_add_u32 m0, s65, 0
s_nop 0
buffer_load_dwordx4 v28, s[24:27], s75 offen lds
buffer_load_dwordx4 v29, s[24:27], s75 offen offset:1024 lds
buffer_load_dwordx4 v30, s[24:27], s75 offen offset:2048 lds
buffer_load_dwordx4 v31, s[24:27], s75 offen offset:3072 lds
s_add_u32 s75, s75, 32768
s_and_b32 s75, s75, 0xfffff
s_or_b32 s75, s75, s79
s_waitcnt vmcnt(28)
ds_read_b64_tr_b16 v[116:117], v240 offset:16384
ds_read_b64_tr_b16 v[118:119], v240 offset:18432
ds_read_b64_tr_b16 v[120:121], v241 offset:16384
ds_read_b64_tr_b16 v[122:123], v241 offset:18432
ds_read_b64_tr_b16 v[124:125], v242 offset:16384
ds_read_b64_tr_b16 v[126:127], v242 offset:18432
ds_read_b64_tr_b16 v[128:129], v243 offset:16384
s_waitcnt lgkmcnt(14)
ds_read_b64_tr_b16 v[130:131], v243 offset:18432
s_waitcnt lgkmcnt(8)
global_load_dwordx2 v[6:7], v1, s[72:73] sc1
s_add_u32 m0, s65, 49152
s_nop 0
buffer_load_dwordx4 v28, s[24:27], s75 offen lds
buffer_load_dwordx4 v29, s[24:27], s75 offen offset:1024 lds
buffer_load_dwordx4 v30, s[24:27], s75 offen offset:2048 lds
buffer_load_dwordx4 v31, s[24:27], s75 offen offset:3072 lds
s_add_u32 s75, s75, 32768
s_waitcnt vmcnt(29)
ds_read_b64_tr_b16 v[132:133], v236 offset:32768
ds_read_b64_tr_b16 v[134:135], v236 offset:34816
ds_read_b64_tr_b16 v[136:137], v237 offset:32768
ds_read_b64_tr_b16 v[138:139], v237 offset:34816
ds_read_b64_tr_b16 v[248:249], v238 offset:32768
ds_read_b64_tr_b16 v[250:251], v238 offset:34816
ds_read_b64_tr_b16 v[252:253], v239 offset:32768
s_waitcnt lgkmcnt(14)
ds_read_b64_tr_b16 v[254:255], v239 offset:34816
s_waitcnt lgkmcnt(8)
s_add_u32 m0, s65, 81920
s_nop 0
buffer_load_dwordx4 v28, s[24:27], s75 offen lds
buffer_load_dwordx4 v29, s[24:27], s75 offen offset:1024 lds
buffer_load_dwordx4 v30, s[24:27], s75 offen offset:2048 lds
buffer_load_dwordx4 v31, s[24:27], s75 offen offset:3072 lds
s_add_u32 s75, s75, 32768
s_waitcnt lgkmcnt(0)
s_add_u32 m0, s65, 32768
s_nop 0
buffer_load_dwordx4 v28, s[24:27], s75 offen lds
buffer_load_dwordx4 v29, s[24:27], s75 offen offset:1024 lds
buffer_load_dwordx4 v30, s[24:27], s75 offen offset:2048 lds
buffer_load_dwordx4 v31, s[24:27], s75 offen offset:3072 lds
s_add_u32 s75, s75, 32768
s_mov_b32 s6, 200000
s_waitcnt vmcnt(12)
v_cmp_eq_u32 vcc, v6, v4
v_cmp_eq_u32 s[4:5], v7, v5
s_nop 1
s_and_b64 vcc, vcc, s[4:5]
s_cmp_eq_u64 vcc, -1
s_cbranch_scc1 L_ready
L_poll:
global_load_dwordx2 v[6:7], v1, s[72:73] sc1
s_waitcnt vmcnt(0)
v_cmp_eq_u32 vcc, v6, v4
v_cmp_eq_u32 s[4:5], v7, v5
s_nop 1
s_and_b64 vcc, vcc, s[4:5]
s_cmp_eq_u64 vcc, -1
s_cbranch_scc1 L_ready
s_sub_u32 s6, s6, 1
s_cmp_lg_u32 s6, 0
s_cbranch_scc1 L_poll
L_ready:
buffer_load_dwordx4 v[44:47], v26, s[32:35], s76 offen sc1
buffer_load_dwordx4 v[48:51], v26, s[32:35], s76 offen offset:1024 sc1
buffer_load_dwordx4 v[52:55], v26, s[32:35], s76 offen offset:2048 sc1
s_add_u32 s76, s76, 3072
buffer_load_dwordx4 v[56:59], v26, s[32:35], s76 offen sc1
buffer_load_dwordx4 v[60:63], v26, s[32:35], s76 offen offset:1024 sc1
buffer_load_dwordx4 v[64:67], v26, s[32:35], s76 offen offset:2048 sc1
s_add_u32 s76, s76, 3072
buffer_load_dwordx4 v[68:71], v26, s[32:35], s76 offen sc1
buffer_load_dwordx4 v[72:75], v26, s[32:35], s76 offen offset:1024 sc1
buffer_load_dwordx4 v[76:79], v26, s[32:35], s76 offen offset:2048 sc1
s_add_u32 s76, s76, 3072
buffer_load_dwordx4 v[80:83], v26, s[32:35], s76 offen sc1
buffer_load_dwordx4 v[84:87], v26, s[32:35], s76 offen offset:1024 sc1
buffer_load_dwordx4 v[88:91], v26, s[32:35], s76 offen offset:2048 sc1
s_add_u32 s76, s76, 3072
s_cmp_eq_u32 s76, 98304
s_cselect_b32 s76, 0, s76
s_waitcnt vmcnt(8)
v_mfma_f32_16x16x32_bf16 v[140:143], a[128:131], v[44:47], 0
buffer_load_dwordx4 v[92:95], v26, s[32:35], s76 offen sc1
v_mfma_f32_16x16x32_bf16 v[140:143], a[144:147], v[56:59], v[140:143]
s_waitcnt vmcnt(8)
v_mfma_f32_16x16x32_bf16 v[156:159], a[144:147], v[60:63], 0
v_mfma_f32_16x16x32_bf16 v[156:159], a[128:131], v[48:51], v[156:159]
s_waitcnt vmcnt(7)
v_mfma_f32_16x16x32_bf16 v[172:175], a[128:131], v[52:55], 0
buffer_load_dwordx4 v[96:99], v26, s[32:35], s76 offen offset:1024 sc1
v_mfma_f32_16x16x32_bf16 v[172:175], a[144:147], v[64:67], v[172:175]
v_mfma_f32_16x16x32_bf16 v[144:147], a[132:135], v[44:47], 0
v_mfma_f32_16x16x32_bf16 v[144:147], a[148:151], v[56:59], v[144:147]
v_mfma_f32_16x16x32_bf16 v[160:163], a[148:151], v[60:63], 0
buffer_load_dwordx4 v[100:103], v26, s[32:35], s76 offen offset:2048 sc1
s_add_u32 s76, s76, 3072
v_mfma_f32_16x16x32_bf16 v[160:163], a[132:135], v[48:51], v[160:163]
v_mfma_f32_16x16x32_bf16 v[176:179], a[132:135], v[52:55], 0
v_mfma_f32_16x16x32_bf16 v[176:179], a[148:151], v[64:67], v[176:179]
v_mfma_f32_16x16x32_bf16 v[148:151], a[136:139], v[44:47], 0
buffer_load_dwordx4 v[104:107], v26, s[32:35], s76 offen sc1
v_mfma_f32_16x16x32_bf16 v[148:151], a[152:155], v[56:59], v[148:151]
v_mfma_f32_16x16x32_bf16 v[164:167], a[152:155], v[60:63], 0
v_mfma_f32_16x16x32_bf16 v[164:167], a[136:139], v[48:51], v[164:167]
v_mfma_f32_16x16x32_bf16 v[180:183], a[136:139], v[52:55], 0
buffer_load_dwordx4 v[108:111], v26, s[32:35], s76 offen offset:1024 sc1
v_mfma_f32_16x16x32_bf16 v[180:183], a[152:155], v[64:67], v[180:183]
v_mfma_f32_16x16x32_bf16 v[152:155], a[140:143], v[44:47], 0
v_mfma_f32_16x16x32_bf16 v[152:155], a[156:159], v[56:59], v[152:155]
v_mfma_f32_16x16x32_bf16 v[168:171], a[156:159], v[60:63], 0
buffer_load_dwordx4 v[112:115], v26, s[32:35], s76 offen offset:2048 sc1
s_add_u32 s76, s76, 3072
v_mfma_f32_16x16x32_bf16 v[168:171], a[140:143], v[48:51], v[168:171]
v_mfma_f32_16x16x32_bf16 v[184:187], a[140:143], v[52:55], 0
v_mfma_f32_16x16x32_bf16 v[184:187], a[156:159], v[64:67], v[184:187]
s_waitcnt vmcnt(8)
v_mfma_f32_16x16x32_bf16 v[140:143], a[160:163], v[68:71], v[140:143]
buffer_load_dwordx4 v[44:47], v26, s[32:35], s76 offen sc1
v_mfma_f32_16x16x32_bf16 v[140:143], a[176:179], v[80:83], v[140:143]
s_waitcnt vmcnt(8)
v_mfma_f32_16x16x32_bf16 v[156:159], a[176:179], v[84:87], v[156:159]
v_mfma_f32_16x16x32_bf16 v[156:159], a[160:163], v[72:75], v[156:159]
s_waitcnt vmcnt(7)
v_mfma_f32_16x16x32_bf16 v[172:175], a[160:163], v[76:79], v[172:175]
buffer_load_dwordx4 v[48:51], v26, s[32:35], s76 offen offset:1024 sc1
v_mfma_f32_16x16x32_bf16 v[172:175], a[176:179], v[88:91], v[172:175]
v_mfma_f32_16x16x32_bf16 v[144:147], a[164:167], v[68:71], v[144:147]
v_mfma_f32_16x16x32_bf16 v[144:147], a[180:183], v[80:83], v[144:147]
v_mfma_f32_16x16x32_bf16 v[160:163], a[180:183], v[84:87], v[160:163]
buffer_load_dwordx4 v[52:55], v26, s[32:35], s76 offen offset:2048 sc1
s_add_u32 s76, s76, 3072
v_mfma_f32_16x16x32_bf16 v[160:163], a[164:167], v[72:75], v[160:163]
v_mfma_f32_16x16x32_bf16 v[176:179], a[164:167], v[76:79], v[176:179]
v_mfma_f32_16x16x32_bf16 v[176:179], a[180:183], v[88:91], v[176:179]
v_mfma_f32_16x16x32_bf16 v[148:151], a[168:171], v[68:71], v[148:151]
buffer_load_dwordx4 v[56:59], v26, s[32:35], s76 offen sc1
v_mfma_f32_16x16x32_bf16 v[148:151], a[184:187], v[80:83], v[148:151]
v_mfma_f32_16x16x32_bf16 v[164:167], a[184:187], v[84:87], v[164:167]
v_mfma_f32_16x16x32_bf16 v[164:167], a[168:171], v[72:75], v[164:167]
v_mfma_f32_16x16x32_bf16 v[180:183], a[168:171], v[76:79], v[180:183]
buffer_load_dwordx4 v[60:63], v26, s[32:35], s76 offen offset:1024 sc1
v_mfma_f32_16x16x32_bf16 v[180:183], a[184:187], v[88:91], v[180:183]
v_mfma_f32_16x16x32_bf16 v[152:155], a[172:175], v[68:71], v[152:155]
v_mfma_f32_16x16x32_bf16 v[152:155], a[188:191], v[80:83], v[152:155]
v_mfma_f32_16x16x32_bf16 v[168:171], a[188:191], v[84:87], v[168:171]
buffer_load_dwordx4 v[64:67], v26, s[32:35], s76 offen offset:2048 sc1
s_add_u32 s76, s76, 3072
s_cmp_eq_u32 s76, 98304
s_cselect_b32 s76, 0, s76
v_mfma_f32_16x16x32_bf16 v[168:171], a[172:175], v[72:75], v[168:171]
v_mfma_f32_16x16x32_bf16 v[184:187], a[172:175], v[76:79], v[184:187]
v_mfma_f32_16x16x32_bf16 v[184:187], a[188:191], v[88:91], v[184:187]
s_waitcnt vmcnt(8)
v_mfma_f32_16x16x32_bf16 v[140:143], a[192:195], v[92:95], v[140:143]
buffer_load_dwordx4 v[68:71], v26, s[32:35], s76 offen sc1
v_mfma_f32_16x16x32_bf16 v[140:143], a[208:211], v[104:107], v[140:143]
s_waitcnt vmcnt(8)
v_mfma_f32_16x16x32_bf16 v[156:159], a[208:211], v[108:111], v[156:159]
v_mfma_f32_16x16x32_bf16 v[156:159], a[192:195], v[96:99], v[156:159]
s_waitcnt vmcnt(7)
v_mfma_f32_16x16x32_bf16 v[172:175], a[192:195], v[100:103], v[172:175]
buffer_load_dwordx4 v[72:75], v26, s[32:35], s76 offen offset:1024 sc1
v_mfma_f32_16x16x32_bf16 v[172:175], a[208:211], v[112:115], v[172:175]
v_mfma_f32_16x16x32_bf16 v[144:147], a[196:199], v[92:95], v[144:147]
v_mfma_f32_16x16x32_bf16 v[144:147], a[212:215], v[104:107], v[144:147]
v_mfma_f32_16x16x32_bf16 v[160:163], a[212:215], v[108:111], v[160:163]
buffer_load_dwordx4 v[76:79], v26, s[32:35], s76 offen offset:2048 sc1
s_add_u32 s76, s76, 3072
v_mfma_f32_16x16x32_bf16 v[160:163], a[196:199], v[96:99], v[160:163]
v_mfma_f32_16x16x32_bf16 v[176:179], a[196:199], v[100:103], v[176:179]
v_mfma_f32_16x16x32_bf16 v[176:179], a[212:215], v[112:115], v[176:179]
v_mfma_f32_16x16x32_bf16 v[148:151], a[200:203], v[92:95], v[148:151]
buffer_load_dwordx4 v[80:83], v26, s[32:35], s76 offen sc1
v_mfma_f32_16x16x32_bf16 v[148:151], a[216:219], v[104:107], v[148:151]
v_mfma_f32_16x16x32_bf16 v[164:167], a[216:219], v[108:111], v[164:167]
v_mfma_f32_16x16x32_bf16 v[164:167], a[200:203], v[96:99], v[164:167]
v_mfma_f32_16x16x32_bf16 v[180:183], a[200:203], v[100:103], v[180:183]
buffer_load_dwordx4 v[84:87], v26, s[32:35], s76 offen offset:1024 sc1
v_mfma_f32_16x16x32_bf16 v[180:183], a[216:219], v[112:115], v[180:183]
v_mfma_f32_16x16x32_bf16 v[152:155], a[204:207], v[92:95], v[152:155]
v_mfma_f32_16x16x32_bf16 v[152:155], a[220:223], v[104:107], v[152:155]
v_mfma_f32_16x16x32_bf16 v[168:171], a[220:223], v[108:111], v[168:171]
buffer_load_dwordx4 v[88:91], v26, s[32:35], s76 offen offset:2048 sc1
s_add_u32 s76, s76, 3072
v_mfma_f32_16x16x32_bf16 v[168:171], a[204:207], v[96:99], v[168:171]
v_mfma_f32_16x16x32_bf16 v[184:187], a[204:207], v[100:103], v[184:187]
v_mfma_f32_16x16x32_bf16 v[184:187], a[220:223], v[112:115], v[184:187]
s_waitcnt vmcnt(8)
v_mfma_f32_16x16x32_bf16 v[140:143], a[224:227], v[44:47], v[140:143]
buffer_load_dwordx4 v[92:95], v26, s[32:35], s76 offen sc1
v_mfma_f32_16x16x32_bf16 v[140:143], a[240:243], v[56:59], v[140:143]
s_waitcnt vmcnt(8)
v_mfma_f32_16x16x32_bf16 v[156:159], a[240:243], v[60:63], v[156:159]
v_mfma_f32_16x16x32_bf16 v[156:159], a[224:227], v[48:51], v[156:159]
s_waitcnt vmcnt(7)
v_mfma_f32_16x16x32_bf16 v[172:175], a[224:227], v[52:55], v[172:175]
buffer_load_dwordx4 v[96:99], v26, s[32:35], s76 offen offset:1024 sc1
v_mfma_f32_16x16x32_bf16 v[172:175], a[240:243], v[64:67], v[172:175]
v_mfma_f32_16x16x32_bf16 v[144:147], a[228:231], v[44:47], v[144:147]
v_mfma_f32_16x16x32_bf16 v[144:147], a[244:247], v[56:59], v[144:147]
v_mfma_f32_16x16x32_bf16 v[160:163], a[244:247], v[60:63], v[160:163]
buffer_load_dwordx4 v[100:103], v26, s[32:35], s76 offen offset:2048 sc1
s_add_u32 s76, s76, 3072
v_mfma_f32_16x16x32_bf16 v[160:163], a[228:231], v[48:51], v[160:163]
v_mfma_f32_16x16x32_bf16 v[176:179], a[228:231], v[52:55], v[176:179]
v_mfma_f32_16x16x32_bf16 v[176:179], a[244:247], v[64:67], v[176:179]
v_mfma_f32_16x16x32_bf16 v[148:151], a[232:235], v[44:47], v[148:151]
buffer_load_dwordx4 v[104:107], v26, s[32:35], s76 offen sc1
v_mfma_f32_16x16x32_bf16 v[148:151], a[248:251], v[56:59], v[148:151]
v_mfma_f32_16x16x32_bf16 v[164:167], a[248:251], v[60:63], v[164:167]
v_mfma_f32_16x16x32_bf16 v[164:167], a[232:235], v[48:51], v[164:167]
v_mfma_f32_16x16x32_bf16 v[180:183], a[232:235], v[52:55], v[180:183]
buffer_load_dwordx4 v[108:111], v26, s[32:35], s76 offen offset:1024 sc1
v_mfma_f32_16x16x32_bf16 v[180:183], a[248:251], v[64:67], v[180:183]
v_mfma_f32_16x16x32_bf16 v[152:155], a[236:239], v[44:47], v[152:155]
v_mfma_f32_16x16x32_bf16 v[152:155], a[252:255], v[56:59], v[152:155]
v_mfma_f32_16x16x32_bf16 v[168:171], a[252:255], v[60:63], v[168:171]
buffer_load_dwordx4 v[112:115], v26, s[32:35], s76 offen offset:2048 sc1
s_add_u32 s76, s76, 3072
s_cmp_eq_u32 s76, 98304
s_cselect_b32 s76, 0, s76
v_mfma_f32_16x16x32_bf16 v[168:171], a[236:239], v[48:51], v[168:171]
v_mfma_f32_16x16x32_bf16 v[184:187], a[236:239], v[52:55], v[184:187]
v_mfma_f32_16x16x32_bf16 v[184:187], a[252:255], v[64:67], v[184:187]
s_waitcnt vmcnt(8)
v_mfma_f32_16x16x32_bf16 v[140:143], a[0:3], v[68:71], v[140:143]
buffer_load_dwordx4 v[44:47], v26, s[32:35], s76 offen sc1
v_mfma_f32_16x16x32_bf16 v[140:143], a[16:19], v[80:83], v[140:143]
s_waitcnt vmcnt(8)
v_mfma_f32_16x16x32_bf16 v[156:159], a[16:19], v[84:87], v[156:159]
v_mfma_f32_16x16x32_bf16 v[156:159], a[0:3], v[72:75], v[156:159]
s_waitcnt vmcnt(7)
v_mfma_f32_16x16x32_bf16 v[172:175], a[0:3], v[76:79], v[172:175]
buffer_load_dwordx4 v[48:51], v26, s[32:35], s76 offen offset:1024 sc1
v_mfma_f32_16x16x32_bf16 v[172:175], a[16:19], v[88:91], v[172:175]
v_mfma_f32_16x16x32_bf16 v[144:147], a[4:7], v[68:71], v[144:147]
v_mfma_f32_16x16x32_bf16 v[144:147], a[20:23], v[80:83], v[144:147]
v_mfma_f32_16x16x32_bf16 v[160:163], a[20:23], v[84:87], v[160:163]
buffer_load_dwordx4 v[52:55], v26, s[32:35], s76 offen offset:2048 sc1
s_add_u32 s76, s76, 3072
v_mfma_f32_16x16x32_bf16 v[160:163], a[4:7], v[72:75], v[160:163]
v_mfma_f32_16x16x32_bf16 v[176:179], a[4:7], v[76:79], v[176:179]
v_mfma_f32_16x16x32_bf16 v[176:179], a[20:23], v[88:91], v[176:179]
v_mfma_f32_16x16x32_bf16 v[148:151], a[8:11], v[68:71], v[148:151]
buffer_load_dwordx4 v[56:59], v26, s[32:35], s76 offen sc1
v_mfma_f32_16x16x32_bf16 v[148:151], a[24:27], v[80:83], v[148:151]
v_mfma_f32_16x16x32_bf16 v[164:167], a[24:27], v[84:87], v[164:167]
v_mfma_f32_16x16x32_bf16 v[164:167], a[8:11], v[72:75], v[164:167]
v_mfma_f32_16x16x32_bf16 v[180:183], a[8:11], v[76:79], v[180:183]
buffer_load_dwordx4 v[60:63], v26, s[32:35], s76 offen offset:1024 sc1
v_mfma_f32_16x16x32_bf16 v[180:183], a[24:27], v[88:91], v[180:183]
v_mfma_f32_16x16x32_bf16 v[152:155], a[12:15], v[68:71], v[152:155]
v_mfma_f32_16x16x32_bf16 v[152:155], a[28:31], v[80:83], v[152:155]
v_mfma_f32_16x16x32_bf16 v[168:171], a[28:31], v[84:87], v[168:171]
buffer_load_dwordx4 v[64:67], v26, s[32:35], s76 offen offset:2048 sc1
s_add_u32 s76, s76, 3072
v_mfma_f32_16x16x32_bf16 v[168:171], a[12:15], v[72:75], v[168:171]
v_mfma_f32_16x16x32_bf16 v[184:187], a[12:15], v[76:79], v[184:187]
v_mfma_f32_16x16x32_bf16 v[184:187], a[28:31], v[88:91], v[184:187]
s_waitcnt vmcnt(8)
v_mfma_f32_16x16x32_bf16 v[140:143], a[32:35], v[92:95], v[140:143]
buffer_load_dwordx4 v[68:71], v26, s[32:35], s76 offen sc1
v_mfma_f32_16x16x32_bf16 v[140:143], a[48:51], v[104:107], v[140:143]
s_waitcnt vmcnt(8)
v_mfma_f32_16x16x32_bf16 v[156:159], a[48:51], v[108:111], v[156:159]
v_mfma_f32_16x16x32_bf16 v[156:159], a[32:35], v[96:99], v[156:159]
s_waitcnt vmcnt(7)
v_mfma_f32_16x16x32_bf16 v[172:175], a[32:35], v[100:103], v[172:175]
buffer_load_dwordx4 v[72:75], v26, s[32:35], s76 offen offset:1024 sc1
v_mfma_f32_16x16x32_bf16 v[172:175], a[48:51], v[112:115], v[172:175]
v_mfma_f32_16x16x32_bf16 v[144:147], a[36:39], v[92:95], v[144:147]
v_mfma_f32_16x16x32_bf16 v[144:147], a[52:55], v[104:107], v[144:147]
v_mfma_f32_16x16x32_bf16 v[160:163], a[52:55], v[108:111], v[160:163]
buffer_load_dwordx4 v[76:79], v26, s[32:35], s76 offen offset:2048 sc1
s_add_u32 s76, s76, 3072
v_mfma_f32_16x16x32_bf16 v[160:163], a[36:39], v[96:99], v[160:163]
v_mfma_f32_16x16x32_bf16 v[176:179], a[36:39], v[100:103], v[176:179]
v_mfma_f32_16x16x32_bf16 v[176:179], a[52:55], v[112:115], v[176:179]
v_mfma_f32_16x16x32_bf16 v[148:151], a[40:43], v[92:95], v[148:151]
buffer_load_dwordx4 v[80:83], v26, s[32:35], s76 offen sc1
v_mfma_f32_16x16x32_bf16 v[148:151], a[56:59], v[104:107], v[148:151]
v_mfma_f32_16x16x32_bf16 v[164:167], a[56:59], v[108:111], v[164:167]
v_mfma_f32_16x16x32_bf16 v[164:167], a[40:43], v[96:99], v[164:167]
v_mfma_f32_16x16x32_bf16 v[180:183], a[40:43], v[100:103], v[180:183]
buffer_load_dwordx4 v[84:87], v26, s[32:35], s76 offen offset:1024 sc1
v_mfma_f32_16x16x32_bf16 v[180:183], a[56:59], v[112:115], v[180:183]
v_mfma_f32_16x16x32_bf16 v[152:155], a[44:47], v[92:95], v[152:155]
v_mfma_f32_16x16x32_bf16 v[152:155], a[60:63], v[104:107], v[152:155]
v_mfma_f32_16x16x32_bf16 v[168:171], a[60:63], v[108:111], v[168:171]
buffer_load_dwordx4 v[88:91], v26, s[32:35], s76 offen offset:2048 sc1
s_add_u32 s76, s76, 3072
s_cmp_eq_u32 s76, 98304
s_cselect_b32 s76, 0, s76
v_mfma_f32_16x16x32_bf16 v[168:171], a[44:47], v[96:99], v[168:171]
v_mfma_f32_16x16x32_bf16 v[184:187], a[44:47], v[100:103], v[184:187]
v_mfma_f32_16x16x32_bf16 v[184:187], a[60:63], v[112:115], v[184:187]
s_waitcnt vmcnt(8)
v_mfma_f32_16x16x32_bf16 v[140:143], a[64:67], v[44:47], v[140:143]
buffer_load_dwordx4 v[92:95], v26, s[32:35], s76 offen sc1
v_mfma_f32_16x16x32_bf16 v[140:143], a[80:83], v[56:59], v[140:143]
s_waitcnt vmcnt(8)
v_mfma_f32_16x16x32_bf16 v[156:159], a[80:83], v[60:63], v[156:159]
v_mfma_f32_16x16x32_bf16 v[156:159], a[64:67], v[48:51], v[156:159]
s_waitcnt vmcnt(7)
v_mfma_f32_16x16x32_bf16 v[172:175], a[64:67], v[52:55], v[172:175]
buffer_load_dwordx4 v[96:99], v26, s[32:35], s76 offen offset:1024 sc1
v_mfma_f32_16x16x32_bf16 v[172:175], a[80:83], v[64:67], v[172:175]
v_mfma_f32_16x16x32_bf16 v[144:147], a[68:71], v[44:47], v[144:147]
v_mfma_f32_16x16x32_bf16 v[144:147], a[84:87], v[56:59], v[144:147]
v_mfma_f32_16x16x32_bf16 v[160:163], a[84:87], v[60:63], v[160:163]
buffer_load_dwordx4 v[100:103], v26, s[32:35], s76 offen offset:2048 sc1
s_add_u32 s76, s76, 3072
v_mfma_f32_16x16x32_bf16 v[160:163], a[68:71], v[48:51], v[160:163]
v_mfma_f32_16x16x32_bf16 v[176:179], a[68:71], v[52:55], v[176:179]
v_mfma_f32_16x16x32_bf16 v[176:179], a[84:87], v[64:67], v[176:179]
v_mfma_f32_16x16x32_bf16 v[148:151], a[72:75], v[44:47], v[148:151]
buffer_load_dwordx4 v[104:107], v26, s[32:35], s76 offen sc1
v_mfma_f32_16x16x32_bf16 v[148:151], a[88:91], v[56:59], v[148:151]
v_mfma_f32_16x16x32_bf16 v[164:167], a[88:91], v[60:63], v[164:167]
v_mfma_f32_16x16x32_bf16 v[164:167], a[72:75], v[48:51], v[164:167]
v_mfma_f32_16x16x32_bf16 v[180:183], a[72:75], v[52:55], v[180:183]
buffer_load_dwordx4 v[108:111], v26, s[32:35], s76 offen offset:1024 sc1
v_mfma_f32_16x16x32_bf16 v[180:183], a[88:91], v[64:67], v[180:183]
v_mfma_f32_16x16x32_bf16 v[152:155], a[76:79], v[44:47], v[152:155]
v_mfma_f32_16x16x32_bf16 v[152:155], a[92:95], v[56:59], v[152:155]
v_mfma_f32_16x16x32_bf16 v[168:171], a[92:95], v[60:63], v[168:171]
buffer_load_dwordx4 v[112:115], v26, s[32:35], s76 offen offset:2048 sc1
s_add_u32 s76, s76, 3072
v_mfma_f32_16x16x32_bf16 v[168:171], a[76:79], v[48:51], v[168:171]
v_mfma_f32_16x16x32_bf16 v[184:187], a[76:79], v[52:55], v[184:187]
v_mfma_f32_16x16x32_bf16 v[184:187], a[92:95], v[64:67], v[184:187]
s_waitcnt vmcnt(8)
v_mfma_f32_16x16x32_bf16 v[140:143], a[96:99], v[68:71], v[140:143]
buffer_load_dwordx4 v[44:47], v26, s[32:35], s76 offen sc1
v_mfma_f32_16x16x32_bf16 v[140:143], a[112:115], v[80:83], v[140:143]
s_waitcnt vmcnt(8)
v_mfma_f32_16x16x32_bf16 v[156:159], a[112:115], v[84:87], v[156:159]
v_mfma_f32_16x16x32_bf16 v[156:159], a[96:99], v[72:75], v[156:159]
s_waitcnt vmcnt(7)
v_mfma_f32_16x16x32_bf16 v[172:175], a[96:99], v[76:79], v[172:175]
buffer_load_dwordx4 v[48:51], v26, s[32:35], s76 offen offset:1024 sc1
v_mfma_f32_16x16x32_bf16 v[172:175], a[112:115], v[88:91], v[172:175]
v_mfma_f32_16x16x32_bf16 v[144:147], a[100:103], v[68:71], v[144:147]
v_mfma_f32_16x16x32_bf16 v[144:147], a[116:119], v[80:83], v[144:147]
v_mfma_f32_16x16x32_bf16 v[160:163], a[116:119], v[84:87], v[160:163]
buffer_load_dwordx4 v[52:55], v26, s[32:35], s76 offen offset:2048 sc1
s_add_u32 s76, s76, 3072
v_mfma_f32_16x16x32_bf16 v[160:163], a[100:103], v[72:75], v[160:163]
v_mfma_f32_16x16x32_bf16 v[176:179], a[100:103], v[76:79], v[176:179]
v_mfma_f32_16x16x32_bf16 v[176:179], a[116:119], v[88:91], v[176:179]
v_mfma_f32_16x16x32_bf16 v[148:151], a[104:107], v[68:71], v[148:151]
buffer_load_dwordx4 v[56:59], v26, s[32:35], s76 offen sc1
v_mfma_f32_16x16x32_bf16 v[148:151], a[120:123], v[80:83], v[148:151]
v_mfma_f32_16x16x32_bf16 v[164:167], a[120:123], v[84:87], v[164:167]
v_mfma_f32_16x16x32_bf16 v[164:167], a[104:107], v[72:75], v[164:167]
v_mfma_f32_16x16x32_bf16 v[180:183], a[104:107], v[76:79], v[180:183]
buffer_load_dwordx4 v[60:63], v26, s[32:35], s76 offen offset:1024 sc1
v_mfma_f32_16x16x32_bf16 v[180:183], a[120:123], v[88:91], v[180:183]
v_mfma_f32_16x16x32_bf16 v[152:155], a[108:111], v[68:71], v[152:155]
v_mfma_f32_16x16x32_bf16 v[152:155], a[124:127], v[80:83], v[152:155]
v_mfma_f32_16x16x32_bf16 v[168:171], a[124:127], v[84:87], v[168:171]
buffer_load_dwordx4 v[64:67], v26, s[32:35], s76 offen offset:2048 sc1
s_add_u32 s76, s76, 3072
s_cmp_eq_u32 s76, 98304
s_cselect_b32 s76, 0, s76
v_mfma_f32_16x16x32_bf16 v[168:171], a[108:111], v[72:75], v[168:171]
v_mfma_f32_16x16x32_bf16 v[184:187], a[108:111], v[76:79], v[184:187]
v_mfma_f32_16x16x32_bf16 v[184:187], a[124:127], v[88:91], v[184:187]
s_waitcnt vmcnt(8)
v_mfma_f32_16x16x32_bf16 v[140:143], v[188:191], v[92:95], v[140:143]
buffer_load_dwordx4 v[68:71], v26, s[32:35], s76 offen sc1
v_mfma_f32_16x16x32_bf16 v[140:143], v[204:207], v[104:107], v[140:143]
s_waitcnt vmcnt(8)
v_mfma_f32_16x16x32_bf16 v[156:159], v[204:207], v[108:111], v[156:159]
v_mfma_f32_16x16x32_bf16 v[156:159], v[188:191], v[96:99], v[156:159]
s_waitcnt vmcnt(7)
v_mfma_f32_16x16x32_bf16 v[172:175], v[188:191], v[100:103], v[172:175]
buffer_load_dwordx4 v[72:75], v26, s[32:35], s76 offen offset:1024 sc1
v_mfma_f32_16x16x32_bf16 v[172:175], v[204:207], v[112:115], v[172:175]
v_mfma_f32_16x16x32_bf16 v[144:147], v[192:195], v[92:95], v[144:147]
v_mfma_f32_16x16x32_bf16 v[144:147], v[208:211], v[104:107], v[144:147]
v_mfma_f32_16x16x32_bf16 v[160:163], v[208:211], v[108:111], v[160:163]
buffer_load_dwordx4 v[76:79], v26, s[32:35], s76 offen offset:2048 sc1
s_add_u32 s76, s76, 3072
v_mfma_f32_16x16x32_bf16 v[160:163], v[192:195], v[96:99], v[160:163]
v_mfma_f32_16x16x32_bf16 v[176:179], v[192:195], v[100:103], v[176:179]
v_mfma_f32_16x16x32_bf16 v[176:179], v[208:211], v[112:115], v[176:179]
v_mfma_f32_16x16x32_bf16 v[148:151], v[196:199], v[92:95], v[148:151]
buffer_load_dwordx4 v[80:83], v26, s[32:35], s76 offen sc1
v_mfma_f32_16x16x32_bf16 v[148:151], v[212:215], v[104:107], v[148:151]
v_mfma_f32_16x16x32_bf16 v[164:167], v[212:215], v[108:111], v[164:167]
v_mfma_f32_16x16x32_bf16 v[164:167], v[196:199], v[96:99], v[164:167]
v_mfma_f32_16x16x32_bf16 v[180:183], v[196:199], v[100:103], v[180:183]
buffer_load_dwordx4 v[84:87], v26, s[32:35], s76 offen offset:1024 sc1
v_mfma_f32_16x16x32_bf16 v[180:183], v[212:215], v[112:115], v[180:183]
v_mfma_f32_16x16x32_bf16 v[152:155], v[200:203], v[92:95], v[152:155]
v_mfma_f32_16x16x32_bf16 v[152:155], v[216:219], v[104:107], v[152:155]
v_mfma_f32_16x16x32_bf16 v[168:171], v[216:219], v[108:111], v[168:171]
buffer_load_dwordx4 v[88:91], v26, s[32:35], s76 offen offset:2048 sc1
s_add_u32 s76, s76, 3072
v_mfma_f32_16x16x32_bf16 v[168:171], v[200:203], v[96:99], v[168:171]
v_mfma_f32_16x16x32_bf16 v[184:187], v[200:203], v[100:103], v[184:187]
v_mfma_f32_16x16x32_bf16 v[184:187], v[216:219], v[112:115], v[184:187]
s_waitcnt vmcnt(8)
v_mfma_f32_16x16x32_bf16 v[140:143], v[220:223], v[44:47], v[140:143]
buffer_load_dwordx4 v[92:95], v26, s[32:35], s76 offen sc1
v_mfma_f32_16x16x32_bf16 v[140:143], v[8:11], v[56:59], v[140:143]
s_waitcnt vmcnt(8)
v_mfma_f32_16x16x32_bf16 v[156:159], v[8:11], v[60:63], v[156:159]
v_mfma_f32_16x16x32_bf16 v[156:159], v[220:223], v[48:51], v[156:159]
s_waitcnt vmcnt(7)
v_mfma_f32_16x16x32_bf16 v[172:175], v[220:223], v[52:55], v[172:175]
buffer_load_dwordx4 v[96:99], v26, s[32:35], s76 offen offset:1024 sc1
v_mfma_f32_16x16x32_bf16 v[172:175], v[8:11], v[64:67], v[172:175]
v_mfma_f32_16x16x32_bf16 v[144:147], v[224:227], v[44:47], v[144:147]
v_mfma_f32_16x16x32_bf16 v[144:147], v[12:15], v[56:59], v[144:147]
v_mfma_f32_16x16x32_bf16 v[160:163], v[12:15], v[60:63], v[160:163]
buffer_load_dwordx4 v[100:103], v26, s[32:35], s76 offen offset:2048 sc1
s_add_u32 s76, s76, 3072
v_mfma_f32_16x16x32_bf16 v[160:163], v[224:227], v[48:51], v[160:163]
v_mfma_f32_16x16x32_bf16 v[176:179], v[224:227], v[52:55], v[176:179]
v_mfma_f32_16x16x32_bf16 v[176:179], v[12:15], v[64:67], v[176:179]
v_mfma_f32_16x16x32_bf16 v[148:151], v[228:231], v[44:47], v[148:151]
buffer_load_dwordx4 v[104:107], v26, s[32:35], s76 offen sc1
v_mfma_f32_16x16x32_bf16 v[148:151], v[16:19], v[56:59], v[148:151]
v_mfma_f32_16x16x32_bf16 v[164:167], v[16:19], v[60:63], v[164:167]
v_mfma_f32_16x16x32_bf16 v[164:167], v[228:231], v[48:51], v[164:167]
v_mfma_f32_16x16x32_bf16 v[180:183], v[228:231], v[52:55], v[180:183]
buffer_load_dwordx4 v[108:111], v26, s[32:35], s76 offen offset:1024 sc1
v_mfma_f32_16x16x32_bf16 v[180:183], v[16:19], v[64:67], v[180:183]
v_mfma_f32_16x16x32_bf16 v[152:155], v[232:235], v[44:47], v[152:155]
v_mfma_f32_16x16x32_bf16 v[152:155], v[20:23], v[56:59], v[152:155]
v_mfma_f32_16x16x32_bf16 v[168:171], v[20:23], v[60:63], v[168:171]
buffer_load_dwordx4 v[112:115], v26, s[32:35], s76 offen offset:2048 sc1
s_add_u32 s76, s76, 3072
s_cmp_eq_u32 s76, 98304
s_cselect_b32 s76, 0, s76
v_mfma_f32_16x16x32_bf16 v[168:171], v[232:235], v[48:51], v[168:171]
v_mfma_f32_16x16x32_bf16 v[184:187], v[232:235], v[52:55], v[184:187]
v_mfma_f32_16x16x32_bf16 v[184:187], v[20:23], v[64:67], v[184:187]
s_waitcnt vmcnt(8)
v_mfma_f32_16x16x32_bf16 v[140:143], v[116:119], v[68:71], v[140:143]
buffer_load_dwordx4 v[44:47], v26, s[32:35], s76 offen sc1
v_mfma_f32_16x16x32_bf16 v[140:143], v[132:135], v[80:83], v[140:143]
ds_read_b64_tr_b16 a[128:129], v240 offset:0
s_waitcnt vmcnt(8)
v_mfma_f32_16x16x32_bf16 v[156:159], v[132:135], v[84:87], v[156:159]
ds_read_b64_tr_b16 a[130:131], v240 offset:2048
ds_read_b64_tr_b16 a[132:133], v241 offset:0
v_mfma_f32_16x16x32_bf16 v[156:159], v[116:119], v[72:75], v[156:159]
ds_read_b64_tr_b16 a[134:135], v241 offset:2048
ds_read_b64_tr_b16 a[136:137], v242 offset:0
s_waitcnt vmcnt(7)
v_mfma_f32_16x16x32_bf16 v[172:175], v[116:119], v[76:79], v[172:175]
buffer_load_dwordx4 v[48:51], v26, s[32:35], s76 offen offset:1024 sc1
ds_read_b64_tr_b16 a[138:139], v242 offset:2048
v_mfma_f32_16x16x32_bf16 v[172:175], v[132:135], v[88:91], v[172:175]
ds_read_b64_tr_b16 a[140:141], v243 offset:0
v_mfma_f32_16x16x32_bf16 v[144:147], v[120:123], v[68:71], v[144:147]
ds_read_b64_tr_b16 a[142:143], v243 offset:2048
v_mfma_f32_16x16x32_bf16 v[144:147], v[136:139], v[80:83], v[144:147]
v_mfma_f32_16x16x32_bf16 v[160:163], v[136:139], v[84:87], v[160:163]
buffer_load_dwordx4 v[52:55], v26, s[32:35], s76 offen offset:2048 sc1
s_add_u32 s76, s76, 3072
v_mfma_f32_16x16x32_bf16 v[160:163], v[120:123], v[72:75], v[160:163]
v_mfma_f32_16x16x32_bf16 v[176:179], v[120:123], v[76:79], v[176:179]
v_mfma_f32_16x16x32_bf16 v[176:179], v[136:139], v[88:91], v[176:179]
v_mfma_f32_16x16x32_bf16 v[148:151], v[124:127], v[68:71], v[148:151]
buffer_load_dwordx4 v[56:59], v26, s[32:35], s76 offen sc1
v_mfma_f32_16x16x32_bf16 v[148:151], v[248:251], v[80:83], v[148:151]
ds_read_b64_tr_b16 a[144:145], v236 offset:16384
v_mfma_f32_16x16x32_bf16 v[164:167], v[248:251], v[84:87], v[164:167]
ds_read_b64_tr_b16 a[146:147], v236 offset:18432
ds_read_b64_tr_b16 a[148:149], v237 offset:16384
v_mfma_f32_16x16x32_bf16 v[164:167], v[124:127], v[72:75], v[164:167]
ds_read_b64_tr_b16 a[150:151], v237 offset:18432
ds_read_b64_tr_b16 a[152:153], v238 offset:16384
v_mfma_f32_16x16x32_bf16 v[180:183], v[124:127], v[76:79], v[180:183]
ds_read_b64_tr_b16 a[154:155], v238 offset:18432
buffer_load_dwordx4 v[60:63], v26, s[32:35], s76 offen offset:1024 sc1
v_mfma_f32_16x16x32_bf16 v[180:183], v[248:251], v[88:91], v[180:183]
ds_read_b64_tr_b16 a[156:157], v239 offset:16384
s_waitcnt lgkmcnt(14)
ds_read_b64_tr_b16 a[158:159], v239 offset:18432
v_mfma_f32_16x16x32_bf16 v[152:155], v[128:131], v[68:71], v[152:155]
v_mfma_f32_16x16x32_bf16 v[152:155], v[252:255], v[80:83], v[152:155]
v_mfma_f32_16x16x32_bf16 v[168:171], v[252:255], v[84:87], v[168:171]
buffer_load_dwordx4 v[64:67], v26, s[32:35], s76 offen offset:2048 sc1
s_add_u32 s76, s76, 3072
v_mfma_f32_16x16x32_bf16 v[168:171], v[128:131], v[72:75], v[168:171]
v_mfma_f32_16x16x32_bf16 v[184:187], v[128:131], v[76:79], v[184:187]
v_mfma_f32_16x16x32_bf16 v[184:187], v[252:255], v[88:91], v[184:187]
s_waitcnt lgkmcnt(0)
s_waitcnt vmcnt(8)
v_mfma_f32_16x16x32_bf16 v[140:143], a[128:131], v[92:95], v[140:143]
buffer_load_dwordx4 v[68:71], v26, s[32:35], s76 offen sc1
v_mfma_f32_16x16x32_bf16 v[140:143], a[144:147], v[104:107], v[140:143]
s_add_u32 m0, s65, 65536
s_waitcnt vmcnt(8)
v_mfma_f32_16x16x32_bf16 v[156:159], a[144:147], v[108:111], v[156:159]
ds_read_b64_tr_b16 a[160:161], v240 offset:32768
ds_read_b64_tr_b16 a[162:163], v240 offset:34816
v_mfma_f32_16x16x32_bf16 v[156:159], a[128:131], v[96:99], v[156:159]
buffer_load_dwordx4 v28, s[24:27], s75 offen lds
ds_read_b64_tr_b16 a[164:165], v241 offset:32768
s_waitcnt vmcnt(8)
v_mfma_f32_16x16x32_bf16 v[172:175], a[128:131], v[100:103], v[172:175]
buffer_load_dwordx4 v[72:75], v26, s[32:35], s76 offen offset:1024 sc1
ds_read_b64_tr_b16 a[166:167], v241 offset:34816
v_mfma_f32_16x16x32_bf16 v[172:175], a[144:147], v[112:115], v[172:175]
buffer_load_dwordx4 v29, s[24:27], s75 offen offset:1024 lds
ds_read_b64_tr_b16 a[168:169], v242 offset:32768
v_mfma_f32_16x16x32_bf16 v[144:147], a[132:135], v[92:95], v[144:147]
ds_read_b64_tr_b16 a[170:171], v242 offset:34816
ds_read_b64_tr_b16 a[172:173], v243 offset:32768
v_mfma_f32_16x16x32_bf16 v[144:147], a[148:151], v[104:107], v[144:147]
buffer_load_dwordx4 v30, s[24:27], s75 offen offset:2048 lds
ds_read_b64_tr_b16 a[174:175], v243 offset:34816
v_mfma_f32_16x16x32_bf16 v[160:163], a[148:151], v[108:111], v[160:163]
buffer_load_dwordx4 v[76:79], v26, s[32:35], s76 offen offset:2048 sc1
s_add_u32 s76, s76, 3072
v_mfma_f32_16x16x32_bf16 v[160:163], a[132:135], v[96:99], v[160:163]
v_mfma_f32_16x16x32_bf16 v[176:179], a[132:135], v[100:103], v[176:179]
v_mfma_f32_16x16x32_bf16 v[176:179], a[148:151], v[112:115], v[176:179]
buffer_load_dwordx4 v31, s[24:27], s75 offen offset:3072 lds
s_add_u32 s75, s75, 32768
s_and_b32 s75, s75, 0xfffff
s_or_b32 s75, s75, s79
v_mfma_f32_16x16x32_bf16 v[148:151], a[136:139], v[92:95], v[148:151]
buffer_load_dwordx4 v[80:83], v26, s[32:35], s76 offen sc1
v_mfma_f32_16x16x32_bf16 v[148:151], a[152:155], v[104:107], v[148:151]
ds_read_b64_tr_b16 a[176:177], v240 offset:49152
v_mfma_f32_16x16x32_bf16 v[164:167], a[152:155], v[108:111], v[164:167]
ds_read_b64_tr_b16 a[178:179], v240 offset:51200
ds_read_b64_tr_b16 a[180:181], v241 offset:49152
v_mfma_f32_16x16x32_bf16 v[164:167], a[136:139], v[96:99], v[164:167]
ds_read_b64_tr_b16 a[182:183], v241 offset:51200
ds_read_b64_tr_b16 a[184:185], v242 offset:49152
v_mfma_f32_16x16x32_bf16 v[180:183], a[136:139], v[100:103], v[180:183]
ds_read_b64_tr_b16 a[186:187], v242 offset:51200
buffer_load_dwordx4 v[84:87], v26, s[32:35], s76 offen offset:1024 sc1
v_mfma_f32_16x16x32_bf16 v[180:183], a[152:155], v[112:115], v[180:183]
ds_read_b64_tr_b16 a[188:189], v243 offset:49152
s_waitcnt lgkmcnt(14)
ds_read_b64_tr_b16 a[190:191], v243 offset:51200
v_mfma_f32_16x16x32_bf16 v[152:155], a[140:143], v[92:95], v[152:155]
v_mfma_f32_16x16x32_bf16 v[152:155], a[156:159], v[104:107], v[152:155]
v_mfma_f32_16x16x32_bf16 v[168:171], a[156:159], v[108:111], v[168:171]
buffer_load_dwordx4 v[88:91], v26, s[32:35], s76 offen offset:2048 sc1
s_add_u32 s76, s76, 3072
s_cmp_eq_u32 s76, 98304
s_cselect_b32 s76, 0, s76
v_mfma_f32_16x16x32_bf16 v[168:171], a[140:143], v[96:99], v[168:171]
v_mfma_f32_16x16x32_bf16 v[184:187], a[140:143], v[100:103], v[184:187]
v_mfma_f32_16x16x32_bf16 v[184:187], a[156:159], v[112:115], v[184:187]
s_waitcnt lgkmcnt(0)
s_waitcnt vmcnt(12)
v_mfma_f32_16x16x32_bf16 v[140:143], a[160:163], v[44:47], v[140:143]
buffer_load_dwordx4 v[92:95], v26, s[32:35], s76 offen sc1
v_mfma_f32_16x16x32_bf16 v[140:143], a[176:179], v[56:59], v[140:143]
ds_read_b64_tr_b16 a[192:193], v244 offset:0
s_waitcnt vmcnt(12)
v_mfma_f32_16x16x32_bf16 v[156:159], a[176:179], v[60:63], v[156:159]
ds_read_b64_tr_b16 a[194:195], v244 offset:2048
ds_read_b64_tr_b16 a[196:197], v245 offset:0
v_mfma_f32_16x16x32_bf16 v[156:159], a[160:163], v[48:51], v[156:159]
ds_read_b64_tr_b16 a[198:199], v245 offset:2048
ds_read_b64_tr_b16 a[200:201], v246 offset:0
s_waitcnt vmcnt(11)
v_mfma_f32_16x16x32_bf16 v[172:175], a[160:163], v[52:55], v[172:175]
buffer_load_dwordx4 v[96:99], v26, s[32:35], s76 offen offset:1024 sc1
ds_read_b64_tr_b16 a[202:203], v246 offset:2048
v_mfma_f32_16x16x32_bf16 v[172:175], a[176:179], v[64:67], v[172:175]
ds_read_b64_tr_b16 a[204:205], v247 offset:0
v_mfma_f32_16x16x32_bf16 v[144:147], a[164:167], v[44:47], v[144:147]
ds_read_b64_tr_b16 a[206:207], v247 offset:2048
v_mfma_f32_16x16x32_bf16 v[144:147], a[180:183], v[56:59], v[144:147]
v_mfma_f32_16x16x32_bf16 v[160:163], a[180:183], v[60:63], v[160:163]
buffer_load_dwordx4 v[100:103], v26, s[32:35], s76 offen offset:2048 sc1
s_add_u32 s76, s76, 3072
v_mfma_f32_16x16x32_bf16 v[160:163], a[164:167], v[48:51], v[160:163]
v_mfma_f32_16x16x32_bf16 v[176:179], a[164:167], v[52:55], v[176:179]
v_mfma_f32_16x16x32_bf16 v[176:179], a[180:183], v[64:67], v[176:179]
v_mfma_f32_16x16x32_bf16 v[148:151], a[168:171], v[44:47], v[148:151]
buffer_load_dwordx4 v[104:107], v26, s[32:35], s76 offen sc1
v_mfma_f32_16x16x32_bf16 v[148:151], a[184:187], v[56:59], v[148:151]
ds_read_b64_tr_b16 a[208:209], v236 offset:0
v_mfma_f32_16x16x32_bf16 v[164:167], a[184:187], v[60:63], v[164:167]
ds_read_b64_tr_b16 a[210:211], v236 offset:2048
ds_read_b64_tr_b16 a[212:213], v237 offset:0
v_mfma_f32_16x16x32_bf16 v[164:167], a[168:171], v[48:51], v[164:167]
ds_read_b64_tr_b16 a[214:215], v237 offset:2048
ds_read_b64_tr_b16 a[216:217], v238 offset:0
v_mfma_f32_16x16x32_bf16 v[180:183], a[168:171], v[52:55], v[180:183]
ds_read_b64_tr_b16 a[218:219], v238 offset:2048
buffer_load_dwordx4 v[108:111], v26, s[32:35], s76 offen offset:1024 sc1
v_mfma_f32_16x16x32_bf16 v[180:183], a[184:187], v[64:67], v[180:183]
ds_read_b64_tr_b16 a[220:221], v239 offset:0
s_waitcnt lgkmcnt(14)
ds_read_b64_tr_b16 a[222:223], v239 offset:2048
v_mfma_f32_16x16x32_bf16 v[152:155], a[172:175], v[44:47], v[152:155]
v_mfma_f32_16x16x32_bf16 v[152:155], a[188:191], v[56:59], v[152:155]
v_mfma_f32_16x16x32_bf16 v[168:171], a[188:191], v[60:63], v[168:171]
buffer_load_dwordx4 v[112:115], v26, s[32:35], s76 offen offset:2048 sc1
s_add_u32 s76, s76, 3072
v_mfma_f32_16x16x32_bf16 v[168:171], a[172:175], v[48:51], v[168:171]
v_mfma_f32_16x16x32_bf16 v[184:187], a[172:175], v[52:55], v[184:187]
v_mfma_f32_16x16x32_bf16 v[184:187], a[188:191], v[64:67], v[184:187]
s_waitcnt lgkmcnt(0)
s_waitcnt vmcnt(8)
v_mfma_f32_16x16x32_bf16 v[140:143], a[192:195], v[68:71], v[140:143]
buffer_load_dwordx4 v[44:47], v26, s[32:35], s76 offen sc1
v_mfma_f32_16x16x32_bf16 v[140:143], a[208:211], v[80:83], v[140:143]
ds_read_b64_tr_b16 a[224:225], v236 offset:49152
s_waitcnt vmcnt(8)
v_mfma_f32_16x16x32_bf16 v[156:159], a[208:211], v[84:87], v[156:159]
ds_read_b64_tr_b16 a[226:227], v236 offset:51200
ds_read_b64_tr_b16 a[228:229], v237 offset:49152
v_mfma_f32_16x16x32_bf16 v[156:159], a[192:195], v[72:75], v[156:159]
ds_read_b64_tr_b16 a[230:231], v237 offset:51200
ds_read_b64_tr_b16 a[232:233], v238 offset:49152
s_waitcnt vmcnt(7)
v_mfma_f32_16x16x32_bf16 v[172:175], a[192:195], v[76:79], v[172:175]
buffer_load_dwordx4 v[48:51], v26, s[32:35], s76 offen offset:1024 sc1
ds_read_b64_tr_b16 a[234:235], v238 offset:51200
v_mfma_f32_16x16x32_bf16 v[172:175], a[208:211], v[88:91], v[172:175]
ds_read_b64_tr_b16 a[236:237], v239 offset:49152
v_mfma_f32_16x16x32_bf16 v[144:147], a[196:199], v[68:71], v[144:147]
ds_read_b64_tr_b16 a[238:239], v239 offset:51200
v_mfma_f32_16x16x32_bf16 v[144:147], a[212:215], v[80:83], v[144:147]
v_mfma_f32_16x16x32_bf16 v[160:163], a[212:215], v[84:87], v[160:163]
buffer_load_dwordx4 v[52:55], v26, s[32:35], s76 offen offset:2048 sc1
s_add_u32 s76, s76, 3072
v_mfma_f32_16x16x32_bf16 v[160:163], a[196:199], v[72:75], v[160:163]
v_mfma_f32_16x16x32_bf16 v[176:179], a[196:199], v[76:79], v[176:179]
v_mfma_f32_16x16x32_bf16 v[176:179], a[212:215], v[88:91], v[176:179]
v_mfma_f32_16x16x32_bf16 v[148:151], a[200:203], v[68:71], v[148:151]
buffer_load_dwordx4 v[56:59], v26, s[32:35], s76 offen sc1
v_mfma_f32_16x16x32_bf16 v[148:151], a[216:219], v[80:83], v[148:151]
ds_read_b64_tr_b16 a[240:241], v240 offset:16384
v_mfma_f32_16x16x32_bf16 v[164:167], a[216:219], v[84:87], v[164:167]
ds_read_b64_tr_b16 a[242:243], v240 offset:18432
ds_read_b64_tr_b16 a[244:245], v241 offset:16384
v_mfma_f32_16x16x32_bf16 v[164:167], a[200:203], v[72:75], v[164:167]
ds_read_b64_tr_b16 a[246:247], v241 offset:18432
ds_read_b64_tr_b16 a[248:249], v242 offset:16384
v_mfma_f32_16x16x32_bf16 v[180:183], a[200:203], v[76:79], v[180:183]
ds_read_b64_tr_b16 a[250:251], v242 offset:18432
buffer_load_dwordx4 v[60:63], v26, s[32:35], s76 offen offset:1024 sc1
v_mfma_f32_16x16x32_bf16 v[180:183], a[216:219], v[88:91], v[180:183]
ds_read_b64_tr_b16 a[252:253], v243 offset:16384
s_waitcnt lgkmcnt(14)
ds_read_b64_tr_b16 a[254:255], v243 offset:18432
v_mfma_f32_16x16x32_bf16 v[152:155], a[204:207], v[68:71], v[152:155]
v_mfma_f32_16x16x32_bf16 v[152:155], a[220:223], v[80:83], v[152:155]
v_mfma_f32_16x16x32_bf16 v[168:171], a[220:223], v[84:87], v[168:171]
buffer_load_dwordx4 v[64:67], v26, s[32:35], s76 offen offset:2048 sc1
s_add_u32 s76, s76, 3072
s_cmp_eq_u32 s76, 98304
s_cselect_b32 s76, 0, s76
v_mfma_f32_16x16x32_bf16 v[168:171], a[204:207], v[72:75], v[168:171]
v_mfma_f32_16x16x32_bf16 v[184:187], a[204:207], v[76:79], v[184:187]
v_mfma_f32_16x16x32_bf16 v[184:187], a[220:223], v[88:91], v[184:187]
s_waitcnt lgkmcnt(0)
s_waitcnt vmcnt(8)
v_mfma_f32_16x16x32_bf16 v[140:143], a[224:227], v[92:95], v[140:143]
v_mfma_f32_16x16x32_bf16 v[140:143], a[240:243], v[104:107], v[140:143]
ds_read_b64_tr_b16 a[0:1], v236 offset:32768
s_waitcnt vmcnt(7)
v_mfma_f32_16x16x32_bf16 v[156:159], a[240:243], v[108:111], v[156:159]
ds_read_b64_tr_b16 a[2:3], v236 offset:34816
ds_read_b64_tr_b16 a[4:5], v237 offset:32768
v_mfma_f32_16x16x32_bf16 v[156:159], a[224:227], v[96:99], v[156:159]
ds_read_b64_tr_b16 a[6:7], v237 offset:34816
ds_read_b64_tr_b16 a[8:9], v238 offset:32768
s_waitcnt vmcnt(6)
v_mfma_f32_16x16x32_bf16 v[172:175], a[224:227], v[100:103], v[172:175]
ds_read_b64_tr_b16 a[10:11], v238 offset:34816
v_mfma_f32_16x16x32_bf16 v[172:175], a[240:243], v[112:115], v[172:175]
ds_read_b64_tr_b16 a[12:13], v239 offset:32768
v_mfma_f32_16x16x32_bf16 v[144:147], a[228:231], v[92:95], v[144:147]
ds_read_b64_tr_b16 a[14:15], v239 offset:34816
v_mfma_f32_16x16x32_bf16 v[144:147], a[244:247], v[104:107], v[144:147]
v_mfma_f32_16x16x32_bf16 v[160:163], a[244:247], v[108:111], v[160:163]
v_mfma_f32_16x16x32_bf16 v[160:163], a[228:231], v[96:99], v[160:163]
v_mfma_f32_16x16x32_bf16 v[176:179], a[228:231], v[100:103], v[176:179]
v_mfma_f32_16x16x32_bf16 v[176:179], a[244:247], v[112:115], v[176:179]
v_mfma_f32_16x16x32_bf16 v[148:151], a[232:235], v[92:95], v[148:151]
v_mfma_f32_16x16x32_bf16 v[148:151], a[248:251], v[104:107], v[148:151]
ds_read_b64_tr_b16 a[16:17], v240 offset:0
v_mfma_f32_16x16x32_bf16 v[164:167], a[248:251], v[108:111], v[164:167]
ds_read_b64_tr_b16 a[18:19], v240 offset:2048
ds_read_b64_tr_b16 a[20:21], v241 offset:0
v_mfma_f32_16x16x32_bf16 v[164:167], a[232:235], v[96:99], v[164:167]
ds_read_b64_tr_b16 a[22:23], v241 offset:2048
ds_read_b64_tr_b16 a[24:25], v242 offset:0
v_mfma_f32_16x16x32_bf16 v[180:183], a[232:235], v[100:103], v[180:183]
ds_read_b64_tr_b16 a[26:27], v242 offset:2048
ds_read_b64_tr_b16 a[28:29], v243 offset:0
v_mfma_f32_16x16x32_bf16 v[180:183], a[248:251], v[112:115], v[180:183]
s_waitcnt lgkmcnt(14)
ds_read_b64_tr_b16 a[30:31], v243 offset:2048
v_mfma_f32_16x16x32_bf16 v[152:155], a[236:239], v[92:95], v[152:155]
v_mfma_f32_16x16x32_bf16 v[152:155], a[252:255], v[104:107], v[152:155]
v_mfma_f32_16x16x32_bf16 v[168:171], a[252:255], v[108:111], v[168:171]
v_mfma_f32_16x16x32_bf16 v[168:171], a[236:239], v[96:99], v[168:171]
v_mfma_f32_16x16x32_bf16 v[184:187], a[236:239], v[100:103], v[184:187]
v_mfma_f32_16x16x32_bf16 v[184:187], a[252:255], v[112:115], v[184:187]
s_waitcnt lgkmcnt(0)
s_waitcnt vmcnt(2)
v_mfma_f32_16x16x32_bf16 v[140:143], a[0:3], v[44:47], v[140:143]
v_mfma_f32_16x16x32_bf16 v[140:143], a[16:19], v[56:59], v[140:143]
s_waitcnt vmcnt(1)
v_mfma_f32_16x16x32_bf16 v[156:159], a[16:19], v[60:63], v[156:159]
v_mfma_f32_16x16x32_bf16 v[156:159], a[0:3], v[48:51], v[156:159]
s_waitcnt vmcnt(0)
v_mfma_f32_16x16x32_bf16 v[172:175], a[0:3], v[52:55], v[172:175]
v_mfma_f32_16x16x32_bf16 v[172:175], a[16:19], v[64:67], v[172:175]
v_mfma_f32_16x16x32_bf16 v[144:147], a[4:7], v[44:47], v[144:147]
v_mfma_f32_16x16x32_bf16 v[144:147], a[20:23], v[56:59], v[144:147]
ds_write_b128 v32, v[140:143] offset:0
v_mfma_f32_16x16x32_bf16 v[160:163], a[20:23], v[60:63], v[160:163]
v_mfma_f32_16x16x32_bf16 v[160:163], a[4:7], v[48:51], v[160:163]
ds_write_b128 v32, v[156:159] offset:16384
v_mfma_f32_16x16x32_bf16 v[176:179], a[4:7], v[52:55], v[176:179]
v_mfma_f32_16x16x32_bf16 v[176:179], a[20:23], v[64:67], v[176:179]
ds_write_b128 v32, v[172:175] offset:32768
v_mfma_f32_16x16x32_bf16 v[148:151], a[8:11], v[44:47], v[148:151]
v_mfma_f32_16x16x32_bf16 v[148:151], a[24:27], v[56:59], v[148:151]
ds_write_b128 v33, v[144:147] offset:0
v_mfma_f32_16x16x32_bf16 v[164:167], a[24:27], v[60:63], v[164:167]
v_mfma_f32_16x16x32_bf16 v[164:167], a[8:11], v[48:51], v[164:167]
ds_write_b128 v33, v[160:163] offset:16384
v_mfma_f32_16x16x32_bf16 v[180:183], a[8:11], v[52:55], v[180:183]
v_mfma_f32_16x16x32_bf16 v[180:183], a[24:27], v[64:67], v[180:183]
ds_write_b128 v33, v[176:179] offset:32768
v_mfma_f32_16x16x32_bf16 v[152:155], a[12:15], v[44:47], v[152:155]
v_mfma_f32_16x16x32_bf16 v[152:155], a[28:31], v[56:59], v[152:155]
ds_write_b128 v34, v[148:151] offset:0
v_mfma_f32_16x16x32_bf16 v[168:171], a[28:31], v[60:63], v[168:171]
v_mfma_f32_16x16x32_bf16 v[168:171], a[12:15], v[48:51], v[168:171]
ds_write_b128 v34, v[164:167] offset:16384
v_mfma_f32_16x16x32_bf16 v[184:187], a[12:15], v[52:55], v[184:187]
v_mfma_f32_16x16x32_bf16 v[184:187], a[28:31], v[64:67], v[184:187]
ds_write_b128 v34, v[180:183] offset:32768
s_nop 0
ds_write_b128 v35, v[152:155] offset:0
s_nop 1
ds_write_b128 v35, v[168:171] offset:16384
s_nop 1
ds_write_b128 v35, v[184:187] offset:32768
s_waitcnt lgkmcnt(0)
s_barrier
ds_read_b128 v[44:47], v36 offset:0
ds_read_b128 v[48:51], v36 offset:4096
ds_read_b128 v[52:55], v36 offset:8192
ds_read_b128 v[56:59], v36 offset:12288
ds_read_b128 v[60:63], v37 offset:0
ds_read_b128 v[64:67], v37 offset:4096
ds_read_b128 v[68:71], v37 offset:8192
ds_read_b128 v[72:75], v37 offset:12288
ds_read_b128 v[76:79], v38 offset:0
ds_read_b128 v[80:83], v38 offset:4096
ds_read_b128 v[84:87], v38 offset:8192
ds_read_b128 v[88:91], v38 offset:12288
s_waitcnt lgkmcnt(10)
v_pk_add_f32 v[44:45], v[44:45], v[48:49]
v_pk_add_f32 v[46:47], v[46:47], v[50:51]
s_waitcnt lgkmcnt(8)
v_pk_add_f32 v[52:53], v[52:53], v[56:57]
v_pk_add_f32 v[54:55], v[54:55], v[58:59]
v_pk_add_f32 v[44:45], v[44:45], v[52:53]
v_pk_add_f32 v[46:47], v[46:47], v[54:55]
v_cvt_pk_bf16_f32 v48, v44, v45
v_cvt_pk_bf16_f32 v49, v46, v47
buffer_store_dwordx2 v[48:49], v39, s[36:39], 0 offen
s_waitcnt lgkmcnt(6)
v_pk_add_f32 v[60:61], v[60:61], v[64:65]
v_pk_add_f32 v[62:63], v[62:63], v[66:67]
s_waitcnt lgkmcnt(4)
v_pk_add_f32 v[68:69], v[68:69], v[72:73]
v_pk_add_f32 v[70:71], v[70:71], v[74:75]
v_pk_add_f32 v[60:61], v[60:61], v[68:69]
v_pk_add_f32 v[62:63], v[62:63], v[70:71]
v_cvt_pk_bf16_f32 v64, v60, v61
v_cvt_pk_bf16_f32 v65, v62, v63
buffer_store_dwordx2 v[64:65], v40, s[36:39], 0 offen
s_waitcnt lgkmcnt(2)
v_pk_add_f32 v[76:77], v[76:77], v[80:81]
v_pk_add_f32 v[78:79], v[78:79], v[82:83]
s_waitcnt lgkmcnt(0)
v_pk_add_f32 v[84:85], v[84:85], v[88:89]
v_pk_add_f32 v[86:87], v[86:87], v[90:91]
v_pk_add_f32 v[76:77], v[76:77], v[84:85]
v_pk_add_f32 v[78:79], v[78:79], v[86:87]
v_cvt_pk_bf16_f32 v80, v76, v77
v_cvt_pk_bf16_f32 v81, v78, v79
buffer_store_dwordx2 v[80:81], v41, s[36:39], 0 offen
L_end:
s_endpgm
L_fallback:
s_mov_b32 s74, 1
s_waitcnt vmcnt(0) lgkmcnt(0)
s_barrier
v_mov_b32 v249, 0xff800000
v_mov_b32 v250, 0xff800000
v_mov_b32 v251, 0xff800000
s_mov_b32 s59, s98
s_mov_b32 s61, 32
L_fb_loop:
s_add_u32 m0, s65, 0
s_nop 0
buffer_load_dwordx4 v20, s[8:11], s59 offen nt lds
buffer_load_dwordx4 v21, s[8:11], s59 offen offset:1024 nt lds
buffer_load_dwordx4 v22, s[8:11], s59 offen offset:2048 nt lds
buffer_load_dwordx4 v23, s[8:11], s59 offen offset:3072 nt lds
s_add_u32 s59, s59, 16384
s_and_b32 s59, s59, 0x7ffff
s_waitcnt vmcnt(0)
s_barrier
ds_read_b128 a[64:67], v8 offset:0
ds_read_b128 a[68:71], v9 offset:0
ds_read_b128 a[72:75], v10 offset:0
ds_read_b128 a[76:79], v11 offset:0
s_waitcnt lgkmcnt(0)
v_mfma_f32_16x16x32_bf16 v[140:143], a[64:67], a[0:3], 0
v_mfma_f32_16x16x32_bf16 v[140:143], a[68:71], a[4:7], v[140:143]
v_mfma_f32_16x16x32_bf16 v[140:143], a[72:75], a[8:11], v[140:143]
v_mfma_f32_16x16x32_bf16 v[140:143], a[76:79], a[12:15], v[140:143]
v_mfma_f32_16x16x32_bf16 v[156:159], a[76:79], a[28:31], 0
v_mfma_f32_16x16x32_bf16 v[156:159], a[72:75], a[24:27], v[156:159]
v_mfma_f32_16x16x32_bf16 v[156:159], a[68:71], a[20:23], v[156:159]
v_mfma_f32_16x16x32_bf16 v[156:159], a[64:67], a[16:19], v[156:159]
v_mfma_f32_16x16x32_bf16 v[172:175], a[64:67], a[32:35], 0
v_mfma_f32_16x16x32_bf16 v[172:175], a[68:71], a[36:39], v[172:175]
v_mfma_f32_16x16x32_bf16 v[172:175], a[72:75], a[40:43], v[172:175]
v_mfma_f32_16x16x32_bf16 v[172:175], a[76:79], a[44:47], v[172:175]
ds_read_b128 a[80:83], v8 offset:4096
ds_read_b128 a[84:87], v9 offset:4096
ds_read_b128 a[88:91], v10 offset:4096
ds_read_b128 a[92:95], v11 offset:4096
s_waitcnt lgkmcnt(0)
v_mfma_f32_16x16x32_bf16 v[144:147], a[80:83], a[0:3], 0
v_mfma_f32_16x16x32_bf16 v[144:147], a[84:87], a[4:7], v[144:147]
v_mfma_f32_16x16x32_bf16 v[144:147], a[88:91], a[8:11], v[144:147]
v_mfma_f32_16x16x32_bf16 v[144:147], a[92:95], a[12:15], v[144:147]
v_mfma_f32_16x16x32_bf16 v[160:163], a[92:95], a[28:31], 0
v_mfma_f32_16x16x32_bf16 v[160:163], a[88:91], a[24:27], v[160:163]
v_mfma_f32_16x16x32_bf16 v[160:163], a[84:87], a[20:23], v[160:163]
v_mfma_f32_16x16x32_bf16 v[160:163], a[80:83], a[16:19], v[160:163]
v_mfma_f32_16x16x32_bf16 v[176:179], a[80:83], a[32:35], 0
v_mfma_f32_16x16x32_bf16 v[176:179], a[84:87], a[36:39], v[176:179]
v_mfma_f32_16x16x32_bf16 v[176:179], a[88:91], a[40:43], v[176:179]
v_mfma_f32_16x16x32_bf16 v[176:179], a[92:95], a[44:47], v[176:179]
ds_read_b128 a[64:67], v8 offset:8192
ds_read_b128 a[68:71], v9 offset:8192
ds_read_b128 a[72:75], v10 offset:8192
ds_read_b128 a[76:79], v11 offset:8192
s_waitcnt lgkmcnt(0)
v_mfma_f32_16x16x32_bf16 v[148:151], a[64:67], a[0:3], 0
v_mfma_f32_16x16x32_bf16 v[148:151], a[68:71], a[4:7], v[148:151]
v_mfma_f32_16x16x32_bf16 v[148:151], a[72:75], a[8:11], v[148:151]
v_mfma_f32_16x16x32_bf16 v[148:151], a[76:79], a[12:15], v[148:151]
v_mfma_f32_16x16x32_bf16 v[164:167], a[76:79], a[28:31], 0
v_mfma_f32_16x16x32_bf16 v[164:167], a[72:75], a[24:27], v[164:167]
v_mfma_f32_16x16x32_bf16 v[164:167], a[68:71], a[20:23], v[164:167]
v_mfma_f32_16x16x32_bf16 v[164:167], a[64:67], a[16:19], v[164:167]
v_mfma_f32_16x16x32_bf16 v[180:183], a[64:67], a[32:35], 0
v_mfma_f32_16x16x32_bf16 v[180:183], a[68:71], a[36:39], v[180:183]
v_mfma_f32_16x16x32_bf16 v[180:183], a[72:75], a[40:43], v[180:183]
v_mfma_f32_16x16x32_bf16 v[180:183], a[76:79], a[44:47], v[180:183]
ds_read_b128 a[80:83], v8 offset:12288
ds_read_b128 a[84:87], v9 offset:12288
ds_read_b128 a[88:91], v10 offset:12288
ds_read_b128 a[92:95], v11 offset:12288
s_waitcnt lgkmcnt(0)
v_mfma_f32_16x16x32_bf16 v[152:155], a[80:83], a[0:3], 0
v_mfma_f32_16x16x32_bf16 v[152:155], a[84:87], a[4:7], v[152:155]
v_mfma_f32_16x16x32_bf16 v[152:155], a[88:91], a[8:11], v[152:155]
v_mfma_f32_16x16x32_bf16 v[152:155], a[92:95], a[12:15], v[152:155]
v_mfma_f32_16x16x32_bf16 v[168:171], a[92:95], a[28:31], 0
v_mfma_f32_16x16x32_bf16 v[168:171], a[88:91], a[24:27], v[168:171]
v_mfma_f32_16x16x32_bf16 v[168:171], a[84:87], a[20:23], v[168:171]
v_mfma_f32_16x16x32_bf16 v[168:171], a[80:83], a[16:19], v[168:171]
v_mfma_f32_16x16x32_bf16 v[184:187], a[80:83], a[32:35], 0
v_mfma_f32_16x16x32_bf16 v[184:187], a[84:87], a[36:39], v[184:187]
v_mfma_f32_16x16x32_bf16 v[184:187], a[88:91], a[40:43], v[184:187]
v_mfma_f32_16x16x32_bf16 v[184:187], a[92:95], a[44:47], v[184:187]
s_nop 7
v_max3_f32 v249, v249, v140, v141
v_max3_f32 v249, v249, v142, v143
v_max3_f32 v249, v249, v144, v145
v_max3_f32 v249, v249, v146, v147
v_max3_f32 v249, v249, v148, v149
v_max3_f32 v249, v249, v150, v151
v_max3_f32 v249, v249, v152, v153
v_max3_f32 v249, v249, v154, v155
v_max3_f32 v250, v250, v156, v157
v_max3_f32 v250, v250, v158, v159
v_max3_f32 v250, v250, v160, v161
v_max3_f32 v250, v250, v162, v163
v_max3_f32 v250, v250, v164, v165
v_max3_f32 v250, v250, v166, v167
v_max3_f32 v250, v250, v168, v169
v_max3_f32 v250, v250, v170, v171
v_max3_f32 v251, v251, v172, v173
v_max3_f32 v251, v251, v174, v175
v_max3_f32 v251, v251, v176, v177
v_max3_f32 v251, v251, v178, v179
v_max3_f32 v251, v251, v180, v181
v_max3_f32 v251, v251, v182, v183
v_max3_f32 v251, v251, v184, v185
v_max3_f32 v251, v251, v186, v187
s_barrier
s_sub_u32 s61, s61, 1
s_cmp_lg_u32 s61, 0
s_cbranch_scc1 L_fb_loop
v_mov_b32 v1, v249
v_mov_b32 v2, v250
v_mov_b32 v3, v251
s_nop 0
v_permlane16_swap_b32 v249, v1
v_permlane16_swap_b32 v250, v2
v_permlane16_swap_b32 v251, v3
v_max_f32 v249, v249, v1
v_max_f32 v250, v250, v2
v_max_f32 v251, v251, v3
v_mov_b32 v1, v249
v_mov_b32 v2, v250
v_mov_b32 v3, v251
s_nop 0
v_permlane32_swap_b32 v249, v1
v_permlane32_swap_b32 v250, v2
v_permlane32_swap_b32 v251, v3
v_max_f32 v249, v249, v1
v_max_f32 v250, v250, v2
v_max_f32 v251, v251, v3
v_sub_f32 v32, 0, v249
v_sub_f32 v33, 0, v249
v_sub_f32 v34, 0, v249
v_sub_f32 v35, 0, v249
v_sub_f32 v36, 0, v250
v_sub_f32 v37, 0, v250
v_sub_f32 v38, 0, v250
v_sub_f32 v39, 0, v250
v_sub_f32 v40, 0, v251
v_sub_f32 v41, 0, v251
v_sub_f32 v42, 0, v251
v_sub_f32 v43, 0, v251
v_mov_b32 v44, 0
v_mov_b32 v45, 0
v_mov_b32 v46, 0
v_mov_b32 v47, 0
v_mov_b32 v48, 0
v_mov_b32 v49, 0
v_mov_b32 v50, 0
v_mov_b32 v51, 0
v_mov_b32 v52, 0
v_mov_b32 v53, 0
v_mov_b32 v54, 0
v_mov_b32 v55, 0
v_mov_b32 v56, 0
v_mov_b32 v57, 0
v_mov_b32 v58, 0
v_mov_b32 v59, 0
v_mov_b32 v60, 0
v_mov_b32 v61, 0
v_mov_b32 v62, 0
v_mov_b32 v63, 0
v_mov_b32 v64, 0
v_mov_b32 v65, 0
v_mov_b32 v66, 0
v_mov_b32 v67, 0
v_mov_b32 v68, 0
v_mov_b32 v69, 0
v_mov_b32 v70, 0
v_mov_b32 v71, 0
v_mov_b32 v72, 0
v_mov_b32 v73, 0
v_mov_b32 v74, 0
v_mov_b32 v75, 0
v_mov_b32 v76, 0
v_mov_b32 v77, 0
v_mov_b32 v78, 0
v_mov_b32 v79, 0
v_mov_b32 v80, 0
v_mov_b32 v81, 0
v_mov_b32 v82, 0
v_mov_b32 v83, 0
v_mov_b32 v84, 0
v_mov_b32 v85, 0
v_mov_b32 v86, 0
v_mov_b32 v87, 0
v_mov_b32 v88, 0
v_mov_b32 v89, 0
v_mov_b32 v90, 0
v_mov_b32 v91, 0
v_mov_b32 v92, 0
v_mov_b32 v93, 0
v_mov_b32 v94, 0
v_mov_b32 v95, 0
v_mov_b32 v96, 0
v_mov_b32 v97, 0
v_mov_b32 v98, 0
v_mov_b32 v99, 0
v_mov_b32 v100, 0
v_mov_b32 v101, 0
v_mov_b32 v102, 0
v_mov_b32 v103, 0
v_mov_b32 v104, 0
v_mov_b32 v105, 0
v_mov_b32 v106, 0
v_mov_b32 v107, 0
v_mov_b32 v108, 0
v_mov_b32 v109, 0
v_mov_b32 v110, 0
v_mov_b32 v111, 0
v_mov_b32 v112, 0
v_mov_b32 v113, 0
v_mov_b32 v114, 0
v_mov_b32 v115, 0
v_mov_b32 v116, 0
v_mov_b32 v117, 0
v_mov_b32 v118, 0
v_mov_b32 v119, 0
v_mov_b32 v120, 0
v_mov_b32 v121, 0
v_mov_b32 v122, 0
v_mov_b32 v123, 0
v_mov_b32 v124, 0
v_mov_b32 v125, 0
v_mov_b32 v126, 0
v_mov_b32 v127, 0
v_mov_b32 v128, 0
v_mov_b32 v129, 0
v_mov_b32 v130, 0
v_mov_b32 v131, 0
v_mov_b32 v132, 0
v_mov_b32 v133, 0
v_mov_b32 v134, 0
v_mov_b32 v135, 0
v_mov_b32 v136, 0
v_mov_b32 v137, 0
v_mov_b32 v138, 0
v_mov_b32 v139, 0
v_accvgpr_write_b32 a48, 0
v_accvgpr_write_b32 a49, 0
v_accvgpr_write_b32 a50, 0
v_accvgpr_write_b32 a51, 0
v_accvgpr_write_b32 a52, 0
v_accvgpr_write_b32 a53, 0
v_accvgpr_write_b32 a54, 0
v_accvgpr_write_b32 a55, 0
v_accvgpr_write_b32 a56, 0
v_accvgpr_write_b32 a57, 0
v_accvgpr_write_b32 a58, 0
v_accvgpr_write_b32 a59, 0
s_mov_b32 s59, s98
s_mov_b32 s60, s98
s_lshl_b32 s79, s56, 20
s_lshl_b32 s75, s78, 17
s_or_b32 s75, s75, s79
s_add_u32 m0, s65, 0
s_nop 0
buffer_load_dwordx4 v20, s[8:11], s59 offen nt lds
buffer_load_dwordx4 v21, s[8:11], s59 offen offset:1024 nt lds
buffer_load_dwordx4 v22, s[8:11], s59 offen offset:2048 nt lds
buffer_load_dwordx4 v23, s[8:11], s59 offen offset:3072 nt lds
s_add_u32 s59, s59, 16384
s_and_b32 s59, s59, 0x7ffff
s_add_u32 m0, s65, 16384
s_nop 0
buffer_load_dwordx4 v20, s[8:11], s59 offen nt lds
buffer_load_dwordx4 v21, s[8:11], s59 offen offset:1024 nt lds
buffer_load_dwordx4 v22, s[8:11], s59 offen offset:2048 nt lds
buffer_load_dwordx4 v23, s[8:11], s59 offen offset:3072 nt lds
s_add_u32 s59, s59, 16384
s_and_b32 s59, s59, 0x7ffff
s_add_u32 m0, s65, 32768
s_nop 0
buffer_load_dwordx4 v20, s[8:11], s59 offen nt lds
buffer_load_dwordx4 v21, s[8:11], s59 offen offset:1024 nt lds
buffer_load_dwordx4 v22, s[8:11], s59 offen offset:2048 nt lds
buffer_load_dwordx4 v23, s[8:11], s59 offen offset:3072 nt lds
s_add_u32 s59, s59, 16384
s_and_b32 s59, s59, 0x7ffff
s_add_u32 m0, s65, 49152
s_nop 0
buffer_load_dwordx4 v20, s[8:11], s59 offen nt lds
buffer_load_dwordx4 v21, s[8:11], s59 offen offset:1024 nt lds
buffer_load_dwordx4 v22, s[8:11], s59 offen offset:2048 nt lds
buffer_load_dwordx4 v23, s[8:11], s59 offen offset:3072 nt lds
s_add_u32 s59, s59, 16384
s_and_b32 s59, s59, 0x7ffff
s_add_u32 m0, s65, 65536
s_nop 0
buffer_load_dwordx4 v24, s[12:15], s60 offen nt lds
buffer_load_dwordx4 v25, s[12:15], s60 offen offset:1024 nt lds
buffer_load_dwordx4 v24, s[12:15], s60 offen offset:2048 nt lds
buffer_load_dwordx4 v25, s[12:15], s60 offen offset:3072 nt lds
s_add_u32 s60, s60, 16384
s_and_b32 s60, s60, 0x7ffff
s_waitcnt vmcnt(0)
s_barrier
ds_read_b128 a[64:67], v8 offset:0
ds_read_b128 a[68:71], v9 offset:0
ds_read_b128 a[72:75], v10 offset:0
ds_read_b128 a[76:79], v11 offset:0
s_waitcnt lgkmcnt(0)
s_branch L_start
L_codeend:
.section .rodata,"a"
.p2align 6
.amdhsa_kernel standalone__mha_block_cached__near_ridge_kernel
  .amdhsa_next_free_vgpr 512
  .amdhsa_next_free_sgpr 102
  .amdhsa_accum_offset 256
  .amdhsa_group_segment_fixed_size 0
  .amdhsa_kernarg_size 64
  .amdhsa_user_sgpr_count 2
  .amdhsa_user_sgpr_kernarg_segment_ptr 1
  .amdhsa_system_sgpr_workgroup_id_x 1
.end_amdhsa_kernel
```
